```python
import torch

def _softmax(x, axis=-1):
    return torch.softmax(x, dim=axis)

def _gelu(x):
    return torch.nn.functional.gelu(x, approximate='tanh')

def _silu(x):
    return torch.nn.functional.silu(x)

def _sigmoid(x):
    return torch.sigmoid(x)

def _layernorm(x, axis=-1, eps=1e-05):
    m = x.mean(dim=axis, keepdim=True)
    v = x.var(dim=axis, keepdim=True, unbiased=False)
    return (x - m) / torch.sqrt(v + eps)

def _scatter_add(tgt, idx, src, axis=0):
    return tgt.clone().index_add_(axis, idx, src)

def _segment_sum(src, seg, n):
    out = torch.zeros((n,) + src.shape[1:], dtype=src.dtype)
    return out.index_add_(0, seg, src)

def _pad(x, pw):
    flat = tuple((v for pair in reversed(pw) for v in pair))
    return torch.nn.functional.pad(x, flat)
kernel_name = 'adaLN_cond__gqa_block_cached__dense_activation_relu__prompt'

def setup_inputs():

    _w = lambda a: (lambda t: t.to(torch.bfloat16) if t.is_floating_point() else t)(torch.as_tensor(a))

    def _A_setup():
        B, Sq, D = (1, 2048, 512)
        Hq, Hkv, Sk, Dh = (32, 8, 2048, 128)
        assert Hq % Hkv == 0, (Hq, Hkv)
        return {'x': _w((lambda *s: torch.randn(*s, dtype=torch.bfloat16) * 0.05)(B, Sq, D)), 'k_cache': _w((lambda *s: torch.randn(*s, dtype=torch.bfloat16) * 3.2)(B, Hkv, Sk, Dh)), 'v_cache': _w((lambda *s: torch.randn(*s, dtype=torch.bfloat16) * 0.4)(B, Hkv, Sk, Dh)), 'wq': _w((lambda *s: torch.randn(*s, dtype=torch.bfloat16) * 3.2)(D, Hq * Dh) * D ** (-0.5)), 'wo': _w((lambda *s: torch.randn(*s, dtype=torch.bfloat16) * 0.4)(Hq * Dh, D) * (Hq * Dh) ** (-0.5))}
    _A_in = _A_setup()

    def _B_setup():
        B, S, D, Dff = (1, 2048, 512, 1792)
        return {'x': _w((lambda *s: torch.randn(*s, dtype=torch.bfloat16) * 0.05)(B, S, D)), 'w1': _w((lambda *s: torch.randn(*s, dtype=torch.bfloat16) * 0.05)(D, Dff)), 'w2': _w((lambda *s: torch.randn(*s, dtype=torch.bfloat16) * 0.05)(Dff, D))}
    _B_in = _B_setup()
    return {'A_x': _A_in['x'], 'A_k_cache': _A_in['k_cache'], 'A_v_cache': _A_in['v_cache'], 'A_wq': _A_in['wq'], 'A_wo': _A_in['wo'], 'B_x': _B_in['x'], 'B_w1': _B_in['w1'], 'B_w2': _B_in['w2'], 'c': _w((lambda *s: torch.randn(*s, dtype=torch.bfloat16) * 0.1)(1, 512) * 8.0), 'w_mod': _w((lambda *s: torch.randn(*s, dtype=torch.bfloat16) * 0.1)(512, 6 * 512) * 512 ** (-0.5) * 8.0)}

def reference(A_x, A_k_cache, A_v_cache, A_wq, A_wo, B_x, B_w1, B_w2, c, w_mod):

    def _A_ref(x, k_cache, v_cache, wq, wo):
        B, Sq, D = x.shape
        Hq, Dh = (32, 128)
        Hkv = k_cache.shape[1]
        rep = Hq // Hkv
        q = (lambda x, *d: x.permute(*d))((x @ wq).reshape(B, Sq, Hq, Dh), 0, 2, 1, 3)
        k = (lambda x, n, axis: torch.repeat_interleave(x, n, dim=axis))(k_cache, rep, axis=1)
        v = (lambda x, n, axis: torch.repeat_interleave(x, n, dim=axis))(v_cache, rep, axis=1)
        scores = torch.einsum('bhqd,bhkd->bhqk', q, k) * Dh ** (-0.5)
        p = _softmax(scores, axis=-1)
        o = torch.einsum('bhqk,bhkd->bhqd', p, v)
        return (lambda x, *d: x.permute(*d))(o, 0, 2, 1, 3).reshape(B, Sq, Hq * Dh) @ wo

    def _B_ref(x, w1, w2):
        h = torch.einsum('bsd,df->bsf', x, w1)
        zero = torch.zeros_like(h)
        h = torch.maximum(h, zero)
        return torch.einsum('bsf,fd->bsd', h, w2)
    x = A_x
    mod = (_silu(c) @ w_mod).reshape(c.shape[0], 6, 1, -1)
    sa, ca, ga, sb, cb, gb = (mod[:, 0].clone(), mod[:, 1].clone(), mod[:, 2].clone(), mod[:, 3].clone(), mod[:, 4].clone(), mod[:, 5].clone())
    h = _layernorm(x, axis=-1) * (1 + ca) + sa
    x = x + ga * _A_ref(h, A_k_cache, A_v_cache, A_wq, A_wo)
    h = _layernorm(x, axis=-1) * (1 + cb) + sb
    x = x + gb * _B_ref(h, B_w1, B_w2)
    return x
```

```asm
; @launch grid=(256,1,1) block=(256,1,1) lds=163840
.amdgcn_target "amdgcn-amd-amdhsa--gfx950"
.text
.globl adaLN_cond__gqa_block_cached__dense_activation_relu__prompt_kernel
.p2align 8
.type adaLN_cond__gqa_block_cached__dense_activation_relu__prompt_kernel,@function
adaLN_cond__gqa_block_cached__dense_activation_relu__prompt_kernel:
s_cmp_ge_u32 s2, 256
s_cbranch_scc1 L_k1_end
s_load_dwordx8 s[48:55], s[0:1], 0
s_load_dwordx2 s[56:57], s[0:1], 32
s_load_dwordx2 s[58:59], s[0:1], 96
s_load_dwordx4 s[4:7], s[0:1], 48
v_lshlrev_b32 v6, 4, v0
s_getpc_b64 s[62:63]
L_pc_a:
s_add_u32 s62, s62, L_k1_body-L_pc_a
s_addc_u32 s63, s63, 0
s_lshr_b32 s61, s2, 3
s_lshl_b32 s61, s61, 12
v_add_u32_e64 v4, s61, v6
v_min_u32 v4, L_k1_post-L_k1_body-16, v4
v_mov_b32 v5, s63
v_add_co_u32 v4, vcc, s62, v4
s_nop 1
v_addc_co_u32 v5, vcc, 0, v5, vcc
global_load_dwordx4 a[244:247], v[4:5], off
L_k1_body:
s_load_dwordx8 s[64:71], s[0:1], 64
v_mov_b32 v15, v0
s_and_b32 s84, s2, 7
s_lshr_b32 s85, s2, 3
s_and_b32 s60, s2, 7
s_lshr_b32 s61, s2, 3
s_lshl_b32 s36, s60, 2
s_and_b32 s36, s36, 7
s_and_b32 s62, s61, 3
s_add_u32 s36, s36, s62
s_lshr_b32 s60, s60, 1
s_lshl_b32 s60, s60, 3
s_lshr_b32 s47, s61, 2
s_add_u32 s37, s60, s47
v_lshrrev_b32 v4, 6, v0
v_and_b32 v0, 63, v0
v_readfirstlane_b32 s38, v4
v_and_b32 v1, 15, v0
v_lshrrev_b32 v2, 4, v0
v_and_b32 v4, 1, v2
v_lshlrev_b32 v4, 1, v4
v_lshrrev_b32 v5, 1, v2
v_or_b32 v3, v4, v5
s_lshl_b32 s39, s38, 12
s_and_b32 s42, s47, 7
s_lshl_b32 s42, s42, 1
v_lshlrev_b32 v7, 4, v0
s_lshl_b32 s62, s42, 2
s_lshl_b32 s60, s37, 16
s_lshl_b32 s61, s38, 14
s_add_u32 s60, s60, s61
s_add_u32 s61, s61, 98304
s_waitcnt lgkmcnt(0)
s_mov_b32 s28, s58
s_mov_b32 s29, s59
s_mov_b32 s30, 16777216
s_mov_b32 s31, 0x20000
s_mov_b32 s80, s70
s_mov_b32 s81, s71
s_mov_b32 s82, 256
s_mov_b32 s83, 0x20000
s_sub_u32 s63, s2, 243
s_cmp_ge_u32 s63, 5
s_cbranch_scc1 L_f_noclr
v_lshlrev_b32 v4, 4, v15
s_lshl_b32 s63, s63, 14
s_add_u32 s63, s63, 16384
v_mov_b32 v8, 0
v_mov_b32 v9, 0
v_mov_b32 v10, 0
v_mov_b32_e64 v11, 0
buffer_store_dwordx4 v[8:11], v4, s[28:31], s63 offen sc1
s_add_u32 s63, s63, 4096
buffer_store_dwordx4 v[8:11], v4, s[28:31], s63 offen sc1
s_add_u32 s63, s63, 4096
buffer_store_dwordx4 v[8:11], v4, s[28:31], s63 offen sc1
s_add_u32 s63, s63, 4096
buffer_store_dwordx4 v[8:11], v4, s[28:31], s63 offen sc1
s_add_u32 s63, s63, 4096
v_mov_b32 v6, 1
s_waitcnt vmcnt(0)
s_barrier
s_cmp_lg_u32 s38, 0
s_cbranch_scc1 L_f_noclr
s_mov_b64 exec, 1
buffer_atomic_add v6, v8, s[80:83], 0 offen sc1
s_mov_b64 exec, -1
L_f_noclr:
s_mov_b32 s72, s64
s_mov_b32 s73, s65
s_mov_b32 s74, 1024
s_mov_b32 s75, 0x20000
s_mov_b32 s64, s66
s_mov_b32 s65, s67
s_mov_b32 s66, 3145728
s_mov_b32 s67, 0x20000
s_mul_i32 s86, s85, 57
s_lshr_b32 s86, s86, 9
s_lshl_b32 s87, s84, 2
s_add_u32 s87, s87, s86
s_mul_i32 s86, s86, 9
s_sub_u32 s86, s85, s86
s_lshl_b32 s63, s86, 3
s_add_u32 s87, s87, s63
s_and_b32 s86, s86, 11
s_cselect_b32 s87, 64, s87
s_cmp_ge_u32 s87, 64
s_cbranch_scc1 L_f_noload
v_lshrrev_b32 v208, 2, v15
v_and_b32_e64 v210, 3, v15
s_mov_b32 s86, 24576
v_mul_lo_u32 v209, v208, s86
v_lshl_add_u32 v209, v210, 4, v209
v_lshlrev_b32 v208, 3, v208
s_lshr_b32 s63, s87, 5
s_mul_i32 s86, s63, 1570816
s_lshl_b32 s63, s63, 9
s_lshl_b32 s79, s87, 6
s_add_u32 s86, s86, s79
buffer_load_dwordx2 v[146:147], v208, s[72:75], s63 offen
buffer_load_dwordx4 v[152:155], v209, s[64:67], s86 offen
s_add_u32 s86, s86, 6144
buffer_load_dwordx4 v[156:159], v209, s[64:67], s86 offen
s_add_u32 s86, s86, 6144
buffer_load_dwordx4 v[160:163], v209, s[64:67], s86 offen
s_add_u32 s86, s86, 6144
buffer_load_dwordx4 v[164:167], v209, s[64:67], s86 offen
L_f_noload:
s_mov_b32 s86, 12288
v_mul_lo_u32 v221, v15, s86
v_lshlrev_b32 v222, 2, v15
s_lshl_b32 s79, s84, 5
s_add_u32 s79, s79, s85
s_lshl_b32 s79, s79, 4
s_add_u32 s79, s79, 2048
s_add_u32 s86, s79, 6144
v_xad_u32 v80, v0, 0, s62
v_and_b32 v80, 63, v80
v_lshlrev_b32_e64 v80, 4, v80
v_xad_u32 v81, v0, 1, s62
v_and_b32 v81, 63, v81
v_lshlrev_b32 v81, 4, v81
v_xad_u32 v82, v0, 2, s62
v_and_b32 v82, 63, v82
v_lshlrev_b32 v82, 4, v82
v_xad_u32 v83, v0, 3, s62
v_and_b32 v83, 63, v83
v_lshlrev_b32 v83, 4, v83
v_xad_u32 v84, v0, 4, s62
v_and_b32 v84, 63, v84
v_lshlrev_b32 v84, 4, v84
v_xad_u32 v85, v0, 5, s62
v_and_b32 v85, 63, v85
v_lshlrev_b32 v85, 4, v85
v_xad_u32 v86, v0, 6, s62
v_and_b32 v86, 63, v86
v_lshlrev_b32 v86, 4, v86
v_xad_u32 v87, v0, 7, s62
v_and_b32 v87, 63, v87
v_lshlrev_b32 v87, 4, v87
v_xad_u32 v88, v0, 8, s62
v_and_b32 v88, 63, v88
v_lshlrev_b32 v88, 4, v88
v_xad_u32 v89, v0, 9, s62
v_and_b32 v89, 63, v89
v_lshlrev_b32 v89, 4, v89
v_xad_u32 v90, v0, 10, s62
v_and_b32 v90, 63, v90
v_lshlrev_b32 v90, 4, v90
v_xad_u32 v91, v0, 11, s62
v_and_b32 v91, 63, v91
v_lshlrev_b32 v91, 4, v91
v_xad_u32 v92, v0, 12, s62
v_and_b32 v92, 63, v92
v_lshlrev_b32 v92, 4, v92
v_xad_u32 v93, v0, 13, s62
v_and_b32 v93, 63, v93
v_lshlrev_b32 v93, 4, v93
v_xad_u32 v94, v0, 14, s62
v_and_b32 v94, 63, v94
v_lshlrev_b32 v94, 4, v94
v_xad_u32 v95, v0, 15, s62
v_and_b32 v95, 63, v95
v_lshlrev_b32 v95, 4, v95
s_mov_b32 s8, s48
s_mov_b32 s9, s49
s_mov_b32 s10, 2097152
s_mov_b32 s11, 0x20000
s_mov_b32 s77, s60
s_mov_b32 s78, s61
s_cmp_lt_u32 s87, 64
s_cbranch_scc1 L_f_xlate
s_mov_b32 s76, s77
s_add_u32 m0, s78, 0
s_nop 0
s_nop 0
buffer_load_dwordx4 v80, s[8:11], s76 offen offset:0 lds
buffer_load_dwordx4 v81, s[8:11], s76 offen offset:1024 lds
buffer_load_dwordx4 v82, s[8:11], s76 offen offset:2048 lds
buffer_load_dwordx4 v83, s[8:11], s76 offen offset:3072 lds
s_add_u32 m0, s78, 4096
s_add_u32 s76, s76, 4096
buffer_load_dwordx4 v84, s[8:11], s76 offen offset:0 lds
buffer_load_dwordx4 v85, s[8:11], s76 offen offset:1024 lds
buffer_load_dwordx4 v86, s[8:11], s76 offen offset:2048 lds
buffer_load_dwordx4 v87, s[8:11], s76 offen offset:3072 lds
s_add_u32 m0, s78, 8192
s_add_u32 s76, s76, 4096
buffer_load_dwordx4 v88, s[8:11], s76 offen offset:0 lds
buffer_load_dwordx4 v89, s[8:11], s76 offen offset:1024 lds
buffer_load_dwordx4 v90, s[8:11], s76 offen offset:2048 lds
buffer_load_dwordx4 v91, s[8:11], s76 offen offset:3072 lds
s_add_u32 m0, s78, 12288
s_add_u32 s76, s76, 4096
buffer_load_dwordx4 v92, s[8:11], s76 offen offset:0 lds
buffer_load_dwordx4 v93, s[8:11], s76 offen offset:1024 lds
buffer_load_dwordx4 v94, s[8:11], s76 offen offset:2048 lds
buffer_load_dwordx4 v95, s[8:11], s76 offen offset:3072 lds
L_f_xlate:
s_lshl_b32 s62, s36, 10
s_sub_u32 s63, 4194304, s62
s_add_u32 s12, s54, s62
s_addc_u32 s13, s55, 0
s_mov_b32 s14, s63
s_mov_b32 s15, 0x20000
s_lshl_b32 s61, s38, 8
v_lshrrev_b32 v8, 3, v0
v_lshl_add_u32 v8, v8, 13, s61
v_and_b32 v5, 7, v0
v_and_b32 v4, 1, v2
v_lshlrev_b32 v4, 1, v4
v_xor_b32 v4, v4, v5
v_lshl_add_u32 v9, v4, 4, v8
v_xor_b32_e64 v4, 4, v4
v_lshl_add_u32 v10, v4, 4, v8
v_add_u32_e64 v16, 0, v9
v_add_u32 v17, 64512, v10
v_add_u32 v18, 129024, v9
v_add_u32 v19, 193536, v10
v_add_u32 v20, 262144, v9
v_add_u32 v21, 326656, v10
v_add_u32 v22, 391168, v9
v_add_u32 v23, 455680, v10
s_lshl_b32 s45, s42, 18
s_lshl_b32 s62, s36, 19
s_add_u32 s16, s50, s62
s_addc_u32 s17, s51, 0
s_mov_b32 s18, 524288
s_mov_b32 s19, 0x20000
s_add_u32 s20, s52, s62
s_addc_u32 s21, s53, 0
s_mov_b32 s22, 524288
s_mov_b32 s23, 0x20000
s_add_u32 s24, s56, s62
s_addc_u32 s25, s57, 0
s_mov_b32 s26, 524288
s_mov_b32 s27, 0x20000
s_lshl_b32 s62, s36, 21
s_add_u32 s62, s62, 16777216
s_add_u32 s32, s58, s62
s_addc_u32 s33, s59, 0
s_mov_b32 s34, 2097152
s_mov_b32 s35, 0x20000
s_and_b32 s61, s2, 1
s_mul_i32 s62, s61, 1792
s_sub_u32 s63, 1835008, s62
s_add_u32 s92, s4, s62
s_addc_u32 s93, s5, 0
s_mov_b32 s94, s63
s_mov_b32 s95, 0x20000
s_lshl_b32 s62, s61, 9
s_sub_u32 s63, 1835008, s62
s_add_u32 s96, s6, s62
s_addc_u32 s97, s7, 0
s_mov_b32 s98, s63
s_mov_b32 s99, 0x20000
s_lshr_b32 s4, s2, 3
s_lshl_b32 s4, s4, 2
s_add_u32 s4, s4, s38
s_mul_i32 s7, s4, 14336
s_mul_i32 s4, s4, 14336
v_lshrrev_b32 v251, 5, v0
v_lshlrev_b32 v251, 10, v251
v_and_b32_e64 v4, 31, v0
v_lshl_add_u32 v251, v4, 4, v251
v_lshlrev_b32 v252, 4, v0
s_mov_b32 s40, 0
s_mov_b32 s41, 0
s_add_u32 s43, s39, 65536
s_mov_b32 s46, 0
v_add_u32 v5, 0, v3
v_xor_b32 v5, v5, v1
v_lshlrev_b32_e64 v5, 4, v5
v_lshl_add_u32 v224, v1, 8, v5
v_add_u32 v5, 4, v3
v_xor_b32 v5, v5, v1
v_lshlrev_b32_e64 v5, 4, v5
v_lshl_add_u32 v225, v1, 8, v5
v_add_u32 v5, 8, v3
v_xor_b32 v5, v5, v1
v_lshlrev_b32_e64 v5, 4, v5
v_lshl_add_u32 v226, v1, 8, v5
v_add_u32 v5, 12, v3
v_xor_b32 v5, v5, v1
v_lshlrev_b32_e64 v5, 4, v5
v_lshl_add_u32 v227, v1, 8, v5
v_lshrrev_b32 v11, 2, v1
v_and_b32 v12, 3, v1
v_lshlrev_b32_e64 v12, 3, v12
v_lshl_add_u32 v5, v2, 2, v11
v_and_b32_e64 v13, 7, v5
v_lshl_add_u32 v14, v5, 8, v12
v_add_u32 v14, 65536, v14
v_xor_b32_e64 v4, 0, v13
v_lshl_add_u32 v228, v4, 5, v14
v_xor_b32_e64 v4, 1, v13
v_lshl_add_u32 v229, v4, 5, v14
v_xor_b32_e64 v4, 2, v13
v_lshl_add_u32 v230, v4, 5, v14
v_xor_b32_e64 v4, 3, v13
v_lshl_add_u32 v231, v4, 5, v14
v_xor_b32_e64 v4, 4, v13
v_lshl_add_u32 v232, v4, 5, v14
v_xor_b32_e64 v4, 5, v13
v_lshl_add_u32 v233, v4, 5, v14
v_xor_b32_e64 v4, 6, v13
v_lshl_add_u32 v234, v4, 5, v14
v_xor_b32_e64 v4, 7, v13
v_lshl_add_u32 v235, v4, 5, v14
v_lshl_add_u32 v9, v2, 8, s39
v_add_u32 v5, 0, v2
v_xor_b32 v5, v5, v1
v_lshl_add_u32 v236, v5, 4, v9
v_add_u32 v5, 4, v2
v_xor_b32 v5, v5, v1
v_lshl_add_u32 v237, v5, 4, v9
v_add_u32 v5, 8, v2
v_xor_b32 v5, v5, v1
v_lshl_add_u32 v238, v5, 4, v9
v_add_u32 v5, 12, v2
v_xor_b32 v5, v5, v1
v_lshl_add_u32 v239, v5, 4, v9
v_add_u32 v5, 0, v2
v_lshlrev_b32 v5, 1, v5
v_xor_b32_e64 v5, v5, v1
v_lshl_add_u32 v240, v5, 4, v9
v_add_u32 v5, 4, v2
v_lshlrev_b32 v5, 1, v5
v_xor_b32_e64 v5, v5, v1
v_lshl_add_u32 v241, v5, 4, v9
s_lshl_b32 s61, s38, 8
v_lshrrev_b32 v8, 3, v0
v_lshl_add_u32 v8, v8, 10, s61
v_and_b32 v5, 7, v0
v_lshlrev_b32 v4, 1, v2
v_xor_b32_e64 v4, v4, v5
v_lshl_add_u32 v242, v4, 4, v8
v_add_u32 v243, 7168, v242
v_add_u32 v244, 14336, v242
v_add_u32 v245, 21504, v242
v_add_u32 v246, 32768, v242
v_add_u32 v247, 39936, v242
v_add_u32 v248, 47104, v242
v_add_u32 v249, 54272, v242
v_and_b32 v4, 1, v2
v_lshrrev_b32 v13, 3, v1
v_lshl_add_u32 v13, v4, 1, v13
v_lshl_add_u32 v5, v2, 3, v11
v_lshl_add_u32 v14, v5, 7, v12
v_add_u32 v14, s39, v14
v_xor_b32 v4, 0, v13
v_lshl_add_u32 v24, v4, 5, v14
v_add_u32 v28, 65536, v24
v_xor_b32_e64 v4, 1, v13
v_lshl_add_u32 v25, v4, 5, v14
v_add_u32 v29, 65536, v25
v_xor_b32_e64 v4, 2, v13
v_lshl_add_u32 v26, v4, 5, v14
v_add_u32 v30, 65536, v26
v_xor_b32_e64 v4, 3, v13
v_lshl_add_u32 v27, v4, 5, v14
v_add_u32 v31, 65536, v27
v_add_u32 v40, 98304, v7
s_lshl_b32 s61, s38, 12
v_add_u32 v8, s61, v40
s_lshl_b32 s61, s38, 8
s_mov_b32 s62, 81920
v_lshl_add_u32 v9, v2, 5, s62
s_add_u32 s61, s61, 98304
v_lshl_add_u32 v14, v1, 10, s61
v_add_u32 v4, 0, v2
v_xor_b32_e64 v4, v4, v1
v_lshl_add_u32 v10, v4, 4, v14
v_add_u32 v4, 4, v2
v_xor_b32 v4, v4, v1
v_lshl_add_u32 v11, v4, 4, v14
v_add_u32 v4, 8, v2
v_xor_b32 v4, v4, v1
v_lshl_add_u32 v12, v4, 4, v14
v_add_u32 v4, 12, v2
v_xor_b32 v4, v4, v1
v_lshl_add_u32 v13, v4, 4, v14
v_mul_u32_u24 v14, 0x410, v1
v_add_u32 v14, 98304, v14
s_lshl_b32 s60, s38, 10
v_add_u32 v9, s60, v9
v_lshlrev_b32_e64 v41, 5, v1
v_add_u32 v41, 90112, v41
s_lshl_b32 s60, s38, 9
v_add_u32 v42, s60, v41
v_accvgpr_write_b32 a0, 0
v_accvgpr_write_b32 a1, 0
v_accvgpr_write_b32 a2, 0
v_accvgpr_write_b32 a3, 0
v_accvgpr_write_b32 a4, 0
v_accvgpr_write_b32 a5, 0
v_accvgpr_write_b32 a6, 0
v_accvgpr_write_b32 a7, 0
v_accvgpr_write_b32 a8, 0
v_accvgpr_write_b32 a9, 0
v_accvgpr_write_b32 a10, 0
v_accvgpr_write_b32 a11, 0
v_accvgpr_write_b32 a12, 0
v_accvgpr_write_b32 a13, 0
v_accvgpr_write_b32 a14, 0
v_accvgpr_write_b32 a15, 0
v_accvgpr_write_b32 a16, 0
v_accvgpr_write_b32 a17, 0
v_accvgpr_write_b32 a18, 0
v_accvgpr_write_b32 a19, 0
v_accvgpr_write_b32 a20, 0
v_accvgpr_write_b32 a21, 0
v_accvgpr_write_b32 a22, 0
v_accvgpr_write_b32 a23, 0
v_accvgpr_write_b32 a24, 0
v_accvgpr_write_b32 a25, 0
v_accvgpr_write_b32 a26, 0
v_accvgpr_write_b32 a27, 0
v_accvgpr_write_b32 a28, 0
v_accvgpr_write_b32 a29, 0
v_accvgpr_write_b32 a30, 0
v_accvgpr_write_b32 a31, 0
v_accvgpr_write_b32 a32, 0
v_accvgpr_write_b32 a33, 0
v_accvgpr_write_b32 a34, 0
v_accvgpr_write_b32 a35, 0
v_accvgpr_write_b32 a36, 0
v_accvgpr_write_b32 a37, 0
v_accvgpr_write_b32 a38, 0
v_accvgpr_write_b32 a39, 0
v_accvgpr_write_b32 a40, 0
v_accvgpr_write_b32 a41, 0
v_accvgpr_write_b32 a42, 0
v_accvgpr_write_b32 a43, 0
v_accvgpr_write_b32 a44, 0
v_accvgpr_write_b32 a45, 0
v_accvgpr_write_b32 a46, 0
v_accvgpr_write_b32 a47, 0
v_accvgpr_write_b32 a48, 0
v_accvgpr_write_b32 a49, 0
v_accvgpr_write_b32 a50, 0
v_accvgpr_write_b32 a51, 0
v_accvgpr_write_b32 a52, 0
v_accvgpr_write_b32 a53, 0
v_accvgpr_write_b32 a54, 0
v_accvgpr_write_b32 a55, 0
v_accvgpr_write_b32 a56, 0
v_accvgpr_write_b32 a57, 0
v_accvgpr_write_b32 a58, 0
v_accvgpr_write_b32 a59, 0
v_accvgpr_write_b32 a60, 0
v_accvgpr_write_b32 a61, 0
v_accvgpr_write_b32 a62, 0
v_accvgpr_write_b32 a63, 0
v_accvgpr_write_b32 a64, 0
v_accvgpr_write_b32 a65, 0
v_accvgpr_write_b32 a66, 0
v_accvgpr_write_b32 a67, 0
v_accvgpr_write_b32 a68, 0
v_accvgpr_write_b32 a69, 0
v_accvgpr_write_b32 a70, 0
v_accvgpr_write_b32 a71, 0
v_accvgpr_write_b32 a72, 0
v_accvgpr_write_b32 a73, 0
v_accvgpr_write_b32 a74, 0
v_accvgpr_write_b32 a75, 0
v_accvgpr_write_b32 a76, 0
v_accvgpr_write_b32 a77, 0
v_accvgpr_write_b32 a78, 0
v_accvgpr_write_b32 a79, 0
v_accvgpr_write_b32 a80, 0
v_accvgpr_write_b32 a81, 0
v_accvgpr_write_b32 a82, 0
v_accvgpr_write_b32 a83, 0
v_accvgpr_write_b32 a84, 0
v_accvgpr_write_b32 a85, 0
v_accvgpr_write_b32 a86, 0
v_accvgpr_write_b32 a87, 0
v_accvgpr_write_b32 a88, 0
v_accvgpr_write_b32 a89, 0
v_accvgpr_write_b32 a90, 0
v_accvgpr_write_b32 a91, 0
v_accvgpr_write_b32 a92, 0
v_accvgpr_write_b32 a93, 0
v_accvgpr_write_b32 a94, 0
v_accvgpr_write_b32 a95, 0
v_accvgpr_write_b32 a96, 0
v_accvgpr_write_b32 a97, 0
v_accvgpr_write_b32 a98, 0
v_accvgpr_write_b32 a99, 0
v_accvgpr_write_b32 a100, 0
v_accvgpr_write_b32 a101, 0
v_accvgpr_write_b32 a102, 0
v_accvgpr_write_b32 a103, 0
v_accvgpr_write_b32 a104, 0
v_accvgpr_write_b32 a105, 0
v_accvgpr_write_b32 a106, 0
v_accvgpr_write_b32 a107, 0
v_accvgpr_write_b32 a108, 0
v_accvgpr_write_b32 a109, 0
v_accvgpr_write_b32 a110, 0
v_accvgpr_write_b32 a111, 0
v_accvgpr_write_b32 a112, 0
v_accvgpr_write_b32 a113, 0
v_accvgpr_write_b32 a114, 0
v_accvgpr_write_b32 a115, 0
v_accvgpr_write_b32 a116, 0
v_accvgpr_write_b32 a117, 0
v_accvgpr_write_b32 a118, 0
v_accvgpr_write_b32 a119, 0
v_accvgpr_write_b32 a120, 0
v_accvgpr_write_b32 a121, 0
v_accvgpr_write_b32 a122, 0
v_accvgpr_write_b32 a123, 0
v_accvgpr_write_b32 a124, 0
v_accvgpr_write_b32 a125, 0
v_accvgpr_write_b32 a126, 0
v_accvgpr_write_b32 a127, 0
v_accvgpr_write_b32 a192, 0
v_accvgpr_write_b32 a193, 0
v_accvgpr_write_b32 a194, 0
v_accvgpr_write_b32 a195, 0
v_accvgpr_write_b32 a196, 0
v_accvgpr_write_b32 a197, 0
v_accvgpr_write_b32 a198, 0
v_accvgpr_write_b32 a199, 0
v_accvgpr_write_b32 a200, 0
v_accvgpr_write_b32 a201, 0
v_accvgpr_write_b32 a202, 0
v_accvgpr_write_b32 a203, 0
v_accvgpr_write_b32 a204, 0
v_accvgpr_write_b32 a205, 0
v_accvgpr_write_b32 a206, 0
v_accvgpr_write_b32 a207, 0
v_mov_b32 v5, 0x3f803f80
v_accvgpr_write_b32 a208, v5
v_accvgpr_write_b32 a209, v5
v_accvgpr_write_b32 a210, v5
v_accvgpr_write_b32 a211, v5
s_cmp_ge_u32 s87, 64
s_cbranch_scc1 L_f_nourg
s_and_b32 s61, s87, 15
s_lshl_b32 s61, s61, 8
s_and_b32 s60, s87, 16
s_cselect_b32 s60, 0, 128
s_add_u32 s61, s61, s60
s_lshr_b32 s60, s87, 5
s_lshl_b32 s60, s60, 12
s_add_u32 s61, s61, s60
s_add_u32 s3, s61, 32768
s_waitcnt vmcnt(4)
v_lshlrev_b32_e64 v144, 16, v146
v_and_b32 v145, 0xffff0000, v146
v_lshlrev_b32_e64 v146, 16, v147
v_and_b32 v147, 0xffff0000, v147
v_mul_f32 v184, 0xbfb8aa3b, v144
v_mul_f32 v185, 0xbfb8aa3b, v145
v_mul_f32 v186, 0xbfb8aa3b, v146
v_mul_f32 v187, 0xbfb8aa3b, v147
v_exp_f32 v184, v184
v_exp_f32 v185, v185
v_exp_f32 v186, v186
v_exp_f32 v187, v187
v_add_f32 v184, 1.0, v184
v_add_f32 v185, 1.0, v185
v_add_f32 v186, 1.0, v186
v_add_f32 v187, 1.0, v187
v_rcp_f32 v184, v184
v_rcp_f32 v185, v185
v_rcp_f32 v186, v186
v_rcp_f32 v187, v187
v_mul_f32 v144, v144, v184
v_mul_f32 v145, v145, v185
v_mul_f32 v146, v146, v186
v_mul_f32 v147, v147, v187
v_cvt_pk_bf16_f32 v144, v144, v144
v_cvt_pk_bf16_f32 v145, v145, v145
v_cvt_pk_bf16_f32 v146, v146, v146
v_cvt_pk_bf16_f32 v147, v147, v147
v_lshlrev_b32 v144, 16, v144
v_lshlrev_b32 v145, 16, v145
v_lshlrev_b32 v146, 16, v146
v_lshlrev_b32 v147, 16, v147
s_waitcnt vmcnt(3)
v_mov_b32 v6, 0
buffer_load_dword v220, v6, s[80:83], 0 offen sc1
s_mov_b32 s76, s77
s_add_u32 m0, s78, 0
s_nop 0
buffer_load_dwordx4 v80, s[8:11], s76 offen offset:0 lds
buffer_load_dwordx4 v81, s[8:11], s76 offen offset:1024 lds
buffer_load_dwordx4 v82, s[8:11], s76 offen offset:2048 lds
buffer_load_dwordx4 v83, s[8:11], s76 offen offset:3072 lds
v_lshlrev_b32 v184, 16, v152
v_and_b32 v185, 0xffff0000, v152
v_lshlrev_b32_e64 v186, 16, v153
v_and_b32 v187, 0xffff0000, v153
v_lshlrev_b32_e64 v188, 16, v154
v_and_b32 v189, 0xffff0000, v154
v_lshlrev_b32_e64 v190, 16, v155
v_and_b32 v191, 0xffff0000, v155
v_pk_mul_f32 v[192:193], v[184:185], v[144:145] op_sel_hi:[1,0]
v_pk_mul_f32 v[194:195], v[186:187], v[144:145] op_sel_hi:[1,0]
v_pk_mul_f32 v[196:197], v[188:189], v[144:145] op_sel_hi:[1,0]
v_pk_mul_f32 v[198:199], v[190:191], v[144:145] op_sel_hi:[1,0]
s_waitcnt vmcnt(7)
s_add_u32 m0, s78, 4096
s_add_u32 s76, s76, 4096
buffer_load_dwordx4 v84, s[8:11], s76 offen offset:0 lds
buffer_load_dwordx4 v85, s[8:11], s76 offen offset:1024 lds
buffer_load_dwordx4 v86, s[8:11], s76 offen offset:2048 lds
buffer_load_dwordx4 v87, s[8:11], s76 offen offset:3072 lds
v_lshlrev_b32 v184, 16, v156
v_and_b32 v185, 0xffff0000, v156
v_lshlrev_b32_e64 v186, 16, v157
v_and_b32 v187, 0xffff0000, v157
v_lshlrev_b32_e64 v188, 16, v158
v_and_b32 v189, 0xffff0000, v158
v_lshlrev_b32_e64 v190, 16, v159
v_and_b32 v191, 0xffff0000, v159
v_pk_fma_f32 v[192:193], v[184:185], v[144:145], v[192:193] op_sel:[0,1,0] op_sel_hi:[1,1,1]
v_pk_fma_f32 v[194:195], v[186:187], v[144:145], v[194:195] op_sel:[0,1,0] op_sel_hi:[1,1,1]
v_pk_fma_f32 v[196:197], v[188:189], v[144:145], v[196:197] op_sel:[0,1,0] op_sel_hi:[1,1,1]
v_pk_fma_f32 v[198:199], v[190:191], v[144:145], v[198:199] op_sel:[0,1,0] op_sel_hi:[1,1,1]
s_waitcnt vmcnt(10)
s_add_u32 m0, s78, 8192
s_add_u32 s76, s76, 4096
buffer_load_dwordx4 v88, s[8:11], s76 offen offset:0 lds
buffer_load_dwordx4 v89, s[8:11], s76 offen offset:1024 lds
buffer_load_dwordx4 v90, s[8:11], s76 offen offset:2048 lds
buffer_load_dwordx4 v91, s[8:11], s76 offen offset:3072 lds
v_lshlrev_b32 v184, 16, v160
v_and_b32 v185, 0xffff0000, v160
v_lshlrev_b32_e64 v186, 16, v161
v_and_b32 v187, 0xffff0000, v161
v_lshlrev_b32_e64 v188, 16, v162
v_and_b32 v189, 0xffff0000, v162
v_lshlrev_b32_e64 v190, 16, v163
v_and_b32 v191, 0xffff0000, v163
v_pk_fma_f32 v[192:193], v[184:185], v[146:147], v[192:193] op_sel_hi:[1,0,1]
v_pk_fma_f32 v[194:195], v[186:187], v[146:147], v[194:195] op_sel_hi:[1,0,1]
v_pk_fma_f32 v[196:197], v[188:189], v[146:147], v[196:197] op_sel_hi:[1,0,1]
v_pk_fma_f32 v[198:199], v[190:191], v[146:147], v[198:199] op_sel_hi:[1,0,1]
s_waitcnt vmcnt(13)
s_add_u32 m0, s78, 12288
s_add_u32 s76, s76, 4096
buffer_load_dwordx4 v92, s[8:11], s76 offen offset:0 lds
buffer_load_dwordx4 v93, s[8:11], s76 offen offset:1024 lds
buffer_load_dwordx4 v94, s[8:11], s76 offen offset:2048 lds
buffer_load_dwordx4 v95, s[8:11], s76 offen offset:3072 lds
v_lshlrev_b32 v184, 16, v164
v_and_b32 v185, 0xffff0000, v164
v_lshlrev_b32_e64 v186, 16, v165
v_and_b32 v187, 0xffff0000, v165
v_lshlrev_b32_e64 v188, 16, v166
v_and_b32 v189, 0xffff0000, v166
v_lshlrev_b32_e64 v190, 16, v167
v_and_b32 v191, 0xffff0000, v167
v_pk_fma_f32 v[192:193], v[184:185], v[146:147], v[192:193] op_sel:[0,1,0] op_sel_hi:[1,1,1]
v_pk_fma_f32 v[194:195], v[186:187], v[146:147], v[194:195] op_sel:[0,1,0] op_sel_hi:[1,1,1]
v_pk_fma_f32 v[196:197], v[188:189], v[146:147], v[196:197] op_sel:[0,1,0] op_sel_hi:[1,1,1]
v_pk_fma_f32 v[198:199], v[190:191], v[146:147], v[198:199] op_sel:[0,1,0] op_sel_hi:[1,1,1]
s_lshl_b32 s60, s38, 7
s_add_u32 s60, s60, 86016
v_and_b32 v5, 3, v0
v_lshl_add_u32 v5, v5, 5, s60
v_lshl_add_u32 v5, v3, 2, v5
v_permlane32_swap_b32 v192, v193
v_permlane32_swap_b32 v194, v195
v_permlane32_swap_b32 v196, v197
v_permlane32_swap_b32 v198, v199
v_add_f32 v192, v192, v193
v_add_f32 v194, v194, v195
v_add_f32 v196, v196, v197
v_add_f32 v198, v198, v199
s_nop 0
v_permlane16_swap_b32 v192, v194
v_permlane16_swap_b32 v196, v198
v_add_f32 v192, v192, v194
v_add_f32 v196, v196, v198
s_nop 0
v_add_f32_dpp v192, v192, v192 row_ror:4 row_mask:0xf bank_mask:0xf
v_add_f32_dpp v196, v196, v196 row_ror:4 row_mask:0xf bank_mask:0xf
s_nop 0
v_add_f32_dpp v192, v192, v192 row_ror:8 row_mask:0xf bank_mask:0xf
v_add_f32_dpp v196, v196, v196 row_ror:8 row_mask:0xf bank_mask:0xf
ds_write_b32 v5, v192
ds_write_b32 v5, v196 offset:16
s_waitcnt lgkmcnt(0)
s_barrier
s_cmp_lg_u32 s38, 0
s_cbranch_scc1 L_f_urg123
v_and_b32 v5, 7, v0
v_lshlrev_b32_e64 v5, 4, v5
v_add_u32 v6, 86016, v5
ds_read_b128 v[144:147], v6 offset:0
ds_read_b128 v[148:151], v6 offset:128
ds_read_b128 v[152:155], v6 offset:256
ds_read_b128 v[156:159], v6 offset:384
v_lshrrev_b32_e64 v4, 3, v0
v_lshl_add_u32 v5, v4, 13, v5
s_waitcnt lgkmcnt(0)
v_pk_add_f32 v[144:145], v[144:145], v[148:149]
v_pk_add_f32 v[152:153], v[152:153], v[156:157]
v_pk_add_f32 v[146:147], v[146:147], v[150:151]
v_pk_add_f32 v[154:155], v[154:155], v[158:159]
v_pk_add_f32 v[144:145], v[144:145], v[152:153]
v_pk_add_f32 v[146:147], v[146:147], v[154:155]
v_or_b32 v216, 1, v144
v_or_b32 v217, 1, v145
v_or_b32 v218, 1, v146
v_or_b32 v219, 1, v147
s_waitcnt vmcnt(16)
s_mov_b32 s60, 400000
L_f_clr1:
v_readfirstlane_b32 s61, v220
s_sub_u32 s60, s60, 1
s_cbranch_scc1 L_f_clr1_done
s_cmp_ge_u32 s61, 5
s_cbranch_scc1 L_f_clr1_done
v_mov_b32 v6, 0
buffer_load_dword v220, v6, s[80:83], 0 offen sc1
s_waitcnt vmcnt(0)
s_branch L_f_clr1
L_f_clr1_done:
buffer_store_dwordx4 v[216:219], v5, s[28:31], s3 offen sc1
L_f_urg123:
L_f_nourg:
s_lshl_b32 s60, s38, 8
s_add_u32 s60, s60, s87
s_cmp_lt_u32 s60, 64
s_cbranch_scc1 L_f_xw1
s_waitcnt vmcnt(0)
L_f_xw1:
s_waitcnt vmcnt(1)
v_mov_b32_e64 v6, 0
buffer_load_dword v220, v6, s[80:83], 0 offen sc1
s_barrier
s_nop 0
ds_read_u16 v64, v14 offset:0
ds_read_u16 v65, v14 offset:16384
ds_read_u16 v66, v14 offset:32768
ds_read_u16 v67, v14 offset:49152
ds_read_b128 v[84:87], v10 offset:0
ds_read_b128 v[92:95], v10 offset:16384
ds_read_b128 v[100:103], v10 offset:32768
ds_read_b128 v[108:111], v10 offset:49152
ds_read_b128 v[116:119], v11 offset:0
ds_read_b128 v[124:127], v11 offset:16384
ds_read_b128 v[132:135], v11 offset:32768
ds_read_b128 v[140:143], v11 offset:49152
ds_read_b128 v[148:151], v12 offset:0
ds_read_b128 v[156:159], v12 offset:16384
ds_read_b128 v[164:167], v12 offset:32768
ds_read_b128 v[172:175], v12 offset:49152
ds_read_b128 v[180:183], v13 offset:0
ds_read_b128 v[188:191], v13 offset:16384
ds_read_b128 v[196:199], v13 offset:32768
ds_read_b128 v[204:207], v13 offset:49152
s_add_u32 m0, s39, 32768
s_waitcnt lgkmcnt(15)
buffer_load_dwordx4 v16, s[12:15], s45 offen offset:0 lds
v_lshlrev_b32 v64, 16, v64
v_lshlrev_b32 v65, 16, v65
v_lshlrev_b32 v66, 16, v66
v_lshlrev_b32 v67, 16, v67
s_waitcnt lgkmcnt(14)
v_lshlrev_b32_e64 v80, 16, v84
v_and_b32 v81, 0xffff0000, v84
v_lshlrev_b32_e64 v82, 16, v85
v_and_b32 v83, 0xffff0000, v85
v_lshlrev_b32_e64 v84, 16, v86
v_and_b32 v85, 0xffff0000, v86
v_lshlrev_b32_e64 v86, 16, v87
v_and_b32 v87, 0xffff0000, v87
v_pk_add_f32 v[80:81], v[80:81], v[64:65] op_sel:[0,0] op_sel_hi:[1,0] neg_lo:[0,1] neg_hi:[0,1]
v_pk_add_f32 v[82:83], v[82:83], v[64:65] op_sel:[0,0] op_sel_hi:[1,0] neg_lo:[0,1] neg_hi:[0,1]
v_pk_add_f32 v[84:85], v[84:85], v[64:65] op_sel:[0,0] op_sel_hi:[1,0] neg_lo:[0,1] neg_hi:[0,1]
v_pk_add_f32 v[86:87], v[86:87], v[64:65] op_sel:[0,0] op_sel_hi:[1,0] neg_lo:[0,1] neg_hi:[0,1]
v_pk_mul_f32 v[32:33], v[80:81], v[80:81]
v_pk_add_f32 v[68:69], v[82:83], v[80:81]
v_pk_fma_f32 v[32:33], v[82:83], v[82:83], v[32:33]
v_pk_add_f32 v[68:69], v[84:85], v[68:69]
v_pk_fma_f32 v[32:33], v[84:85], v[84:85], v[32:33]
v_pk_add_f32 v[68:69], v[86:87], v[68:69]
v_pk_fma_f32 v[32:33], v[86:87], v[86:87], v[32:33]
v_lshlrev_b32_e64 v88, 16, v92
v_and_b32 v89, 0xffff0000, v92
v_lshlrev_b32_e64 v90, 16, v93
v_and_b32 v91, 0xffff0000, v93
v_lshlrev_b32_e64 v92, 16, v94
v_and_b32 v93, 0xffff0000, v94
v_lshlrev_b32_e64 v94, 16, v95
v_and_b32 v95, 0xffff0000, v95
v_pk_add_f32 v[88:89], v[88:89], v[64:65] op_sel:[0,1] op_sel_hi:[1,1] neg_lo:[0,1] neg_hi:[0,1]
v_pk_add_f32 v[90:91], v[90:91], v[64:65] op_sel:[0,1] op_sel_hi:[1,1] neg_lo:[0,1] neg_hi:[0,1]
v_pk_add_f32 v[92:93], v[92:93], v[64:65] op_sel:[0,1] op_sel_hi:[1,1] neg_lo:[0,1] neg_hi:[0,1]
v_pk_add_f32 v[94:95], v[94:95], v[64:65] op_sel:[0,1] op_sel_hi:[1,1] neg_lo:[0,1] neg_hi:[0,1]
v_pk_mul_f32 v[34:35], v[88:89], v[88:89]
v_pk_add_f32 v[70:71], v[90:91], v[88:89]
v_pk_fma_f32 v[34:35], v[90:91], v[90:91], v[34:35]
v_pk_add_f32 v[70:71], v[92:93], v[70:71]
buffer_load_dwordx4 v17, s[12:15], s45 offen offset:1024 lds
v_pk_fma_f32 v[34:35], v[92:93], v[92:93], v[34:35]
v_pk_add_f32 v[70:71], v[94:95], v[70:71]
v_pk_fma_f32 v[34:35], v[94:95], v[94:95], v[34:35]
s_waitcnt lgkmcnt(12)
v_lshlrev_b32 v96, 16, v100
v_and_b32 v97, 0xffff0000, v100
v_lshlrev_b32_e64 v98, 16, v101
v_and_b32 v99, 0xffff0000, v101
v_lshlrev_b32_e64 v100, 16, v102
v_and_b32 v101, 0xffff0000, v102
v_lshlrev_b32_e64 v102, 16, v103
v_and_b32 v103, 0xffff0000, v103
v_pk_add_f32 v[96:97], v[96:97], v[66:67] op_sel:[0,0] op_sel_hi:[1,0] neg_lo:[0,1] neg_hi:[0,1]
v_pk_add_f32 v[98:99], v[98:99], v[66:67] op_sel:[0,0] op_sel_hi:[1,0] neg_lo:[0,1] neg_hi:[0,1]
v_pk_add_f32 v[100:101], v[100:101], v[66:67] op_sel:[0,0] op_sel_hi:[1,0] neg_lo:[0,1] neg_hi:[0,1]
v_pk_add_f32 v[102:103], v[102:103], v[66:67] op_sel:[0,0] op_sel_hi:[1,0] neg_lo:[0,1] neg_hi:[0,1]
v_pk_mul_f32 v[36:37], v[96:97], v[96:97]
v_pk_add_f32 v[72:73], v[98:99], v[96:97]
v_pk_fma_f32 v[36:37], v[98:99], v[98:99], v[36:37]
v_pk_add_f32 v[72:73], v[100:101], v[72:73]
v_pk_fma_f32 v[36:37], v[100:101], v[100:101], v[36:37]
v_pk_add_f32 v[72:73], v[102:103], v[72:73]
v_pk_fma_f32 v[36:37], v[102:103], v[102:103], v[36:37]
v_lshlrev_b32_e64 v104, 16, v108
v_and_b32 v105, 0xffff0000, v108
v_lshlrev_b32_e64 v106, 16, v109
v_and_b32 v107, 0xffff0000, v109
v_lshlrev_b32_e64 v108, 16, v110
v_and_b32 v109, 0xffff0000, v110
v_lshlrev_b32_e64 v110, 16, v111
v_and_b32 v111, 0xffff0000, v111
v_pk_add_f32 v[104:105], v[104:105], v[66:67] op_sel:[0,1] op_sel_hi:[1,1] neg_lo:[0,1] neg_hi:[0,1]
v_pk_add_f32 v[106:107], v[106:107], v[66:67] op_sel:[0,1] op_sel_hi:[1,1] neg_lo:[0,1] neg_hi:[0,1]
v_pk_add_f32 v[108:109], v[108:109], v[66:67] op_sel:[0,1] op_sel_hi:[1,1] neg_lo:[0,1] neg_hi:[0,1]
v_pk_add_f32 v[110:111], v[110:111], v[66:67] op_sel:[0,1] op_sel_hi:[1,1] neg_lo:[0,1] neg_hi:[0,1]
v_pk_mul_f32 v[38:39], v[104:105], v[104:105]
v_pk_add_f32 v[74:75], v[106:107], v[104:105]
v_pk_fma_f32 v[38:39], v[106:107], v[106:107], v[38:39]
v_pk_add_f32 v[74:75], v[108:109], v[74:75]
v_pk_fma_f32 v[38:39], v[108:109], v[108:109], v[38:39]
buffer_load_dwordx4 v18, s[12:15], s45 offen offset:2048 lds
v_pk_add_f32 v[74:75], v[110:111], v[74:75]
v_pk_fma_f32 v[38:39], v[110:111], v[110:111], v[38:39]
s_waitcnt lgkmcnt(10)
v_lshlrev_b32 v112, 16, v116
v_and_b32 v113, 0xffff0000, v116
v_lshlrev_b32_e64 v114, 16, v117
v_and_b32 v115, 0xffff0000, v117
v_lshlrev_b32_e64 v116, 16, v118
v_and_b32 v117, 0xffff0000, v118
v_lshlrev_b32_e64 v118, 16, v119
v_and_b32 v119, 0xffff0000, v119
v_pk_add_f32 v[112:113], v[112:113], v[64:65] op_sel:[0,0] op_sel_hi:[1,0] neg_lo:[0,1] neg_hi:[0,1]
v_pk_add_f32 v[114:115], v[114:115], v[64:65] op_sel:[0,0] op_sel_hi:[1,0] neg_lo:[0,1] neg_hi:[0,1]
v_pk_add_f32 v[116:117], v[116:117], v[64:65] op_sel:[0,0] op_sel_hi:[1,0] neg_lo:[0,1] neg_hi:[0,1]
v_pk_add_f32 v[118:119], v[118:119], v[64:65] op_sel:[0,0] op_sel_hi:[1,0] neg_lo:[0,1] neg_hi:[0,1]
v_pk_add_f32 v[68:69], v[112:113], v[68:69]
v_pk_fma_f32 v[32:33], v[112:113], v[112:113], v[32:33]
v_pk_add_f32 v[68:69], v[114:115], v[68:69]
v_pk_fma_f32 v[32:33], v[114:115], v[114:115], v[32:33]
v_pk_add_f32 v[68:69], v[116:117], v[68:69]
v_pk_fma_f32 v[32:33], v[116:117], v[116:117], v[32:33]
v_pk_add_f32 v[68:69], v[118:119], v[68:69]
v_pk_fma_f32 v[32:33], v[118:119], v[118:119], v[32:33]
v_lshlrev_b32_e64 v120, 16, v124
v_and_b32 v121, 0xffff0000, v124
v_lshlrev_b32_e64 v122, 16, v125
v_and_b32 v123, 0xffff0000, v125
v_lshlrev_b32_e64 v124, 16, v126
v_and_b32 v125, 0xffff0000, v126
v_lshlrev_b32_e64 v126, 16, v127
v_and_b32 v127, 0xffff0000, v127
v_pk_add_f32 v[120:121], v[120:121], v[64:65] op_sel:[0,1] op_sel_hi:[1,1] neg_lo:[0,1] neg_hi:[0,1]
v_pk_add_f32 v[122:123], v[122:123], v[64:65] op_sel:[0,1] op_sel_hi:[1,1] neg_lo:[0,1] neg_hi:[0,1]
v_pk_add_f32 v[124:125], v[124:125], v[64:65] op_sel:[0,1] op_sel_hi:[1,1] neg_lo:[0,1] neg_hi:[0,1]
v_pk_add_f32 v[126:127], v[126:127], v[64:65] op_sel:[0,1] op_sel_hi:[1,1] neg_lo:[0,1] neg_hi:[0,1]
v_pk_add_f32 v[70:71], v[120:121], v[70:71]
v_pk_fma_f32 v[34:35], v[120:121], v[120:121], v[34:35]
v_pk_add_f32 v[70:71], v[122:123], v[70:71]
v_pk_fma_f32 v[34:35], v[122:123], v[122:123], v[34:35]
v_pk_add_f32 v[70:71], v[124:125], v[70:71]
buffer_load_dwordx4 v19, s[12:15], s45 offen offset:3072 lds
v_pk_fma_f32 v[34:35], v[124:125], v[124:125], v[34:35]
v_pk_add_f32 v[70:71], v[126:127], v[70:71]
v_pk_fma_f32 v[34:35], v[126:127], v[126:127], v[34:35]
s_waitcnt lgkmcnt(8)
v_lshlrev_b32 v128, 16, v132
v_and_b32 v129, 0xffff0000, v132
v_lshlrev_b32_e64 v130, 16, v133
v_and_b32 v131, 0xffff0000, v133
v_lshlrev_b32_e64 v132, 16, v134
v_and_b32 v133, 0xffff0000, v134
v_lshlrev_b32_e64 v134, 16, v135
v_and_b32 v135, 0xffff0000, v135
v_pk_add_f32 v[128:129], v[128:129], v[66:67] op_sel:[0,0] op_sel_hi:[1,0] neg_lo:[0,1] neg_hi:[0,1]
v_pk_add_f32 v[130:131], v[130:131], v[66:67] op_sel:[0,0] op_sel_hi:[1,0] neg_lo:[0,1] neg_hi:[0,1]
v_pk_add_f32 v[132:133], v[132:133], v[66:67] op_sel:[0,0] op_sel_hi:[1,0] neg_lo:[0,1] neg_hi:[0,1]
v_pk_add_f32 v[134:135], v[134:135], v[66:67] op_sel:[0,0] op_sel_hi:[1,0] neg_lo:[0,1] neg_hi:[0,1]
v_pk_add_f32 v[72:73], v[128:129], v[72:73]
v_pk_fma_f32 v[36:37], v[128:129], v[128:129], v[36:37]
v_pk_add_f32 v[72:73], v[130:131], v[72:73]
v_pk_fma_f32 v[36:37], v[130:131], v[130:131], v[36:37]
v_pk_add_f32 v[72:73], v[132:133], v[72:73]
v_pk_fma_f32 v[36:37], v[132:133], v[132:133], v[36:37]
v_pk_add_f32 v[72:73], v[134:135], v[72:73]
v_pk_fma_f32 v[36:37], v[134:135], v[134:135], v[36:37]
v_lshlrev_b32_e64 v136, 16, v140
v_and_b32 v137, 0xffff0000, v140
v_lshlrev_b32_e64 v138, 16, v141
v_and_b32 v139, 0xffff0000, v141
v_lshlrev_b32_e64 v140, 16, v142
v_and_b32 v141, 0xffff0000, v142
v_lshlrev_b32_e64 v142, 16, v143
v_and_b32 v143, 0xffff0000, v143
v_pk_add_f32 v[136:137], v[136:137], v[66:67] op_sel:[0,1] op_sel_hi:[1,1] neg_lo:[0,1] neg_hi:[0,1]
v_pk_add_f32 v[138:139], v[138:139], v[66:67] op_sel:[0,1] op_sel_hi:[1,1] neg_lo:[0,1] neg_hi:[0,1]
v_pk_add_f32 v[140:141], v[140:141], v[66:67] op_sel:[0,1] op_sel_hi:[1,1] neg_lo:[0,1] neg_hi:[0,1]
v_pk_add_f32 v[142:143], v[142:143], v[66:67] op_sel:[0,1] op_sel_hi:[1,1] neg_lo:[0,1] neg_hi:[0,1]
v_pk_add_f32 v[74:75], v[136:137], v[74:75]
v_pk_fma_f32 v[38:39], v[136:137], v[136:137], v[38:39]
v_pk_add_f32 v[74:75], v[138:139], v[74:75]
v_pk_fma_f32 v[38:39], v[138:139], v[138:139], v[38:39]
s_add_u32 m0, s39, 49152
v_pk_add_f32 v[74:75], v[140:141], v[74:75]
buffer_load_dwordx4 v20, s[12:15], s45 offen offset:0 lds
v_pk_fma_f32 v[38:39], v[140:141], v[140:141], v[38:39]
v_pk_add_f32 v[74:75], v[142:143], v[74:75]
v_pk_fma_f32 v[38:39], v[142:143], v[142:143], v[38:39]
s_waitcnt lgkmcnt(6)
v_lshlrev_b32 v144, 16, v148
v_and_b32 v145, 0xffff0000, v148
v_lshlrev_b32_e64 v146, 16, v149
v_and_b32 v147, 0xffff0000, v149
v_lshlrev_b32_e64 v148, 16, v150
v_and_b32 v149, 0xffff0000, v150
v_lshlrev_b32_e64 v150, 16, v151
v_and_b32 v151, 0xffff0000, v151
v_pk_add_f32 v[144:145], v[144:145], v[64:65] op_sel:[0,0] op_sel_hi:[1,0] neg_lo:[0,1] neg_hi:[0,1]
v_pk_add_f32 v[146:147], v[146:147], v[64:65] op_sel:[0,0] op_sel_hi:[1,0] neg_lo:[0,1] neg_hi:[0,1]
v_pk_add_f32 v[148:149], v[148:149], v[64:65] op_sel:[0,0] op_sel_hi:[1,0] neg_lo:[0,1] neg_hi:[0,1]
v_pk_add_f32 v[150:151], v[150:151], v[64:65] op_sel:[0,0] op_sel_hi:[1,0] neg_lo:[0,1] neg_hi:[0,1]
v_pk_add_f32 v[68:69], v[144:145], v[68:69]
v_pk_fma_f32 v[32:33], v[144:145], v[144:145], v[32:33]
v_pk_add_f32 v[68:69], v[146:147], v[68:69]
v_pk_fma_f32 v[32:33], v[146:147], v[146:147], v[32:33]
v_pk_add_f32 v[68:69], v[148:149], v[68:69]
v_pk_fma_f32 v[32:33], v[148:149], v[148:149], v[32:33]
v_pk_add_f32 v[68:69], v[150:151], v[68:69]
v_pk_fma_f32 v[32:33], v[150:151], v[150:151], v[32:33]
v_lshlrev_b32_e64 v152, 16, v156
v_and_b32 v153, 0xffff0000, v156
v_lshlrev_b32_e64 v154, 16, v157
v_and_b32 v155, 0xffff0000, v157
v_lshlrev_b32_e64 v156, 16, v158
v_and_b32 v157, 0xffff0000, v158
v_lshlrev_b32_e64 v158, 16, v159
v_and_b32 v159, 0xffff0000, v159
v_pk_add_f32 v[152:153], v[152:153], v[64:65] op_sel:[0,1] op_sel_hi:[1,1] neg_lo:[0,1] neg_hi:[0,1]
v_pk_add_f32 v[154:155], v[154:155], v[64:65] op_sel:[0,1] op_sel_hi:[1,1] neg_lo:[0,1] neg_hi:[0,1]
v_pk_add_f32 v[156:157], v[156:157], v[64:65] op_sel:[0,1] op_sel_hi:[1,1] neg_lo:[0,1] neg_hi:[0,1]
v_pk_add_f32 v[158:159], v[158:159], v[64:65] op_sel:[0,1] op_sel_hi:[1,1] neg_lo:[0,1] neg_hi:[0,1]
v_pk_add_f32 v[70:71], v[152:153], v[70:71]
v_pk_fma_f32 v[34:35], v[152:153], v[152:153], v[34:35]
v_pk_add_f32 v[70:71], v[154:155], v[70:71]
v_pk_fma_f32 v[34:35], v[154:155], v[154:155], v[34:35]
buffer_load_dwordx4 v21, s[12:15], s45 offen offset:1024 lds
v_pk_add_f32 v[70:71], v[156:157], v[70:71]
v_pk_fma_f32 v[34:35], v[156:157], v[156:157], v[34:35]
v_pk_add_f32 v[70:71], v[158:159], v[70:71]
v_pk_fma_f32 v[34:35], v[158:159], v[158:159], v[34:35]
s_waitcnt lgkmcnt(4)
v_lshlrev_b32 v160, 16, v164
v_and_b32 v161, 0xffff0000, v164
v_lshlrev_b32_e64 v162, 16, v165
v_and_b32 v163, 0xffff0000, v165
v_lshlrev_b32_e64 v164, 16, v166
v_and_b32 v165, 0xffff0000, v166
v_lshlrev_b32_e64 v166, 16, v167
v_and_b32 v167, 0xffff0000, v167
v_pk_add_f32 v[160:161], v[160:161], v[66:67] op_sel:[0,0] op_sel_hi:[1,0] neg_lo:[0,1] neg_hi:[0,1]
v_pk_add_f32 v[162:163], v[162:163], v[66:67] op_sel:[0,0] op_sel_hi:[1,0] neg_lo:[0,1] neg_hi:[0,1]
v_pk_add_f32 v[164:165], v[164:165], v[66:67] op_sel:[0,0] op_sel_hi:[1,0] neg_lo:[0,1] neg_hi:[0,1]
v_pk_add_f32 v[166:167], v[166:167], v[66:67] op_sel:[0,0] op_sel_hi:[1,0] neg_lo:[0,1] neg_hi:[0,1]
v_pk_add_f32 v[72:73], v[160:161], v[72:73]
v_pk_fma_f32 v[36:37], v[160:161], v[160:161], v[36:37]
v_pk_add_f32 v[72:73], v[162:163], v[72:73]
v_pk_fma_f32 v[36:37], v[162:163], v[162:163], v[36:37]
v_pk_add_f32 v[72:73], v[164:165], v[72:73]
v_pk_fma_f32 v[36:37], v[164:165], v[164:165], v[36:37]
v_pk_add_f32 v[72:73], v[166:167], v[72:73]
v_pk_fma_f32 v[36:37], v[166:167], v[166:167], v[36:37]
v_lshlrev_b32_e64 v168, 16, v172
v_and_b32 v169, 0xffff0000, v172
v_lshlrev_b32_e64 v170, 16, v173
v_and_b32 v171, 0xffff0000, v173
v_lshlrev_b32_e64 v172, 16, v174
v_and_b32 v173, 0xffff0000, v174
v_lshlrev_b32_e64 v174, 16, v175
v_and_b32 v175, 0xffff0000, v175
v_pk_add_f32 v[168:169], v[168:169], v[66:67] op_sel:[0,1] op_sel_hi:[1,1] neg_lo:[0,1] neg_hi:[0,1]
v_pk_add_f32 v[170:171], v[170:171], v[66:67] op_sel:[0,1] op_sel_hi:[1,1] neg_lo:[0,1] neg_hi:[0,1]
v_pk_add_f32 v[172:173], v[172:173], v[66:67] op_sel:[0,1] op_sel_hi:[1,1] neg_lo:[0,1] neg_hi:[0,1]
v_pk_add_f32 v[174:175], v[174:175], v[66:67] op_sel:[0,1] op_sel_hi:[1,1] neg_lo:[0,1] neg_hi:[0,1]
v_pk_add_f32 v[74:75], v[168:169], v[74:75]
v_pk_fma_f32 v[38:39], v[168:169], v[168:169], v[38:39]
v_pk_add_f32 v[74:75], v[170:171], v[74:75]
buffer_load_dwordx4 v22, s[12:15], s45 offen offset:2048 lds
v_pk_fma_f32 v[38:39], v[170:171], v[170:171], v[38:39]
v_pk_add_f32 v[74:75], v[172:173], v[74:75]
v_pk_fma_f32 v[38:39], v[172:173], v[172:173], v[38:39]
v_pk_add_f32 v[74:75], v[174:175], v[74:75]
v_pk_fma_f32 v[38:39], v[174:175], v[174:175], v[38:39]
s_waitcnt lgkmcnt(2)
v_lshlrev_b32 v176, 16, v180
v_and_b32 v177, 0xffff0000, v180
v_lshlrev_b32_e64 v178, 16, v181
v_and_b32 v179, 0xffff0000, v181
v_lshlrev_b32_e64 v180, 16, v182
v_and_b32 v181, 0xffff0000, v182
v_lshlrev_b32_e64 v182, 16, v183
v_and_b32 v183, 0xffff0000, v183
v_pk_add_f32 v[176:177], v[176:177], v[64:65] op_sel:[0,0] op_sel_hi:[1,0] neg_lo:[0,1] neg_hi:[0,1]
v_pk_add_f32 v[178:179], v[178:179], v[64:65] op_sel:[0,0] op_sel_hi:[1,0] neg_lo:[0,1] neg_hi:[0,1]
v_pk_add_f32 v[180:181], v[180:181], v[64:65] op_sel:[0,0] op_sel_hi:[1,0] neg_lo:[0,1] neg_hi:[0,1]
v_pk_add_f32 v[182:183], v[182:183], v[64:65] op_sel:[0,0] op_sel_hi:[1,0] neg_lo:[0,1] neg_hi:[0,1]
v_pk_add_f32 v[68:69], v[176:177], v[68:69]
v_pk_fma_f32 v[32:33], v[176:177], v[176:177], v[32:33]
v_pk_add_f32 v[68:69], v[178:179], v[68:69]
v_pk_fma_f32 v[32:33], v[178:179], v[178:179], v[32:33]
v_pk_add_f32 v[68:69], v[180:181], v[68:69]
v_pk_fma_f32 v[32:33], v[180:181], v[180:181], v[32:33]
v_pk_add_f32 v[68:69], v[182:183], v[68:69]
v_pk_fma_f32 v[32:33], v[182:183], v[182:183], v[32:33]
v_lshlrev_b32_e64 v184, 16, v188
v_and_b32 v185, 0xffff0000, v188
v_lshlrev_b32_e64 v186, 16, v189
v_and_b32 v187, 0xffff0000, v189
v_lshlrev_b32_e64 v188, 16, v190
v_and_b32 v189, 0xffff0000, v190
v_lshlrev_b32_e64 v190, 16, v191
v_and_b32 v191, 0xffff0000, v191
v_pk_add_f32 v[184:185], v[184:185], v[64:65] op_sel:[0,1] op_sel_hi:[1,1] neg_lo:[0,1] neg_hi:[0,1]
v_pk_add_f32 v[186:187], v[186:187], v[64:65] op_sel:[0,1] op_sel_hi:[1,1] neg_lo:[0,1] neg_hi:[0,1]
v_pk_add_f32 v[188:189], v[188:189], v[64:65] op_sel:[0,1] op_sel_hi:[1,1] neg_lo:[0,1] neg_hi:[0,1]
v_pk_add_f32 v[190:191], v[190:191], v[64:65] op_sel:[0,1] op_sel_hi:[1,1] neg_lo:[0,1] neg_hi:[0,1]
v_pk_add_f32 v[70:71], v[184:185], v[70:71]
v_pk_fma_f32 v[34:35], v[184:185], v[184:185], v[34:35]
buffer_load_dwordx4 v23, s[12:15], s45 offen offset:3072 lds
v_pk_add_f32 v[70:71], v[186:187], v[70:71]
v_pk_fma_f32 v[34:35], v[186:187], v[186:187], v[34:35]
v_pk_add_f32 v[70:71], v[188:189], v[70:71]
v_pk_fma_f32 v[34:35], v[188:189], v[188:189], v[34:35]
v_pk_add_f32 v[70:71], v[190:191], v[70:71]
v_pk_fma_f32 v[34:35], v[190:191], v[190:191], v[34:35]
s_waitcnt lgkmcnt(0)
v_lshlrev_b32 v192, 16, v196
v_and_b32 v193, 0xffff0000, v196
v_lshlrev_b32_e64 v194, 16, v197
v_and_b32 v195, 0xffff0000, v197
v_lshlrev_b32_e64 v196, 16, v198
v_and_b32 v197, 0xffff0000, v198
v_lshlrev_b32_e64 v198, 16, v199
v_and_b32 v199, 0xffff0000, v199
v_pk_add_f32 v[192:193], v[192:193], v[66:67] op_sel:[0,0] op_sel_hi:[1,0] neg_lo:[0,1] neg_hi:[0,1]
v_pk_add_f32 v[194:195], v[194:195], v[66:67] op_sel:[0,0] op_sel_hi:[1,0] neg_lo:[0,1] neg_hi:[0,1]
v_pk_add_f32 v[196:197], v[196:197], v[66:67] op_sel:[0,0] op_sel_hi:[1,0] neg_lo:[0,1] neg_hi:[0,1]
v_pk_add_f32 v[198:199], v[198:199], v[66:67] op_sel:[0,0] op_sel_hi:[1,0] neg_lo:[0,1] neg_hi:[0,1]
v_pk_add_f32 v[72:73], v[192:193], v[72:73]
v_pk_fma_f32 v[36:37], v[192:193], v[192:193], v[36:37]
v_pk_add_f32 v[72:73], v[194:195], v[72:73]
v_pk_fma_f32 v[36:37], v[194:195], v[194:195], v[36:37]
v_pk_add_f32 v[72:73], v[196:197], v[72:73]
v_pk_fma_f32 v[36:37], v[196:197], v[196:197], v[36:37]
v_pk_add_f32 v[72:73], v[198:199], v[72:73]
v_pk_fma_f32 v[36:37], v[198:199], v[198:199], v[36:37]
v_lshlrev_b32_e64 v200, 16, v204
v_and_b32 v201, 0xffff0000, v204
v_lshlrev_b32_e64 v202, 16, v205
v_and_b32 v203, 0xffff0000, v205
v_lshlrev_b32_e64 v204, 16, v206
v_and_b32 v205, 0xffff0000, v206
v_lshlrev_b32_e64 v206, 16, v207
v_and_b32 v207, 0xffff0000, v207
v_pk_add_f32 v[200:201], v[200:201], v[66:67] op_sel:[0,1] op_sel_hi:[1,1] neg_lo:[0,1] neg_hi:[0,1]
v_pk_add_f32 v[202:203], v[202:203], v[66:67] op_sel:[0,1] op_sel_hi:[1,1] neg_lo:[0,1] neg_hi:[0,1]
v_pk_add_f32 v[204:205], v[204:205], v[66:67] op_sel:[0,1] op_sel_hi:[1,1] neg_lo:[0,1] neg_hi:[0,1]
v_pk_add_f32 v[206:207], v[206:207], v[66:67] op_sel:[0,1] op_sel_hi:[1,1] neg_lo:[0,1] neg_hi:[0,1]
v_pk_add_f32 v[74:75], v[200:201], v[74:75]
s_add_u32 s3, s45, 128
s_add_u32 m0, s39, 0
v_pk_fma_f32 v[38:39], v[200:201], v[200:201], v[38:39]
buffer_load_dwordx4 v16, s[12:15], s3 offen offset:0 lds
v_pk_add_f32 v[74:75], v[202:203], v[74:75]
v_pk_fma_f32 v[38:39], v[202:203], v[202:203], v[38:39]
v_pk_add_f32 v[74:75], v[204:205], v[74:75]
v_pk_fma_f32 v[38:39], v[204:205], v[204:205], v[38:39]
v_pk_add_f32 v[74:75], v[206:207], v[74:75]
v_pk_fma_f32 v[38:39], v[206:207], v[206:207], v[38:39]
v_add_f32 v208, v68, v69
v_add_f32 v212, v32, v33
v_add_f32 v209, v70, v71
v_add_f32 v213, v34, v35
v_add_f32 v210, v72, v73
v_add_f32 v214, v36, v37
v_add_f32 v211, v74, v75
v_add_f32 v215, v38, v39
s_waitcnt vmcnt(9)
v_readfirstlane_b32 s61, v220
s_lshl_b32 s62, s42, 8
v_lshlrev_b32 v43, 4, v15
v_add_u32 v44, s62, v43
v_and_b32 v44, 0xfff, v44
s_lshl_b32 s63, s84, 13
s_add_u32 s63, s63, 32768
s_add_u32 s62, s63, 4096
v_and_b32 v45, 0x80, v44
v_cmp_eq_u32 vcc, 0, v45
v_mov_b32 v45, 0
s_nop 0
v_cndmask_b32 v45, 0, 1.0, vcc
s_cmp_ge_u32 s61, 5
s_cselect_b32 s61, s63, 0x7fff0000
s_add_u32 s60, s61, 4096
buffer_load_dwordx4 v[32:35], v44, s[28:31], s61 offen sc1
buffer_load_dwordx4 v[36:39], v44, s[28:31], s60 offen sc1
v_mov_b32 v68, v208
v_mov_b32 v69, v209
v_mov_b32 v70, v210
v_mov_b32 v71, v211
v_mov_b32 v72, v212
v_mov_b32 v73, v213
v_mov_b32 v74, v214
buffer_load_dwordx4 v17, s[12:15], s3 offen offset:1024 lds
v_mov_b32 v75, v215
v_permlane32_swap_b32 v68, v208
v_permlane32_swap_b32 v69, v209
v_permlane32_swap_b32 v70, v210
v_permlane32_swap_b32 v71, v211
v_permlane32_swap_b32 v72, v212
v_permlane32_swap_b32 v73, v213
v_permlane32_swap_b32 v74, v214
v_permlane32_swap_b32 v75, v215
v_add_f32 v208, v208, v68
v_add_f32 v209, v209, v69
v_add_f32 v210, v210, v70
v_add_f32 v211, v211, v71
v_add_f32 v212, v212, v72
v_add_f32 v213, v213, v73
v_add_f32 v214, v214, v74
v_add_f32 v215, v215, v75
v_mov_b32 v68, v208
v_mov_b32 v69, v209
v_mov_b32 v70, v210
v_mov_b32 v71, v211
v_mov_b32 v72, v212
v_mov_b32 v73, v213
v_mov_b32 v74, v214
v_mov_b32 v75, v215
v_permlane16_swap_b32 v68, v208
v_permlane16_swap_b32 v69, v209
v_permlane16_swap_b32 v70, v210
v_permlane16_swap_b32 v71, v211
v_permlane16_swap_b32 v72, v212
v_permlane16_swap_b32 v73, v213
v_permlane16_swap_b32 v74, v214
v_permlane16_swap_b32 v75, v215
v_add_f32 v208, v208, v68
v_add_f32 v209, v209, v69
v_add_f32 v210, v210, v70
v_add_f32 v211, v211, v71
v_add_f32 v212, v212, v72
v_add_f32 v213, v213, v73
v_add_f32 v214, v214, v74
buffer_load_dwordx4 v18, s[12:15], s3 offen offset:2048 lds
v_add_f32_e64 v215, v215, v75
ds_write_b128 v42, v[208:211]
ds_write_b128 v42, v[212:215] offset:16
s_waitcnt lgkmcnt(0)
s_barrier
ds_read_b128 v[48:51], v41 offset:0
ds_read_b128 v[52:55], v41 offset:16
ds_read_b128 v[56:59], v41 offset:512
ds_read_b128 v[60:63], v41 offset:528
ds_read_b128 v[64:67], v41 offset:1024
ds_read_b128 v[68:71], v41 offset:1040
ds_read_b128 v[72:75], v41 offset:1536
ds_read_b128 v[76:79], v41 offset:1552
s_waitcnt lgkmcnt(0)
s_nop 0
v_pk_add_f32 v[48:49], v[48:49], v[56:57]
v_pk_add_f32 v[64:65], v[64:65], v[72:73]
v_pk_add_f32 v[50:51], v[50:51], v[58:59]
v_pk_add_f32 v[66:67], v[66:67], v[74:75]
v_pk_add_f32 v[52:53], v[52:53], v[60:61]
v_pk_add_f32 v[68:69], v[68:69], v[76:77]
v_pk_add_f32 v[54:55], v[54:55], v[62:63]
v_pk_add_f32 v[70:71], v[70:71], v[78:79]
v_pk_add_f32 v[64:65], v[48:49], v[64:65]
v_pk_add_f32 v[66:67], v[50:51], v[66:67]
v_pk_add_f32 v[68:69], v[52:53], v[68:69]
v_pk_add_f32 v[70:71], v[54:55], v[70:71]
v_mov_b32 v4, 0x3727c5ac
v_mul_f32 v64, 0x3b000000, v64
v_mul_f32 v68, 0x3b000000, v68
v_mul_f32 v65, 0x3b000000, v65
v_mul_f32 v69, 0x3b000000, v69
v_mul_f32 v66, 0x3b000000, v66
v_mul_f32 v70, 0x3b000000, v70
v_mul_f32 v67, 0x3b000000, v67
v_mul_f32 v71, 0x3b000000, v71
v_fma_f32 v68, -v64, v64, v68
v_fma_f32 v69, -v65, v65, v69
v_fma_f32 v70, -v66, v66, v70
v_fma_f32 v71, -v67, v67, v71
v_max_f32_e64 v68, 0, v68
buffer_load_dwordx4 v19, s[12:15], s3 offen offset:3072 lds
v_max_f32 v69, 0, v69
v_max_f32 v70, 0, v70
v_max_f32 v71, 0, v71
v_add_f32 v68, v4, v68
v_add_f32 v69, v4, v69
v_add_f32 v70, v4, v70
v_add_f32 v71, v4, v71
v_rsq_f32 v208, v68
v_rsq_f32 v209, v69
v_rsq_f32 v210, v70
v_rsq_f32_e64 v211, v71
v_mul_f32_e64 v212, -v64, v208
v_mul_f32_e64 v213, -v65, v209
v_mul_f32_e64 v214, -v66, v210
v_mul_f32_e64 v215, -v67, v211
v_pk_fma_f32 v[80:81], v[80:81], v[208:209], v[212:213] op_sel:[0,0,0] op_sel_hi:[1,0,0]
v_pk_fma_f32 v[82:83], v[82:83], v[208:209], v[212:213] op_sel:[0,0,0] op_sel_hi:[1,0,0]
v_pk_fma_f32 v[84:85], v[84:85], v[208:209], v[212:213] op_sel:[0,0,0] op_sel_hi:[1,0,0]
v_pk_fma_f32 v[86:87], v[86:87], v[208:209], v[212:213] op_sel:[0,0,0] op_sel_hi:[1,0,0]
v_pk_fma_f32 v[88:89], v[88:89], v[208:209], v[212:213] op_sel:[0,1,1] op_sel_hi:[1,1,1]
v_pk_fma_f32 v[90:91], v[90:91], v[208:209], v[212:213] op_sel:[0,1,1] op_sel_hi:[1,1,1]
v_pk_fma_f32 v[92:93], v[92:93], v[208:209], v[212:213] op_sel:[0,1,1] op_sel_hi:[1,1,1]
v_pk_fma_f32 v[94:95], v[94:95], v[208:209], v[212:213] op_sel:[0,1,1] op_sel_hi:[1,1,1]
v_pk_fma_f32 v[96:97], v[96:97], v[210:211], v[214:215] op_sel:[0,0,0] op_sel_hi:[1,0,0]
v_pk_fma_f32 v[98:99], v[98:99], v[210:211], v[214:215] op_sel:[0,0,0] op_sel_hi:[1,0,0]
v_pk_fma_f32 v[100:101], v[100:101], v[210:211], v[214:215] op_sel:[0,0,0] op_sel_hi:[1,0,0]
v_pk_fma_f32 v[102:103], v[102:103], v[210:211], v[214:215] op_sel:[0,0,0] op_sel_hi:[1,0,0]
v_pk_fma_f32 v[104:105], v[104:105], v[210:211], v[214:215] op_sel:[0,1,1] op_sel_hi:[1,1,1]
v_pk_fma_f32 v[106:107], v[106:107], v[210:211], v[214:215] op_sel:[0,1,1] op_sel_hi:[1,1,1]
v_pk_fma_f32 v[108:109], v[108:109], v[210:211], v[214:215] op_sel:[0,1,1] op_sel_hi:[1,1,1]
v_pk_fma_f32 v[110:111], v[110:111], v[210:211], v[214:215] op_sel:[0,1,1] op_sel_hi:[1,1,1]
v_pk_fma_f32 v[112:113], v[112:113], v[208:209], v[212:213] op_sel:[0,0,0] op_sel_hi:[1,0,0]
v_pk_fma_f32 v[114:115], v[114:115], v[208:209], v[212:213] op_sel:[0,0,0] op_sel_hi:[1,0,0]
v_pk_fma_f32 v[116:117], v[116:117], v[208:209], v[212:213] op_sel:[0,0,0] op_sel_hi:[1,0,0]
v_pk_fma_f32 v[118:119], v[118:119], v[208:209], v[212:213] op_sel:[0,0,0] op_sel_hi:[1,0,0]
v_pk_fma_f32 v[120:121], v[120:121], v[208:209], v[212:213] op_sel:[0,1,1] op_sel_hi:[1,1,1]
v_pk_fma_f32 v[122:123], v[122:123], v[208:209], v[212:213] op_sel:[0,1,1] op_sel_hi:[1,1,1]
v_pk_fma_f32 v[124:125], v[124:125], v[208:209], v[212:213] op_sel:[0,1,1] op_sel_hi:[1,1,1]
v_pk_fma_f32 v[126:127], v[126:127], v[208:209], v[212:213] op_sel:[0,1,1] op_sel_hi:[1,1,1]
v_pk_fma_f32 v[128:129], v[128:129], v[210:211], v[214:215] op_sel:[0,0,0] op_sel_hi:[1,0,0]
s_add_u32 m0, s39, 16384
v_pk_fma_f32 v[130:131], v[130:131], v[210:211], v[214:215] op_sel:[0,0,0] op_sel_hi:[1,0,0]
buffer_load_dwordx4 v20, s[12:15], s3 offen offset:0 lds
v_pk_fma_f32 v[132:133], v[132:133], v[210:211], v[214:215] op_sel:[0,0,0] op_sel_hi:[1,0,0]
v_pk_fma_f32 v[134:135], v[134:135], v[210:211], v[214:215] op_sel:[0,0,0] op_sel_hi:[1,0,0]
v_pk_fma_f32 v[136:137], v[136:137], v[210:211], v[214:215] op_sel:[0,1,1] op_sel_hi:[1,1,1]
v_pk_fma_f32 v[138:139], v[138:139], v[210:211], v[214:215] op_sel:[0,1,1] op_sel_hi:[1,1,1]
v_pk_fma_f32 v[140:141], v[140:141], v[210:211], v[214:215] op_sel:[0,1,1] op_sel_hi:[1,1,1]
v_pk_fma_f32 v[142:143], v[142:143], v[210:211], v[214:215] op_sel:[0,1,1] op_sel_hi:[1,1,1]
v_pk_fma_f32 v[144:145], v[144:145], v[208:209], v[212:213] op_sel:[0,0,0] op_sel_hi:[1,0,0]
v_pk_fma_f32 v[146:147], v[146:147], v[208:209], v[212:213] op_sel:[0,0,0] op_sel_hi:[1,0,0]
v_pk_fma_f32 v[148:149], v[148:149], v[208:209], v[212:213] op_sel:[0,0,0] op_sel_hi:[1,0,0]
v_pk_fma_f32 v[150:151], v[150:151], v[208:209], v[212:213] op_sel:[0,0,0] op_sel_hi:[1,0,0]
v_pk_fma_f32 v[152:153], v[152:153], v[208:209], v[212:213] op_sel:[0,1,1] op_sel_hi:[1,1,1]
v_pk_fma_f32 v[154:155], v[154:155], v[208:209], v[212:213] op_sel:[0,1,1] op_sel_hi:[1,1,1]
v_pk_fma_f32 v[156:157], v[156:157], v[208:209], v[212:213] op_sel:[0,1,1] op_sel_hi:[1,1,1]
v_pk_fma_f32 v[158:159], v[158:159], v[208:209], v[212:213] op_sel:[0,1,1] op_sel_hi:[1,1,1]
v_pk_fma_f32 v[160:161], v[160:161], v[210:211], v[214:215] op_sel:[0,0,0] op_sel_hi:[1,0,0]
v_pk_fma_f32 v[162:163], v[162:163], v[210:211], v[214:215] op_sel:[0,0,0] op_sel_hi:[1,0,0]
v_pk_fma_f32 v[164:165], v[164:165], v[210:211], v[214:215] op_sel:[0,0,0] op_sel_hi:[1,0,0]
v_pk_fma_f32 v[166:167], v[166:167], v[210:211], v[214:215] op_sel:[0,0,0] op_sel_hi:[1,0,0]
v_pk_fma_f32 v[168:169], v[168:169], v[210:211], v[214:215] op_sel:[0,1,1] op_sel_hi:[1,1,1]
v_pk_fma_f32 v[170:171], v[170:171], v[210:211], v[214:215] op_sel:[0,1,1] op_sel_hi:[1,1,1]
v_pk_fma_f32 v[172:173], v[172:173], v[210:211], v[214:215] op_sel:[0,1,1] op_sel_hi:[1,1,1]
v_pk_fma_f32 v[174:175], v[174:175], v[210:211], v[214:215] op_sel:[0,1,1] op_sel_hi:[1,1,1]
v_pk_fma_f32 v[176:177], v[176:177], v[208:209], v[212:213] op_sel:[0,0,0] op_sel_hi:[1,0,0]
v_pk_fma_f32 v[178:179], v[178:179], v[208:209], v[212:213] op_sel:[0,0,0] op_sel_hi:[1,0,0]
v_pk_fma_f32 v[180:181], v[180:181], v[208:209], v[212:213] op_sel:[0,0,0] op_sel_hi:[1,0,0]
v_pk_fma_f32 v[182:183], v[182:183], v[208:209], v[212:213] op_sel:[0,0,0] op_sel_hi:[1,0,0]
v_pk_fma_f32 v[184:185], v[184:185], v[208:209], v[212:213] op_sel:[0,1,1] op_sel_hi:[1,1,1]
v_pk_fma_f32 v[186:187], v[186:187], v[208:209], v[212:213] op_sel:[0,1,1] op_sel_hi:[1,1,1]
v_pk_fma_f32 v[188:189], v[188:189], v[208:209], v[212:213] op_sel:[0,1,1] op_sel_hi:[1,1,1]
v_pk_fma_f32 v[190:191], v[190:191], v[208:209], v[212:213] op_sel:[0,1,1] op_sel_hi:[1,1,1]
v_pk_fma_f32 v[192:193], v[192:193], v[210:211], v[214:215] op_sel:[0,0,0] op_sel_hi:[1,0,0]
v_pk_fma_f32 v[194:195], v[194:195], v[210:211], v[214:215] op_sel:[0,0,0] op_sel_hi:[1,0,0]
v_pk_fma_f32 v[196:197], v[196:197], v[210:211], v[214:215] op_sel:[0,0,0] op_sel_hi:[1,0,0]
v_pk_fma_f32 v[198:199], v[198:199], v[210:211], v[214:215] op_sel:[0,0,0] op_sel_hi:[1,0,0]
v_pk_fma_f32 v[200:201], v[200:201], v[210:211], v[214:215] op_sel:[0,1,1] op_sel_hi:[1,1,1]
v_pk_fma_f32 v[202:203], v[202:203], v[210:211], v[214:215] op_sel:[0,1,1] op_sel_hi:[1,1,1]
v_pk_fma_f32 v[204:205], v[204:205], v[210:211], v[214:215] op_sel:[0,1,1] op_sel_hi:[1,1,1]
v_pk_fma_f32 v[206:207], v[206:207], v[210:211], v[214:215] op_sel:[0,1,1] op_sel_hi:[1,1,1]
buffer_load_dwordx4 v21, s[12:15], s3 offen offset:1024 lds
buffer_load_dwordx4 v22, s[12:15], s3 offen offset:2048 lds
buffer_load_dwordx4 v23, s[12:15], s3 offen offset:3072 lds
s_add_u32 s45, s45, 524288
s_and_b32 s45, s45, 0x3fffff
s_add_u32 m0, s39, 65536
s_nop 0
buffer_load_dwordx4 v16, s[12:15], s45 offen offset:0 lds
buffer_load_dwordx4 v17, s[12:15], s45 offen offset:1024 lds
buffer_load_dwordx4 v18, s[12:15], s45 offen offset:2048 lds
buffer_load_dwordx4 v19, s[12:15], s45 offen offset:3072 lds
s_waitcnt vmcnt(11)
v_and_b32 v46, v32, v33
v_and_b32 v47, v34, v35
v_and_b32 v4, v36, v37
v_and_b32 v5, v38, v39
v_and_b32 v46, v46, v47
v_and_b32 v4, v4, v5
v_and_b32 v46, v46, v4
v_and_b32 v46, 1, v46
v_cmp_eq_u32 vcc, 0, v46
v_add_u32 v6, 81920, v43
s_nop 0
s_cmp_eq_u64 vcc, 0
s_cbranch_scc1 L_f_pmod_done
s_mov_b32 s60, 400000
L_f_clr2:
v_readfirstlane_b32 s61, v220
s_sub_u32 s60, s60, 1
s_cbranch_scc1 L_f_clr2_done
s_cmp_ge_u32 s61, 5
s_cbranch_scc1 L_f_clr2_done
v_mov_b32 v6, 0
buffer_load_dword v220, v6, s[80:83], 0 offen sc1
s_waitcnt vmcnt(0)
s_branch L_f_clr2
L_f_clr2_done:
v_add_u32 v6, 81920, v43
s_mov_b32 s60, 400000
L_f_pmod:
buffer_load_dwordx4 v[32:35], v44, s[28:31], s63 offen sc1
buffer_load_dwordx4 v[36:39], v44, s[28:31], s62 offen sc1
s_waitcnt vmcnt(0)
v_and_b32 v46, v32, v33
v_and_b32 v47, v34, v35
v_and_b32 v4, v36, v37
v_and_b32 v5, v38, v39
v_and_b32 v46, v46, v47
v_and_b32 v4, v4, v5
v_and_b32 v46, v46, v4
v_and_b32 v46, 1, v46
v_cmp_eq_u32 vcc, 0, v46
s_sub_u32 s60, s60, 1
s_cbranch_scc1 L_f_pmod_done
s_cmp_lg_u64 vcc, 0
s_cbranch_scc1 L_f_pmod
L_f_pmod_done:
v_pk_add_f32 v[32:33], v[32:33], v[36:37]
v_pk_add_f32 v[34:35], v[34:35], v[38:39]
v_cvt_pk_bf16_f32 v46, v32, v33
v_cvt_pk_bf16_f32 v47, v34, v35
v_lshlrev_b32_e64 v32, 16, v46
v_and_b32 v33, 0xffff0000, v46
v_lshlrev_b32_e64 v34, 16, v47
v_and_b32 v35, 0xffff0000, v47
v_add_f32 v32, v45, v32
v_add_f32 v33, v45, v33
v_add_f32 v34, v45, v34
v_add_f32 v35, v45, v35
v_cvt_pk_bf16_f32 v46, v32, v33
v_cvt_pk_bf16_f32 v47, v34, v35
v_lshlrev_b32_e64 v32, 16, v46
v_and_b32 v33, 0xffff0000, v46
v_lshlrev_b32_e64 v34, 16, v47
v_and_b32 v35, 0xffff0000, v47
v_mul_f32 v32, 0x3e0293ee, v32
v_mul_f32 v33, 0x3e0293ee, v33
v_mul_f32 v34, 0x3e0293ee, v34
v_mul_f32 v35, 0x3e0293ee, v35
ds_write_b128 v6, v[32:35]
s_waitcnt lgkmcnt(0)
ds_read_b128 v[48:51], v9 offset:0
ds_read_b128 v[52:55], v9 offset:16
ds_read_b128 v[56:59], v9 offset:128
ds_read_b128 v[60:63], v9 offset:144
ds_read_b128 v[64:67], v9 offset:256
ds_read_b128 v[68:71], v9 offset:272
ds_read_b128 v[72:75], v9 offset:384
ds_read_b128 v[76:79], v9 offset:400
buffer_load_dword a244, v222, s[72:75], 0 offen
buffer_load_dwordx4 a[248:251], v221, s[64:67], s79 offen
buffer_load_dwordx4 a[252:255], v221, s[64:67], s86 offen
s_waitcnt lgkmcnt(4)
v_pk_fma_f32 v[80:81], v[80:81], v[48:49], v[56:57]
v_pk_fma_f32 v[82:83], v[82:83], v[50:51], v[58:59]
v_pk_fma_f32 v[84:85], v[84:85], v[52:53], v[60:61]
v_pk_fma_f32 v[86:87], v[86:87], v[54:55], v[62:63]
v_cvt_pk_bf16_f32 v208, v80, v81
v_cvt_pk_bf16_f32 v209, v82, v83
v_cvt_pk_bf16_f32 v210, v84, v85
v_cvt_pk_bf16_f32 v211, v86, v87
v_pk_fma_f32 v[88:89], v[88:89], v[48:49], v[56:57]
v_pk_fma_f32 v[90:91], v[90:91], v[50:51], v[58:59]
v_pk_fma_f32 v[92:93], v[92:93], v[52:53], v[60:61]
v_pk_fma_f32 v[94:95], v[94:95], v[54:55], v[62:63]
ds_write_b128 v8, v[208:211] offset:0
v_cvt_pk_bf16_f32 v212, v88, v89
v_cvt_pk_bf16_f32 v213, v90, v91
v_cvt_pk_bf16_f32 v214, v92, v93
v_cvt_pk_bf16_f32 v215, v94, v95
v_pk_fma_f32 v[96:97], v[96:97], v[48:49], v[56:57]
v_pk_fma_f32 v[98:99], v[98:99], v[50:51], v[58:59]
v_pk_fma_f32 v[100:101], v[100:101], v[52:53], v[60:61]
v_pk_fma_f32 v[102:103], v[102:103], v[54:55], v[62:63]
ds_write_b128 v8, v[212:215] offset:16384
v_cvt_pk_bf16_f32 v208, v96, v97
v_cvt_pk_bf16_f32 v209, v98, v99
v_cvt_pk_bf16_f32 v210, v100, v101
v_cvt_pk_bf16_f32 v211, v102, v103
v_pk_fma_f32 v[104:105], v[104:105], v[48:49], v[56:57]
v_pk_fma_f32 v[106:107], v[106:107], v[50:51], v[58:59]
v_pk_fma_f32 v[108:109], v[108:109], v[52:53], v[60:61]
v_pk_fma_f32 v[110:111], v[110:111], v[54:55], v[62:63]
ds_read_b128 v[48:51], v9 offset:512
ds_read_b128 v[52:55], v9 offset:528
ds_read_b128 v[56:59], v9 offset:640
ds_read_b128 v[60:63], v9 offset:656
ds_write_b128 v8, v[208:211] offset:32768
v_cvt_pk_bf16_f32 v212, v104, v105
v_cvt_pk_bf16_f32 v213, v106, v107
v_cvt_pk_bf16_f32 v214, v108, v109
v_cvt_pk_bf16_f32 v215, v110, v111
s_waitcnt lgkmcnt(7)
s_nop 0
v_pk_fma_f32 v[112:113], v[112:113], v[64:65], v[72:73]
v_pk_fma_f32 v[114:115], v[114:115], v[66:67], v[74:75]
v_pk_fma_f32 v[116:117], v[116:117], v[68:69], v[76:77]
v_pk_fma_f32 v[118:119], v[118:119], v[70:71], v[78:79]
ds_write_b128 v8, v[212:215] offset:49152
v_cvt_pk_bf16_f32 v208, v112, v113
v_cvt_pk_bf16_f32 v209, v114, v115
v_cvt_pk_bf16_f32 v210, v116, v117
v_cvt_pk_bf16_f32 v211, v118, v119
v_pk_fma_f32 v[120:121], v[120:121], v[64:65], v[72:73]
v_pk_fma_f32 v[122:123], v[122:123], v[66:67], v[74:75]
v_pk_fma_f32 v[124:125], v[124:125], v[68:69], v[76:77]
v_pk_fma_f32 v[126:127], v[126:127], v[70:71], v[78:79]
ds_write_b128 v8, v[208:211] offset:1024
v_cvt_pk_bf16_f32 v212, v120, v121
v_cvt_pk_bf16_f32 v213, v122, v123
v_cvt_pk_bf16_f32 v214, v124, v125
v_cvt_pk_bf16_f32 v215, v126, v127
v_pk_fma_f32 v[128:129], v[128:129], v[64:65], v[72:73]
v_pk_fma_f32 v[130:131], v[130:131], v[66:67], v[74:75]
v_pk_fma_f32 v[132:133], v[132:133], v[68:69], v[76:77]
v_pk_fma_f32 v[134:135], v[134:135], v[70:71], v[78:79]
ds_write_b128 v8, v[212:215] offset:17408
v_cvt_pk_bf16_f32 v208, v128, v129
v_cvt_pk_bf16_f32 v209, v130, v131
v_cvt_pk_bf16_f32 v210, v132, v133
v_cvt_pk_bf16_f32 v211, v134, v135
v_pk_fma_f32 v[136:137], v[136:137], v[64:65], v[72:73]
v_pk_fma_f32 v[138:139], v[138:139], v[66:67], v[74:75]
v_pk_fma_f32 v[140:141], v[140:141], v[68:69], v[76:77]
v_pk_fma_f32 v[142:143], v[142:143], v[70:71], v[78:79]
ds_read_b128 v[64:67], v9 offset:768
ds_read_b128 v[68:71], v9 offset:784
ds_read_b128 v[72:75], v9 offset:896
ds_read_b128 v[76:79], v9 offset:912
ds_write_b128 v8, v[208:211] offset:33792
v_cvt_pk_bf16_f32 v212, v136, v137
v_cvt_pk_bf16_f32 v213, v138, v139
v_cvt_pk_bf16_f32 v214, v140, v141
v_cvt_pk_bf16_f32 v215, v142, v143
s_waitcnt lgkmcnt(9)
s_nop 0
v_pk_fma_f32 v[144:145], v[144:145], v[48:49], v[56:57]
v_pk_fma_f32 v[146:147], v[146:147], v[50:51], v[58:59]
v_pk_fma_f32 v[148:149], v[148:149], v[52:53], v[60:61]
v_pk_fma_f32 v[150:151], v[150:151], v[54:55], v[62:63]
ds_write_b128 v8, v[212:215] offset:50176
v_cvt_pk_bf16_f32 v208, v144, v145
v_cvt_pk_bf16_f32 v209, v146, v147
v_cvt_pk_bf16_f32 v210, v148, v149
v_cvt_pk_bf16_f32 v211, v150, v151
v_pk_fma_f32 v[152:153], v[152:153], v[48:49], v[56:57]
v_pk_fma_f32 v[154:155], v[154:155], v[50:51], v[58:59]
v_pk_fma_f32 v[156:157], v[156:157], v[52:53], v[60:61]
v_pk_fma_f32 v[158:159], v[158:159], v[54:55], v[62:63]
ds_write_b128 v8, v[208:211] offset:2048
v_cvt_pk_bf16_f32 v212, v152, v153
v_cvt_pk_bf16_f32 v213, v154, v155
v_cvt_pk_bf16_f32 v214, v156, v157
v_cvt_pk_bf16_f32 v215, v158, v159
v_pk_fma_f32 v[160:161], v[160:161], v[48:49], v[56:57]
v_pk_fma_f32 v[162:163], v[162:163], v[50:51], v[58:59]
v_pk_fma_f32 v[164:165], v[164:165], v[52:53], v[60:61]
v_pk_fma_f32 v[166:167], v[166:167], v[54:55], v[62:63]
ds_write_b128 v8, v[212:215] offset:18432
v_cvt_pk_bf16_f32 v208, v160, v161
v_cvt_pk_bf16_f32 v209, v162, v163
v_cvt_pk_bf16_f32 v210, v164, v165
v_cvt_pk_bf16_f32 v211, v166, v167
v_pk_fma_f32 v[168:169], v[168:169], v[48:49], v[56:57]
v_pk_fma_f32 v[170:171], v[170:171], v[50:51], v[58:59]
v_pk_fma_f32 v[172:173], v[172:173], v[52:53], v[60:61]
v_pk_fma_f32 v[174:175], v[174:175], v[54:55], v[62:63]
ds_write_b128 v8, v[208:211] offset:34816
v_cvt_pk_bf16_f32 v212, v168, v169
v_cvt_pk_bf16_f32 v213, v170, v171
v_cvt_pk_bf16_f32 v214, v172, v173
v_cvt_pk_bf16_f32 v215, v174, v175
s_waitcnt lgkmcnt(5)
s_nop 0
v_pk_fma_f32 v[176:177], v[176:177], v[64:65], v[72:73]
v_pk_fma_f32 v[178:179], v[178:179], v[66:67], v[74:75]
v_pk_fma_f32 v[180:181], v[180:181], v[68:69], v[76:77]
v_pk_fma_f32 v[182:183], v[182:183], v[70:71], v[78:79]
ds_write_b128 v8, v[212:215] offset:51200
v_cvt_pk_bf16_f32 v208, v176, v177
v_cvt_pk_bf16_f32 v209, v178, v179
v_cvt_pk_bf16_f32 v210, v180, v181
v_cvt_pk_bf16_f32 v211, v182, v183
v_pk_fma_f32 v[184:185], v[184:185], v[64:65], v[72:73]
v_pk_fma_f32 v[186:187], v[186:187], v[66:67], v[74:75]
v_pk_fma_f32 v[188:189], v[188:189], v[68:69], v[76:77]
v_pk_fma_f32 v[190:191], v[190:191], v[70:71], v[78:79]
ds_write_b128 v8, v[208:211] offset:3072
v_cvt_pk_bf16_f32 v212, v184, v185
v_cvt_pk_bf16_f32 v213, v186, v187
v_cvt_pk_bf16_f32 v214, v188, v189
v_cvt_pk_bf16_f32 v215, v190, v191
v_pk_fma_f32 v[192:193], v[192:193], v[64:65], v[72:73]
v_pk_fma_f32 v[194:195], v[194:195], v[66:67], v[74:75]
v_pk_fma_f32 v[196:197], v[196:197], v[68:69], v[76:77]
v_pk_fma_f32 v[198:199], v[198:199], v[70:71], v[78:79]
ds_write_b128 v8, v[212:215] offset:19456
v_cvt_pk_bf16_f32 v208, v192, v193
v_cvt_pk_bf16_f32 v209, v194, v195
v_cvt_pk_bf16_f32 v210, v196, v197
v_cvt_pk_bf16_f32 v211, v198, v199
v_pk_fma_f32 v[200:201], v[200:201], v[64:65], v[72:73]
v_pk_fma_f32 v[202:203], v[202:203], v[66:67], v[74:75]
v_pk_fma_f32 v[204:205], v[204:205], v[68:69], v[76:77]
v_pk_fma_f32 v[206:207], v[206:207], v[70:71], v[78:79]
ds_write_b128 v8, v[208:211] offset:35840
v_cvt_pk_bf16_f32 v212, v200, v201
v_cvt_pk_bf16_f32 v213, v202, v203
v_cvt_pk_bf16_f32 v214, v204, v205
v_cvt_pk_bf16_f32 v215, v206, v207
ds_write_b128 v8, v[212:215] offset:52224
s_waitcnt lgkmcnt(0)
s_barrier
ds_read_b128 a[128:131], v40 offset:0
ds_read_b128 a[144:147], v40 offset:1024
ds_read_b128 a[132:135], v40 offset:16384
ds_read_b128 a[148:151], v40 offset:17408
ds_read_b128 a[136:139], v40 offset:32768
ds_read_b128 a[152:155], v40 offset:33792
ds_read_b128 a[140:143], v40 offset:49152
ds_read_b128 a[156:159], v40 offset:50176
s_waitcnt vmcnt(17)
ds_read_b64_tr_b16 a[212:213], v24 offset:32768
ds_read_b64_tr_b16 a[214:215], v24 offset:33280
ds_read_b64_tr_b16 a[216:217], v24 offset:49152
ds_read_b64_tr_b16 a[218:219], v24 offset:49664
ds_read_b64_tr_b16 a[220:221], v25 offset:32768
ds_read_b64_tr_b16 a[222:223], v25 offset:33280
ds_read_b64_tr_b16 a[224:225], v25 offset:49152
ds_read_b64_tr_b16 a[226:227], v25 offset:49664
s_waitcnt lgkmcnt(4)
v_mfma_f32_16x16x32_bf16 v[80:83], a[212:215], a[128:131], 0
s_add_u32 m0, s39, 81920
v_mfma_f32_16x16x32_bf16 v[80:83], a[216:219], a[144:147], v[80:83]
buffer_load_dwordx4 v20, s[12:15], s45 offen offset:0 lds
v_mfma_f32_16x16x32_bf16 v[84:87], a[216:219], a[148:151], 0
buffer_load_dwordx4 v21, s[12:15], s45 offen offset:1024 lds
v_mfma_f32_16x16x32_bf16 v[84:87], a[212:215], a[132:135], v[84:87]
buffer_load_dwordx4 v22, s[12:15], s45 offen offset:2048 lds
v_mfma_f32_16x16x32_bf16 v[88:91], a[212:215], a[136:139], 0
buffer_load_dwordx4 v23, s[12:15], s45 offen offset:3072 lds
v_mfma_f32_16x16x32_bf16 v[88:91], a[216:219], a[152:155], v[88:91]
ds_read_b64_tr_b16 a[228:229], v26 offset:32768
ds_read_b64_tr_b16 a[230:231], v26 offset:33280
v_mfma_f32_16x16x32_bf16 v[92:95], a[216:219], a[156:159], 0
ds_read_b64_tr_b16 a[232:233], v26 offset:49152
ds_read_b64_tr_b16 a[234:235], v26 offset:49664
v_mfma_f32_16x16x32_bf16 v[92:95], a[212:215], a[140:143], v[92:95]
s_add_u32 s3, s45, 128
s_waitcnt lgkmcnt(4)
v_mfma_f32_16x16x32_bf16 v[96:99], a[220:223], a[128:131], 0
v_mfma_f32_16x16x32_bf16 v[96:99], a[224:227], a[144:147], v[96:99]
v_mfma_f32_16x16x32_bf16 v[100:103], a[224:227], a[148:151], 0
ds_read_b64_tr_b16 a[236:237], v27 offset:32768
ds_read_b64_tr_b16 a[238:239], v27 offset:33280
v_mfma_f32_16x16x32_bf16 v[100:103], a[220:223], a[132:135], v[100:103]
ds_read_b64_tr_b16 a[240:241], v27 offset:49152
ds_read_b64_tr_b16 a[242:243], v27 offset:49664
v_mfma_f32_16x16x32_bf16 v[104:107], a[220:223], a[136:139], 0
v_mfma_f32_16x16x32_bf16 v[104:107], a[224:227], a[152:155], v[104:107]
v_mfma_f32_16x16x32_bf16 v[108:111], a[224:227], a[156:159], 0
v_mfma_f32_16x16x32_bf16 v[108:111], a[220:223], a[140:143], v[108:111]
s_waitcnt lgkmcnt(4)
v_mfma_f32_16x16x32_bf16 v[112:115], a[228:231], a[128:131], 0
v_mfma_f32_16x16x32_bf16 v[112:115], a[232:235], a[144:147], v[112:115]
v_mfma_f32_16x16x32_bf16 v[116:119], a[232:235], a[148:151], 0
s_waitcnt vmcnt(11)
ds_read_b64_tr_b16 a[212:213], v24 offset:0
v_mfma_f32_16x16x32_bf16 v[116:119], a[228:231], a[132:135], v[116:119]
ds_read_b64_tr_b16 a[214:215], v24 offset:512
ds_read_b64_tr_b16 a[216:217], v24 offset:16384
v_mfma_f32_16x16x32_bf16 v[120:123], a[228:231], a[136:139], 0
ds_read_b64_tr_b16 a[218:219], v24 offset:16896
v_mfma_f32_16x16x32_bf16 v[120:123], a[232:235], a[152:155], v[120:123]
v_mfma_f32_16x16x32_bf16 v[124:127], a[232:235], a[156:159], 0
v_mfma_f32_16x16x32_bf16 v[124:127], a[228:231], a[140:143], v[124:127]
s_waitcnt lgkmcnt(4)
v_mfma_f32_16x16x32_bf16 v[128:131], a[236:239], a[128:131], 0
s_add_u32 m0, s39, 32768
v_mfma_f32_16x16x32_bf16 v[128:131], a[240:243], a[144:147], v[128:131]
buffer_load_dwordx4 v16, s[12:15], s3 offen offset:0 lds
v_mfma_f32_16x16x32_bf16 v[132:135], a[240:243], a[148:151], 0
buffer_load_dwordx4 v17, s[12:15], s3 offen offset:1024 lds
v_mfma_f32_16x16x32_bf16 v[132:135], a[236:239], a[132:135], v[132:135]
buffer_load_dwordx4 v18, s[12:15], s3 offen offset:2048 lds
v_mfma_f32_16x16x32_bf16 v[136:139], a[236:239], a[136:139], 0
buffer_load_dwordx4 v19, s[12:15], s3 offen offset:3072 lds
v_mfma_f32_16x16x32_bf16 v[136:139], a[240:243], a[152:155], v[136:139]
ds_read_b64_tr_b16 a[220:221], v25 offset:0
ds_read_b64_tr_b16 a[222:223], v25 offset:512
v_mfma_f32_16x16x32_bf16 v[140:143], a[240:243], a[156:159], 0
ds_read_b64_tr_b16 a[224:225], v25 offset:16384
ds_read_b64_tr_b16 a[226:227], v25 offset:16896
v_mfma_f32_16x16x32_bf16 v[140:143], a[236:239], a[140:143], v[140:143]
s_add_u32 m0, s39, 49152
s_waitcnt lgkmcnt(4)
v_mfma_f32_16x16x32_bf16 v[144:147], a[212:215], a[128:131], 0
buffer_load_dwordx4 v20, s[12:15], s3 offen offset:0 lds
v_mfma_f32_16x16x32_bf16 v[144:147], a[216:219], a[144:147], v[144:147]
buffer_load_dwordx4 v21, s[12:15], s3 offen offset:1024 lds
v_mfma_f32_16x16x32_bf16 v[148:151], a[216:219], a[148:151], 0
buffer_load_dwordx4 v22, s[12:15], s3 offen offset:2048 lds
v_mfma_f32_16x16x32_bf16 v[148:151], a[212:215], a[132:135], v[148:151]
buffer_load_dwordx4 v23, s[12:15], s3 offen offset:3072 lds
v_mfma_f32_16x16x32_bf16 v[152:155], a[212:215], a[136:139], 0
ds_read_b64_tr_b16 a[228:229], v26 offset:0
ds_read_b64_tr_b16 a[230:231], v26 offset:512
v_mfma_f32_16x16x32_bf16 v[152:155], a[216:219], a[152:155], v[152:155]
ds_read_b64_tr_b16 a[232:233], v26 offset:16384
ds_read_b64_tr_b16 a[234:235], v26 offset:16896
v_mfma_f32_16x16x32_bf16 v[156:159], a[216:219], a[156:159], 0
ds_read_b128 a[160:163], v40 offset:2048
ds_read_b128 a[176:179], v40 offset:3072
v_mfma_f32_16x16x32_bf16 v[156:159], a[212:215], a[140:143], v[156:159]
ds_read_b128 a[164:167], v40 offset:18432
s_waitcnt lgkmcnt(7)
v_mfma_f32_16x16x32_bf16 v[160:163], a[220:223], a[128:131], 0
ds_read_b128 a[180:183], v40 offset:19456
ds_read_b128 a[168:171], v40 offset:34816
v_mfma_f32_16x16x32_bf16 v[160:163], a[224:227], a[144:147], v[160:163]
ds_read_b128 a[184:187], v40 offset:35840
ds_read_b128 a[172:175], v40 offset:51200
v_mfma_f32_16x16x32_bf16 v[164:167], a[224:227], a[148:151], 0
ds_read_b128 a[188:191], v40 offset:52224
ds_read_b64_tr_b16 a[236:237], v27 offset:0
v_mfma_f32_16x16x32_bf16 v[164:167], a[220:223], a[132:135], v[164:167]
ds_read_b64_tr_b16 a[238:239], v27 offset:512
ds_read_b64_tr_b16 a[240:241], v27 offset:16384
v_mfma_f32_16x16x32_bf16 v[168:171], a[220:223], a[136:139], 0
ds_read_b64_tr_b16 a[242:243], v27 offset:16896
s_add_u32 s45, s45, 524288
v_mfma_f32_16x16x32_bf16 v[168:171], a[224:227], a[152:155], v[168:171]
s_and_b32 s45, s45, 0x3fffff
v_mfma_f32_16x16x32_bf16 v[172:175], a[224:227], a[156:159], 0
v_mfma_f32_16x16x32_bf16 v[172:175], a[220:223], a[140:143], v[172:175]
s_waitcnt lgkmcnt(12)
v_mfma_f32_16x16x32_bf16 v[176:179], a[228:231], a[128:131], 0
v_mfma_f32_16x16x32_bf16 v[176:179], a[232:235], a[144:147], v[176:179]
v_mfma_f32_16x16x32_bf16 v[180:183], a[232:235], a[148:151], 0
s_waitcnt vmcnt(8)
ds_read_b64_tr_b16 a[212:213], v28 offset:0
v_mfma_f32_16x16x32_bf16 v[180:183], a[228:231], a[132:135], v[180:183]
ds_read_b64_tr_b16 a[214:215], v28 offset:512
ds_read_b64_tr_b16 a[216:217], v28 offset:16384
v_mfma_f32_16x16x32_bf16 v[184:187], a[228:231], a[136:139], 0
ds_read_b64_tr_b16 a[218:219], v28 offset:16896
v_mfma_f32_16x16x32_bf16 v[184:187], a[232:235], a[152:155], v[184:187]
v_mfma_f32_16x16x32_bf16 v[188:191], a[232:235], a[156:159], 0
v_mfma_f32_16x16x32_bf16 v[188:191], a[228:231], a[140:143], v[188:191]
s_waitcnt lgkmcnt(4)
v_mfma_f32_16x16x32_bf16 v[192:195], a[236:239], a[128:131], 0
s_add_u32 m0, s39, 0
v_mfma_f32_16x16x32_bf16 v[192:195], a[240:243], a[144:147], v[192:195]
buffer_load_dwordx4 v16, s[12:15], s45 offen offset:0 lds
v_mfma_f32_16x16x32_bf16 v[196:199], a[240:243], a[148:151], 0
buffer_load_dwordx4 v17, s[12:15], s45 offen offset:1024 lds
v_mfma_f32_16x16x32_bf16 v[196:199], a[236:239], a[132:135], v[196:199]
buffer_load_dwordx4 v18, s[12:15], s45 offen offset:2048 lds
v_mfma_f32_16x16x32_bf16 v[200:203], a[236:239], a[136:139], 0
buffer_load_dwordx4 v19, s[12:15], s45 offen offset:3072 lds
v_mfma_f32_16x16x32_bf16 v[200:203], a[240:243], a[152:155], v[200:203]
ds_read_b64_tr_b16 a[220:221], v29 offset:0
ds_read_b64_tr_b16 a[222:223], v29 offset:512
v_mfma_f32_16x16x32_bf16 v[204:207], a[240:243], a[156:159], 0
ds_read_b64_tr_b16 a[224:225], v29 offset:16384
ds_read_b64_tr_b16 a[226:227], v29 offset:16896
v_mfma_f32_16x16x32_bf16 v[204:207], a[236:239], a[140:143], v[204:207]
s_add_u32 m0, s39, 16384
s_waitcnt lgkmcnt(4)
v_mfma_f32_16x16x32_bf16 v[80:83], a[212:215], a[160:163], v[80:83]
buffer_load_dwordx4 v20, s[12:15], s45 offen offset:0 lds
v_mfma_f32_16x16x32_bf16 v[80:83], a[216:219], a[176:179], v[80:83]
buffer_load_dwordx4 v21, s[12:15], s45 offen offset:1024 lds
v_mfma_f32_16x16x32_bf16 v[84:87], a[216:219], a[180:183], v[84:87]
buffer_load_dwordx4 v22, s[12:15], s45 offen offset:2048 lds
v_mfma_f32_16x16x32_bf16 v[84:87], a[212:215], a[164:167], v[84:87]
buffer_load_dwordx4 v23, s[12:15], s45 offen offset:3072 lds
v_mfma_f32_16x16x32_bf16 v[88:91], a[212:215], a[168:171], v[88:91]
ds_read_b64_tr_b16 a[228:229], v30 offset:0
ds_read_b64_tr_b16 a[230:231], v30 offset:512
v_mfma_f32_16x16x32_bf16 v[88:91], a[216:219], a[184:187], v[88:91]
ds_read_b64_tr_b16 a[232:233], v30 offset:16384
ds_read_b64_tr_b16 a[234:235], v30 offset:16896
v_mfma_f32_16x16x32_bf16 v[92:95], a[216:219], a[188:191], v[92:95]
s_add_u32 s3, s45, 128
v_mfma_f32_16x16x32_bf16 v[92:95], a[212:215], a[172:175], v[92:95]
s_waitcnt lgkmcnt(4)
v_mfma_f32_16x16x32_bf16 v[96:99], a[220:223], a[160:163], v[96:99]
v_mfma_f32_16x16x32_bf16 v[96:99], a[224:227], a[176:179], v[96:99]
v_mfma_f32_16x16x32_bf16 v[100:103], a[224:227], a[180:183], v[100:103]
ds_read_b64_tr_b16 a[236:237], v31 offset:0
ds_read_b64_tr_b16 a[238:239], v31 offset:512
v_mfma_f32_16x16x32_bf16 v[100:103], a[220:223], a[164:167], v[100:103]
ds_read_b64_tr_b16 a[240:241], v31 offset:16384
ds_read_b64_tr_b16 a[242:243], v31 offset:16896
v_mfma_f32_16x16x32_bf16 v[104:107], a[220:223], a[168:171], v[104:107]
v_mfma_f32_16x16x32_bf16 v[104:107], a[224:227], a[184:187], v[104:107]
v_mfma_f32_16x16x32_bf16 v[108:111], a[224:227], a[188:191], v[108:111]
v_mfma_f32_16x16x32_bf16 v[108:111], a[220:223], a[172:175], v[108:111]
s_waitcnt lgkmcnt(4)
v_mfma_f32_16x16x32_bf16 v[112:115], a[228:231], a[160:163], v[112:115]
v_mfma_f32_16x16x32_bf16 v[112:115], a[232:235], a[176:179], v[112:115]
v_mfma_f32_16x16x32_bf16 v[116:119], a[232:235], a[180:183], v[116:119]
s_waitcnt vmcnt(8)
ds_read_b64_tr_b16 a[212:213], v24 offset:32768
v_mfma_f32_16x16x32_bf16 v[116:119], a[228:231], a[164:167], v[116:119]
ds_read_b64_tr_b16 a[214:215], v24 offset:33280
ds_read_b64_tr_b16 a[216:217], v24 offset:49152
v_mfma_f32_16x16x32_bf16 v[120:123], a[228:231], a[168:171], v[120:123]
ds_read_b64_tr_b16 a[218:219], v24 offset:49664
v_mfma_f32_16x16x32_bf16 v[120:123], a[232:235], a[184:187], v[120:123]
v_mfma_f32_16x16x32_bf16 v[124:127], a[232:235], a[188:191], v[124:127]
v_mfma_f32_16x16x32_bf16 v[124:127], a[228:231], a[172:175], v[124:127]
s_waitcnt lgkmcnt(4)
v_mfma_f32_16x16x32_bf16 v[128:131], a[236:239], a[160:163], v[128:131]
s_add_u32 m0, s39, 65536
v_accvgpr_read_b32 v41, a244
v_mfma_f32_16x16x32_bf16 v[128:131], a[240:243], a[176:179], v[128:131]
buffer_load_dwordx4 v16, s[12:15], s3 offen offset:0 lds
v_mfma_f32_16x16x32_bf16 v[132:135], a[240:243], a[180:183], v[132:135]
buffer_load_dwordx4 v17, s[12:15], s3 offen offset:1024 lds
v_mfma_f32_16x16x32_bf16 v[132:135], a[236:239], a[164:167], v[132:135]
buffer_load_dwordx4 v18, s[12:15], s3 offen offset:2048 lds
v_mfma_f32_16x16x32_bf16 v[136:139], a[236:239], a[168:171], v[136:139]
buffer_load_dwordx4 v19, s[12:15], s3 offen offset:3072 lds
v_mfma_f32_16x16x32_bf16 v[136:139], a[240:243], a[184:187], v[136:139]
ds_read_b64_tr_b16 a[220:221], v25 offset:32768
ds_read_b64_tr_b16 a[222:223], v25 offset:33280
v_mfma_f32_16x16x32_bf16 v[140:143], a[240:243], a[188:191], v[140:143]
ds_read_b64_tr_b16 a[224:225], v25 offset:49152
ds_read_b64_tr_b16 a[226:227], v25 offset:49664
v_mfma_f32_16x16x32_bf16 v[140:143], a[236:239], a[172:175], v[140:143]
s_add_u32 m0, s39, 81920
s_waitcnt lgkmcnt(4)
v_mfma_f32_16x16x32_bf16 v[144:147], a[212:215], a[160:163], v[144:147]
buffer_load_dwordx4 v20, s[12:15], s3 offen offset:0 lds
v_mfma_f32_16x16x32_bf16 v[144:147], a[216:219], a[176:179], v[144:147]
buffer_load_dwordx4 v21, s[12:15], s3 offen offset:1024 lds
v_mfma_f32_16x16x32_bf16 v[148:151], a[216:219], a[180:183], v[148:151]
buffer_load_dwordx4 v22, s[12:15], s3 offen offset:2048 lds
v_mfma_f32_16x16x32_bf16 v[148:151], a[212:215], a[164:167], v[148:151]
buffer_load_dwordx4 v23, s[12:15], s3 offen offset:3072 lds
v_mfma_f32_16x16x32_bf16 v[152:155], a[212:215], a[168:171], v[152:155]
ds_read_b64_tr_b16 a[228:229], v26 offset:32768
ds_read_b64_tr_b16 a[230:231], v26 offset:33280
v_mfma_f32_16x16x32_bf16 v[152:155], a[216:219], a[184:187], v[152:155]
ds_read_b64_tr_b16 a[232:233], v26 offset:49152
ds_read_b64_tr_b16 a[234:235], v26 offset:49664
v_mfma_f32_16x16x32_bf16 v[156:159], a[216:219], a[188:191], v[156:159]
ds_read_b128 a[128:131], v40 offset:4096
ds_read_b128 a[144:147], v40 offset:5120
v_mfma_f32_16x16x32_bf16 v[156:159], a[212:215], a[172:175], v[156:159]
ds_read_b128 a[132:135], v40 offset:20480
s_waitcnt lgkmcnt(7)
v_mfma_f32_16x16x32_bf16 v[160:163], a[220:223], a[160:163], v[160:163]
ds_read_b128 a[148:151], v40 offset:21504
ds_read_b128 a[136:139], v40 offset:36864
v_mfma_f32_16x16x32_bf16 v[160:163], a[224:227], a[176:179], v[160:163]
ds_read_b128 a[152:155], v40 offset:37888
ds_read_b128 a[140:143], v40 offset:53248
v_mfma_f32_16x16x32_bf16 v[164:167], a[224:227], a[180:183], v[164:167]
ds_read_b128 a[156:159], v40 offset:54272
ds_read_b64_tr_b16 a[236:237], v27 offset:32768
v_mfma_f32_16x16x32_bf16 v[164:167], a[220:223], a[164:167], v[164:167]
ds_read_b64_tr_b16 a[238:239], v27 offset:33280
ds_read_b64_tr_b16 a[240:241], v27 offset:49152
v_mfma_f32_16x16x32_bf16 v[168:171], a[220:223], a[168:171], v[168:171]
ds_read_b64_tr_b16 a[242:243], v27 offset:49664
s_add_u32 s45, s45, 524288
v_mfma_f32_16x16x32_bf16 v[168:171], a[224:227], a[184:187], v[168:171]
s_and_b32 s45, s45, 0x3fffff
v_accvgpr_read_b32 v44, a248
v_mfma_f32_16x16x32_bf16 v[172:175], a[224:227], a[188:191], v[172:175]
v_accvgpr_read_b32 v45, a249
v_accvgpr_read_b32 v46, a250
v_mfma_f32_16x16x32_bf16 v[172:175], a[220:223], a[172:175], v[172:175]
v_accvgpr_read_b32 v47, a251
s_waitcnt lgkmcnt(12)
v_mfma_f32_16x16x32_bf16 v[176:179], a[228:231], a[160:163], v[176:179]
v_accvgpr_read_b32 v48, a252
v_accvgpr_read_b32 v49, a253
v_mfma_f32_16x16x32_bf16 v[176:179], a[232:235], a[176:179], v[176:179]
v_accvgpr_read_b32 v50, a254
v_accvgpr_read_b32 v51, a255
v_mfma_f32_16x16x32_bf16 v[180:183], a[232:235], a[180:183], v[180:183]
s_waitcnt vmcnt(8)
ds_read_b64_tr_b16 a[212:213], v24 offset:0
v_mfma_f32_16x16x32_bf16 v[180:183], a[228:231], a[164:167], v[180:183]
ds_read_b64_tr_b16 a[214:215], v24 offset:512
ds_read_b64_tr_b16 a[216:217], v24 offset:16384
v_mfma_f32_16x16x32_bf16 v[184:187], a[228:231], a[168:171], v[184:187]
ds_read_b64_tr_b16 a[218:219], v24 offset:16896
v_lshlrev_b32 v42, 16, v41
v_mfma_f32_16x16x32_bf16 v[184:187], a[232:235], a[184:187], v[184:187]
v_and_b32 v43, 0xffff0000, v41
v_mul_f32 v52, 0xbfb8aa3b, v42
v_mfma_f32_16x16x32_bf16 v[188:191], a[232:235], a[188:191], v[188:191]
v_mul_f32 v53, 0xbfb8aa3b, v43
v_exp_f32 v52, v52
v_mfma_f32_16x16x32_bf16 v[188:191], a[228:231], a[172:175], v[188:191]
v_exp_f32 v53, v53
s_waitcnt lgkmcnt(4)
v_mfma_f32_16x16x32_bf16 v[192:195], a[236:239], a[160:163], v[192:195]
s_add_u32 m0, s39, 32768
v_add_f32 v52, 1.0, v52
v_mfma_f32_16x16x32_bf16 v[192:195], a[240:243], a[176:179], v[192:195]
buffer_load_dwordx4 v16, s[12:15], s45 offen offset:0 lds
v_mfma_f32_16x16x32_bf16 v[196:199], a[240:243], a[180:183], v[196:199]
buffer_load_dwordx4 v17, s[12:15], s45 offen offset:1024 lds
v_mfma_f32_16x16x32_bf16 v[196:199], a[236:239], a[164:167], v[196:199]
buffer_load_dwordx4 v18, s[12:15], s45 offen offset:2048 lds
v_mfma_f32_16x16x32_bf16 v[200:203], a[236:239], a[168:171], v[200:203]
buffer_load_dwordx4 v19, s[12:15], s45 offen offset:3072 lds
v_mfma_f32_16x16x32_bf16 v[200:203], a[240:243], a[184:187], v[200:203]
ds_read_b64_tr_b16 a[220:221], v25 offset:0
ds_read_b64_tr_b16 a[222:223], v25 offset:512
v_mfma_f32_16x16x32_bf16 v[204:207], a[240:243], a[188:191], v[204:207]
ds_read_b64_tr_b16 a[224:225], v25 offset:16384
ds_read_b64_tr_b16 a[226:227], v25 offset:16896
v_mfma_f32_16x16x32_bf16 v[204:207], a[236:239], a[172:175], v[204:207]
s_add_u32 m0, s39, 49152
s_waitcnt lgkmcnt(4)
v_mfma_f32_16x16x32_bf16 v[80:83], a[212:215], a[128:131], v[80:83]
buffer_load_dwordx4 v20, s[12:15], s45 offen offset:0 lds
v_mfma_f32_16x16x32_bf16 v[80:83], a[216:219], a[144:147], v[80:83]
buffer_load_dwordx4 v21, s[12:15], s45 offen offset:1024 lds
v_mfma_f32_16x16x32_bf16 v[84:87], a[216:219], a[148:151], v[84:87]
buffer_load_dwordx4 v22, s[12:15], s45 offen offset:2048 lds
v_mfma_f32_16x16x32_bf16 v[84:87], a[212:215], a[132:135], v[84:87]
buffer_load_dwordx4 v23, s[12:15], s45 offen offset:3072 lds
v_mfma_f32_16x16x32_bf16 v[88:91], a[212:215], a[136:139], v[88:91]
ds_read_b64_tr_b16 a[228:229], v26 offset:0
ds_read_b64_tr_b16 a[230:231], v26 offset:512
v_mfma_f32_16x16x32_bf16 v[88:91], a[216:219], a[152:155], v[88:91]
ds_read_b64_tr_b16 a[232:233], v26 offset:16384
ds_read_b64_tr_b16 a[234:235], v26 offset:16896
v_mfma_f32_16x16x32_bf16 v[92:95], a[216:219], a[156:159], v[92:95]
s_add_u32 s3, s45, 128
v_add_f32 v53, 1.0, v53
v_mfma_f32_16x16x32_bf16 v[92:95], a[212:215], a[140:143], v[92:95]
v_rcp_f32 v52, v52
s_waitcnt lgkmcnt(4)
v_mfma_f32_16x16x32_bf16 v[96:99], a[220:223], a[128:131], v[96:99]
v_rcp_f32 v53, v53
v_mul_f32 v42, v42, v52
v_mfma_f32_16x16x32_bf16 v[96:99], a[224:227], a[144:147], v[96:99]
v_mul_f32 v43, v43, v53
v_cvt_pk_bf16_f32 v41, v42, v43
v_mfma_f32_16x16x32_bf16 v[100:103], a[224:227], a[148:151], v[100:103]
ds_read_b64_tr_b16 a[236:237], v27 offset:0
ds_read_b64_tr_b16 a[238:239], v27 offset:512
v_mfma_f32_16x16x32_bf16 v[100:103], a[220:223], a[132:135], v[100:103]
ds_read_b64_tr_b16 a[240:241], v27 offset:16384
ds_read_b64_tr_b16 a[242:243], v27 offset:16896
v_mfma_f32_16x16x32_bf16 v[104:107], a[220:223], a[136:139], v[104:107]
v_lshlrev_b32 v42, 16, v41
v_and_b32 v43, 0xffff0000, v41
v_mfma_f32_16x16x32_bf16 v[104:107], a[224:227], a[152:155], v[104:107]
v_lshlrev_b32 v52, 16, v44
v_and_b32 v53, 0xffff0000, v44
v_mfma_f32_16x16x32_bf16 v[108:111], a[224:227], a[156:159], v[108:111]
v_mul_f32 v54, v52, v42
v_mul_f32 v55, v53, v42
v_mfma_f32_16x16x32_bf16 v[108:111], a[220:223], a[140:143], v[108:111]
v_lshlrev_b32 v52, 16, v45
s_waitcnt lgkmcnt(4)
v_mfma_f32_16x16x32_bf16 v[112:115], a[228:231], a[128:131], v[112:115]
v_and_b32 v53, 0xffff0000, v45
v_mul_f32 v56, v52, v42
v_mfma_f32_16x16x32_bf16 v[112:115], a[232:235], a[144:147], v[112:115]
v_mul_f32 v57, v53, v42
v_lshlrev_b32 v52, 16, v46
v_mfma_f32_16x16x32_bf16 v[116:119], a[232:235], a[148:151], v[116:119]
s_waitcnt vmcnt(8)
ds_read_b64_tr_b16 a[212:213], v28 offset:0
v_mfma_f32_16x16x32_bf16 v[116:119], a[228:231], a[132:135], v[116:119]
ds_read_b64_tr_b16 a[214:215], v28 offset:512
ds_read_b64_tr_b16 a[216:217], v28 offset:16384
v_mfma_f32_16x16x32_bf16 v[120:123], a[228:231], a[136:139], v[120:123]
ds_read_b64_tr_b16 a[218:219], v28 offset:16896
v_and_b32 v53, 0xffff0000, v46
v_mfma_f32_16x16x32_bf16 v[120:123], a[232:235], a[152:155], v[120:123]
v_mul_f32 v58, v52, v42
v_mul_f32 v59, v53, v42
v_mfma_f32_16x16x32_bf16 v[124:127], a[232:235], a[156:159], v[124:127]
v_lshlrev_b32 v52, 16, v47
v_and_b32 v53, 0xffff0000, v47
v_mfma_f32_16x16x32_bf16 v[124:127], a[228:231], a[140:143], v[124:127]
v_mul_f32 v60, v52, v42
s_waitcnt lgkmcnt(4)
v_mfma_f32_16x16x32_bf16 v[128:131], a[236:239], a[128:131], v[128:131]
s_add_u32 m0, s39, 0
v_mul_f32 v61, v53, v42
v_mfma_f32_16x16x32_bf16 v[128:131], a[240:243], a[144:147], v[128:131]
buffer_load_dwordx4 v16, s[12:15], s3 offen offset:0 lds
v_mfma_f32_16x16x32_bf16 v[132:135], a[240:243], a[148:151], v[132:135]
buffer_load_dwordx4 v17, s[12:15], s3 offen offset:1024 lds
v_mfma_f32_16x16x32_bf16 v[132:135], a[236:239], a[132:135], v[132:135]
buffer_load_dwordx4 v18, s[12:15], s3 offen offset:2048 lds
v_mfma_f32_16x16x32_bf16 v[136:139], a[236:239], a[136:139], v[136:139]
buffer_load_dwordx4 v19, s[12:15], s3 offen offset:3072 lds
v_mfma_f32_16x16x32_bf16 v[136:139], a[240:243], a[152:155], v[136:139]
ds_read_b64_tr_b16 a[220:221], v29 offset:0
ds_read_b64_tr_b16 a[222:223], v29 offset:512
v_mfma_f32_16x16x32_bf16 v[140:143], a[240:243], a[156:159], v[140:143]
ds_read_b64_tr_b16 a[224:225], v29 offset:16384
ds_read_b64_tr_b16 a[226:227], v29 offset:16896
v_mfma_f32_16x16x32_bf16 v[140:143], a[236:239], a[140:143], v[140:143]
s_add_u32 m0, s39, 16384
s_waitcnt lgkmcnt(4)
v_mfma_f32_16x16x32_bf16 v[144:147], a[212:215], a[128:131], v[144:147]
buffer_load_dwordx4 v20, s[12:15], s3 offen offset:0 lds
v_mfma_f32_16x16x32_bf16 v[144:147], a[216:219], a[144:147], v[144:147]
buffer_load_dwordx4 v21, s[12:15], s3 offen offset:1024 lds
v_mfma_f32_16x16x32_bf16 v[148:151], a[216:219], a[148:151], v[148:151]
buffer_load_dwordx4 v22, s[12:15], s3 offen offset:2048 lds
v_mfma_f32_16x16x32_bf16 v[148:151], a[212:215], a[132:135], v[148:151]
buffer_load_dwordx4 v23, s[12:15], s3 offen offset:3072 lds
v_mfma_f32_16x16x32_bf16 v[152:155], a[212:215], a[136:139], v[152:155]
ds_read_b64_tr_b16 a[228:229], v30 offset:0
ds_read_b64_tr_b16 a[230:231], v30 offset:512
v_mfma_f32_16x16x32_bf16 v[152:155], a[216:219], a[152:155], v[152:155]
ds_read_b64_tr_b16 a[232:233], v30 offset:16384
ds_read_b64_tr_b16 a[234:235], v30 offset:16896
v_mfma_f32_16x16x32_bf16 v[156:159], a[216:219], a[156:159], v[156:159]
ds_read_b128 a[160:163], v40 offset:6144
ds_read_b128 a[176:179], v40 offset:7168
v_mfma_f32_16x16x32_bf16 v[156:159], a[212:215], a[140:143], v[156:159]
ds_read_b128 a[164:167], v40 offset:22528
s_waitcnt lgkmcnt(7)
v_mfma_f32_16x16x32_bf16 v[160:163], a[220:223], a[128:131], v[160:163]
ds_read_b128 a[180:183], v40 offset:23552
ds_read_b128 a[168:171], v40 offset:38912
v_mfma_f32_16x16x32_bf16 v[160:163], a[224:227], a[144:147], v[160:163]
ds_read_b128 a[184:187], v40 offset:39936
ds_read_b128 a[172:175], v40 offset:55296
v_mfma_f32_16x16x32_bf16 v[164:167], a[224:227], a[148:151], v[164:167]
ds_read_b128 a[188:191], v40 offset:56320
ds_read_b64_tr_b16 a[236:237], v31 offset:0
v_mfma_f32_16x16x32_bf16 v[164:167], a[220:223], a[132:135], v[164:167]
ds_read_b64_tr_b16 a[238:239], v31 offset:512
ds_read_b64_tr_b16 a[240:241], v31 offset:16384
v_mfma_f32_16x16x32_bf16 v[168:171], a[220:223], a[136:139], v[168:171]
ds_read_b64_tr_b16 a[242:243], v31 offset:16896
s_add_u32 s45, s45, 524288
v_mfma_f32_16x16x32_bf16 v[168:171], a[224:227], a[152:155], v[168:171]
s_and_b32 s45, s45, 0x3fffff
v_lshlrev_b32 v52, 16, v48
v_mfma_f32_16x16x32_bf16 v[172:175], a[224:227], a[156:159], v[172:175]
v_and_b32 v53, 0xffff0000, v48
v_fmac_f32 v54, v52, v43
v_mfma_f32_16x16x32_bf16 v[172:175], a[220:223], a[140:143], v[172:175]
v_fmac_f32 v55, v53, v43
s_waitcnt lgkmcnt(12)
v_mfma_f32_16x16x32_bf16 v[176:179], a[228:231], a[128:131], v[176:179]
v_lshlrev_b32 v52, 16, v49
v_and_b32 v53, 0xffff0000, v49
v_mfma_f32_16x16x32_bf16 v[176:179], a[232:235], a[144:147], v[176:179]
v_fmac_f32 v56, v52, v43
v_fmac_f32 v57, v53, v43
v_mfma_f32_16x16x32_bf16 v[180:183], a[232:235], a[148:151], v[180:183]
s_waitcnt vmcnt(8)
ds_read_b64_tr_b16 a[212:213], v24 offset:32768
v_mfma_f32_16x16x32_bf16 v[180:183], a[228:231], a[132:135], v[180:183]
ds_read_b64_tr_b16 a[214:215], v24 offset:33280
ds_read_b64_tr_b16 a[216:217], v24 offset:49152
v_mfma_f32_16x16x32_bf16 v[184:187], a[228:231], a[136:139], v[184:187]
ds_read_b64_tr_b16 a[218:219], v24 offset:49664
v_lshlrev_b32 v52, 16, v50
v_mfma_f32_16x16x32_bf16 v[184:187], a[232:235], a[152:155], v[184:187]
v_and_b32 v53, 0xffff0000, v50
v_fmac_f32 v58, v52, v43
v_mfma_f32_16x16x32_bf16 v[188:191], a[232:235], a[156:159], v[188:191]
v_fmac_f32 v59, v53, v43
v_lshlrev_b32 v52, 16, v51
v_mfma_f32_16x16x32_bf16 v[188:191], a[228:231], a[140:143], v[188:191]
v_and_b32 v53, 0xffff0000, v51
s_waitcnt lgkmcnt(4)
v_mfma_f32_16x16x32_bf16 v[192:195], a[236:239], a[128:131], v[192:195]
s_add_u32 m0, s39, 65536
v_fmac_f32 v60, v52, v43
v_mfma_f32_16x16x32_bf16 v[192:195], a[240:243], a[144:147], v[192:195]
buffer_load_dwordx4 v16, s[12:15], s45 offen offset:0 lds
v_mfma_f32_16x16x32_bf16 v[196:199], a[240:243], a[148:151], v[196:199]
buffer_load_dwordx4 v17, s[12:15], s45 offen offset:1024 lds
v_mfma_f32_16x16x32_bf16 v[196:199], a[236:239], a[132:135], v[196:199]
buffer_load_dwordx4 v18, s[12:15], s45 offen offset:2048 lds
v_mfma_f32_16x16x32_bf16 v[200:203], a[236:239], a[136:139], v[200:203]
buffer_load_dwordx4 v19, s[12:15], s45 offen offset:3072 lds
v_mfma_f32_16x16x32_bf16 v[200:203], a[240:243], a[152:155], v[200:203]
ds_read_b64_tr_b16 a[220:221], v25 offset:32768
ds_read_b64_tr_b16 a[222:223], v25 offset:33280
v_mfma_f32_16x16x32_bf16 v[204:207], a[240:243], a[156:159], v[204:207]
ds_read_b64_tr_b16 a[224:225], v25 offset:49152
ds_read_b64_tr_b16 a[226:227], v25 offset:49664
v_mfma_f32_16x16x32_bf16 v[204:207], a[236:239], a[140:143], v[204:207]
s_add_u32 m0, s39, 81920
s_waitcnt lgkmcnt(4)
v_mfma_f32_16x16x32_bf16 v[80:83], a[212:215], a[160:163], v[80:83]
buffer_load_dwordx4 v20, s[12:15], s45 offen offset:0 lds
v_mfma_f32_16x16x32_bf16 v[80:83], a[216:219], a[176:179], v[80:83]
buffer_load_dwordx4 v21, s[12:15], s45 offen offset:1024 lds
v_mfma_f32_16x16x32_bf16 v[84:87], a[216:219], a[180:183], v[84:87]
buffer_load_dwordx4 v22, s[12:15], s45 offen offset:2048 lds
v_mfma_f32_16x16x32_bf16 v[84:87], a[212:215], a[164:167], v[84:87]
buffer_load_dwordx4 v23, s[12:15], s45 offen offset:3072 lds
v_mfma_f32_16x16x32_bf16 v[88:91], a[212:215], a[168:171], v[88:91]
ds_read_b64_tr_b16 a[228:229], v26 offset:32768
ds_read_b64_tr_b16 a[230:231], v26 offset:33280
v_mfma_f32_16x16x32_bf16 v[88:91], a[216:219], a[184:187], v[88:91]
ds_read_b64_tr_b16 a[232:233], v26 offset:49152
ds_read_b64_tr_b16 a[234:235], v26 offset:49664
v_mfma_f32_16x16x32_bf16 v[92:95], a[216:219], a[188:191], v[92:95]
s_add_u32 s3, s45, 128
v_fmac_f32 v61, v53, v43
v_mfma_f32_16x16x32_bf16 v[92:95], a[212:215], a[172:175], v[92:95]
s_nop 0
s_waitcnt lgkmcnt(4)
v_mfma_f32_16x16x32_bf16 v[96:99], a[220:223], a[160:163], v[96:99]
v_permlane32_swap_b32 v54, v55
v_permlane32_swap_b32 v56, v57
v_mfma_f32_16x16x32_bf16 v[96:99], a[224:227], a[176:179], v[96:99]
v_permlane32_swap_b32 v58, v59
v_permlane32_swap_b32 v60, v61
v_mfma_f32_16x16x32_bf16 v[100:103], a[224:227], a[180:183], v[100:103]
ds_read_b64_tr_b16 a[236:237], v27 offset:32768
ds_read_b64_tr_b16 a[238:239], v27 offset:33280
v_mfma_f32_16x16x32_bf16 v[100:103], a[220:223], a[164:167], v[100:103]
ds_read_b64_tr_b16 a[240:241], v27 offset:49152
ds_read_b64_tr_b16 a[242:243], v27 offset:49664
v_mfma_f32_16x16x32_bf16 v[104:107], a[220:223], a[168:171], v[104:107]
v_add_f32 v54, v54, v55
v_add_f32 v56, v56, v57
v_mfma_f32_16x16x32_bf16 v[104:107], a[224:227], a[184:187], v[104:107]
v_add_f32 v58, v58, v59
v_add_f32 v60, v60, v61
v_mfma_f32_16x16x32_bf16 v[108:111], a[224:227], a[188:191], v[108:111]
s_nop 0
v_permlane16_swap_b32 v54, v56
v_mfma_f32_16x16x32_bf16 v[108:111], a[220:223], a[172:175], v[108:111]
v_permlane16_swap_b32 v58, v60
s_waitcnt lgkmcnt(4)
v_mfma_f32_16x16x32_bf16 v[112:115], a[228:231], a[160:163], v[112:115]
v_add_f32 v62, v54, v56
v_add_f32 v63, v58, v60
v_mfma_f32_16x16x32_bf16 v[112:115], a[232:235], a[176:179], v[112:115]
s_nop 0
v_add_f32_dpp v62, v62, v62 row_ror:8 row_mask:0xf bank_mask:0xf
v_mfma_f32_16x16x32_bf16 v[116:119], a[232:235], a[180:183], v[116:119]
s_waitcnt vmcnt(8)
ds_read_b64_tr_b16 a[212:213], v24 offset:0
v_mfma_f32_16x16x32_bf16 v[116:119], a[228:231], a[164:167], v[116:119]
ds_read_b64_tr_b16 a[214:215], v24 offset:512
ds_read_b64_tr_b16 a[216:217], v24 offset:16384
v_mfma_f32_16x16x32_bf16 v[120:123], a[228:231], a[168:171], v[120:123]
ds_read_b64_tr_b16 a[218:219], v24 offset:16896
v_add_f32_dpp v63, v63, v63 row_ror:8 row_mask:0xf bank_mask:0xf
v_mfma_f32_16x16x32_bf16 v[120:123], a[232:235], a[184:187], v[120:123]
s_nop 0
v_add_f32_dpp v62, v62, v62 row_ror:4 row_mask:0xf bank_mask:0xf
v_mfma_f32_16x16x32_bf16 v[124:127], a[232:235], a[188:191], v[124:127]
v_add_f32_dpp v63, v63, v63 row_ror:4 row_mask:0xf bank_mask:0xf
s_nop 0
v_mfma_f32_16x16x32_bf16 v[124:127], a[228:231], a[172:175], v[124:127]
v_add_f32_dpp v62, v62, v62 row_ror:2 row_mask:0xf bank_mask:0xf
s_waitcnt lgkmcnt(4)
v_mfma_f32_16x16x32_bf16 v[128:131], a[236:239], a[160:163], v[128:131]
s_add_u32 m0, s39, 32768
v_add_f32_dpp v63, v63, v63 row_ror:2 row_mask:0xf bank_mask:0xf
v_mfma_f32_16x16x32_bf16 v[128:131], a[240:243], a[176:179], v[128:131]
buffer_load_dwordx4 v16, s[12:15], s3 offen offset:0 lds
v_mfma_f32_16x16x32_bf16 v[132:135], a[240:243], a[180:183], v[132:135]
buffer_load_dwordx4 v17, s[12:15], s3 offen offset:1024 lds
v_mfma_f32_16x16x32_bf16 v[132:135], a[236:239], a[164:167], v[132:135]
buffer_load_dwordx4 v18, s[12:15], s3 offen offset:2048 lds
v_mfma_f32_16x16x32_bf16 v[136:139], a[236:239], a[168:171], v[136:139]
buffer_load_dwordx4 v19, s[12:15], s3 offen offset:3072 lds
v_mfma_f32_16x16x32_bf16 v[136:139], a[240:243], a[184:187], v[136:139]
ds_read_b64_tr_b16 a[220:221], v25 offset:0
ds_read_b64_tr_b16 a[222:223], v25 offset:512
v_mfma_f32_16x16x32_bf16 v[140:143], a[240:243], a[188:191], v[140:143]
ds_read_b64_tr_b16 a[224:225], v25 offset:16384
ds_read_b64_tr_b16 a[226:227], v25 offset:16896
v_mfma_f32_16x16x32_bf16 v[140:143], a[236:239], a[172:175], v[140:143]
s_add_u32 m0, s39, 49152
s_waitcnt lgkmcnt(4)
v_mfma_f32_16x16x32_bf16 v[144:147], a[212:215], a[160:163], v[144:147]
buffer_load_dwordx4 v20, s[12:15], s3 offen offset:0 lds
v_mfma_f32_16x16x32_bf16 v[144:147], a[216:219], a[176:179], v[144:147]
buffer_load_dwordx4 v21, s[12:15], s3 offen offset:1024 lds
v_mfma_f32_16x16x32_bf16 v[148:151], a[216:219], a[180:183], v[148:151]
buffer_load_dwordx4 v22, s[12:15], s3 offen offset:2048 lds
v_mfma_f32_16x16x32_bf16 v[148:151], a[212:215], a[164:167], v[148:151]
buffer_load_dwordx4 v23, s[12:15], s3 offen offset:3072 lds
v_mfma_f32_16x16x32_bf16 v[152:155], a[212:215], a[168:171], v[152:155]
ds_read_b64_tr_b16 a[228:229], v26 offset:0
ds_read_b64_tr_b16 a[230:231], v26 offset:512
v_mfma_f32_16x16x32_bf16 v[152:155], a[216:219], a[184:187], v[152:155]
ds_read_b64_tr_b16 a[232:233], v26 offset:16384
ds_read_b64_tr_b16 a[234:235], v26 offset:16896
v_mfma_f32_16x16x32_bf16 v[156:159], a[216:219], a[188:191], v[156:159]
ds_read_b128 a[128:131], v40 offset:8192
ds_read_b128 a[144:147], v40 offset:9216
v_mfma_f32_16x16x32_bf16 v[156:159], a[212:215], a[172:175], v[156:159]
ds_read_b128 a[132:135], v40 offset:24576
s_waitcnt lgkmcnt(7)
v_mfma_f32_16x16x32_bf16 v[160:163], a[220:223], a[160:163], v[160:163]
ds_read_b128 a[148:151], v40 offset:25600
ds_read_b128 a[136:139], v40 offset:40960
v_mfma_f32_16x16x32_bf16 v[160:163], a[224:227], a[176:179], v[160:163]
ds_read_b128 a[152:155], v40 offset:41984
ds_read_b128 a[140:143], v40 offset:57344
v_mfma_f32_16x16x32_bf16 v[164:167], a[224:227], a[180:183], v[164:167]
ds_read_b128 a[156:159], v40 offset:58368
ds_read_b64_tr_b16 a[236:237], v27 offset:0
v_mfma_f32_16x16x32_bf16 v[164:167], a[220:223], a[164:167], v[164:167]
ds_read_b64_tr_b16 a[238:239], v27 offset:512
ds_read_b64_tr_b16 a[240:241], v27 offset:16384
v_mfma_f32_16x16x32_bf16 v[168:171], a[220:223], a[168:171], v[168:171]
ds_read_b64_tr_b16 a[242:243], v27 offset:16896
s_add_u32 s45, s45, 524288
v_mfma_f32_16x16x32_bf16 v[168:171], a[224:227], a[184:187], v[168:171]
s_and_b32 s45, s45, 0x3fffff
s_nop 0
v_mfma_f32_16x16x32_bf16 v[172:175], a[224:227], a[188:191], v[172:175]
v_add_f32_dpp v62, v62, v62 row_ror:1 row_mask:0xf bank_mask:0xf
v_add_f32_dpp v63, v63, v63 row_ror:1 row_mask:0xf bank_mask:0xf
v_mfma_f32_16x16x32_bf16 v[172:175], a[220:223], a[172:175], v[172:175]
v_mov_b32 v14, v62
s_waitcnt lgkmcnt(12)
v_mfma_f32_16x16x32_bf16 v[176:179], a[228:231], a[160:163], v[176:179]
v_mov_b32 v15, v63
v_mfma_f32_16x16x32_bf16 v[176:179], a[232:235], a[176:179], v[176:179]
v_mfma_f32_16x16x32_bf16 v[180:183], a[232:235], a[180:183], v[180:183]
s_waitcnt vmcnt(8)
ds_read_b64_tr_b16 a[212:213], v28 offset:0
v_mfma_f32_16x16x32_bf16 v[180:183], a[228:231], a[164:167], v[180:183]
ds_read_b64_tr_b16 a[214:215], v28 offset:512
ds_read_b64_tr_b16 a[216:217], v28 offset:16384
v_mfma_f32_16x16x32_bf16 v[184:187], a[228:231], a[168:171], v[184:187]
ds_read_b64_tr_b16 a[218:219], v28 offset:16896
v_mfma_f32_16x16x32_bf16 v[184:187], a[232:235], a[184:187], v[184:187]
v_mfma_f32_16x16x32_bf16 v[188:191], a[232:235], a[188:191], v[188:191]
v_mfma_f32_16x16x32_bf16 v[188:191], a[228:231], a[172:175], v[188:191]
s_waitcnt lgkmcnt(4)
v_mfma_f32_16x16x32_bf16 v[192:195], a[236:239], a[160:163], v[192:195]
s_add_u32 m0, s39, 0
v_mfma_f32_16x16x32_bf16 v[192:195], a[240:243], a[176:179], v[192:195]
buffer_load_dwordx4 v16, s[12:15], s45 offen offset:0 lds
v_mfma_f32_16x16x32_bf16 v[196:199], a[240:243], a[180:183], v[196:199]
buffer_load_dwordx4 v17, s[12:15], s45 offen offset:1024 lds
v_mfma_f32_16x16x32_bf16 v[196:199], a[236:239], a[164:167], v[196:199]
buffer_load_dwordx4 v18, s[12:15], s45 offen offset:2048 lds
v_mfma_f32_16x16x32_bf16 v[200:203], a[236:239], a[168:171], v[200:203]
buffer_load_dwordx4 v19, s[12:15], s45 offen offset:3072 lds
v_mfma_f32_16x16x32_bf16 v[200:203], a[240:243], a[184:187], v[200:203]
ds_read_b64_tr_b16 a[220:221], v29 offset:0
ds_read_b64_tr_b16 a[222:223], v29 offset:512
v_mfma_f32_16x16x32_bf16 v[204:207], a[240:243], a[188:191], v[204:207]
ds_read_b64_tr_b16 a[224:225], v29 offset:16384
ds_read_b64_tr_b16 a[226:227], v29 offset:16896
v_mfma_f32_16x16x32_bf16 v[204:207], a[236:239], a[172:175], v[204:207]
s_add_u32 m0, s39, 16384
s_waitcnt lgkmcnt(4)
v_mfma_f32_16x16x32_bf16 v[80:83], a[212:215], a[128:131], v[80:83]
buffer_load_dwordx4 v20, s[12:15], s45 offen offset:0 lds
v_mfma_f32_16x16x32_bf16 v[80:83], a[216:219], a[144:147], v[80:83]
buffer_load_dwordx4 v21, s[12:15], s45 offen offset:1024 lds
v_mfma_f32_16x16x32_bf16 v[84:87], a[216:219], a[148:151], v[84:87]
buffer_load_dwordx4 v22, s[12:15], s45 offen offset:2048 lds
v_mfma_f32_16x16x32_bf16 v[84:87], a[212:215], a[132:135], v[84:87]
buffer_load_dwordx4 v23, s[12:15], s45 offen offset:3072 lds
v_mfma_f32_16x16x32_bf16 v[88:91], a[212:215], a[136:139], v[88:91]
ds_read_b64_tr_b16 a[228:229], v30 offset:0
ds_read_b64_tr_b16 a[230:231], v30 offset:512
v_mfma_f32_16x16x32_bf16 v[88:91], a[216:219], a[152:155], v[88:91]
ds_read_b64_tr_b16 a[232:233], v30 offset:16384
ds_read_b64_tr_b16 a[234:235], v30 offset:16896
v_mfma_f32_16x16x32_bf16 v[92:95], a[216:219], a[156:159], v[92:95]
s_add_u32 s3, s45, 128
v_mfma_f32_16x16x32_bf16 v[92:95], a[212:215], a[140:143], v[92:95]
s_waitcnt lgkmcnt(4)
v_mfma_f32_16x16x32_bf16 v[96:99], a[220:223], a[128:131], v[96:99]
v_mfma_f32_16x16x32_bf16 v[96:99], a[224:227], a[144:147], v[96:99]
v_mfma_f32_16x16x32_bf16 v[100:103], a[224:227], a[148:151], v[100:103]
ds_read_b64_tr_b16 a[236:237], v31 offset:0
ds_read_b64_tr_b16 a[238:239], v31 offset:512
v_mfma_f32_16x16x32_bf16 v[100:103], a[220:223], a[132:135], v[100:103]
ds_read_b64_tr_b16 a[240:241], v31 offset:16384
ds_read_b64_tr_b16 a[242:243], v31 offset:16896
v_mfma_f32_16x16x32_bf16 v[104:107], a[220:223], a[136:139], v[104:107]
v_mfma_f32_16x16x32_bf16 v[104:107], a[224:227], a[152:155], v[104:107]
v_mfma_f32_16x16x32_bf16 v[108:111], a[224:227], a[156:159], v[108:111]
v_mfma_f32_16x16x32_bf16 v[108:111], a[220:223], a[140:143], v[108:111]
s_waitcnt lgkmcnt(4)
v_mfma_f32_16x16x32_bf16 v[112:115], a[228:231], a[128:131], v[112:115]
v_mfma_f32_16x16x32_bf16 v[112:115], a[232:235], a[144:147], v[112:115]
v_mfma_f32_16x16x32_bf16 v[116:119], a[232:235], a[148:151], v[116:119]
s_waitcnt vmcnt(8)
ds_read_b64_tr_b16 a[212:213], v24 offset:32768
v_mfma_f32_16x16x32_bf16 v[116:119], a[228:231], a[132:135], v[116:119]
ds_read_b64_tr_b16 a[214:215], v24 offset:33280
ds_read_b64_tr_b16 a[216:217], v24 offset:49152
v_mfma_f32_16x16x32_bf16 v[120:123], a[228:231], a[136:139], v[120:123]
ds_read_b64_tr_b16 a[218:219], v24 offset:49664
v_mfma_f32_16x16x32_bf16 v[120:123], a[232:235], a[152:155], v[120:123]
v_mfma_f32_16x16x32_bf16 v[124:127], a[232:235], a[156:159], v[124:127]
v_mfma_f32_16x16x32_bf16 v[124:127], a[228:231], a[140:143], v[124:127]
s_waitcnt lgkmcnt(4)
v_mfma_f32_16x16x32_bf16 v[128:131], a[236:239], a[128:131], v[128:131]
s_add_u32 m0, s39, 65536
v_mfma_f32_16x16x32_bf16 v[128:131], a[240:243], a[144:147], v[128:131]
buffer_load_dwordx4 v16, s[12:15], s3 offen offset:0 lds
v_mfma_f32_16x16x32_bf16 v[132:135], a[240:243], a[148:151], v[132:135]
buffer_load_dwordx4 v17, s[12:15], s3 offen offset:1024 lds
v_mfma_f32_16x16x32_bf16 v[132:135], a[236:239], a[132:135], v[132:135]
buffer_load_dwordx4 v18, s[12:15], s3 offen offset:2048 lds
v_mfma_f32_16x16x32_bf16 v[136:139], a[236:239], a[136:139], v[136:139]
buffer_load_dwordx4 v19, s[12:15], s3 offen offset:3072 lds
v_mfma_f32_16x16x32_bf16 v[136:139], a[240:243], a[152:155], v[136:139]
ds_read_b64_tr_b16 a[220:221], v25 offset:32768
ds_read_b64_tr_b16 a[222:223], v25 offset:33280
v_mfma_f32_16x16x32_bf16 v[140:143], a[240:243], a[156:159], v[140:143]
ds_read_b64_tr_b16 a[224:225], v25 offset:49152
ds_read_b64_tr_b16 a[226:227], v25 offset:49664
v_mfma_f32_16x16x32_bf16 v[140:143], a[236:239], a[140:143], v[140:143]
s_add_u32 m0, s39, 81920
s_waitcnt lgkmcnt(4)
v_mfma_f32_16x16x32_bf16 v[144:147], a[212:215], a[128:131], v[144:147]
buffer_load_dwordx4 v20, s[12:15], s3 offen offset:0 lds
v_mfma_f32_16x16x32_bf16 v[144:147], a[216:219], a[144:147], v[144:147]
buffer_load_dwordx4 v21, s[12:15], s3 offen offset:1024 lds
v_mfma_f32_16x16x32_bf16 v[148:151], a[216:219], a[148:151], v[148:151]
buffer_load_dwordx4 v22, s[12:15], s3 offen offset:2048 lds
v_mfma_f32_16x16x32_bf16 v[148:151], a[212:215], a[132:135], v[148:151]
buffer_load_dwordx4 v23, s[12:15], s3 offen offset:3072 lds
v_mfma_f32_16x16x32_bf16 v[152:155], a[212:215], a[136:139], v[152:155]
ds_read_b64_tr_b16 a[228:229], v26 offset:32768
ds_read_b64_tr_b16 a[230:231], v26 offset:33280
v_mfma_f32_16x16x32_bf16 v[152:155], a[216:219], a[152:155], v[152:155]
ds_read_b64_tr_b16 a[232:233], v26 offset:49152
ds_read_b64_tr_b16 a[234:235], v26 offset:49664
v_mfma_f32_16x16x32_bf16 v[156:159], a[216:219], a[156:159], v[156:159]
ds_read_b128 a[160:163], v40 offset:10240
ds_read_b128 a[176:179], v40 offset:11264
v_mfma_f32_16x16x32_bf16 v[156:159], a[212:215], a[140:143], v[156:159]
ds_read_b128 a[164:167], v40 offset:26624
s_waitcnt lgkmcnt(7)
v_mfma_f32_16x16x32_bf16 v[160:163], a[220:223], a[128:131], v[160:163]
ds_read_b128 a[180:183], v40 offset:27648
ds_read_b128 a[168:171], v40 offset:43008
v_mfma_f32_16x16x32_bf16 v[160:163], a[224:227], a[144:147], v[160:163]
ds_read_b128 a[184:187], v40 offset:44032
ds_read_b128 a[172:175], v40 offset:59392
v_mfma_f32_16x16x32_bf16 v[164:167], a[224:227], a[148:151], v[164:167]
ds_read_b128 a[188:191], v40 offset:60416
ds_read_b64_tr_b16 a[236:237], v27 offset:32768
v_mfma_f32_16x16x32_bf16 v[164:167], a[220:223], a[132:135], v[164:167]
ds_read_b64_tr_b16 a[238:239], v27 offset:33280
ds_read_b64_tr_b16 a[240:241], v27 offset:49152
v_mfma_f32_16x16x32_bf16 v[168:171], a[220:223], a[136:139], v[168:171]
ds_read_b64_tr_b16 a[242:243], v27 offset:49664
s_add_u32 s45, s45, 524288
v_mfma_f32_16x16x32_bf16 v[168:171], a[224:227], a[152:155], v[168:171]
s_and_b32 s45, s45, 0x3fffff
v_mfma_f32_16x16x32_bf16 v[172:175], a[224:227], a[156:159], v[172:175]
v_mfma_f32_16x16x32_bf16 v[172:175], a[220:223], a[140:143], v[172:175]
s_waitcnt lgkmcnt(12)
v_mfma_f32_16x16x32_bf16 v[176:179], a[228:231], a[128:131], v[176:179]
v_mfma_f32_16x16x32_bf16 v[176:179], a[232:235], a[144:147], v[176:179]
v_mfma_f32_16x16x32_bf16 v[180:183], a[232:235], a[148:151], v[180:183]
s_waitcnt vmcnt(8)
ds_read_b64_tr_b16 a[212:213], v24 offset:0
v_mfma_f32_16x16x32_bf16 v[180:183], a[228:231], a[132:135], v[180:183]
ds_read_b64_tr_b16 a[214:215], v24 offset:512
ds_read_b64_tr_b16 a[216:217], v24 offset:16384
v_mfma_f32_16x16x32_bf16 v[184:187], a[228:231], a[136:139], v[184:187]
ds_read_b64_tr_b16 a[218:219], v24 offset:16896
v_mfma_f32_16x16x32_bf16 v[184:187], a[232:235], a[152:155], v[184:187]
v_mfma_f32_16x16x32_bf16 v[188:191], a[232:235], a[156:159], v[188:191]
v_mfma_f32_16x16x32_bf16 v[188:191], a[228:231], a[140:143], v[188:191]
s_waitcnt lgkmcnt(4)
v_mfma_f32_16x16x32_bf16 v[192:195], a[236:239], a[128:131], v[192:195]
s_add_u32 m0, s39, 32768
v_mfma_f32_16x16x32_bf16 v[192:195], a[240:243], a[144:147], v[192:195]
buffer_load_dwordx4 v16, s[12:15], s45 offen offset:0 lds
v_mfma_f32_16x16x32_bf16 v[196:199], a[240:243], a[148:151], v[196:199]
buffer_load_dwordx4 v17, s[12:15], s45 offen offset:1024 lds
v_mfma_f32_16x16x32_bf16 v[196:199], a[236:239], a[132:135], v[196:199]
buffer_load_dwordx4 v18, s[12:15], s45 offen offset:2048 lds
v_mfma_f32_16x16x32_bf16 v[200:203], a[236:239], a[136:139], v[200:203]
buffer_load_dwordx4 v19, s[12:15], s45 offen offset:3072 lds
v_mfma_f32_16x16x32_bf16 v[200:203], a[240:243], a[152:155], v[200:203]
ds_read_b64_tr_b16 a[220:221], v25 offset:0
ds_read_b64_tr_b16 a[222:223], v25 offset:512
v_mfma_f32_16x16x32_bf16 v[204:207], a[240:243], a[156:159], v[204:207]
ds_read_b64_tr_b16 a[224:225], v25 offset:16384
ds_read_b64_tr_b16 a[226:227], v25 offset:16896
v_mfma_f32_16x16x32_bf16 v[204:207], a[236:239], a[140:143], v[204:207]
s_add_u32 m0, s39, 49152
s_waitcnt lgkmcnt(4)
v_mfma_f32_16x16x32_bf16 v[80:83], a[212:215], a[160:163], v[80:83]
buffer_load_dwordx4 v20, s[12:15], s45 offen offset:0 lds
v_mfma_f32_16x16x32_bf16 v[80:83], a[216:219], a[176:179], v[80:83]
buffer_load_dwordx4 v21, s[12:15], s45 offen offset:1024 lds
v_mfma_f32_16x16x32_bf16 v[84:87], a[216:219], a[180:183], v[84:87]
buffer_load_dwordx4 v22, s[12:15], s45 offen offset:2048 lds
v_mfma_f32_16x16x32_bf16 v[84:87], a[212:215], a[164:167], v[84:87]
buffer_load_dwordx4 v23, s[12:15], s45 offen offset:3072 lds
v_mfma_f32_16x16x32_bf16 v[88:91], a[212:215], a[168:171], v[88:91]
ds_read_b64_tr_b16 a[228:229], v26 offset:0
ds_read_b64_tr_b16 a[230:231], v26 offset:512
v_mfma_f32_16x16x32_bf16 v[88:91], a[216:219], a[184:187], v[88:91]
ds_read_b64_tr_b16 a[232:233], v26 offset:16384
ds_read_b64_tr_b16 a[234:235], v26 offset:16896
v_mfma_f32_16x16x32_bf16 v[92:95], a[216:219], a[188:191], v[92:95]
s_add_u32 s3, s45, 128
v_mfma_f32_16x16x32_bf16 v[92:95], a[212:215], a[172:175], v[92:95]
s_waitcnt lgkmcnt(4)
v_mfma_f32_16x16x32_bf16 v[96:99], a[220:223], a[160:163], v[96:99]
v_mfma_f32_16x16x32_bf16 v[96:99], a[224:227], a[176:179], v[96:99]
v_mfma_f32_16x16x32_bf16 v[100:103], a[224:227], a[180:183], v[100:103]
ds_read_b64_tr_b16 a[236:237], v27 offset:0
ds_read_b64_tr_b16 a[238:239], v27 offset:512
v_mfma_f32_16x16x32_bf16 v[100:103], a[220:223], a[164:167], v[100:103]
ds_read_b64_tr_b16 a[240:241], v27 offset:16384
ds_read_b64_tr_b16 a[242:243], v27 offset:16896
v_mfma_f32_16x16x32_bf16 v[104:107], a[220:223], a[168:171], v[104:107]
v_mfma_f32_16x16x32_bf16 v[104:107], a[224:227], a[184:187], v[104:107]
v_mfma_f32_16x16x32_bf16 v[108:111], a[224:227], a[188:191], v[108:111]
v_mfma_f32_16x16x32_bf16 v[108:111], a[220:223], a[172:175], v[108:111]
s_waitcnt lgkmcnt(4)
v_mfma_f32_16x16x32_bf16 v[112:115], a[228:231], a[160:163], v[112:115]
v_mfma_f32_16x16x32_bf16 v[112:115], a[232:235], a[176:179], v[112:115]
v_mfma_f32_16x16x32_bf16 v[116:119], a[232:235], a[180:183], v[116:119]
s_waitcnt vmcnt(8)
ds_read_b64_tr_b16 a[212:213], v28 offset:0
v_mfma_f32_16x16x32_bf16 v[116:119], a[228:231], a[164:167], v[116:119]
ds_read_b64_tr_b16 a[214:215], v28 offset:512
ds_read_b64_tr_b16 a[216:217], v28 offset:16384
v_mfma_f32_16x16x32_bf16 v[120:123], a[228:231], a[168:171], v[120:123]
ds_read_b64_tr_b16 a[218:219], v28 offset:16896
v_mfma_f32_16x16x32_bf16 v[120:123], a[232:235], a[184:187], v[120:123]
v_mfma_f32_16x16x32_bf16 v[124:127], a[232:235], a[188:191], v[124:127]
v_mfma_f32_16x16x32_bf16 v[124:127], a[228:231], a[172:175], v[124:127]
s_waitcnt lgkmcnt(4)
v_mfma_f32_16x16x32_bf16 v[128:131], a[236:239], a[160:163], v[128:131]
s_add_u32 m0, s39, 0
v_mfma_f32_16x16x32_bf16 v[128:131], a[240:243], a[176:179], v[128:131]
buffer_load_dwordx4 v16, s[12:15], s3 offen offset:0 lds
v_mfma_f32_16x16x32_bf16 v[132:135], a[240:243], a[180:183], v[132:135]
buffer_load_dwordx4 v17, s[12:15], s3 offen offset:1024 lds
v_mfma_f32_16x16x32_bf16 v[132:135], a[236:239], a[164:167], v[132:135]
buffer_load_dwordx4 v18, s[12:15], s3 offen offset:2048 lds
v_mfma_f32_16x16x32_bf16 v[136:139], a[236:239], a[168:171], v[136:139]
buffer_load_dwordx4 v19, s[12:15], s3 offen offset:3072 lds
v_mfma_f32_16x16x32_bf16 v[136:139], a[240:243], a[184:187], v[136:139]
ds_read_b64_tr_b16 a[220:221], v29 offset:0
ds_read_b64_tr_b16 a[222:223], v29 offset:512
v_mfma_f32_16x16x32_bf16 v[140:143], a[240:243], a[188:191], v[140:143]
ds_read_b64_tr_b16 a[224:225], v29 offset:16384
ds_read_b64_tr_b16 a[226:227], v29 offset:16896
v_mfma_f32_16x16x32_bf16 v[140:143], a[236:239], a[172:175], v[140:143]
s_add_u32 m0, s39, 16384
s_waitcnt lgkmcnt(4)
v_mfma_f32_16x16x32_bf16 v[144:147], a[212:215], a[160:163], v[144:147]
buffer_load_dwordx4 v20, s[12:15], s3 offen offset:0 lds
v_mfma_f32_16x16x32_bf16 v[144:147], a[216:219], a[176:179], v[144:147]
buffer_load_dwordx4 v21, s[12:15], s3 offen offset:1024 lds
v_mfma_f32_16x16x32_bf16 v[148:151], a[216:219], a[180:183], v[148:151]
buffer_load_dwordx4 v22, s[12:15], s3 offen offset:2048 lds
v_mfma_f32_16x16x32_bf16 v[148:151], a[212:215], a[164:167], v[148:151]
buffer_load_dwordx4 v23, s[12:15], s3 offen offset:3072 lds
v_mfma_f32_16x16x32_bf16 v[152:155], a[212:215], a[168:171], v[152:155]
ds_read_b64_tr_b16 a[228:229], v30 offset:0
ds_read_b64_tr_b16 a[230:231], v30 offset:512
v_mfma_f32_16x16x32_bf16 v[152:155], a[216:219], a[184:187], v[152:155]
ds_read_b64_tr_b16 a[232:233], v30 offset:16384
ds_read_b64_tr_b16 a[234:235], v30 offset:16896
v_mfma_f32_16x16x32_bf16 v[156:159], a[216:219], a[188:191], v[156:159]
ds_read_b128 a[128:131], v40 offset:12288
ds_read_b128 a[144:147], v40 offset:13312
v_mfma_f32_16x16x32_bf16 v[156:159], a[212:215], a[172:175], v[156:159]
ds_read_b128 a[132:135], v40 offset:28672
s_waitcnt lgkmcnt(7)
v_mfma_f32_16x16x32_bf16 v[160:163], a[220:223], a[160:163], v[160:163]
ds_read_b128 a[148:151], v40 offset:29696
ds_read_b128 a[136:139], v40 offset:45056
v_mfma_f32_16x16x32_bf16 v[160:163], a[224:227], a[176:179], v[160:163]
ds_read_b128 a[152:155], v40 offset:46080
ds_read_b128 a[140:143], v40 offset:61440
v_mfma_f32_16x16x32_bf16 v[164:167], a[224:227], a[180:183], v[164:167]
ds_read_b128 a[156:159], v40 offset:62464
ds_read_b64_tr_b16 a[236:237], v31 offset:0
v_mfma_f32_16x16x32_bf16 v[164:167], a[220:223], a[164:167], v[164:167]
ds_read_b64_tr_b16 a[238:239], v31 offset:512
ds_read_b64_tr_b16 a[240:241], v31 offset:16384
v_mfma_f32_16x16x32_bf16 v[168:171], a[220:223], a[168:171], v[168:171]
ds_read_b64_tr_b16 a[242:243], v31 offset:16896
s_add_u32 s45, s45, 524288
v_mfma_f32_16x16x32_bf16 v[168:171], a[224:227], a[184:187], v[168:171]
s_and_b32 s45, s45, 0x3fffff
v_mfma_f32_16x16x32_bf16 v[172:175], a[224:227], a[188:191], v[172:175]
v_mfma_f32_16x16x32_bf16 v[172:175], a[220:223], a[172:175], v[172:175]
s_waitcnt lgkmcnt(12)
v_mfma_f32_16x16x32_bf16 v[176:179], a[228:231], a[160:163], v[176:179]
v_mfma_f32_16x16x32_bf16 v[176:179], a[232:235], a[176:179], v[176:179]
v_mfma_f32_16x16x32_bf16 v[180:183], a[232:235], a[180:183], v[180:183]
s_waitcnt vmcnt(8)
ds_read_b64_tr_b16 a[212:213], v24 offset:32768
v_mfma_f32_16x16x32_bf16 v[180:183], a[228:231], a[164:167], v[180:183]
ds_read_b64_tr_b16 a[214:215], v24 offset:33280
ds_read_b64_tr_b16 a[216:217], v24 offset:49152
v_mfma_f32_16x16x32_bf16 v[184:187], a[228:231], a[168:171], v[184:187]
ds_read_b64_tr_b16 a[218:219], v24 offset:49664
v_mfma_f32_16x16x32_bf16 v[184:187], a[232:235], a[184:187], v[184:187]
v_mfma_f32_16x16x32_bf16 v[188:191], a[232:235], a[188:191], v[188:191]
v_mfma_f32_16x16x32_bf16 v[188:191], a[228:231], a[172:175], v[188:191]
s_waitcnt lgkmcnt(4)
v_mfma_f32_16x16x32_bf16 v[192:195], a[236:239], a[160:163], v[192:195]
s_add_u32 m0, s39, 65536
v_mfma_f32_16x16x32_bf16 v[192:195], a[240:243], a[176:179], v[192:195]
buffer_load_dwordx4 v16, s[12:15], s45 offen offset:0 lds
v_mfma_f32_16x16x32_bf16 v[196:199], a[240:243], a[180:183], v[196:199]
buffer_load_dwordx4 v17, s[12:15], s45 offen offset:1024 lds
v_mfma_f32_16x16x32_bf16 v[196:199], a[236:239], a[164:167], v[196:199]
buffer_load_dwordx4 v18, s[12:15], s45 offen offset:2048 lds
v_mfma_f32_16x16x32_bf16 v[200:203], a[236:239], a[168:171], v[200:203]
buffer_load_dwordx4 v19, s[12:15], s45 offen offset:3072 lds
v_mfma_f32_16x16x32_bf16 v[200:203], a[240:243], a[184:187], v[200:203]
ds_read_b64_tr_b16 a[220:221], v25 offset:32768
ds_read_b64_tr_b16 a[222:223], v25 offset:33280
v_mfma_f32_16x16x32_bf16 v[204:207], a[240:243], a[188:191], v[204:207]
ds_read_b64_tr_b16 a[224:225], v25 offset:49152
ds_read_b64_tr_b16 a[226:227], v25 offset:49664
v_mfma_f32_16x16x32_bf16 v[204:207], a[236:239], a[172:175], v[204:207]
s_add_u32 m0, s39, 81920
s_waitcnt lgkmcnt(4)
v_mfma_f32_16x16x32_bf16 v[80:83], a[212:215], a[128:131], v[80:83]
buffer_load_dwordx4 v20, s[12:15], s45 offen offset:0 lds
v_mfma_f32_16x16x32_bf16 v[80:83], a[216:219], a[144:147], v[80:83]
buffer_load_dwordx4 v21, s[12:15], s45 offen offset:1024 lds
v_mfma_f32_16x16x32_bf16 v[84:87], a[216:219], a[148:151], v[84:87]
buffer_load_dwordx4 v22, s[12:15], s45 offen offset:2048 lds
v_mfma_f32_16x16x32_bf16 v[84:87], a[212:215], a[132:135], v[84:87]
buffer_load_dwordx4 v23, s[12:15], s45 offen offset:3072 lds
v_mfma_f32_16x16x32_bf16 v[88:91], a[212:215], a[136:139], v[88:91]
ds_read_b64_tr_b16 a[228:229], v26 offset:32768
ds_read_b64_tr_b16 a[230:231], v26 offset:33280
v_mfma_f32_16x16x32_bf16 v[88:91], a[216:219], a[152:155], v[88:91]
ds_read_b64_tr_b16 a[232:233], v26 offset:49152
ds_read_b64_tr_b16 a[234:235], v26 offset:49664
v_mfma_f32_16x16x32_bf16 v[92:95], a[216:219], a[156:159], v[92:95]
s_add_u32 s3, s45, 128
v_mfma_f32_16x16x32_bf16 v[92:95], a[212:215], a[140:143], v[92:95]
s_waitcnt lgkmcnt(4)
v_mfma_f32_16x16x32_bf16 v[96:99], a[220:223], a[128:131], v[96:99]
v_mfma_f32_16x16x32_bf16 v[96:99], a[224:227], a[144:147], v[96:99]
v_mfma_f32_16x16x32_bf16 v[100:103], a[224:227], a[148:151], v[100:103]
ds_read_b64_tr_b16 a[236:237], v27 offset:32768
ds_read_b64_tr_b16 a[238:239], v27 offset:33280
v_mfma_f32_16x16x32_bf16 v[100:103], a[220:223], a[132:135], v[100:103]
ds_read_b64_tr_b16 a[240:241], v27 offset:49152
ds_read_b64_tr_b16 a[242:243], v27 offset:49664
v_mfma_f32_16x16x32_bf16 v[104:107], a[220:223], a[136:139], v[104:107]
v_mfma_f32_16x16x32_bf16 v[104:107], a[224:227], a[152:155], v[104:107]
v_mfma_f32_16x16x32_bf16 v[108:111], a[224:227], a[156:159], v[108:111]
v_mfma_f32_16x16x32_bf16 v[108:111], a[220:223], a[140:143], v[108:111]
s_waitcnt lgkmcnt(4)
v_mfma_f32_16x16x32_bf16 v[112:115], a[228:231], a[128:131], v[112:115]
v_mfma_f32_16x16x32_bf16 v[112:115], a[232:235], a[144:147], v[112:115]
v_mfma_f32_16x16x32_bf16 v[116:119], a[232:235], a[148:151], v[116:119]
s_waitcnt vmcnt(8)
ds_read_b64_tr_b16 a[212:213], v24 offset:0
v_mfma_f32_16x16x32_bf16 v[116:119], a[228:231], a[132:135], v[116:119]
ds_read_b64_tr_b16 a[214:215], v24 offset:512
ds_read_b64_tr_b16 a[216:217], v24 offset:16384
v_mfma_f32_16x16x32_bf16 v[120:123], a[228:231], a[136:139], v[120:123]
ds_read_b64_tr_b16 a[218:219], v24 offset:16896
v_mfma_f32_16x16x32_bf16 v[120:123], a[232:235], a[152:155], v[120:123]
v_mfma_f32_16x16x32_bf16 v[124:127], a[232:235], a[156:159], v[124:127]
v_mfma_f32_16x16x32_bf16 v[124:127], a[228:231], a[140:143], v[124:127]
s_waitcnt lgkmcnt(4)
v_mfma_f32_16x16x32_bf16 v[128:131], a[236:239], a[128:131], v[128:131]
s_add_u32 m0, s39, 32768
v_mfma_f32_16x16x32_bf16 v[128:131], a[240:243], a[144:147], v[128:131]
buffer_load_dwordx4 v16, s[12:15], s3 offen offset:0 lds
v_mfma_f32_16x16x32_bf16 v[132:135], a[240:243], a[148:151], v[132:135]
buffer_load_dwordx4 v17, s[12:15], s3 offen offset:1024 lds
v_mfma_f32_16x16x32_bf16 v[132:135], a[236:239], a[132:135], v[132:135]
buffer_load_dwordx4 v18, s[12:15], s3 offen offset:2048 lds
v_mfma_f32_16x16x32_bf16 v[136:139], a[236:239], a[136:139], v[136:139]
buffer_load_dwordx4 v19, s[12:15], s3 offen offset:3072 lds
v_mfma_f32_16x16x32_bf16 v[136:139], a[240:243], a[152:155], v[136:139]
ds_read_b64_tr_b16 a[220:221], v25 offset:0
ds_read_b64_tr_b16 a[222:223], v25 offset:512
v_mfma_f32_16x16x32_bf16 v[140:143], a[240:243], a[156:159], v[140:143]
ds_read_b64_tr_b16 a[224:225], v25 offset:16384
ds_read_b64_tr_b16 a[226:227], v25 offset:16896
v_mfma_f32_16x16x32_bf16 v[140:143], a[236:239], a[140:143], v[140:143]
s_add_u32 m0, s39, 49152
s_waitcnt lgkmcnt(4)
v_mfma_f32_16x16x32_bf16 v[144:147], a[212:215], a[128:131], v[144:147]
buffer_load_dwordx4 v20, s[12:15], s3 offen offset:0 lds
v_mfma_f32_16x16x32_bf16 v[144:147], a[216:219], a[144:147], v[144:147]
buffer_load_dwordx4 v21, s[12:15], s3 offen offset:1024 lds
v_mfma_f32_16x16x32_bf16 v[148:151], a[216:219], a[148:151], v[148:151]
buffer_load_dwordx4 v22, s[12:15], s3 offen offset:2048 lds
v_mfma_f32_16x16x32_bf16 v[148:151], a[212:215], a[132:135], v[148:151]
buffer_load_dwordx4 v23, s[12:15], s3 offen offset:3072 lds
v_mfma_f32_16x16x32_bf16 v[152:155], a[212:215], a[136:139], v[152:155]
ds_read_b64_tr_b16 a[228:229], v26 offset:0
ds_read_b64_tr_b16 a[230:231], v26 offset:512
v_mfma_f32_16x16x32_bf16 v[152:155], a[216:219], a[152:155], v[152:155]
ds_read_b64_tr_b16 a[232:233], v26 offset:16384
ds_read_b64_tr_b16 a[234:235], v26 offset:16896
v_mfma_f32_16x16x32_bf16 v[156:159], a[216:219], a[156:159], v[156:159]
ds_read_b128 a[160:163], v40 offset:14336
ds_read_b128 a[176:179], v40 offset:15360
v_mfma_f32_16x16x32_bf16 v[156:159], a[212:215], a[140:143], v[156:159]
ds_read_b128 a[164:167], v40 offset:30720
s_waitcnt lgkmcnt(7)
v_mfma_f32_16x16x32_bf16 v[160:163], a[220:223], a[128:131], v[160:163]
ds_read_b128 a[180:183], v40 offset:31744
ds_read_b128 a[168:171], v40 offset:47104
v_mfma_f32_16x16x32_bf16 v[160:163], a[224:227], a[144:147], v[160:163]
ds_read_b128 a[184:187], v40 offset:48128
ds_read_b128 a[172:175], v40 offset:63488
v_mfma_f32_16x16x32_bf16 v[164:167], a[224:227], a[148:151], v[164:167]
ds_read_b128 a[188:191], v40 offset:64512
ds_read_b64_tr_b16 a[236:237], v27 offset:0
v_mfma_f32_16x16x32_bf16 v[164:167], a[220:223], a[132:135], v[164:167]
ds_read_b64_tr_b16 a[238:239], v27 offset:512
ds_read_b64_tr_b16 a[240:241], v27 offset:16384
v_mfma_f32_16x16x32_bf16 v[168:171], a[220:223], a[136:139], v[168:171]
ds_read_b64_tr_b16 a[242:243], v27 offset:16896
s_add_u32 s45, s45, 524288
v_mfma_f32_16x16x32_bf16 v[168:171], a[224:227], a[152:155], v[168:171]
s_and_b32 s45, s45, 0x3fffff
v_mfma_f32_16x16x32_bf16 v[172:175], a[224:227], a[156:159], v[172:175]
v_mfma_f32_16x16x32_bf16 v[172:175], a[220:223], a[140:143], v[172:175]
s_waitcnt lgkmcnt(12)
v_mfma_f32_16x16x32_bf16 v[176:179], a[228:231], a[128:131], v[176:179]
v_mfma_f32_16x16x32_bf16 v[176:179], a[232:235], a[144:147], v[176:179]
v_mfma_f32_16x16x32_bf16 v[180:183], a[232:235], a[148:151], v[180:183]
s_waitcnt vmcnt(8)
ds_read_b64_tr_b16 a[212:213], v28 offset:0
v_mfma_f32_16x16x32_bf16 v[180:183], a[228:231], a[132:135], v[180:183]
ds_read_b64_tr_b16 a[214:215], v28 offset:512
ds_read_b64_tr_b16 a[216:217], v28 offset:16384
v_mfma_f32_16x16x32_bf16 v[184:187], a[228:231], a[136:139], v[184:187]
ds_read_b64_tr_b16 a[218:219], v28 offset:16896
v_mfma_f32_16x16x32_bf16 v[184:187], a[232:235], a[152:155], v[184:187]
v_mfma_f32_16x16x32_bf16 v[188:191], a[232:235], a[156:159], v[188:191]
v_mfma_f32_16x16x32_bf16 v[188:191], a[228:231], a[140:143], v[188:191]
s_waitcnt lgkmcnt(4)
v_mfma_f32_16x16x32_bf16 v[192:195], a[236:239], a[128:131], v[192:195]
s_add_u32 m0, s39, 0
v_mfma_f32_16x16x32_bf16 v[192:195], a[240:243], a[144:147], v[192:195]
buffer_load_dwordx4 v236, s[16:19], s40 offen offset:0 lds
v_mfma_f32_16x16x32_bf16 v[196:199], a[240:243], a[148:151], v[196:199]
buffer_load_dwordx4 v237, s[16:19], s40 offen offset:1024 lds
v_mfma_f32_16x16x32_bf16 v[196:199], a[236:239], a[132:135], v[196:199]
buffer_load_dwordx4 v238, s[16:19], s40 offen offset:2048 lds
v_mfma_f32_16x16x32_bf16 v[200:203], a[236:239], a[136:139], v[200:203]
buffer_load_dwordx4 v239, s[16:19], s40 offen offset:3072 lds
v_mfma_f32_16x16x32_bf16 v[200:203], a[240:243], a[152:155], v[200:203]
ds_read_b64_tr_b16 a[220:221], v29 offset:0
ds_read_b64_tr_b16 a[222:223], v29 offset:512
v_mfma_f32_16x16x32_bf16 v[204:207], a[240:243], a[156:159], v[204:207]
ds_read_b64_tr_b16 a[224:225], v29 offset:16384
ds_read_b64_tr_b16 a[226:227], v29 offset:16896
v_mfma_f32_16x16x32_bf16 v[204:207], a[236:239], a[140:143], v[204:207]
s_add_u32 s40, s40, 16384
s_waitcnt lgkmcnt(4)
v_mfma_f32_16x16x32_bf16 v[80:83], a[212:215], a[160:163], v[80:83]
s_add_u32 m0, s39, 16384
v_mfma_f32_16x16x32_bf16 v[80:83], a[216:219], a[176:179], v[80:83]
buffer_load_dwordx4 v236, s[16:19], s40 offen offset:0 lds
v_mfma_f32_16x16x32_bf16 v[84:87], a[216:219], a[180:183], v[84:87]
buffer_load_dwordx4 v237, s[16:19], s40 offen offset:1024 lds
v_mfma_f32_16x16x32_bf16 v[84:87], a[212:215], a[164:167], v[84:87]
buffer_load_dwordx4 v238, s[16:19], s40 offen offset:2048 lds
v_mfma_f32_16x16x32_bf16 v[88:91], a[212:215], a[168:171], v[88:91]
buffer_load_dwordx4 v239, s[16:19], s40 offen offset:3072 lds
v_mfma_f32_16x16x32_bf16 v[88:91], a[216:219], a[184:187], v[88:91]
ds_read_b64_tr_b16 a[228:229], v30 offset:0
ds_read_b64_tr_b16 a[230:231], v30 offset:512
v_mfma_f32_16x16x32_bf16 v[92:95], a[216:219], a[188:191], v[92:95]
ds_read_b64_tr_b16 a[232:233], v30 offset:16384
ds_read_b64_tr_b16 a[234:235], v30 offset:16896
v_mfma_f32_16x16x32_bf16 v[92:95], a[212:215], a[172:175], v[92:95]
s_add_u32 s40, s40, 16384
s_waitcnt lgkmcnt(4)
v_mfma_f32_16x16x32_bf16 v[96:99], a[220:223], a[160:163], v[96:99]
v_mfma_f32_16x16x32_bf16 v[96:99], a[224:227], a[176:179], v[96:99]
v_mfma_f32_16x16x32_bf16 v[100:103], a[224:227], a[180:183], v[100:103]
ds_read_b64_tr_b16 a[236:237], v31 offset:0
ds_read_b64_tr_b16 a[238:239], v31 offset:512
v_mfma_f32_16x16x32_bf16 v[100:103], a[220:223], a[164:167], v[100:103]
ds_read_b64_tr_b16 a[240:241], v31 offset:16384
ds_read_b64_tr_b16 a[242:243], v31 offset:16896
v_mfma_f32_16x16x32_bf16 v[104:107], a[220:223], a[168:171], v[104:107]
v_mfma_f32_16x16x32_bf16 v[104:107], a[224:227], a[184:187], v[104:107]
v_mfma_f32_16x16x32_bf16 v[108:111], a[224:227], a[188:191], v[108:111]
v_mfma_f32_16x16x32_bf16 v[108:111], a[220:223], a[172:175], v[108:111]
s_waitcnt lgkmcnt(4)
v_mfma_f32_16x16x32_bf16 v[112:115], a[228:231], a[160:163], v[112:115]
v_mfma_f32_16x16x32_bf16 v[112:115], a[232:235], a[176:179], v[112:115]
v_mfma_f32_16x16x32_bf16 v[116:119], a[232:235], a[180:183], v[116:119]
s_waitcnt vmcnt(8)
ds_read_b64_tr_b16 a[212:213], v24 offset:32768
v_mfma_f32_16x16x32_bf16 v[116:119], a[228:231], a[164:167], v[116:119]
ds_read_b64_tr_b16 a[214:215], v24 offset:33280
ds_read_b64_tr_b16 a[216:217], v24 offset:49152
v_mfma_f32_16x16x32_bf16 v[120:123], a[228:231], a[168:171], v[120:123]
ds_read_b64_tr_b16 a[218:219], v24 offset:49664
v_mfma_f32_16x16x32_bf16 v[120:123], a[232:235], a[184:187], v[120:123]
v_mfma_f32_16x16x32_bf16 v[124:127], a[232:235], a[188:191], v[124:127]
v_mfma_f32_16x16x32_bf16 v[124:127], a[228:231], a[172:175], v[124:127]
s_waitcnt lgkmcnt(4)
v_mfma_f32_16x16x32_bf16 v[128:131], a[236:239], a[160:163], v[128:131]
s_add_u32 m0, s43, 0
v_mfma_f32_16x16x32_bf16 v[128:131], a[240:243], a[176:179], v[128:131]
buffer_load_dwordx4 v240, s[20:23], s41 offen offset:0 lds
v_mfma_f32_16x16x32_bf16 v[132:135], a[240:243], a[180:183], v[132:135]
buffer_load_dwordx4 v241, s[20:23], s41 offen offset:1024 lds
v_mfma_f32_16x16x32_bf16 v[132:135], a[236:239], a[164:167], v[132:135]
buffer_load_dwordx4 v240, s[20:23], s41 offen offset:2048 lds
v_mfma_f32_16x16x32_bf16 v[136:139], a[236:239], a[168:171], v[136:139]
buffer_load_dwordx4 v241, s[20:23], s41 offen offset:3072 lds
v_mfma_f32_16x16x32_bf16 v[136:139], a[240:243], a[184:187], v[136:139]
ds_read_b64_tr_b16 a[220:221], v25 offset:32768
ds_read_b64_tr_b16 a[222:223], v25 offset:33280
v_mfma_f32_16x16x32_bf16 v[140:143], a[240:243], a[188:191], v[140:143]
ds_read_b64_tr_b16 a[224:225], v25 offset:49152
ds_read_b64_tr_b16 a[226:227], v25 offset:49664
v_mfma_f32_16x16x32_bf16 v[140:143], a[236:239], a[172:175], v[140:143]
s_add_u32 s41, s41, 16384
s_waitcnt lgkmcnt(4)
v_mfma_f32_16x16x32_bf16 v[144:147], a[212:215], a[160:163], v[144:147]
s_add_u32 m0, s43, 16384
v_cvt_pk_bf16_f32 v16, v80, v81
v_mfma_f32_16x16x32_bf16 v[144:147], a[216:219], a[176:179], v[144:147]
buffer_load_dwordx4 v240, s[20:23], s41 offen offset:0 lds
v_mfma_f32_16x16x32_bf16 v[148:151], a[216:219], a[180:183], v[148:151]
buffer_load_dwordx4 v241, s[20:23], s41 offen offset:1024 lds
v_mfma_f32_16x16x32_bf16 v[148:151], a[212:215], a[164:167], v[148:151]
buffer_load_dwordx4 v240, s[20:23], s41 offen offset:2048 lds
v_mfma_f32_16x16x32_bf16 v[152:155], a[212:215], a[168:171], v[152:155]
buffer_load_dwordx4 v241, s[20:23], s41 offen offset:3072 lds
v_mfma_f32_16x16x32_bf16 v[152:155], a[216:219], a[184:187], v[152:155]
ds_read_b64_tr_b16 a[228:229], v26 offset:32768
ds_read_b64_tr_b16 a[230:231], v26 offset:33280
v_mfma_f32_16x16x32_bf16 v[156:159], a[216:219], a[188:191], v[156:159]
ds_read_b64_tr_b16 a[232:233], v26 offset:49152
ds_read_b64_tr_b16 a[234:235], v26 offset:49664
v_mfma_f32_16x16x32_bf16 v[156:159], a[212:215], a[172:175], v[156:159]
s_add_u32 s41, s41, 16384
s_waitcnt lgkmcnt(4)
v_mfma_f32_16x16x32_bf16 v[160:163], a[220:223], a[160:163], v[160:163]
v_cvt_pk_bf16_f32 v17, v82, v83
v_cvt_pk_bf16_f32 v18, v96, v97
v_mfma_f32_16x16x32_bf16 v[160:163], a[224:227], a[176:179], v[160:163]
v_cvt_pk_bf16_f32 v19, v98, v99
v_cvt_pk_bf16_f32 v32, v84, v85
v_mfma_f32_16x16x32_bf16 v[164:167], a[224:227], a[180:183], v[164:167]
ds_read_b64_tr_b16 a[236:237], v27 offset:32768
ds_read_b64_tr_b16 a[238:239], v27 offset:33280
v_mfma_f32_16x16x32_bf16 v[164:167], a[220:223], a[164:167], v[164:167]
ds_read_b64_tr_b16 a[240:241], v27 offset:49152
ds_read_b64_tr_b16 a[242:243], v27 offset:49664
v_mfma_f32_16x16x32_bf16 v[168:171], a[220:223], a[168:171], v[168:171]
v_cvt_pk_bf16_f32 v33, v86, v87
v_cvt_pk_bf16_f32 v34, v100, v101
v_mfma_f32_16x16x32_bf16 v[168:171], a[224:227], a[184:187], v[168:171]
v_cvt_pk_bf16_f32 v35, v102, v103
v_cvt_pk_bf16_f32 v48, v88, v89
v_mfma_f32_16x16x32_bf16 v[172:175], a[224:227], a[188:191], v[172:175]
v_cvt_pk_bf16_f32 v49, v90, v91
v_cvt_pk_bf16_f32 v50, v104, v105
v_mfma_f32_16x16x32_bf16 v[172:175], a[220:223], a[172:175], v[172:175]
v_cvt_pk_bf16_f32 v51, v106, v107
s_waitcnt lgkmcnt(4)
v_mfma_f32_16x16x32_bf16 v[176:179], a[228:231], a[160:163], v[176:179]
v_cvt_pk_bf16_f32 v64, v92, v93
v_cvt_pk_bf16_f32 v65, v94, v95
v_mfma_f32_16x16x32_bf16 v[176:179], a[232:235], a[176:179], v[176:179]
v_cvt_pk_bf16_f32 v66, v108, v109
v_cvt_pk_bf16_f32 v67, v110, v111
v_mfma_f32_16x16x32_bf16 v[180:183], a[232:235], a[180:183], v[180:183]
v_permlane16_swap_b32 v16, v18
v_permlane16_swap_b32 v17, v19
v_mfma_f32_16x16x32_bf16 v[180:183], a[228:231], a[164:167], v[180:183]
v_permlane16_swap_b32 v32, v34
v_permlane16_swap_b32 v33, v35
v_mfma_f32_16x16x32_bf16 v[184:187], a[228:231], a[168:171], v[184:187]
v_permlane16_swap_b32 v48, v50
v_permlane16_swap_b32 v49, v51
v_mfma_f32_16x16x32_bf16 v[184:187], a[232:235], a[184:187], v[184:187]
v_permlane16_swap_b32 v64, v66
v_permlane16_swap_b32 v65, v67
v_mfma_f32_16x16x32_bf16 v[188:191], a[232:235], a[188:191], v[188:191]
v_cvt_pk_bf16_f32 v20, v112, v113
v_cvt_pk_bf16_f32 v21, v114, v115
v_mfma_f32_16x16x32_bf16 v[188:191], a[228:231], a[172:175], v[188:191]
v_cvt_pk_bf16_f32 v22, v128, v129
s_waitcnt lgkmcnt(0)
v_mfma_f32_16x16x32_bf16 v[192:195], a[236:239], a[160:163], v[192:195]
v_cvt_pk_bf16_f32 v23, v130, v131
v_cvt_pk_bf16_f32 v36, v116, v117
v_mfma_f32_16x16x32_bf16 v[192:195], a[240:243], a[176:179], v[192:195]
v_cvt_pk_bf16_f32 v37, v118, v119
v_cvt_pk_bf16_f32 v38, v132, v133
v_mfma_f32_16x16x32_bf16 v[196:199], a[240:243], a[180:183], v[196:199]
v_cvt_pk_bf16_f32 v39, v134, v135
v_cvt_pk_bf16_f32 v52, v120, v121
v_mfma_f32_16x16x32_bf16 v[196:199], a[236:239], a[164:167], v[196:199]
v_cvt_pk_bf16_f32 v53, v122, v123
v_cvt_pk_bf16_f32 v54, v136, v137
v_mfma_f32_16x16x32_bf16 v[200:203], a[236:239], a[168:171], v[200:203]
v_cvt_pk_bf16_f32 v55, v138, v139
v_cvt_pk_bf16_f32 v68, v124, v125
v_mfma_f32_16x16x32_bf16 v[200:203], a[240:243], a[184:187], v[200:203]
v_cvt_pk_bf16_f32 v69, v126, v127
v_cvt_pk_bf16_f32 v70, v140, v141
v_mfma_f32_16x16x32_bf16 v[204:207], a[240:243], a[188:191], v[204:207]
v_cvt_pk_bf16_f32 v71, v142, v143
v_permlane16_swap_b32 v20, v22
v_mfma_f32_16x16x32_bf16 v[204:207], a[236:239], a[172:175], v[204:207]
v_permlane16_swap_b32 v21, v23
v_permlane16_swap_b32 v36, v38
v_permlane16_swap_b32 v37, v39
v_permlane16_swap_b32 v52, v54
v_permlane16_swap_b32 v53, v55
v_permlane16_swap_b32 v68, v70
v_permlane16_swap_b32 v69, v71
s_nop 3
s_nop 0
v_cvt_pk_bf16_f32 v24, v144, v145
v_cvt_pk_bf16_f32 v25, v146, v147
v_cvt_pk_bf16_f32 v26, v160, v161
v_cvt_pk_bf16_f32 v27, v162, v163
v_cvt_pk_bf16_f32 v40, v148, v149
v_cvt_pk_bf16_f32 v41, v150, v151
v_cvt_pk_bf16_f32 v42, v164, v165
v_cvt_pk_bf16_f32 v43, v166, v167
v_cvt_pk_bf16_f32 v56, v152, v153
v_cvt_pk_bf16_f32 v57, v154, v155
v_cvt_pk_bf16_f32 v58, v168, v169
v_cvt_pk_bf16_f32 v59, v170, v171
v_cvt_pk_bf16_f32 v72, v156, v157
v_cvt_pk_bf16_f32 v73, v158, v159
v_cvt_pk_bf16_f32 v74, v172, v173
v_cvt_pk_bf16_f32 v75, v174, v175
v_permlane16_swap_b32 v24, v26
v_permlane16_swap_b32 v25, v27
v_permlane16_swap_b32 v40, v42
v_permlane16_swap_b32 v41, v43
v_permlane16_swap_b32 v56, v58
v_permlane16_swap_b32 v57, v59
v_permlane16_swap_b32 v72, v74
v_permlane16_swap_b32 v73, v75
v_cvt_pk_bf16_f32 v28, v176, v177
v_cvt_pk_bf16_f32 v29, v178, v179
v_cvt_pk_bf16_f32 v30, v192, v193
v_cvt_pk_bf16_f32 v31, v194, v195
v_cvt_pk_bf16_f32 v44, v180, v181
v_cvt_pk_bf16_f32 v45, v182, v183
v_cvt_pk_bf16_f32 v46, v196, v197
v_cvt_pk_bf16_f32 v47, v198, v199
v_cvt_pk_bf16_f32 v60, v184, v185
v_cvt_pk_bf16_f32 v61, v186, v187
v_cvt_pk_bf16_f32 v62, v200, v201
v_cvt_pk_bf16_f32 v63, v202, v203
v_cvt_pk_bf16_f32 v76, v188, v189
v_cvt_pk_bf16_f32 v77, v190, v191
v_cvt_pk_bf16_f32 v78, v204, v205
v_cvt_pk_bf16_f32 v79, v206, v207
v_permlane16_swap_b32 v28, v30
v_permlane16_swap_b32 v29, v31
v_permlane16_swap_b32 v44, v46
v_permlane16_swap_b32 v45, v47
v_permlane16_swap_b32 v60, v62
v_permlane16_swap_b32 v61, v63
v_permlane16_swap_b32 v76, v78
v_permlane16_swap_b32 v77, v79
s_lshl_b32 s60, s38, 10
v_lshl_add_u32 v6, v0, 4, s60
s_getpc_b64 s[62:63]
L_pc_b:
s_add_u32 s62, s62, L_k1_post-L_pc_b
s_addc_u32 s63, s63, 0
s_lshr_b32 s61, s2, 3
s_lshl_b32 s61, s61, 12
v_add_u32 v12, s61, v6
v_min_u32 v12, L_k1_end-L_k1_post-16, v12
v_mov_b32 v13, s63
v_add_co_u32 v12, vcc, s62, v12
s_nop 1
v_addc_co_u32 v13, vcc, 0, v13, vcc
s_waitcnt vmcnt(12)
s_barrier
s_lshl_b32 s60, s38, 5
s_nop 0
s_add_u32 s60, s60, 131072
v_lshl_add_u32 v4, v3, 2, s60
ds_write_b32 v4, v14
ds_write_b32 v4, v15 offset:16
L_k1_attn_start:
ds_read_b128 a[128:131], v224 offset:0
ds_read_b128 a[132:135], v225 offset:0
ds_read_b128 a[136:139], v226 offset:0
ds_read_b128 a[140:143], v227 offset:0
ds_read_b128 a[144:147], v224 offset:4096
ds_read_b128 a[148:151], v225 offset:4096
ds_read_b128 a[152:155], v226 offset:4096
ds_read_b128 a[156:159], v227 offset:4096
s_waitcnt lgkmcnt(4)
v_mfma_f32_16x16x32_bf16 v[80:83], a[128:131], v[16:19], 0
s_add_u32 m0, s39, 32768
v_mfma_f32_16x16x32_bf16 v[80:83], a[132:135], v[20:23], v[80:83]
buffer_load_dwordx4 v236, s[16:19], s40 offen offset:0 lds
v_mfma_f32_16x16x32_bf16 v[80:83], a[136:139], v[24:27], v[80:83]
v_mfma_f32_16x16x32_bf16 v[80:83], a[140:143], v[28:31], v[80:83]
v_mfma_f32_16x16x32_bf16 v[84:87], a[140:143], v[44:47], 0
buffer_load_dwordx4 v237, s[16:19], s40 offen offset:1024 lds
v_mfma_f32_16x16x32_bf16 v[84:87], a[136:139], v[40:43], v[84:87]
v_mfma_f32_16x16x32_bf16 v[84:87], a[132:135], v[36:39], v[84:87]
v_mfma_f32_16x16x32_bf16 v[84:87], a[128:131], v[32:35], v[84:87]
buffer_load_dwordx4 v238, s[16:19], s40 offen offset:2048 lds
v_mfma_f32_16x16x32_bf16 v[88:91], a[128:131], v[48:51], 0
v_mfma_f32_16x16x32_bf16 v[88:91], a[132:135], v[52:55], v[88:91]
v_mfma_f32_16x16x32_bf16 v[88:91], a[136:139], v[56:59], v[88:91]
buffer_load_dwordx4 v239, s[16:19], s40 offen offset:3072 lds
v_mfma_f32_16x16x32_bf16 v[88:91], a[140:143], v[60:63], v[88:91]
s_add_u32 s40, s40, 16384
s_add_u32 m0, s39, 49152
v_mfma_f32_16x16x32_bf16 v[92:95], a[140:143], v[76:79], 0
ds_read_b128 a[160:163], v224 offset:8192
v_mfma_f32_16x16x32_bf16 v[92:95], a[136:139], v[72:75], v[92:95]
buffer_load_dwordx4 v236, s[16:19], s40 offen offset:0 lds
v_mfma_f32_16x16x32_bf16 v[92:95], a[132:135], v[68:71], v[92:95]
ds_read_b128 a[164:167], v225 offset:8192
v_mfma_f32_16x16x32_bf16 v[92:95], a[128:131], v[64:67], v[92:95]
ds_read_b128 a[168:171], v226 offset:8192
s_waitcnt lgkmcnt(3)
v_mfma_f32_16x16x32_bf16 v[96:99], a[144:147], v[16:19], 0
buffer_load_dwordx4 v237, s[16:19], s40 offen offset:1024 lds
v_mfma_f32_16x16x32_bf16 v[96:99], a[148:151], v[20:23], v[96:99]
ds_read_b128 a[172:175], v227 offset:8192
v_mfma_f32_16x16x32_bf16 v[96:99], a[152:155], v[24:27], v[96:99]
v_mfma_f32_16x16x32_bf16 v[96:99], a[156:159], v[28:31], v[96:99]
buffer_load_dwordx4 v238, s[16:19], s40 offen offset:2048 lds
v_mfma_f32_16x16x32_bf16 v[100:103], a[156:159], v[44:47], 0
v_mfma_f32_16x16x32_bf16 v[100:103], a[152:155], v[40:43], v[100:103]
v_mfma_f32_16x16x32_bf16 v[100:103], a[148:151], v[36:39], v[100:103]
buffer_load_dwordx4 v239, s[16:19], s40 offen offset:3072 lds
v_mfma_f32_16x16x32_bf16 v[100:103], a[144:147], v[32:35], v[100:103]
s_add_u32 s40, s40, 16384
s_add_u32 m0, s43, 32768
v_mfma_f32_16x16x32_bf16 v[104:107], a[144:147], v[48:51], 0
v_mfma_f32_16x16x32_bf16 v[104:107], a[148:151], v[52:55], v[104:107]
buffer_load_dwordx4 v240, s[20:23], s41 offen offset:0 lds
v_mfma_f32_16x16x32_bf16 v[104:107], a[152:155], v[56:59], v[104:107]
v_mfma_f32_16x16x32_bf16 v[104:107], a[156:159], v[60:63], v[104:107]
v_mfma_f32_16x16x32_bf16 v[108:111], a[156:159], v[76:79], 0
buffer_load_dwordx4 v241, s[20:23], s41 offen offset:1024 lds
v_mfma_f32_16x16x32_bf16 v[108:111], a[152:155], v[72:75], v[108:111]
ds_read_b128 a[176:179], v224 offset:12288
v_mfma_f32_16x16x32_bf16 v[108:111], a[148:151], v[68:71], v[108:111]
ds_read_b128 a[180:183], v225 offset:12288
v_mfma_f32_16x16x32_bf16 v[108:111], a[144:147], v[64:67], v[108:111]
s_waitcnt lgkmcnt(2)
buffer_load_dwordx4 v240, s[20:23], s41 offen offset:2048 lds
v_mfma_f32_16x16x32_bf16 v[112:115], a[160:163], v[16:19], 0
ds_read_b128 a[184:187], v226 offset:12288
v_max3_f32 v4, v80, v81, v82
v_mfma_f32_16x16x32_bf16 v[112:115], a[164:167], v[20:23], v[112:115]
ds_read_b128 a[188:191], v227 offset:12288
v_max3_f32 v5, v84, v85, v86
v_mfma_f32_16x16x32_bf16 v[112:115], a[168:171], v[24:27], v[112:115]
buffer_load_dwordx4 v241, s[20:23], s41 offen offset:3072 lds
v_mfma_f32_16x16x32_bf16 v[112:115], a[172:175], v[28:31], v[112:115]
s_add_u32 s41, s41, 16384
v_max3_f32 v6, v88, v89, v90
v_mfma_f32_16x16x32_bf16 v[116:119], a[172:175], v[44:47], 0
v_max3_f32 v7, v92, v93, v94
v_max_f32 v4, v4, v83
v_mfma_f32_16x16x32_bf16 v[116:119], a[168:171], v[40:43], v[116:119]
v_max_f32 v5, v5, v87
v_max_f32 v6, v6, v91
v_mfma_f32_16x16x32_bf16 v[116:119], a[164:167], v[36:39], v[116:119]
v_max_f32 v7, v7, v95
v_mfma_f32_16x16x32_bf16 v[116:119], a[160:163], v[32:35], v[116:119]
v_mfma_f32_16x16x32_bf16 v[120:123], a[160:163], v[48:51], 0
v_mfma_f32_16x16x32_bf16 v[120:123], a[164:167], v[52:55], v[120:123]
v_mfma_f32_16x16x32_bf16 v[120:123], a[168:171], v[56:59], v[120:123]
v_mfma_f32_16x16x32_bf16 v[120:123], a[172:175], v[60:63], v[120:123]
v_mfma_f32_16x16x32_bf16 v[124:127], a[172:175], v[76:79], 0
v_mfma_f32_16x16x32_bf16 v[124:127], a[168:171], v[72:75], v[124:127]
v_mfma_f32_16x16x32_bf16 v[124:127], a[164:167], v[68:71], v[124:127]
v_mfma_f32_16x16x32_bf16 v[124:127], a[160:163], v[64:67], v[124:127]
s_waitcnt lgkmcnt(0)
v_mfma_f32_16x16x32_bf16 v[128:131], a[176:179], v[16:19], 0
v_max3_f32 v4, v96, v97, v4
v_max3_f32 v5, v100, v101, v5
v_mfma_f32_16x16x32_bf16 v[128:131], a[180:183], v[20:23], v[128:131]
v_max3_f32 v6, v104, v105, v6
v_max3_f32 v7, v108, v109, v7
v_mfma_f32_16x16x32_bf16 v[128:131], a[184:187], v[24:27], v[128:131]
v_max3_f32 v4, v98, v99, v4
v_max3_f32 v5, v102, v103, v5
v_mfma_f32_16x16x32_bf16 v[128:131], a[188:191], v[28:31], v[128:131]
v_max3_f32 v6, v106, v107, v6
v_max3_f32 v7, v110, v111, v7
v_mfma_f32_16x16x32_bf16 v[132:135], a[188:191], v[44:47], 0
v_max3_f32 v4, v112, v113, v4
v_max3_f32 v5, v116, v117, v5
v_mfma_f32_16x16x32_bf16 v[132:135], a[184:187], v[40:43], v[132:135]
v_max3_f32 v6, v120, v121, v6
v_max3_f32 v7, v124, v125, v7
v_mfma_f32_16x16x32_bf16 v[132:135], a[180:183], v[36:39], v[132:135]
v_max3_f32 v4, v114, v115, v4
v_max3_f32 v5, v118, v119, v5
v_mfma_f32_16x16x32_bf16 v[132:135], a[176:179], v[32:35], v[132:135]
v_max3_f32 v6, v122, v123, v6
v_max3_f32 v7, v126, v127, v7
v_mfma_f32_16x16x32_bf16 v[136:139], a[176:179], v[48:51], 0
v_mfma_f32_16x16x32_bf16 v[136:139], a[180:183], v[52:55], v[136:139]
v_mfma_f32_16x16x32_bf16 v[136:139], a[184:187], v[56:59], v[136:139]
v_mfma_f32_16x16x32_bf16 v[136:139], a[188:191], v[60:63], v[136:139]
v_mfma_f32_16x16x32_bf16 v[140:143], a[188:191], v[76:79], 0
v_mfma_f32_16x16x32_bf16 v[140:143], a[184:187], v[72:75], v[140:143]
v_mfma_f32_16x16x32_bf16 v[140:143], a[180:183], v[68:71], v[140:143]
v_mfma_f32_16x16x32_bf16 v[140:143], a[176:179], v[64:67], v[140:143]
s_cmp_lg_u32 s46, 0
s_cbranch_scc1 L_k1_havemax0
s_nop 2
v_max3_f32 v4, v128, v129, v4
v_max3_f32 v5, v132, v133, v5
v_max3_f32 v6, v136, v137, v6
v_max3_f32 v7, v140, v141, v7
v_max3_f32 v4, v130, v131, v4
v_max3_f32 v5, v134, v135, v5
v_max3_f32 v6, v138, v139, v6
v_max3_f32 v7, v142, v143, v7
v_mov_b32 v8, v4
v_mov_b32 v9, v5
v_mov_b32 v10, v6
v_mov_b32 v11, v7
v_permlane32_swap_b32 v8, v4
v_permlane32_swap_b32 v9, v5
v_permlane32_swap_b32 v10, v6
v_permlane32_swap_b32 v11, v7
v_max_f32 v4, v4, v8
v_max_f32 v5, v5, v9
v_max_f32 v6, v6, v10
v_max_f32 v7, v7, v11
v_mov_b32 v8, v4
v_mov_b32 v9, v5
v_mov_b32 v10, v6
v_mov_b32 v11, v7
v_permlane16_swap_b32 v8, v4
v_permlane16_swap_b32 v9, v5
v_permlane16_swap_b32 v10, v6
v_permlane16_swap_b32 v11, v7
v_max_f32 v4, v4, v8
v_max_f32 v5, v5, v9
v_max_f32 v6, v6, v10
v_max_f32_e64 v7, v7, v11
v_sub_f32 v208, 0xc2cc0000, v4
v_sub_f32 v209, 0xc2cc0000, v4
v_sub_f32 v210, 0xc2cc0000, v4
v_sub_f32 v211, 0xc2cc0000, v4
v_sub_f32 v212, 0xc2cc0000, v5
v_sub_f32 v213, 0xc2cc0000, v5
v_sub_f32 v214, 0xc2cc0000, v5
v_sub_f32 v215, 0xc2cc0000, v5
v_sub_f32 v216, 0xc2cc0000, v6
v_sub_f32 v217, 0xc2cc0000, v6
v_sub_f32 v218, 0xc2cc0000, v6
v_sub_f32 v219, 0xc2cc0000, v6
v_sub_f32 v220, 0xc2cc0000, v7
v_sub_f32 v221, 0xc2cc0000, v7
v_sub_f32 v222, 0xc2cc0000, v7
v_sub_f32 v223, 0xc2cc0000, v7
L_k1_havemax0:
s_nop 5
L_k1_havemax:
s_nop 0
v_pk_add_f32 v[80:81], v[80:81], v[208:209]
v_pk_add_f32 v[82:83], v[82:83], v[208:209]
v_pk_add_f32 v[84:85], v[84:85], v[212:213]
v_pk_add_f32 v[86:87], v[86:87], v[212:213]
v_pk_add_f32 v[88:89], v[88:89], v[216:217]
v_pk_add_f32 v[90:91], v[90:91], v[216:217]
v_pk_add_f32 v[92:93], v[92:93], v[220:221]
v_pk_add_f32 v[94:95], v[94:95], v[220:221]
v_pk_add_f32 v[96:97], v[96:97], v[208:209]
v_pk_add_f32 v[98:99], v[98:99], v[208:209]
v_pk_add_f32 v[100:101], v[100:101], v[212:213]
v_pk_add_f32 v[102:103], v[102:103], v[212:213]
v_pk_add_f32 v[104:105], v[104:105], v[216:217]
v_pk_add_f32 v[106:107], v[106:107], v[216:217]
v_pk_add_f32 v[108:109], v[108:109], v[220:221]
v_pk_add_f32 v[110:111], v[110:111], v[220:221]
v_pk_add_f32 v[112:113], v[112:113], v[208:209]
v_pk_add_f32 v[114:115], v[114:115], v[208:209]
v_pk_add_f32 v[116:117], v[116:117], v[212:213]
v_pk_add_f32 v[118:119], v[118:119], v[212:213]
v_pk_add_f32 v[120:121], v[120:121], v[216:217]
v_pk_add_f32 v[122:123], v[122:123], v[216:217]
v_pk_add_f32 v[124:125], v[124:125], v[220:221]
v_pk_add_f32 v[126:127], v[126:127], v[220:221]
v_pk_add_f32 v[128:129], v[128:129], v[208:209]
v_pk_add_f32 v[130:131], v[130:131], v[208:209]
v_pk_add_f32 v[132:133], v[132:133], v[212:213]
v_pk_add_f32 v[134:135], v[134:135], v[212:213]
v_pk_add_f32 v[136:137], v[136:137], v[216:217]
v_pk_add_f32 v[138:139], v[138:139], v[216:217]
v_pk_add_f32 v[140:141], v[140:141], v[220:221]
v_pk_add_f32 v[142:143], v[142:143], v[220:221]
v_mov_b32 v8, 0
v_mov_b32 v9, 0
v_mov_b32 v10, 0
v_mov_b32 v11, 0
s_waitcnt vmcnt(16) lgkmcnt(0)
s_barrier
s_cmp_lg_u32 s46, 0
s_cbranch_scc1 L_f_norest
s_cmp_lg_u32 s38, 0
s_cbranch_scc1 L_f_norest
s_mov_b64 exec, 0xff
v_lshlrev_b32_e64 v5, 2, v0
v_add_u32 v6, 131072, v5
ds_read_b32 v176, v6 offset:0
ds_read_b32 v177, v6 offset:32
ds_read_b32 v178, v6 offset:64
ds_read_b32 v179, v6 offset:96
s_lshr_b32 s60, s84, 1
s_lshl_b32 s61, s60, 11
s_cmp_eq_u32 s60, 1
s_cselect_b32 s61, 4096, s61
s_cmp_eq_u32 s60, 2
s_cselect_b32 s61, 2048, s61
s_cselect_b32 s62, 1.0, 0
s_and_b32 s60, s84, 1
s_lshl_b32 s60, s60, 5
s_add_u32 s60, s60, s85
s_lshl_b32 s60, s60, 5
s_add_u32 s61, s61, s60
s_add_u32 s61, s61, 4096
s_waitcnt lgkmcnt(0)
v_add_f32 v176, v176, v177
v_add_f32 v178, v178, v179
v_add_f32 v176, v176, v178
v_cvt_pk_bf16_f32 v176, v176, v176
v_lshlrev_b32 v176, 16, v176
v_add_f32 v176, s62, v176
v_cvt_pk_bf16_f32 v176, v176, v176
v_lshlrev_b32_e64 v176, 16, v176
buffer_store_dword v176, v5, s[28:31], s61 offen sc1
s_mov_b64 exec, -1
L_f_norest:
ds_read_b128 a[128:131], v224 offset:16384
ds_read_b128 a[132:135], v225 offset:16384
ds_read_b128 a[136:139], v226 offset:16384
ds_read_b128 a[140:143], v227 offset:16384
ds_read_b128 a[144:147], v224 offset:20480
ds_read_b128 a[148:151], v225 offset:20480
ds_read_b128 a[152:155], v226 offset:20480
s_add_u32 m0, s43, 49152
s_nop 0
buffer_load_dwordx4 v240, s[20:23], s41 offen offset:0 lds
buffer_load_dwordx4 v241, s[20:23], s41 offen offset:1024 lds
v_exp_f32 v80, v80
v_exp_f32 v81, v81
v_exp_f32_e64 v82, v82
v_cvt_pk_bf16_f32 v144, v80, v81
v_exp_f32 v83, v83
v_exp_f32 v84, v84
v_cvt_pk_bf16_f32 v145, v82, v83
v_exp_f32 v85, v85
v_add_f32 v8, v8, v84
v_exp_f32 v86, v86
v_add_f32 v9, v9, v85
v_cvt_pk_bf16_f32 v148, v84, v85
v_exp_f32 v87, v87
v_add_f32 v8, v8, v86
v_exp_f32 v88, v88
v_add_f32 v9, v9, v87
v_cvt_pk_bf16_f32 v149, v86, v87
v_exp_f32 v89, v89
v_exp_f32 v90, v90
v_cvt_pk_bf16_f32 v152, v88, v89
v_exp_f32 v91, v91
v_exp_f32 v92, v92
v_cvt_pk_bf16_f32 v153, v90, v91
v_exp_f32 v93, v93
v_add_f32 v10, v10, v92
v_exp_f32 v94, v94
v_add_f32 v11, v11, v93
v_cvt_pk_bf16_f32 v156, v92, v93
v_exp_f32 v95, v95
v_add_f32 v10, v10, v94
v_exp_f32 v96, v96
v_add_f32 v11, v11, v95
v_cvt_pk_bf16_f32 v157, v94, v95
v_exp_f32 v97, v97
v_exp_f32 v98, v98
v_cvt_pk_bf16_f32 v146, v96, v97
v_exp_f32 v99, v99
v_exp_f32 v100, v100
v_cvt_pk_bf16_f32 v147, v98, v99
v_exp_f32 v101, v101
v_add_f32 v8, v8, v100
v_exp_f32 v102, v102
v_add_f32 v9, v9, v101
v_cvt_pk_bf16_f32 v150, v100, v101
v_exp_f32 v103, v103
v_add_f32 v8, v8, v102
v_exp_f32 v104, v104
v_add_f32 v9, v9, v103
v_cvt_pk_bf16_f32 v151, v102, v103
v_exp_f32 v105, v105
v_exp_f32 v106, v106
v_cvt_pk_bf16_f32 v154, v104, v105
v_exp_f32 v107, v107
v_exp_f32 v108, v108
v_cvt_pk_bf16_f32 v155, v106, v107
v_exp_f32 v109, v109
v_add_f32 v10, v10, v108
v_exp_f32 v110, v110
v_add_f32 v11, v11, v109
v_cvt_pk_bf16_f32 v158, v108, v109
v_exp_f32 v111, v111
v_add_f32 v10, v10, v110
v_exp_f32 v112, v112
v_add_f32 v11, v11, v111
v_cvt_pk_bf16_f32 v159, v110, v111
v_exp_f32 v113, v113
v_exp_f32 v114, v114
v_cvt_pk_bf16_f32 v160, v112, v113
v_exp_f32 v115, v115
v_exp_f32 v116, v116
v_cvt_pk_bf16_f32 v161, v114, v115
v_exp_f32 v117, v117
v_add_f32 v8, v8, v116
v_exp_f32 v118, v118
v_add_f32 v9, v9, v117
v_exp_f32 v119, v119
v_exp_f32 v120, v120
s_nop 0
s_waitcnt lgkmcnt(3)
s_mov_b32 s44, 7
.p2align 6
L_k1_loop:
v_mfma_f32_16x16x32_bf16 v[80:83], a[128:131], v[16:19], v[208:211]
v_exp_f32 v121, v121
v_mfma_f32_16x16x32_bf16 v[80:83], a[132:135], v[20:23], v[80:83]
ds_read_b128 a[156:159], v227 offset:20480
v_cvt_pk_bf16_f32 v164, v116, v117
v_mfma_f32_16x16x32_bf16 v[80:83], a[136:139], v[24:27], v[80:83]
v_exp_f32 v122, v122
v_mfma_f32_16x16x32_bf16 v[80:83], a[140:143], v[28:31], v[80:83]
v_add_f32 v8, v8, v118
v_add_f32 v9, v9, v119
v_mfma_f32_16x16x32_bf16 v[84:87], a[140:143], v[44:47], v[212:215]
v_exp_f32 v123, v123
v_mfma_f32_16x16x32_bf16 v[84:87], a[136:139], v[40:43], v[84:87]
v_cvt_pk_bf16_f32 v165, v118, v119
v_cvt_pk_bf16_f32 v168, v120, v121
v_mfma_f32_16x16x32_bf16 v[84:87], a[132:135], v[36:39], v[84:87]
buffer_load_dwordx4 v240, s[20:23], s41 offen offset:2048 lds
v_mfma_f32_16x16x32_bf16 v[84:87], a[128:131], v[32:35], v[84:87]
v_exp_f32 v124, v124
v_mfma_f32_16x16x32_bf16 v[88:91], a[128:131], v[48:51], v[216:219]
v_exp_f32 v125, v125
v_mfma_f32_16x16x32_bf16 v[88:91], a[132:135], v[52:55], v[88:91]
v_cvt_pk_bf16_f32 v169, v122, v123
v_add_f32 v10, v10, v124
v_mfma_f32_16x16x32_bf16 v[88:91], a[136:139], v[56:59], v[88:91]
v_exp_f32 v126, v126
v_mfma_f32_16x16x32_bf16 v[88:91], a[140:143], v[60:63], v[88:91]
v_add_f32 v11, v11, v125
v_cvt_pk_bf16_f32 v172, v124, v125
v_mfma_f32_16x16x32_bf16 v[92:95], a[140:143], v[76:79], v[220:223]
v_exp_f32 v127, v127
v_mfma_f32_16x16x32_bf16 v[92:95], a[136:139], v[72:75], v[92:95]
ds_read_b128 a[160:163], v224 offset:24576
ds_read_b128 a[164:167], v225 offset:24576
v_mfma_f32_16x16x32_bf16 v[92:95], a[132:135], v[68:71], v[92:95]
v_exp_f32 v128, v128
v_mfma_f32_16x16x32_bf16 v[92:95], a[128:131], v[64:67], v[92:95]
ds_read_b128 a[168:171], v226 offset:24576
s_waitcnt lgkmcnt(3)
v_mfma_f32_16x16x32_bf16 v[96:99], a[144:147], v[16:19], v[208:211]
v_exp_f32 v129, v129
v_mfma_f32_16x16x32_bf16 v[96:99], a[148:151], v[20:23], v[96:99]
ds_read_b128 a[172:175], v227 offset:24576
v_add_f32 v10, v10, v126
v_mfma_f32_16x16x32_bf16 v[96:99], a[152:155], v[24:27], v[96:99]
buffer_load_dwordx4 v241, s[20:23], s41 offen offset:3072 lds
v_mfma_f32_16x16x32_bf16 v[96:99], a[156:159], v[28:31], v[96:99]
s_add_u32 s41, s41, 16384
v_exp_f32 v130, v130
v_mfma_f32_16x16x32_bf16 v[100:103], a[156:159], v[44:47], v[212:215]
s_add_u32 m0, s39, 0
v_exp_f32 v131, v131
v_mfma_f32_16x16x32_bf16 v[100:103], a[152:155], v[40:43], v[100:103]
v_add_f32 v11, v11, v127
v_cvt_pk_bf16_f32 v173, v126, v127
v_mfma_f32_16x16x32_bf16 v[100:103], a[148:151], v[36:39], v[100:103]
v_exp_f32 v132, v132
v_mfma_f32_16x16x32_bf16 v[100:103], a[144:147], v[32:35], v[100:103]
v_cvt_pk_bf16_f32 v162, v128, v129
v_cvt_pk_bf16_f32 v163, v130, v131
v_mfma_f32_16x16x32_bf16 v[104:107], a[144:147], v[48:51], v[216:219]
v_exp_f32 v133, v133
v_mfma_f32_16x16x32_bf16 v[104:107], a[148:151], v[52:55], v[104:107]
v_add_f32 v8, v8, v132
v_add_f32 v9, v9, v133
v_mfma_f32_16x16x32_bf16 v[104:107], a[152:155], v[56:59], v[104:107]
v_exp_f32 v134, v134
v_mfma_f32_16x16x32_bf16 v[104:107], a[156:159], v[60:63], v[104:107]
v_cvt_pk_bf16_f32 v166, v132, v133
v_add_f32 v8, v8, v134
v_mfma_f32_16x16x32_bf16 v[108:111], a[156:159], v[76:79], v[220:223]
v_exp_f32 v135, v135
v_mfma_f32_16x16x32_bf16 v[108:111], a[152:155], v[72:75], v[108:111]
ds_read_b128 a[176:179], v224 offset:28672
ds_read_b128 a[180:183], v225 offset:28672
v_mfma_f32_16x16x32_bf16 v[108:111], a[148:151], v[68:71], v[108:111]
buffer_load_dwordx4 v236, s[16:19], s40 offen offset:0 lds
v_mfma_f32_16x16x32_bf16 v[108:111], a[144:147], v[64:67], v[108:111]
s_waitcnt lgkmcnt(2)
v_exp_f32 v136, v136
v_mfma_f32_16x16x32_bf16 v[112:115], a[160:163], v[16:19], v[208:211]
v_exp_f32 v137, v137
v_mfma_f32_16x16x32_bf16 v[112:115], a[164:167], v[20:23], v[112:115]
ds_read_b128 a[184:187], v226 offset:28672
ds_read_b128 a[188:191], v227 offset:28672
v_mfma_f32_16x16x32_bf16 v[112:115], a[168:171], v[24:27], v[112:115]
v_exp_f32 v138, v138
v_mfma_f32_16x16x32_bf16 v[112:115], a[172:175], v[28:31], v[112:115]
v_add_f32 v9, v9, v135
v_cvt_pk_bf16_f32 v167, v134, v135
v_mfma_f32_16x16x32_bf16 v[116:119], a[172:175], v[44:47], v[212:215]
v_exp_f32 v139, v139
v_mfma_f32_16x16x32_bf16 v[116:119], a[168:171], v[40:43], v[116:119]
v_cvt_pk_bf16_f32 v170, v136, v137
v_cvt_pk_bf16_f32 v171, v138, v139
v_mfma_f32_16x16x32_bf16 v[116:119], a[164:167], v[36:39], v[116:119]
v_exp_f32 v140, v140
v_mfma_f32_16x16x32_bf16 v[116:119], a[160:163], v[32:35], v[116:119]
v_add_f32 v10, v10, v140
v_mfma_f32_16x16x32_bf16 v[120:123], a[160:163], v[48:51], v[216:219]
v_exp_f32 v141, v141
v_mfma_f32_16x16x32_bf16 v[120:123], a[164:167], v[52:55], v[120:123]
v_add_f32 v11, v11, v141
v_cvt_pk_bf16_f32 v174, v140, v141
v_mfma_f32_16x16x32_bf16 v[120:123], a[168:171], v[56:59], v[120:123]
buffer_load_dwordx4 v237, s[16:19], s40 offen offset:1024 lds
v_mfma_f32_16x16x32_bf16 v[120:123], a[172:175], v[60:63], v[120:123]
v_exp_f32 v142, v142
v_mfma_f32_16x16x32_bf16 v[124:127], a[172:175], v[76:79], v[220:223]
ds_read_b64_tr_b16 a[128:129], v228 offset:0
ds_read_b64_tr_b16 a[130:131], v228 offset:4096
v_mfma_f32_16x16x32_bf16 v[124:127], a[168:171], v[72:75], v[124:127]
v_exp_f32 v143, v143
v_mfma_f32_16x16x32_bf16 v[124:127], a[164:167], v[68:71], v[124:127]
ds_read_b64_tr_b16 a[132:133], v228 offset:8192
ds_read_b64_tr_b16 a[134:135], v228 offset:12288
v_mfma_f32_16x16x32_bf16 v[124:127], a[160:163], v[64:67], v[124:127]
v_add_f32 v10, v10, v142
s_waitcnt lgkmcnt(4)
v_mfma_f32_16x16x32_bf16 v[128:131], a[176:179], v[16:19], v[208:211]
v_exp_f32 v80, v80
v_mfma_f32_16x16x32_bf16 v[128:131], a[180:183], v[20:23], v[128:131]
v_add_f32 v11, v11, v143
v_cvt_pk_bf16_f32 v175, v142, v143
v_mfma_f32_16x16x32_bf16 v[128:131], a[184:187], v[24:27], v[128:131]
v_exp_f32 v81, v81
v_mfma_f32_16x16x32_bf16 v[128:131], a[188:191], v[28:31], v[128:131]
v_cvt_pk_bf16_f32 v176, v80, v81
v_mfma_f32_16x16x32_bf16 v[132:135], a[188:191], v[44:47], v[212:215]
v_exp_f32 v82, v82
v_mfma_f32_16x16x32_bf16 v[132:135], a[184:187], v[40:43], v[132:135]
ds_read_b64_tr_b16 a[136:137], v229 offset:0
ds_read_b64_tr_b16 a[138:139], v229 offset:4096
v_mfma_f32_16x16x32_bf16 v[132:135], a[180:183], v[36:39], v[132:135]
buffer_load_dwordx4 v238, s[16:19], s40 offen offset:2048 lds
v_mfma_f32_16x16x32_bf16 v[132:135], a[176:179], v[32:35], v[132:135]
v_exp_f32 v83, v83
v_mfma_f32_16x16x32_bf16 v[136:139], a[176:179], v[48:51], v[216:219]
ds_read_b64_tr_b16 a[140:141], v229 offset:8192
ds_read_b64_tr_b16 a[142:143], v229 offset:12288
v_mfma_f32_16x16x32_bf16 v[136:139], a[180:183], v[52:55], v[136:139]
v_exp_f32 v84, v84
v_mfma_f32_16x16x32_bf16 v[136:139], a[184:187], v[56:59], v[136:139]
v_cvt_pk_bf16_f32 v177, v82, v83
v_add_f32 v8, v8, v84
v_mfma_f32_16x16x32_bf16 v[136:139], a[188:191], v[60:63], v[136:139]
v_exp_f32 v85, v85
v_mfma_f32_16x16x32_bf16 v[140:143], a[188:191], v[76:79], v[220:223]
ds_read_b64_tr_b16 a[144:145], v230 offset:0
ds_read_b64_tr_b16 a[146:147], v230 offset:4096
v_mfma_f32_16x16x32_bf16 v[140:143], a[184:187], v[72:75], v[140:143]
v_exp_f32 v86, v86
v_mfma_f32_16x16x32_bf16 v[140:143], a[180:183], v[68:71], v[140:143]
ds_read_b64_tr_b16 a[148:149], v230 offset:8192
ds_read_b64_tr_b16 a[150:151], v230 offset:12288
v_mfma_f32_16x16x32_bf16 v[140:143], a[176:179], v[64:67], v[140:143]
s_waitcnt lgkmcnt(4)
v_exp_f32 v87, v87
v_mfma_f32_16x16x32_bf16 a[0:3], a[128:131], v[144:147], a[0:3]
v_add_f32 v9, v9, v85
v_cvt_pk_bf16_f32 v180, v84, v85
v_mfma_f32_16x16x32_bf16 a[0:3], a[132:135], v[160:163], a[0:3]
v_exp_f32 v88, v88
v_mfma_f32_16x16x32_bf16 a[4:7], a[132:135], v[164:167], a[4:7]
v_add_f32 v8, v8, v86
v_add_f32 v9, v9, v87
v_mfma_f32_16x16x32_bf16 a[4:7], a[128:131], v[148:151], a[4:7]
buffer_load_dwordx4 v239, s[16:19], s40 offen offset:3072 lds
v_mfma_f32_16x16x32_bf16 a[8:11], a[128:131], v[152:155], a[8:11]
s_add_u32 s40, s40, 16384
v_exp_f32 v89, v89
v_mfma_f32_16x16x32_bf16 a[8:11], a[132:135], v[168:171], a[8:11]
ds_read_b64_tr_b16 a[152:153], v231 offset:0
ds_read_b64_tr_b16 a[154:155], v231 offset:4096
v_mfma_f32_16x16x32_bf16 a[12:15], a[132:135], v[172:175], a[12:15]
v_exp_f32 v90, v90
v_mfma_f32_16x16x32_bf16 a[12:15], a[128:131], v[156:159], a[12:15]
ds_read_b64_tr_b16 a[156:157], v231 offset:8192
ds_read_b64_tr_b16 a[158:159], v231 offset:12288
v_mfma_f32_16x16x32_bf16 a[16:19], a[136:139], v[144:147], a[16:19]
v_exp_f32 v91, v91
v_mfma_f32_16x16x32_bf16 a[16:19], a[140:143], v[160:163], a[16:19]
v_cvt_pk_bf16_f32 v181, v86, v87
v_cvt_pk_bf16_f32 v184, v88, v89
v_mfma_f32_16x16x32_bf16 a[20:23], a[140:143], v[164:167], a[20:23]
v_exp_f32 v92, v92
v_mfma_f32_16x16x32_bf16 a[20:23], a[136:139], v[148:151], a[20:23]
v_cvt_pk_bf16_f32 v185, v90, v91
v_add_f32 v10, v10, v92
v_mfma_f32_16x16x32_bf16 a[24:27], a[136:139], v[152:155], a[24:27]
v_exp_f32 v93, v93
v_mfma_f32_16x16x32_bf16 a[24:27], a[140:143], v[168:171], a[24:27]
ds_read_b64_tr_b16 a[160:161], v232 offset:0
ds_read_b64_tr_b16 a[162:163], v232 offset:4096
v_mfma_f32_16x16x32_bf16 a[28:31], a[140:143], v[172:175], a[28:31]
v_exp_f32 v94, v94
v_mfma_f32_16x16x32_bf16 a[28:31], a[136:139], v[156:159], a[28:31]
ds_read_b64_tr_b16 a[164:165], v232 offset:8192
s_waitcnt lgkmcnt(3)
v_mfma_f32_16x16x32_bf16 a[32:35], a[144:147], v[144:147], a[32:35]
v_exp_f32 v95, v95
v_mfma_f32_16x16x32_bf16 a[32:35], a[148:151], v[160:163], a[32:35]
ds_read_b64_tr_b16 a[166:167], v232 offset:12288
v_add_f32 v11, v11, v93
v_mfma_f32_16x16x32_bf16 a[36:39], a[148:151], v[164:167], a[36:39]
v_exp_f32 v96, v96
v_mfma_f32_16x16x32_bf16 a[36:39], a[144:147], v[148:151], a[36:39]
v_cvt_pk_bf16_f32 v188, v92, v93
v_add_f32 v10, v10, v94
v_mfma_f32_16x16x32_bf16 a[40:43], a[144:147], v[152:155], a[40:43]
v_exp_f32 v97, v97
v_mfma_f32_16x16x32_bf16 a[40:43], a[148:151], v[168:171], a[40:43]
ds_read_b64_tr_b16 a[168:169], v233 offset:0
ds_read_b64_tr_b16 a[170:171], v233 offset:4096
v_mfma_f32_16x16x32_bf16 a[44:47], a[148:151], v[172:175], a[44:47]
v_exp_f32 v98, v98
v_mfma_f32_16x16x32_bf16 a[44:47], a[144:147], v[156:159], a[44:47]
ds_read_b64_tr_b16 a[172:173], v233 offset:8192
ds_read_b64_tr_b16 a[174:175], v233 offset:12288
v_mfma_f32_16x16x32_bf16 a[48:51], a[152:155], v[144:147], a[48:51]
v_exp_f32 v99, v99
v_mfma_f32_16x16x32_bf16 a[48:51], a[156:159], v[160:163], a[48:51]
v_add_f32 v11, v11, v95
v_cvt_pk_bf16_f32 v189, v94, v95
v_mfma_f32_16x16x32_bf16 a[52:55], a[156:159], v[164:167], a[52:55]
v_exp_f32 v100, v100
v_mfma_f32_16x16x32_bf16 a[52:55], a[152:155], v[148:151], a[52:55]
v_cvt_pk_bf16_f32 v178, v96, v97
v_cvt_pk_bf16_f32 v179, v98, v99
v_mfma_f32_16x16x32_bf16 a[56:59], a[152:155], v[152:155], a[56:59]
v_exp_f32 v101, v101
v_mfma_f32_16x16x32_bf16 a[56:59], a[156:159], v[168:171], a[56:59]
ds_read_b64_tr_b16 a[176:177], v234 offset:0
ds_read_b64_tr_b16 a[178:179], v234 offset:4096
v_mfma_f32_16x16x32_bf16 a[60:63], a[156:159], v[172:175], a[60:63]
v_exp_f32 v102, v102
v_mfma_f32_16x16x32_bf16 a[60:63], a[152:155], v[156:159], a[60:63]
ds_read_b64_tr_b16 a[180:181], v234 offset:8192
s_waitcnt lgkmcnt(3)
v_mfma_f32_16x16x32_bf16 a[64:67], a[160:163], v[144:147], a[64:67]
v_exp_f32 v103, v103
v_mfma_f32_16x16x32_bf16 a[64:67], a[164:167], v[160:163], a[64:67]
ds_read_b64_tr_b16 a[182:183], v234 offset:12288
ds_read_b64_tr_b16 a[184:185], v235 offset:0
v_mfma_f32_16x16x32_bf16 a[68:71], a[164:167], v[164:167], a[68:71]
v_exp_f32 v104, v104
v_mfma_f32_16x16x32_bf16 a[68:71], a[160:163], v[148:151], a[68:71]
ds_read_b64_tr_b16 a[186:187], v235 offset:4096
ds_read_b64_tr_b16 a[188:189], v235 offset:8192
v_mfma_f32_16x16x32_bf16 a[72:75], a[160:163], v[152:155], a[72:75]
v_exp_f32 v105, v105
v_mfma_f32_16x16x32_bf16 a[72:75], a[164:167], v[168:171], a[72:75]
ds_read_b64_tr_b16 a[190:191], v235 offset:12288
v_add_f32 v8, v8, v100
v_add_f32 v9, v9, v101
v_mfma_f32_16x16x32_bf16 a[76:79], a[164:167], v[172:175], a[76:79]
v_exp_f32 v106, v106
v_mfma_f32_16x16x32_bf16 a[76:79], a[160:163], v[156:159], a[76:79]
v_cvt_pk_bf16_f32 v182, v100, v101
v_add_f32 v8, v8, v102
v_mfma_f32_16x16x32_bf16 a[80:83], a[168:171], v[144:147], a[80:83]
v_exp_f32 v107, v107
v_mfma_f32_16x16x32_bf16 a[80:83], a[172:175], v[160:163], a[80:83]
v_add_f32 v9, v9, v103
v_cvt_pk_bf16_f32 v183, v102, v103
v_mfma_f32_16x16x32_bf16 a[84:87], a[172:175], v[164:167], a[84:87]
v_exp_f32 v108, v108
v_mfma_f32_16x16x32_bf16 a[84:87], a[168:171], v[148:151], a[84:87]
v_cvt_pk_bf16_f32 v186, v104, v105
v_cvt_pk_bf16_f32 v187, v106, v107
v_mfma_f32_16x16x32_bf16 a[88:91], a[168:171], v[152:155], a[88:91]
v_exp_f32 v109, v109
v_mfma_f32_16x16x32_bf16 a[88:91], a[172:175], v[168:171], a[88:91]
v_add_f32 v10, v10, v108
v_add_f32 v11, v11, v109
v_mfma_f32_16x16x32_bf16 a[92:95], a[172:175], v[172:175], a[92:95]
v_exp_f32 v110, v110
v_mfma_f32_16x16x32_bf16 a[92:95], a[168:171], v[156:159], a[92:95]
s_waitcnt vmcnt(16) lgkmcnt(0)
s_barrier
v_mfma_f32_16x16x32_bf16 a[96:99], a[176:179], v[144:147], a[96:99]
s_add_u32 m0, s43, 0
v_exp_f32 v111, v111
v_mfma_f32_16x16x32_bf16 a[96:99], a[180:183], v[160:163], a[96:99]
ds_read_b128 a[128:131], v224 offset:32768
ds_read_b128 a[132:135], v225 offset:32768
v_mfma_f32_16x16x32_bf16 a[100:103], a[180:183], v[164:167], a[100:103]
buffer_load_dwordx4 v240, s[20:23], s41 offen offset:0 lds
v_mfma_f32_16x16x32_bf16 a[100:103], a[176:179], v[148:151], a[100:103]
v_exp_f32 v112, v112
v_mfma_f32_16x16x32_bf16 a[104:107], a[176:179], v[152:155], a[104:107]
v_exp_f32 v113, v113
v_mfma_f32_16x16x32_bf16 a[104:107], a[180:183], v[168:171], a[104:107]
ds_read_b128 a[136:139], v226 offset:32768
ds_read_b128 a[140:143], v227 offset:32768
v_mfma_f32_16x16x32_bf16 a[108:111], a[180:183], v[172:175], a[108:111]
v_exp_f32 v114, v114
v_mfma_f32_16x16x32_bf16 a[108:111], a[176:179], v[156:159], a[108:111]
v_cvt_pk_bf16_f32 v190, v108, v109
v_add_f32 v10, v10, v110
v_mfma_f32_16x16x32_bf16 a[112:115], a[184:187], v[144:147], a[112:115]
v_exp_f32 v115, v115
v_mfma_f32_16x16x32_bf16 a[112:115], a[188:191], v[160:163], a[112:115]
v_add_f32 v11, v11, v111
v_cvt_pk_bf16_f32 v191, v110, v111
v_mfma_f32_16x16x32_bf16 a[116:119], a[188:191], v[164:167], a[116:119]
v_exp_f32 v116, v116
v_mfma_f32_16x16x32_bf16 a[116:119], a[184:187], v[148:151], a[116:119]
v_cvt_pk_bf16_f32 v192, v112, v113
v_cvt_pk_bf16_f32 v193, v114, v115
v_mfma_f32_16x16x32_bf16 a[120:123], a[184:187], v[152:155], a[120:123]
v_exp_f32 v117, v117
v_mfma_f32_16x16x32_bf16 a[120:123], a[188:191], v[168:171], a[120:123]
v_add_f32 v8, v8, v116
v_add_f32 v9, v9, v117
v_mfma_f32_16x16x32_bf16 a[124:127], a[188:191], v[172:175], a[124:127]
buffer_load_dwordx4 v241, s[20:23], s41 offen offset:1024 lds
v_mfma_f32_16x16x32_bf16 a[124:127], a[184:187], v[156:159], a[124:127]
v_exp_f32 v118, v118
v_mfma_f32_16x16x32_bf16 a[192:195], a[208:211], v[144:147], a[192:195]
v_exp_f32 v119, v119
v_mfma_f32_16x16x32_bf16 a[192:195], a[208:211], v[160:163], a[192:195]
ds_read_b128 a[144:147], v224 offset:36864
ds_read_b128 a[148:151], v225 offset:36864
v_mfma_f32_16x16x32_bf16 a[200:203], a[208:211], v[152:155], a[200:203]
v_exp_f32 v120, v120
v_mfma_f32_16x16x32_bf16 a[200:203], a[208:211], v[168:171], a[200:203]
ds_read_b128 a[152:155], v226 offset:36864
s_waitcnt lgkmcnt(3)
v_mfma_f32_16x16x32_bf16 v[80:83], a[128:131], v[16:19], v[208:211]
v_exp_f32 v121, v121
v_mfma_f32_16x16x32_bf16 v[80:83], a[132:135], v[20:23], v[80:83]
ds_read_b128 a[156:159], v227 offset:36864
v_cvt_pk_bf16_f32 v196, v116, v117
v_mfma_f32_16x16x32_bf16 v[80:83], a[136:139], v[24:27], v[80:83]
v_exp_f32 v122, v122
v_mfma_f32_16x16x32_bf16 v[80:83], a[140:143], v[28:31], v[80:83]
v_add_f32 v8, v8, v118
v_add_f32 v9, v9, v119
v_mfma_f32_16x16x32_bf16 v[84:87], a[140:143], v[44:47], v[212:215]
v_exp_f32 v123, v123
v_mfma_f32_16x16x32_bf16 v[84:87], a[136:139], v[40:43], v[84:87]
v_cvt_pk_bf16_f32 v197, v118, v119
v_cvt_pk_bf16_f32 v200, v120, v121
v_mfma_f32_16x16x32_bf16 v[84:87], a[132:135], v[36:39], v[84:87]
buffer_load_dwordx4 v240, s[20:23], s41 offen offset:2048 lds
v_mfma_f32_16x16x32_bf16 v[84:87], a[128:131], v[32:35], v[84:87]
v_exp_f32 v124, v124
v_mfma_f32_16x16x32_bf16 v[88:91], a[128:131], v[48:51], v[216:219]
v_exp_f32 v125, v125
v_mfma_f32_16x16x32_bf16 v[88:91], a[132:135], v[52:55], v[88:91]
v_cvt_pk_bf16_f32 v201, v122, v123
v_add_f32 v10, v10, v124
v_mfma_f32_16x16x32_bf16 v[88:91], a[136:139], v[56:59], v[88:91]
v_exp_f32 v126, v126
v_mfma_f32_16x16x32_bf16 v[88:91], a[140:143], v[60:63], v[88:91]
v_add_f32 v11, v11, v125
v_cvt_pk_bf16_f32 v204, v124, v125
v_mfma_f32_16x16x32_bf16 v[92:95], a[140:143], v[76:79], v[220:223]
v_exp_f32 v127, v127
v_mfma_f32_16x16x32_bf16 v[92:95], a[136:139], v[72:75], v[92:95]
ds_read_b128 a[160:163], v224 offset:40960
ds_read_b128 a[164:167], v225 offset:40960
v_mfma_f32_16x16x32_bf16 v[92:95], a[132:135], v[68:71], v[92:95]
v_exp_f32 v128, v128
v_mfma_f32_16x16x32_bf16 v[92:95], a[128:131], v[64:67], v[92:95]
ds_read_b128 a[168:171], v226 offset:40960
s_waitcnt lgkmcnt(3)
v_mfma_f32_16x16x32_bf16 v[96:99], a[144:147], v[16:19], v[208:211]
v_exp_f32 v129, v129
v_mfma_f32_16x16x32_bf16 v[96:99], a[148:151], v[20:23], v[96:99]
ds_read_b128 a[172:175], v227 offset:40960
v_add_f32 v10, v10, v126
v_mfma_f32_16x16x32_bf16 v[96:99], a[152:155], v[24:27], v[96:99]
buffer_load_dwordx4 v241, s[20:23], s41 offen offset:3072 lds
v_mfma_f32_16x16x32_bf16 v[96:99], a[156:159], v[28:31], v[96:99]
s_add_u32 s41, s41, 16384
v_exp_f32 v130, v130
v_mfma_f32_16x16x32_bf16 v[100:103], a[156:159], v[44:47], v[212:215]
s_add_u32 m0, s39, 16384
v_exp_f32 v131, v131
v_mfma_f32_16x16x32_bf16 v[100:103], a[152:155], v[40:43], v[100:103]
v_add_f32 v11, v11, v127
v_cvt_pk_bf16_f32 v205, v126, v127
v_mfma_f32_16x16x32_bf16 v[100:103], a[148:151], v[36:39], v[100:103]
v_exp_f32 v132, v132
v_mfma_f32_16x16x32_bf16 v[100:103], a[144:147], v[32:35], v[100:103]
v_cvt_pk_bf16_f32 v194, v128, v129
v_cvt_pk_bf16_f32 v195, v130, v131
v_mfma_f32_16x16x32_bf16 v[104:107], a[144:147], v[48:51], v[216:219]
v_exp_f32 v133, v133
v_mfma_f32_16x16x32_bf16 v[104:107], a[148:151], v[52:55], v[104:107]
v_add_f32 v8, v8, v132
v_add_f32 v9, v9, v133
v_mfma_f32_16x16x32_bf16 v[104:107], a[152:155], v[56:59], v[104:107]
v_exp_f32 v134, v134
v_mfma_f32_16x16x32_bf16 v[104:107], a[156:159], v[60:63], v[104:107]
v_cvt_pk_bf16_f32 v198, v132, v133
v_add_f32 v8, v8, v134
v_mfma_f32_16x16x32_bf16 v[108:111], a[156:159], v[76:79], v[220:223]
v_exp_f32 v135, v135
v_mfma_f32_16x16x32_bf16 v[108:111], a[152:155], v[72:75], v[108:111]
ds_read_b128 a[176:179], v224 offset:45056
ds_read_b128 a[180:183], v225 offset:45056
v_mfma_f32_16x16x32_bf16 v[108:111], a[148:151], v[68:71], v[108:111]
buffer_load_dwordx4 v236, s[16:19], s40 offen offset:0 lds
v_mfma_f32_16x16x32_bf16 v[108:111], a[144:147], v[64:67], v[108:111]
s_waitcnt lgkmcnt(2)
v_exp_f32 v136, v136
v_mfma_f32_16x16x32_bf16 v[112:115], a[160:163], v[16:19], v[208:211]
v_exp_f32 v137, v137
v_mfma_f32_16x16x32_bf16 v[112:115], a[164:167], v[20:23], v[112:115]
ds_read_b128 a[184:187], v226 offset:45056
ds_read_b128 a[188:191], v227 offset:45056
v_mfma_f32_16x16x32_bf16 v[112:115], a[168:171], v[24:27], v[112:115]
v_exp_f32 v138, v138
v_mfma_f32_16x16x32_bf16 v[112:115], a[172:175], v[28:31], v[112:115]
v_add_f32 v9, v9, v135
v_cvt_pk_bf16_f32 v199, v134, v135
v_mfma_f32_16x16x32_bf16 v[116:119], a[172:175], v[44:47], v[212:215]
v_exp_f32 v139, v139
v_mfma_f32_16x16x32_bf16 v[116:119], a[168:171], v[40:43], v[116:119]
v_cvt_pk_bf16_f32 v202, v136, v137
v_cvt_pk_bf16_f32 v203, v138, v139
v_mfma_f32_16x16x32_bf16 v[116:119], a[164:167], v[36:39], v[116:119]
v_exp_f32 v140, v140
v_mfma_f32_16x16x32_bf16 v[116:119], a[160:163], v[32:35], v[116:119]
v_add_f32 v10, v10, v140
v_mfma_f32_16x16x32_bf16 v[120:123], a[160:163], v[48:51], v[216:219]
v_exp_f32 v141, v141
v_mfma_f32_16x16x32_bf16 v[120:123], a[164:167], v[52:55], v[120:123]
v_add_f32 v11, v11, v141
v_cvt_pk_bf16_f32 v206, v140, v141
v_mfma_f32_16x16x32_bf16 v[120:123], a[168:171], v[56:59], v[120:123]
buffer_load_dwordx4 v237, s[16:19], s40 offen offset:1024 lds
v_mfma_f32_16x16x32_bf16 v[120:123], a[172:175], v[60:63], v[120:123]
v_exp_f32 v142, v142
v_mfma_f32_16x16x32_bf16 v[124:127], a[172:175], v[76:79], v[220:223]
ds_read_b64_tr_b16 a[128:129], v228 offset:16384
ds_read_b64_tr_b16 a[130:131], v228 offset:20480
v_mfma_f32_16x16x32_bf16 v[124:127], a[168:171], v[72:75], v[124:127]
v_exp_f32 v143, v143
v_mfma_f32_16x16x32_bf16 v[124:127], a[164:167], v[68:71], v[124:127]
ds_read_b64_tr_b16 a[132:133], v228 offset:24576
ds_read_b64_tr_b16 a[134:135], v228 offset:28672
v_mfma_f32_16x16x32_bf16 v[124:127], a[160:163], v[64:67], v[124:127]
v_add_f32 v10, v10, v142
s_waitcnt lgkmcnt(4)
v_mfma_f32_16x16x32_bf16 v[128:131], a[176:179], v[16:19], v[208:211]
v_exp_f32 v80, v80
v_mfma_f32_16x16x32_bf16 v[128:131], a[180:183], v[20:23], v[128:131]
v_add_f32 v11, v11, v143
v_cvt_pk_bf16_f32 v207, v142, v143
v_mfma_f32_16x16x32_bf16 v[128:131], a[184:187], v[24:27], v[128:131]
v_exp_f32 v81, v81
v_mfma_f32_16x16x32_bf16 v[128:131], a[188:191], v[28:31], v[128:131]
v_cvt_pk_bf16_f32 v144, v80, v81
v_mfma_f32_16x16x32_bf16 v[132:135], a[188:191], v[44:47], v[212:215]
v_exp_f32 v82, v82
v_mfma_f32_16x16x32_bf16 v[132:135], a[184:187], v[40:43], v[132:135]
ds_read_b64_tr_b16 a[136:137], v229 offset:16384
ds_read_b64_tr_b16 a[138:139], v229 offset:20480
v_mfma_f32_16x16x32_bf16 v[132:135], a[180:183], v[36:39], v[132:135]
buffer_load_dwordx4 v238, s[16:19], s40 offen offset:2048 lds
v_mfma_f32_16x16x32_bf16 v[132:135], a[176:179], v[32:35], v[132:135]
v_exp_f32 v83, v83
v_mfma_f32_16x16x32_bf16 v[136:139], a[176:179], v[48:51], v[216:219]
ds_read_b64_tr_b16 a[140:141], v229 offset:24576
ds_read_b64_tr_b16 a[142:143], v229 offset:28672
v_mfma_f32_16x16x32_bf16 v[136:139], a[180:183], v[52:55], v[136:139]
v_exp_f32 v84, v84
v_mfma_f32_16x16x32_bf16 v[136:139], a[184:187], v[56:59], v[136:139]
v_cvt_pk_bf16_f32 v145, v82, v83
v_add_f32 v8, v8, v84
v_mfma_f32_16x16x32_bf16 v[136:139], a[188:191], v[60:63], v[136:139]
v_exp_f32 v85, v85
v_mfma_f32_16x16x32_bf16 v[140:143], a[188:191], v[76:79], v[220:223]
ds_read_b64_tr_b16 a[144:145], v230 offset:16384
ds_read_b64_tr_b16 a[146:147], v230 offset:20480
v_mfma_f32_16x16x32_bf16 v[140:143], a[184:187], v[72:75], v[140:143]
v_exp_f32 v86, v86
v_mfma_f32_16x16x32_bf16 v[140:143], a[180:183], v[68:71], v[140:143]
ds_read_b64_tr_b16 a[148:149], v230 offset:24576
ds_read_b64_tr_b16 a[150:151], v230 offset:28672
v_mfma_f32_16x16x32_bf16 v[140:143], a[176:179], v[64:67], v[140:143]
s_waitcnt lgkmcnt(4)
v_exp_f32 v87, v87
v_mfma_f32_16x16x32_bf16 a[0:3], a[128:131], v[176:179], a[0:3]
v_add_f32 v9, v9, v85
v_cvt_pk_bf16_f32 v148, v84, v85
v_mfma_f32_16x16x32_bf16 a[0:3], a[132:135], v[192:195], a[0:3]
v_exp_f32 v88, v88
v_mfma_f32_16x16x32_bf16 a[4:7], a[132:135], v[196:199], a[4:7]
v_add_f32 v8, v8, v86
v_add_f32 v9, v9, v87
v_mfma_f32_16x16x32_bf16 a[4:7], a[128:131], v[180:183], a[4:7]
buffer_load_dwordx4 v239, s[16:19], s40 offen offset:3072 lds
v_mfma_f32_16x16x32_bf16 a[8:11], a[128:131], v[184:187], a[8:11]
s_add_u32 s40, s40, 16384
v_exp_f32 v89, v89
v_mfma_f32_16x16x32_bf16 a[8:11], a[132:135], v[200:203], a[8:11]
ds_read_b64_tr_b16 a[152:153], v231 offset:16384
ds_read_b64_tr_b16 a[154:155], v231 offset:20480
v_mfma_f32_16x16x32_bf16 a[12:15], a[132:135], v[204:207], a[12:15]
v_exp_f32 v90, v90
v_mfma_f32_16x16x32_bf16 a[12:15], a[128:131], v[188:191], a[12:15]
ds_read_b64_tr_b16 a[156:157], v231 offset:24576
ds_read_b64_tr_b16 a[158:159], v231 offset:28672
v_mfma_f32_16x16x32_bf16 a[16:19], a[136:139], v[176:179], a[16:19]
v_exp_f32 v91, v91
v_mfma_f32_16x16x32_bf16 a[16:19], a[140:143], v[192:195], a[16:19]
v_cvt_pk_bf16_f32 v149, v86, v87
v_cvt_pk_bf16_f32 v152, v88, v89
v_mfma_f32_16x16x32_bf16 a[20:23], a[140:143], v[196:199], a[20:23]
v_exp_f32 v92, v92
v_mfma_f32_16x16x32_bf16 a[20:23], a[136:139], v[180:183], a[20:23]
v_cvt_pk_bf16_f32 v153, v90, v91
v_add_f32 v10, v10, v92
v_mfma_f32_16x16x32_bf16 a[24:27], a[136:139], v[184:187], a[24:27]
v_exp_f32 v93, v93
v_mfma_f32_16x16x32_bf16 a[24:27], a[140:143], v[200:203], a[24:27]
ds_read_b64_tr_b16 a[160:161], v232 offset:16384
ds_read_b64_tr_b16 a[162:163], v232 offset:20480
v_mfma_f32_16x16x32_bf16 a[28:31], a[140:143], v[204:207], a[28:31]
v_exp_f32 v94, v94
v_mfma_f32_16x16x32_bf16 a[28:31], a[136:139], v[188:191], a[28:31]
ds_read_b64_tr_b16 a[164:165], v232 offset:24576
s_waitcnt lgkmcnt(3)
v_mfma_f32_16x16x32_bf16 a[32:35], a[144:147], v[176:179], a[32:35]
v_exp_f32 v95, v95
v_mfma_f32_16x16x32_bf16 a[32:35], a[148:151], v[192:195], a[32:35]
ds_read_b64_tr_b16 a[166:167], v232 offset:28672
v_add_f32 v11, v11, v93
v_mfma_f32_16x16x32_bf16 a[36:39], a[148:151], v[196:199], a[36:39]
v_exp_f32 v96, v96
v_mfma_f32_16x16x32_bf16 a[36:39], a[144:147], v[180:183], a[36:39]
v_cvt_pk_bf16_f32 v156, v92, v93
v_add_f32 v10, v10, v94
v_mfma_f32_16x16x32_bf16 a[40:43], a[144:147], v[184:187], a[40:43]
v_exp_f32 v97, v97
v_mfma_f32_16x16x32_bf16 a[40:43], a[148:151], v[200:203], a[40:43]
ds_read_b64_tr_b16 a[168:169], v233 offset:16384
ds_read_b64_tr_b16 a[170:171], v233 offset:20480
v_mfma_f32_16x16x32_bf16 a[44:47], a[148:151], v[204:207], a[44:47]
v_exp_f32 v98, v98
v_mfma_f32_16x16x32_bf16 a[44:47], a[144:147], v[188:191], a[44:47]
ds_read_b64_tr_b16 a[172:173], v233 offset:24576
ds_read_b64_tr_b16 a[174:175], v233 offset:28672
v_mfma_f32_16x16x32_bf16 a[48:51], a[152:155], v[176:179], a[48:51]
v_exp_f32 v99, v99
v_mfma_f32_16x16x32_bf16 a[48:51], a[156:159], v[192:195], a[48:51]
v_add_f32 v11, v11, v95
v_cvt_pk_bf16_f32 v157, v94, v95
v_mfma_f32_16x16x32_bf16 a[52:55], a[156:159], v[196:199], a[52:55]
v_exp_f32 v100, v100
v_mfma_f32_16x16x32_bf16 a[52:55], a[152:155], v[180:183], a[52:55]
v_cvt_pk_bf16_f32 v146, v96, v97
v_cvt_pk_bf16_f32 v147, v98, v99
v_mfma_f32_16x16x32_bf16 a[56:59], a[152:155], v[184:187], a[56:59]
v_exp_f32 v101, v101
v_mfma_f32_16x16x32_bf16 a[56:59], a[156:159], v[200:203], a[56:59]
ds_read_b64_tr_b16 a[176:177], v234 offset:16384
ds_read_b64_tr_b16 a[178:179], v234 offset:20480
v_mfma_f32_16x16x32_bf16 a[60:63], a[156:159], v[204:207], a[60:63]
v_exp_f32 v102, v102
v_mfma_f32_16x16x32_bf16 a[60:63], a[152:155], v[188:191], a[60:63]
ds_read_b64_tr_b16 a[180:181], v234 offset:24576
s_waitcnt lgkmcnt(3)
v_mfma_f32_16x16x32_bf16 a[64:67], a[160:163], v[176:179], a[64:67]
v_exp_f32 v103, v103
v_mfma_f32_16x16x32_bf16 a[64:67], a[164:167], v[192:195], a[64:67]
ds_read_b64_tr_b16 a[182:183], v234 offset:28672
ds_read_b64_tr_b16 a[184:185], v235 offset:16384
v_mfma_f32_16x16x32_bf16 a[68:71], a[164:167], v[196:199], a[68:71]
v_exp_f32 v104, v104
v_mfma_f32_16x16x32_bf16 a[68:71], a[160:163], v[180:183], a[68:71]
ds_read_b64_tr_b16 a[186:187], v235 offset:20480
ds_read_b64_tr_b16 a[188:189], v235 offset:24576
v_mfma_f32_16x16x32_bf16 a[72:75], a[160:163], v[184:187], a[72:75]
v_exp_f32 v105, v105
v_mfma_f32_16x16x32_bf16 a[72:75], a[164:167], v[200:203], a[72:75]
ds_read_b64_tr_b16 a[190:191], v235 offset:28672
v_add_f32 v8, v8, v100
v_add_f32 v9, v9, v101
v_mfma_f32_16x16x32_bf16 a[76:79], a[164:167], v[204:207], a[76:79]
v_exp_f32 v106, v106
v_mfma_f32_16x16x32_bf16 a[76:79], a[160:163], v[188:191], a[76:79]
v_cvt_pk_bf16_f32 v150, v100, v101
v_add_f32 v8, v8, v102
v_mfma_f32_16x16x32_bf16 a[80:83], a[168:171], v[176:179], a[80:83]
v_exp_f32 v107, v107
v_mfma_f32_16x16x32_bf16 a[80:83], a[172:175], v[192:195], a[80:83]
v_add_f32 v9, v9, v103
v_cvt_pk_bf16_f32 v151, v102, v103
v_mfma_f32_16x16x32_bf16 a[84:87], a[172:175], v[196:199], a[84:87]
v_exp_f32 v108, v108
v_mfma_f32_16x16x32_bf16 a[84:87], a[168:171], v[180:183], a[84:87]
v_cvt_pk_bf16_f32 v154, v104, v105
v_cvt_pk_bf16_f32 v155, v106, v107
v_mfma_f32_16x16x32_bf16 a[88:91], a[168:171], v[184:187], a[88:91]
v_exp_f32 v109, v109
v_mfma_f32_16x16x32_bf16 a[88:91], a[172:175], v[200:203], a[88:91]
v_add_f32 v10, v10, v108
v_add_f32 v11, v11, v109
v_mfma_f32_16x16x32_bf16 a[92:95], a[172:175], v[204:207], a[92:95]
v_exp_f32 v110, v110
v_mfma_f32_16x16x32_bf16 a[92:95], a[168:171], v[188:191], a[92:95]
s_waitcnt vmcnt(16) lgkmcnt(0)
s_barrier
v_mfma_f32_16x16x32_bf16 a[96:99], a[176:179], v[176:179], a[96:99]
global_load_dwordx4 a[244:247], v[12:13], off
v_mfma_f32_16x16x32_bf16 a[96:99], a[180:183], v[192:195], a[96:99]
s_add_u32 m0, s43, 16384
v_exp_f32 v111, v111
v_mfma_f32_16x16x32_bf16 a[100:103], a[180:183], v[196:199], a[100:103]
v_exp_f32 v112, v112
v_mfma_f32_16x16x32_bf16 a[100:103], a[176:179], v[180:183], a[100:103]
ds_read_b128 a[128:131], v224 offset:49152
ds_read_b128 a[132:135], v225 offset:49152
v_mfma_f32_16x16x32_bf16 a[104:107], a[176:179], v[184:187], a[104:107]
v_exp_f32 v113, v113
v_mfma_f32_16x16x32_bf16 a[104:107], a[180:183], v[200:203], a[104:107]
ds_read_b128 a[136:139], v226 offset:49152
ds_read_b128 a[140:143], v227 offset:49152
v_mfma_f32_16x16x32_bf16 a[108:111], a[180:183], v[204:207], a[108:111]
v_exp_f32 v114, v114
v_mfma_f32_16x16x32_bf16 a[108:111], a[176:179], v[188:191], a[108:111]
v_cvt_pk_bf16_f32 v158, v108, v109
v_add_f32 v10, v10, v110
v_mfma_f32_16x16x32_bf16 a[112:115], a[184:187], v[176:179], a[112:115]
v_exp_f32 v115, v115
v_mfma_f32_16x16x32_bf16 a[112:115], a[188:191], v[192:195], a[112:115]
v_add_f32 v11, v11, v111
v_cvt_pk_bf16_f32 v159, v110, v111
v_mfma_f32_16x16x32_bf16 a[116:119], a[188:191], v[196:199], a[116:119]
v_exp_f32 v116, v116
v_mfma_f32_16x16x32_bf16 a[116:119], a[184:187], v[180:183], a[116:119]
v_cvt_pk_bf16_f32 v160, v112, v113
v_cvt_pk_bf16_f32 v161, v114, v115
v_mfma_f32_16x16x32_bf16 a[120:123], a[184:187], v[184:187], a[120:123]
buffer_load_dwordx4 v240, s[20:23], s41 offen offset:0 lds
v_mfma_f32_16x16x32_bf16 a[120:123], a[188:191], v[200:203], a[120:123]
v_exp_f32 v117, v117
v_mfma_f32_16x16x32_bf16 a[124:127], a[188:191], v[204:207], a[124:127]
v_exp_f32 v118, v118
v_mfma_f32_16x16x32_bf16 a[124:127], a[184:187], v[188:191], a[124:127]
v_add_f32 v8, v8, v116
v_add_f32 v9, v9, v117
v_mfma_f32_16x16x32_bf16 a[192:195], a[208:211], v[176:179], a[192:195]
v_exp_f32 v119, v119
v_mfma_f32_16x16x32_bf16 a[192:195], a[208:211], v[192:195], a[192:195]
ds_read_b128 a[144:147], v224 offset:53248
ds_read_b128 a[148:151], v225 offset:53248
v_mfma_f32_16x16x32_bf16 a[200:203], a[208:211], v[184:187], a[200:203]
v_exp_f32 v120, v120
v_mfma_f32_16x16x32_bf16 a[200:203], a[208:211], v[200:203], a[200:203]
ds_read_b128 a[152:155], v226 offset:53248
s_waitcnt lgkmcnt(3)
v_mfma_f32_16x16x32_bf16 v[80:83], a[128:131], v[16:19], v[208:211]
v_exp_f32 v121, v121
v_mfma_f32_16x16x32_bf16 v[80:83], a[132:135], v[20:23], v[80:83]
ds_read_b128 a[156:159], v227 offset:53248
v_cvt_pk_bf16_f32 v164, v116, v117
v_mfma_f32_16x16x32_bf16 v[80:83], a[136:139], v[24:27], v[80:83]
v_exp_f32 v122, v122
v_mfma_f32_16x16x32_bf16 v[80:83], a[140:143], v[28:31], v[80:83]
v_add_f32 v8, v8, v118
v_add_f32 v9, v9, v119
v_mfma_f32_16x16x32_bf16 v[84:87], a[140:143], v[44:47], v[212:215]
buffer_load_dwordx4 v241, s[20:23], s41 offen offset:1024 lds
v_mfma_f32_16x16x32_bf16 v[84:87], a[136:139], v[40:43], v[84:87]
v_exp_f32 v123, v123
v_mfma_f32_16x16x32_bf16 v[84:87], a[132:135], v[36:39], v[84:87]
v_exp_f32 v124, v124
v_mfma_f32_16x16x32_bf16 v[84:87], a[128:131], v[32:35], v[84:87]
v_cvt_pk_bf16_f32 v165, v118, v119
v_cvt_pk_bf16_f32 v168, v120, v121
v_mfma_f32_16x16x32_bf16 v[88:91], a[128:131], v[48:51], v[216:219]
v_exp_f32 v125, v125
v_mfma_f32_16x16x32_bf16 v[88:91], a[132:135], v[52:55], v[88:91]
v_cvt_pk_bf16_f32 v169, v122, v123
v_add_f32 v10, v10, v124
v_mfma_f32_16x16x32_bf16 v[88:91], a[136:139], v[56:59], v[88:91]
v_exp_f32 v126, v126
v_mfma_f32_16x16x32_bf16 v[88:91], a[140:143], v[60:63], v[88:91]
v_add_f32 v11, v11, v125
v_cvt_pk_bf16_f32 v172, v124, v125
v_mfma_f32_16x16x32_bf16 v[92:95], a[140:143], v[76:79], v[220:223]
v_exp_f32 v127, v127
v_mfma_f32_16x16x32_bf16 v[92:95], a[136:139], v[72:75], v[92:95]
ds_read_b128 a[160:163], v224 offset:57344
ds_read_b128 a[164:167], v225 offset:57344
v_mfma_f32_16x16x32_bf16 v[92:95], a[132:135], v[68:71], v[92:95]
v_exp_f32 v128, v128
v_mfma_f32_16x16x32_bf16 v[92:95], a[128:131], v[64:67], v[92:95]
ds_read_b128 a[168:171], v226 offset:57344
s_waitcnt lgkmcnt(3)
v_mfma_f32_16x16x32_bf16 v[96:99], a[144:147], v[16:19], v[208:211]
buffer_load_dwordx4 v240, s[20:23], s41 offen offset:2048 lds
v_mfma_f32_16x16x32_bf16 v[96:99], a[148:151], v[20:23], v[96:99]
v_exp_f32 v129, v129
v_mfma_f32_16x16x32_bf16 v[96:99], a[152:155], v[24:27], v[96:99]
v_exp_f32 v130, v130
v_mfma_f32_16x16x32_bf16 v[96:99], a[156:159], v[28:31], v[96:99]
ds_read_b128 a[172:175], v227 offset:57344
v_add_f32 v10, v10, v126
v_mfma_f32_16x16x32_bf16 v[100:103], a[156:159], v[44:47], v[212:215]
v_exp_f32 v131, v131
v_mfma_f32_16x16x32_bf16 v[100:103], a[152:155], v[40:43], v[100:103]
v_add_f32 v11, v11, v127
v_cvt_pk_bf16_f32 v173, v126, v127
v_mfma_f32_16x16x32_bf16 v[100:103], a[148:151], v[36:39], v[100:103]
v_exp_f32 v132, v132
v_mfma_f32_16x16x32_bf16 v[100:103], a[144:147], v[32:35], v[100:103]
v_cvt_pk_bf16_f32 v162, v128, v129
v_cvt_pk_bf16_f32 v163, v130, v131
v_mfma_f32_16x16x32_bf16 v[104:107], a[144:147], v[48:51], v[216:219]
v_exp_f32 v133, v133
v_mfma_f32_16x16x32_bf16 v[104:107], a[148:151], v[52:55], v[104:107]
v_add_f32 v8, v8, v132
v_add_f32 v9, v9, v133
v_mfma_f32_16x16x32_bf16 v[104:107], a[152:155], v[56:59], v[104:107]
v_exp_f32 v134, v134
v_mfma_f32_16x16x32_bf16 v[104:107], a[156:159], v[60:63], v[104:107]
v_cvt_pk_bf16_f32 v166, v132, v133
v_add_f32 v8, v8, v134
v_mfma_f32_16x16x32_bf16 v[108:111], a[156:159], v[76:79], v[220:223]
buffer_load_dwordx4 v241, s[20:23], s41 offen offset:3072 lds
v_mfma_f32_16x16x32_bf16 v[108:111], a[152:155], v[72:75], v[108:111]
s_add_u32 s41, s41, 16384
v_exp_f32 v135, v135
v_mfma_f32_16x16x32_bf16 v[108:111], a[148:151], v[68:71], v[108:111]
s_add_u32 m0, s39, 32768
v_exp_f32 v136, v136
v_mfma_f32_16x16x32_bf16 v[108:111], a[144:147], v[64:67], v[108:111]
ds_read_b128 a[176:179], v224 offset:61440
s_waitcnt lgkmcnt(1)
v_mfma_f32_16x16x32_bf16 v[112:115], a[160:163], v[16:19], v[208:211]
v_exp_f32 v137, v137
v_mfma_f32_16x16x32_bf16 v[112:115], a[164:167], v[20:23], v[112:115]
ds_read_b128 a[180:183], v225 offset:61440
ds_read_b128 a[184:187], v226 offset:61440
v_mfma_f32_16x16x32_bf16 v[112:115], a[168:171], v[24:27], v[112:115]
v_exp_f32 v138, v138
v_mfma_f32_16x16x32_bf16 v[112:115], a[172:175], v[28:31], v[112:115]
ds_read_b128 a[188:191], v227 offset:61440
v_add_f32 v9, v9, v135
v_mfma_f32_16x16x32_bf16 v[116:119], a[172:175], v[44:47], v[212:215]
v_exp_f32 v139, v139
v_mfma_f32_16x16x32_bf16 v[116:119], a[168:171], v[40:43], v[116:119]
v_cvt_pk_bf16_f32 v167, v134, v135
v_cvt_pk_bf16_f32 v170, v136, v137
v_mfma_f32_16x16x32_bf16 v[116:119], a[164:167], v[36:39], v[116:119]
v_exp_f32 v140, v140
v_mfma_f32_16x16x32_bf16 v[116:119], a[160:163], v[32:35], v[116:119]
v_cvt_pk_bf16_f32 v171, v138, v139
v_add_f32 v10, v10, v140
v_mfma_f32_16x16x32_bf16 v[120:123], a[160:163], v[48:51], v[216:219]
buffer_load_dwordx4 v236, s[16:19], s40 offen offset:0 lds
v_mfma_f32_16x16x32_bf16 v[120:123], a[164:167], v[52:55], v[120:123]
v_exp_f32 v141, v141
v_mfma_f32_16x16x32_bf16 v[120:123], a[168:171], v[56:59], v[120:123]
v_exp_f32 v142, v142
v_mfma_f32_16x16x32_bf16 v[120:123], a[172:175], v[60:63], v[120:123]
v_add_f32 v11, v11, v141
v_cvt_pk_bf16_f32 v174, v140, v141
v_mfma_f32_16x16x32_bf16 v[124:127], a[172:175], v[76:79], v[220:223]
v_exp_f32 v143, v143
v_mfma_f32_16x16x32_bf16 v[124:127], a[168:171], v[72:75], v[124:127]
ds_read_b64_tr_b16 a[128:129], v228 offset:32768
ds_read_b64_tr_b16 a[130:131], v228 offset:36864
v_mfma_f32_16x16x32_bf16 v[124:127], a[164:167], v[68:71], v[124:127]
ds_read_b64_tr_b16 a[132:133], v228 offset:40960
ds_read_b64_tr_b16 a[134:135], v228 offset:45056
v_mfma_f32_16x16x32_bf16 v[124:127], a[160:163], v[64:67], v[124:127]
v_add_f32 v10, v10, v142
s_waitcnt lgkmcnt(4)
v_mfma_f32_16x16x32_bf16 v[128:131], a[176:179], v[16:19], v[208:211]
v_exp_f32 v80, v80
v_mfma_f32_16x16x32_bf16 v[128:131], a[180:183], v[20:23], v[128:131]
v_add_f32 v11, v11, v143
v_cvt_pk_bf16_f32 v175, v142, v143
v_mfma_f32_16x16x32_bf16 v[128:131], a[184:187], v[24:27], v[128:131]
v_exp_f32 v81, v81
v_mfma_f32_16x16x32_bf16 v[128:131], a[188:191], v[28:31], v[128:131]
v_cvt_pk_bf16_f32 v176, v80, v81
v_mfma_f32_16x16x32_bf16 v[132:135], a[188:191], v[44:47], v[212:215]
buffer_load_dwordx4 v237, s[16:19], s40 offen offset:1024 lds
v_mfma_f32_16x16x32_bf16 v[132:135], a[184:187], v[40:43], v[132:135]
v_exp_f32 v82, v82
v_mfma_f32_16x16x32_bf16 v[132:135], a[180:183], v[36:39], v[132:135]
ds_read_b64_tr_b16 a[136:137], v229 offset:32768
ds_read_b64_tr_b16 a[138:139], v229 offset:36864
v_mfma_f32_16x16x32_bf16 v[132:135], a[176:179], v[32:35], v[132:135]
v_exp_f32 v83, v83
v_mfma_f32_16x16x32_bf16 v[136:139], a[176:179], v[48:51], v[216:219]
ds_read_b64_tr_b16 a[140:141], v229 offset:40960
ds_read_b64_tr_b16 a[142:143], v229 offset:45056
v_mfma_f32_16x16x32_bf16 v[136:139], a[180:183], v[52:55], v[136:139]
v_exp_f32 v84, v84
v_mfma_f32_16x16x32_bf16 v[136:139], a[184:187], v[56:59], v[136:139]
v_cvt_pk_bf16_f32 v177, v82, v83
v_add_f32 v8, v8, v84
v_mfma_f32_16x16x32_bf16 v[136:139], a[188:191], v[60:63], v[136:139]
v_exp_f32 v85, v85
v_mfma_f32_16x16x32_bf16 v[140:143], a[188:191], v[76:79], v[220:223]
ds_read_b64_tr_b16 a[144:145], v230 offset:32768
ds_read_b64_tr_b16 a[146:147], v230 offset:36864
v_mfma_f32_16x16x32_bf16 v[140:143], a[184:187], v[72:75], v[140:143]
v_exp_f32 v86, v86
v_mfma_f32_16x16x32_bf16 v[140:143], a[180:183], v[68:71], v[140:143]
ds_read_b64_tr_b16 a[148:149], v230 offset:40960
ds_read_b64_tr_b16 a[150:151], v230 offset:45056
v_mfma_f32_16x16x32_bf16 v[140:143], a[176:179], v[64:67], v[140:143]
s_waitcnt lgkmcnt(4)
v_exp_f32 v87, v87
v_mfma_f32_16x16x32_bf16 a[0:3], a[128:131], v[144:147], a[0:3]
v_add_f32 v9, v9, v85
v_cvt_pk_bf16_f32 v180, v84, v85
v_mfma_f32_16x16x32_bf16 a[0:3], a[132:135], v[160:163], a[0:3]
buffer_load_dwordx4 v238, s[16:19], s40 offen offset:2048 lds
v_mfma_f32_16x16x32_bf16 a[4:7], a[132:135], v[164:167], a[4:7]
v_exp_f32 v88, v88
v_mfma_f32_16x16x32_bf16 a[4:7], a[128:131], v[148:151], a[4:7]
v_add_f32 v8, v8, v86
v_add_f32 v9, v9, v87
v_mfma_f32_16x16x32_bf16 a[8:11], a[128:131], v[152:155], a[8:11]
v_exp_f32 v89, v89
v_mfma_f32_16x16x32_bf16 a[8:11], a[132:135], v[168:171], a[8:11]
ds_read_b64_tr_b16 a[152:153], v231 offset:32768
ds_read_b64_tr_b16 a[154:155], v231 offset:36864
v_mfma_f32_16x16x32_bf16 a[12:15], a[132:135], v[172:175], a[12:15]
v_exp_f32 v90, v90
v_mfma_f32_16x16x32_bf16 a[12:15], a[128:131], v[156:159], a[12:15]
ds_read_b64_tr_b16 a[156:157], v231 offset:40960
ds_read_b64_tr_b16 a[158:159], v231 offset:45056
v_mfma_f32_16x16x32_bf16 a[16:19], a[136:139], v[144:147], a[16:19]
v_exp_f32 v91, v91
v_mfma_f32_16x16x32_bf16 a[16:19], a[140:143], v[160:163], a[16:19]
v_cvt_pk_bf16_f32 v181, v86, v87
v_cvt_pk_bf16_f32 v184, v88, v89
v_mfma_f32_16x16x32_bf16 a[20:23], a[140:143], v[164:167], a[20:23]
v_exp_f32 v92, v92
v_mfma_f32_16x16x32_bf16 a[20:23], a[136:139], v[148:151], a[20:23]
v_cvt_pk_bf16_f32 v185, v90, v91
v_add_f32 v10, v10, v92
v_mfma_f32_16x16x32_bf16 a[24:27], a[136:139], v[152:155], a[24:27]
v_exp_f32 v93, v93
v_mfma_f32_16x16x32_bf16 a[24:27], a[140:143], v[168:171], a[24:27]
ds_read_b64_tr_b16 a[160:161], v232 offset:32768
ds_read_b64_tr_b16 a[162:163], v232 offset:36864
v_mfma_f32_16x16x32_bf16 a[28:31], a[140:143], v[172:175], a[28:31]
buffer_load_dwordx4 v239, s[16:19], s40 offen offset:3072 lds
v_mfma_f32_16x16x32_bf16 a[28:31], a[136:139], v[156:159], a[28:31]
s_waitcnt lgkmcnt(2)
v_exp_f32 v94, v94
v_mfma_f32_16x16x32_bf16 a[32:35], a[144:147], v[144:147], a[32:35]
s_add_u32 s40, s40, 16384
v_exp_f32 v95, v95
v_mfma_f32_16x16x32_bf16 a[32:35], a[148:151], v[160:163], a[32:35]
ds_read_b64_tr_b16 a[164:165], v232 offset:40960
ds_read_b64_tr_b16 a[166:167], v232 offset:45056
v_mfma_f32_16x16x32_bf16 a[36:39], a[148:151], v[164:167], a[36:39]
v_exp_f32 v96, v96
v_mfma_f32_16x16x32_bf16 a[36:39], a[144:147], v[148:151], a[36:39]
v_add_f32 v11, v11, v93
v_cvt_pk_bf16_f32 v188, v92, v93
v_mfma_f32_16x16x32_bf16 a[40:43], a[144:147], v[152:155], a[40:43]
v_exp_f32 v97, v97
v_mfma_f32_16x16x32_bf16 a[40:43], a[148:151], v[168:171], a[40:43]
ds_read_b64_tr_b16 a[168:169], v233 offset:32768
ds_read_b64_tr_b16 a[170:171], v233 offset:36864
v_mfma_f32_16x16x32_bf16 a[44:47], a[148:151], v[172:175], a[44:47]
v_exp_f32 v98, v98
v_mfma_f32_16x16x32_bf16 a[44:47], a[144:147], v[156:159], a[44:47]
ds_read_b64_tr_b16 a[172:173], v233 offset:40960
ds_read_b64_tr_b16 a[174:175], v233 offset:45056
v_mfma_f32_16x16x32_bf16 a[48:51], a[152:155], v[144:147], a[48:51]
v_exp_f32 v99, v99
v_mfma_f32_16x16x32_bf16 a[48:51], a[156:159], v[160:163], a[48:51]
v_add_f32 v10, v10, v94
v_add_f32 v11, v11, v95
v_mfma_f32_16x16x32_bf16 a[52:55], a[156:159], v[164:167], a[52:55]
v_exp_f32 v100, v100
v_mfma_f32_16x16x32_bf16 a[52:55], a[152:155], v[148:151], a[52:55]
v_cvt_pk_bf16_f32 v189, v94, v95
v_cvt_pk_bf16_f32 v178, v96, v97
v_mfma_f32_16x16x32_bf16 a[56:59], a[152:155], v[152:155], a[56:59]
v_exp_f32 v101, v101
v_mfma_f32_16x16x32_bf16 a[56:59], a[156:159], v[168:171], a[56:59]
ds_read_b64_tr_b16 a[176:177], v234 offset:32768
ds_read_b64_tr_b16 a[178:179], v234 offset:36864
v_mfma_f32_16x16x32_bf16 a[60:63], a[156:159], v[172:175], a[60:63]
v_exp_f32 v102, v102
v_mfma_f32_16x16x32_bf16 a[60:63], a[152:155], v[156:159], a[60:63]
ds_read_b64_tr_b16 a[180:181], v234 offset:40960
s_waitcnt lgkmcnt(3)
v_mfma_f32_16x16x32_bf16 a[64:67], a[160:163], v[144:147], a[64:67]
v_exp_f32 v103, v103
v_mfma_f32_16x16x32_bf16 a[64:67], a[164:167], v[160:163], a[64:67]
ds_read_b64_tr_b16 a[182:183], v234 offset:45056
ds_read_b64_tr_b16 a[184:185], v235 offset:32768
v_cvt_pk_bf16_f32 v179, v98, v99
v_mfma_f32_16x16x32_bf16 a[68:71], a[164:167], v[164:167], a[68:71]
v_exp_f32 v104, v104
v_mfma_f32_16x16x32_bf16 a[68:71], a[160:163], v[148:151], a[68:71]
ds_read_b64_tr_b16 a[186:187], v235 offset:36864
ds_read_b64_tr_b16 a[188:189], v235 offset:40960
v_mfma_f32_16x16x32_bf16 a[72:75], a[160:163], v[152:155], a[72:75]
v_exp_f32 v105, v105
v_mfma_f32_16x16x32_bf16 a[72:75], a[164:167], v[168:171], a[72:75]
ds_read_b64_tr_b16 a[190:191], v235 offset:45056
v_add_f32 v8, v8, v100
v_add_f32 v9, v9, v101
v_mfma_f32_16x16x32_bf16 a[76:79], a[164:167], v[172:175], a[76:79]
v_exp_f32 v106, v106
v_mfma_f32_16x16x32_bf16 a[76:79], a[160:163], v[156:159], a[76:79]
v_cvt_pk_bf16_f32 v182, v100, v101
v_add_f32 v8, v8, v102
v_mfma_f32_16x16x32_bf16 a[80:83], a[168:171], v[144:147], a[80:83]
v_exp_f32 v107, v107
v_mfma_f32_16x16x32_bf16 a[80:83], a[172:175], v[160:163], a[80:83]
v_add_f32 v9, v9, v103
v_cvt_pk_bf16_f32 v183, v102, v103
v_mfma_f32_16x16x32_bf16 a[84:87], a[172:175], v[164:167], a[84:87]
v_exp_f32 v108, v108
v_mfma_f32_16x16x32_bf16 a[84:87], a[168:171], v[148:151], a[84:87]
v_cvt_pk_bf16_f32 v186, v104, v105
v_cvt_pk_bf16_f32 v187, v106, v107
v_mfma_f32_16x16x32_bf16 a[88:91], a[168:171], v[152:155], a[88:91]
v_exp_f32 v109, v109
v_mfma_f32_16x16x32_bf16 a[88:91], a[172:175], v[168:171], a[88:91]
v_add_f32 v10, v10, v108
v_add_f32 v11, v11, v109
v_mfma_f32_16x16x32_bf16 a[92:95], a[172:175], v[172:175], a[92:95]
v_exp_f32 v110, v110
v_mfma_f32_16x16x32_bf16 a[92:95], a[168:171], v[156:159], a[92:95]
s_waitcnt vmcnt(17) lgkmcnt(0)
s_barrier
v_mfma_f32_16x16x32_bf16 a[96:99], a[176:179], v[144:147], a[96:99]
s_add_u32 m0, s43, 32768
v_exp_f32 v111, v111
v_mfma_f32_16x16x32_bf16 a[96:99], a[180:183], v[160:163], a[96:99]
ds_read_b128 a[128:131], v224 offset:0
ds_read_b128 a[132:135], v225 offset:0
v_mfma_f32_16x16x32_bf16 a[100:103], a[180:183], v[164:167], a[100:103]
buffer_load_dwordx4 v240, s[20:23], s41 offen offset:0 lds
v_mfma_f32_16x16x32_bf16 a[100:103], a[176:179], v[148:151], a[100:103]
v_exp_f32 v112, v112
v_mfma_f32_16x16x32_bf16 a[104:107], a[176:179], v[152:155], a[104:107]
v_exp_f32 v113, v113
v_mfma_f32_16x16x32_bf16 a[104:107], a[180:183], v[168:171], a[104:107]
ds_read_b128 a[136:139], v226 offset:0
ds_read_b128 a[140:143], v227 offset:0
v_mfma_f32_16x16x32_bf16 a[108:111], a[180:183], v[172:175], a[108:111]
v_exp_f32 v114, v114
v_mfma_f32_16x16x32_bf16 a[108:111], a[176:179], v[156:159], a[108:111]
v_cvt_pk_bf16_f32 v190, v108, v109
v_add_f32 v10, v10, v110
v_mfma_f32_16x16x32_bf16 a[112:115], a[184:187], v[144:147], a[112:115]
v_exp_f32 v115, v115
v_mfma_f32_16x16x32_bf16 a[112:115], a[188:191], v[160:163], a[112:115]
v_add_f32 v11, v11, v111
v_cvt_pk_bf16_f32 v191, v110, v111
v_mfma_f32_16x16x32_bf16 a[116:119], a[188:191], v[164:167], a[116:119]
v_exp_f32 v116, v116
v_mfma_f32_16x16x32_bf16 a[116:119], a[184:187], v[148:151], a[116:119]
v_cvt_pk_bf16_f32 v192, v112, v113
v_cvt_pk_bf16_f32 v193, v114, v115
v_mfma_f32_16x16x32_bf16 a[120:123], a[184:187], v[152:155], a[120:123]
v_exp_f32 v117, v117
v_mfma_f32_16x16x32_bf16 a[120:123], a[188:191], v[168:171], a[120:123]
v_add_f32 v8, v8, v116
v_add_f32 v9, v9, v117
v_mfma_f32_16x16x32_bf16 a[124:127], a[188:191], v[172:175], a[124:127]
buffer_load_dwordx4 v241, s[20:23], s41 offen offset:1024 lds
v_mfma_f32_16x16x32_bf16 a[124:127], a[184:187], v[156:159], a[124:127]
v_exp_f32 v118, v118
v_mfma_f32_16x16x32_bf16 a[192:195], a[208:211], v[144:147], a[192:195]
v_exp_f32 v119, v119
v_mfma_f32_16x16x32_bf16 a[192:195], a[208:211], v[160:163], a[192:195]
ds_read_b128 a[144:147], v224 offset:4096
ds_read_b128 a[148:151], v225 offset:4096
v_mfma_f32_16x16x32_bf16 a[200:203], a[208:211], v[152:155], a[200:203]
v_exp_f32 v120, v120
v_mfma_f32_16x16x32_bf16 a[200:203], a[208:211], v[168:171], a[200:203]
ds_read_b128 a[152:155], v226 offset:4096
s_waitcnt lgkmcnt(3)
v_mfma_f32_16x16x32_bf16 v[80:83], a[128:131], v[16:19], v[208:211]
v_exp_f32 v121, v121
v_mfma_f32_16x16x32_bf16 v[80:83], a[132:135], v[20:23], v[80:83]
ds_read_b128 a[156:159], v227 offset:4096
v_cvt_pk_bf16_f32 v196, v116, v117
v_mfma_f32_16x16x32_bf16 v[80:83], a[136:139], v[24:27], v[80:83]
v_exp_f32 v122, v122
v_mfma_f32_16x16x32_bf16 v[80:83], a[140:143], v[28:31], v[80:83]
v_add_f32 v8, v8, v118
v_add_f32 v9, v9, v119
v_mfma_f32_16x16x32_bf16 v[84:87], a[140:143], v[44:47], v[212:215]
v_exp_f32 v123, v123
v_mfma_f32_16x16x32_bf16 v[84:87], a[136:139], v[40:43], v[84:87]
v_cvt_pk_bf16_f32 v197, v118, v119
v_cvt_pk_bf16_f32 v200, v120, v121
v_mfma_f32_16x16x32_bf16 v[84:87], a[132:135], v[36:39], v[84:87]
buffer_load_dwordx4 v240, s[20:23], s41 offen offset:2048 lds
v_mfma_f32_16x16x32_bf16 v[84:87], a[128:131], v[32:35], v[84:87]
v_exp_f32 v124, v124
v_mfma_f32_16x16x32_bf16 v[88:91], a[128:131], v[48:51], v[216:219]
v_exp_f32 v125, v125
v_mfma_f32_16x16x32_bf16 v[88:91], a[132:135], v[52:55], v[88:91]
v_cvt_pk_bf16_f32 v201, v122, v123
v_add_f32 v10, v10, v124
v_mfma_f32_16x16x32_bf16 v[88:91], a[136:139], v[56:59], v[88:91]
v_exp_f32 v126, v126
v_mfma_f32_16x16x32_bf16 v[88:91], a[140:143], v[60:63], v[88:91]
v_add_f32 v11, v11, v125
v_cvt_pk_bf16_f32 v204, v124, v125
v_mfma_f32_16x16x32_bf16 v[92:95], a[140:143], v[76:79], v[220:223]
v_exp_f32 v127, v127
v_mfma_f32_16x16x32_bf16 v[92:95], a[136:139], v[72:75], v[92:95]
ds_read_b128 a[160:163], v224 offset:8192
ds_read_b128 a[164:167], v225 offset:8192
v_mfma_f32_16x16x32_bf16 v[92:95], a[132:135], v[68:71], v[92:95]
v_exp_f32 v128, v128
v_mfma_f32_16x16x32_bf16 v[92:95], a[128:131], v[64:67], v[92:95]
ds_read_b128 a[168:171], v226 offset:8192
s_waitcnt lgkmcnt(3)
v_mfma_f32_16x16x32_bf16 v[96:99], a[144:147], v[16:19], v[208:211]
v_exp_f32 v129, v129
v_mfma_f32_16x16x32_bf16 v[96:99], a[148:151], v[20:23], v[96:99]
ds_read_b128 a[172:175], v227 offset:8192
v_add_f32 v10, v10, v126
v_mfma_f32_16x16x32_bf16 v[96:99], a[152:155], v[24:27], v[96:99]
buffer_load_dwordx4 v241, s[20:23], s41 offen offset:3072 lds
v_mfma_f32_16x16x32_bf16 v[96:99], a[156:159], v[28:31], v[96:99]
s_add_u32 s41, s41, 16384
v_exp_f32 v130, v130
v_mfma_f32_16x16x32_bf16 v[100:103], a[156:159], v[44:47], v[212:215]
s_add_u32 m0, s39, 49152
v_exp_f32 v131, v131
v_mfma_f32_16x16x32_bf16 v[100:103], a[152:155], v[40:43], v[100:103]
v_add_f32 v11, v11, v127
v_cvt_pk_bf16_f32 v205, v126, v127
v_mfma_f32_16x16x32_bf16 v[100:103], a[148:151], v[36:39], v[100:103]
v_exp_f32 v132, v132
v_mfma_f32_16x16x32_bf16 v[100:103], a[144:147], v[32:35], v[100:103]
v_cvt_pk_bf16_f32 v194, v128, v129
v_cvt_pk_bf16_f32 v195, v130, v131
v_mfma_f32_16x16x32_bf16 v[104:107], a[144:147], v[48:51], v[216:219]
v_exp_f32 v133, v133
v_mfma_f32_16x16x32_bf16 v[104:107], a[148:151], v[52:55], v[104:107]
v_add_f32 v8, v8, v132
v_add_f32 v9, v9, v133
v_mfma_f32_16x16x32_bf16 v[104:107], a[152:155], v[56:59], v[104:107]
v_exp_f32 v134, v134
v_mfma_f32_16x16x32_bf16 v[104:107], a[156:159], v[60:63], v[104:107]
v_cvt_pk_bf16_f32 v198, v132, v133
v_add_f32 v8, v8, v134
v_mfma_f32_16x16x32_bf16 v[108:111], a[156:159], v[76:79], v[220:223]
v_exp_f32 v135, v135
v_mfma_f32_16x16x32_bf16 v[108:111], a[152:155], v[72:75], v[108:111]
ds_read_b128 a[176:179], v224 offset:12288
ds_read_b128 a[180:183], v225 offset:12288
v_mfma_f32_16x16x32_bf16 v[108:111], a[148:151], v[68:71], v[108:111]
buffer_load_dwordx4 v236, s[16:19], s40 offen offset:0 lds
v_mfma_f32_16x16x32_bf16 v[108:111], a[144:147], v[64:67], v[108:111]
s_waitcnt lgkmcnt(2)
v_exp_f32 v136, v136
v_mfma_f32_16x16x32_bf16 v[112:115], a[160:163], v[16:19], v[208:211]
v_exp_f32 v137, v137
v_mfma_f32_16x16x32_bf16 v[112:115], a[164:167], v[20:23], v[112:115]
ds_read_b128 a[184:187], v226 offset:12288
ds_read_b128 a[188:191], v227 offset:12288
v_mfma_f32_16x16x32_bf16 v[112:115], a[168:171], v[24:27], v[112:115]
v_exp_f32 v138, v138
v_mfma_f32_16x16x32_bf16 v[112:115], a[172:175], v[28:31], v[112:115]
v_add_f32 v9, v9, v135
v_cvt_pk_bf16_f32 v199, v134, v135
v_mfma_f32_16x16x32_bf16 v[116:119], a[172:175], v[44:47], v[212:215]
v_exp_f32 v139, v139
v_mfma_f32_16x16x32_bf16 v[116:119], a[168:171], v[40:43], v[116:119]
v_cvt_pk_bf16_f32 v202, v136, v137
v_cvt_pk_bf16_f32 v203, v138, v139
v_mfma_f32_16x16x32_bf16 v[116:119], a[164:167], v[36:39], v[116:119]
v_exp_f32 v140, v140
v_mfma_f32_16x16x32_bf16 v[116:119], a[160:163], v[32:35], v[116:119]
v_add_f32 v10, v10, v140
v_mfma_f32_16x16x32_bf16 v[120:123], a[160:163], v[48:51], v[216:219]
v_exp_f32 v141, v141
v_mfma_f32_16x16x32_bf16 v[120:123], a[164:167], v[52:55], v[120:123]
v_add_f32 v11, v11, v141
v_cvt_pk_bf16_f32 v206, v140, v141
v_mfma_f32_16x16x32_bf16 v[120:123], a[168:171], v[56:59], v[120:123]
buffer_load_dwordx4 v237, s[16:19], s40 offen offset:1024 lds
v_mfma_f32_16x16x32_bf16 v[120:123], a[172:175], v[60:63], v[120:123]
v_exp_f32 v142, v142
v_mfma_f32_16x16x32_bf16 v[124:127], a[172:175], v[76:79], v[220:223]
ds_read_b64_tr_b16 a[128:129], v228 offset:49152
ds_read_b64_tr_b16 a[130:131], v228 offset:53248
v_mfma_f32_16x16x32_bf16 v[124:127], a[168:171], v[72:75], v[124:127]
v_exp_f32 v143, v143
v_mfma_f32_16x16x32_bf16 v[124:127], a[164:167], v[68:71], v[124:127]
ds_read_b64_tr_b16 a[132:133], v228 offset:57344
ds_read_b64_tr_b16 a[134:135], v228 offset:61440
v_mfma_f32_16x16x32_bf16 v[124:127], a[160:163], v[64:67], v[124:127]
v_add_f32 v10, v10, v142
s_waitcnt lgkmcnt(4)
v_mfma_f32_16x16x32_bf16 v[128:131], a[176:179], v[16:19], v[208:211]
v_exp_f32 v80, v80
v_mfma_f32_16x16x32_bf16 v[128:131], a[180:183], v[20:23], v[128:131]
v_add_f32 v11, v11, v143
v_cvt_pk_bf16_f32 v207, v142, v143
v_mfma_f32_16x16x32_bf16 v[128:131], a[184:187], v[24:27], v[128:131]
v_exp_f32 v81, v81
v_mfma_f32_16x16x32_bf16 v[128:131], a[188:191], v[28:31], v[128:131]
v_cvt_pk_bf16_f32 v144, v80, v81
v_mfma_f32_16x16x32_bf16 v[132:135], a[188:191], v[44:47], v[212:215]
v_exp_f32 v82, v82
v_mfma_f32_16x16x32_bf16 v[132:135], a[184:187], v[40:43], v[132:135]
ds_read_b64_tr_b16 a[136:137], v229 offset:49152
ds_read_b64_tr_b16 a[138:139], v229 offset:53248
v_mfma_f32_16x16x32_bf16 v[132:135], a[180:183], v[36:39], v[132:135]
buffer_load_dwordx4 v238, s[16:19], s40 offen offset:2048 lds
v_mfma_f32_16x16x32_bf16 v[132:135], a[176:179], v[32:35], v[132:135]
v_exp_f32 v83, v83
v_mfma_f32_16x16x32_bf16 v[136:139], a[176:179], v[48:51], v[216:219]
ds_read_b64_tr_b16 a[140:141], v229 offset:57344
ds_read_b64_tr_b16 a[142:143], v229 offset:61440
v_mfma_f32_16x16x32_bf16 v[136:139], a[180:183], v[52:55], v[136:139]
v_exp_f32 v84, v84
v_mfma_f32_16x16x32_bf16 v[136:139], a[184:187], v[56:59], v[136:139]
v_cvt_pk_bf16_f32 v145, v82, v83
v_add_f32 v8, v8, v84
v_mfma_f32_16x16x32_bf16 v[136:139], a[188:191], v[60:63], v[136:139]
v_exp_f32 v85, v85
v_mfma_f32_16x16x32_bf16 v[140:143], a[188:191], v[76:79], v[220:223]
ds_read_b64_tr_b16 a[144:145], v230 offset:49152
ds_read_b64_tr_b16 a[146:147], v230 offset:53248
v_mfma_f32_16x16x32_bf16 v[140:143], a[184:187], v[72:75], v[140:143]
v_exp_f32 v86, v86
v_mfma_f32_16x16x32_bf16 v[140:143], a[180:183], v[68:71], v[140:143]
ds_read_b64_tr_b16 a[148:149], v230 offset:57344
ds_read_b64_tr_b16 a[150:151], v230 offset:61440
v_mfma_f32_16x16x32_bf16 v[140:143], a[176:179], v[64:67], v[140:143]
s_waitcnt lgkmcnt(4)
v_exp_f32 v87, v87
v_mfma_f32_16x16x32_bf16 a[0:3], a[128:131], v[176:179], a[0:3]
v_add_f32 v9, v9, v85
v_cvt_pk_bf16_f32 v148, v84, v85
v_mfma_f32_16x16x32_bf16 a[0:3], a[132:135], v[192:195], a[0:3]
v_exp_f32 v88, v88
v_mfma_f32_16x16x32_bf16 a[4:7], a[132:135], v[196:199], a[4:7]
v_add_f32 v8, v8, v86
v_add_f32 v9, v9, v87
v_mfma_f32_16x16x32_bf16 a[4:7], a[128:131], v[180:183], a[4:7]
buffer_load_dwordx4 v239, s[16:19], s40 offen offset:3072 lds
v_mfma_f32_16x16x32_bf16 a[8:11], a[128:131], v[184:187], a[8:11]
s_add_u32 s40, s40, 16384
v_exp_f32 v89, v89
v_mfma_f32_16x16x32_bf16 a[8:11], a[132:135], v[200:203], a[8:11]
ds_read_b64_tr_b16 a[152:153], v231 offset:49152
ds_read_b64_tr_b16 a[154:155], v231 offset:53248
v_mfma_f32_16x16x32_bf16 a[12:15], a[132:135], v[204:207], a[12:15]
v_exp_f32 v90, v90
v_mfma_f32_16x16x32_bf16 a[12:15], a[128:131], v[188:191], a[12:15]
ds_read_b64_tr_b16 a[156:157], v231 offset:57344
ds_read_b64_tr_b16 a[158:159], v231 offset:61440
v_mfma_f32_16x16x32_bf16 a[16:19], a[136:139], v[176:179], a[16:19]
v_exp_f32 v91, v91
v_mfma_f32_16x16x32_bf16 a[16:19], a[140:143], v[192:195], a[16:19]
v_cvt_pk_bf16_f32 v149, v86, v87
v_cvt_pk_bf16_f32 v152, v88, v89
v_mfma_f32_16x16x32_bf16 a[20:23], a[140:143], v[196:199], a[20:23]
v_exp_f32 v92, v92
v_mfma_f32_16x16x32_bf16 a[20:23], a[136:139], v[180:183], a[20:23]
v_cvt_pk_bf16_f32 v153, v90, v91
v_add_f32 v10, v10, v92
v_mfma_f32_16x16x32_bf16 a[24:27], a[136:139], v[184:187], a[24:27]
v_exp_f32 v93, v93
v_mfma_f32_16x16x32_bf16 a[24:27], a[140:143], v[200:203], a[24:27]
ds_read_b64_tr_b16 a[160:161], v232 offset:49152
ds_read_b64_tr_b16 a[162:163], v232 offset:53248
v_mfma_f32_16x16x32_bf16 a[28:31], a[140:143], v[204:207], a[28:31]
v_exp_f32 v94, v94
v_mfma_f32_16x16x32_bf16 a[28:31], a[136:139], v[188:191], a[28:31]
ds_read_b64_tr_b16 a[164:165], v232 offset:57344
s_waitcnt lgkmcnt(3)
v_mfma_f32_16x16x32_bf16 a[32:35], a[144:147], v[176:179], a[32:35]
v_exp_f32 v95, v95
v_mfma_f32_16x16x32_bf16 a[32:35], a[148:151], v[192:195], a[32:35]
ds_read_b64_tr_b16 a[166:167], v232 offset:61440
v_add_f32 v11, v11, v93
v_mfma_f32_16x16x32_bf16 a[36:39], a[148:151], v[196:199], a[36:39]
v_exp_f32 v96, v96
v_mfma_f32_16x16x32_bf16 a[36:39], a[144:147], v[180:183], a[36:39]
v_cvt_pk_bf16_f32 v156, v92, v93
v_add_f32 v10, v10, v94
v_mfma_f32_16x16x32_bf16 a[40:43], a[144:147], v[184:187], a[40:43]
v_exp_f32 v97, v97
v_mfma_f32_16x16x32_bf16 a[40:43], a[148:151], v[200:203], a[40:43]
ds_read_b64_tr_b16 a[168:169], v233 offset:49152
ds_read_b64_tr_b16 a[170:171], v233 offset:53248
v_mfma_f32_16x16x32_bf16 a[44:47], a[148:151], v[204:207], a[44:47]
v_exp_f32 v98, v98
v_mfma_f32_16x16x32_bf16 a[44:47], a[144:147], v[188:191], a[44:47]
ds_read_b64_tr_b16 a[172:173], v233 offset:57344
ds_read_b64_tr_b16 a[174:175], v233 offset:61440
v_mfma_f32_16x16x32_bf16 a[48:51], a[152:155], v[176:179], a[48:51]
v_exp_f32 v99, v99
v_mfma_f32_16x16x32_bf16 a[48:51], a[156:159], v[192:195], a[48:51]
v_add_f32 v11, v11, v95
v_cvt_pk_bf16_f32 v157, v94, v95
v_mfma_f32_16x16x32_bf16 a[52:55], a[156:159], v[196:199], a[52:55]
v_exp_f32 v100, v100
v_mfma_f32_16x16x32_bf16 a[52:55], a[152:155], v[180:183], a[52:55]
v_cvt_pk_bf16_f32 v146, v96, v97
v_cvt_pk_bf16_f32 v147, v98, v99
v_mfma_f32_16x16x32_bf16 a[56:59], a[152:155], v[184:187], a[56:59]
v_exp_f32 v101, v101
v_mfma_f32_16x16x32_bf16 a[56:59], a[156:159], v[200:203], a[56:59]
ds_read_b64_tr_b16 a[176:177], v234 offset:49152
ds_read_b64_tr_b16 a[178:179], v234 offset:53248
v_mfma_f32_16x16x32_bf16 a[60:63], a[156:159], v[204:207], a[60:63]
v_exp_f32 v102, v102
v_mfma_f32_16x16x32_bf16 a[60:63], a[152:155], v[188:191], a[60:63]
ds_read_b64_tr_b16 a[180:181], v234 offset:57344
s_waitcnt lgkmcnt(3)
v_mfma_f32_16x16x32_bf16 a[64:67], a[160:163], v[176:179], a[64:67]
v_exp_f32 v103, v103
v_mfma_f32_16x16x32_bf16 a[64:67], a[164:167], v[192:195], a[64:67]
ds_read_b64_tr_b16 a[182:183], v234 offset:61440
ds_read_b64_tr_b16 a[184:185], v235 offset:49152
v_mfma_f32_16x16x32_bf16 a[68:71], a[164:167], v[196:199], a[68:71]
v_exp_f32 v104, v104
v_mfma_f32_16x16x32_bf16 a[68:71], a[160:163], v[180:183], a[68:71]
ds_read_b64_tr_b16 a[186:187], v235 offset:53248
ds_read_b64_tr_b16 a[188:189], v235 offset:57344
v_mfma_f32_16x16x32_bf16 a[72:75], a[160:163], v[184:187], a[72:75]
v_exp_f32 v105, v105
v_mfma_f32_16x16x32_bf16 a[72:75], a[164:167], v[200:203], a[72:75]
ds_read_b64_tr_b16 a[190:191], v235 offset:61440
v_add_f32 v8, v8, v100
v_add_f32 v9, v9, v101
v_mfma_f32_16x16x32_bf16 a[76:79], a[164:167], v[204:207], a[76:79]
v_exp_f32 v106, v106
v_mfma_f32_16x16x32_bf16 a[76:79], a[160:163], v[188:191], a[76:79]
v_cvt_pk_bf16_f32 v150, v100, v101
v_add_f32 v8, v8, v102
v_mfma_f32_16x16x32_bf16 a[80:83], a[168:171], v[176:179], a[80:83]
v_exp_f32 v107, v107
v_mfma_f32_16x16x32_bf16 a[80:83], a[172:175], v[192:195], a[80:83]
v_add_f32 v9, v9, v103
v_cvt_pk_bf16_f32 v151, v102, v103
v_mfma_f32_16x16x32_bf16 a[84:87], a[172:175], v[196:199], a[84:87]
v_exp_f32 v108, v108
v_mfma_f32_16x16x32_bf16 a[84:87], a[168:171], v[180:183], a[84:87]
v_cvt_pk_bf16_f32 v154, v104, v105
v_cvt_pk_bf16_f32 v155, v106, v107
v_mfma_f32_16x16x32_bf16 a[88:91], a[168:171], v[184:187], a[88:91]
v_exp_f32 v109, v109
v_mfma_f32_16x16x32_bf16 a[88:91], a[172:175], v[200:203], a[88:91]
v_add_f32 v10, v10, v108
v_add_f32 v11, v11, v109
v_mfma_f32_16x16x32_bf16 a[92:95], a[172:175], v[204:207], a[92:95]
v_exp_f32 v110, v110
v_mfma_f32_16x16x32_bf16 a[92:95], a[168:171], v[188:191], a[92:95]
s_waitcnt vmcnt(17) lgkmcnt(0)
s_barrier
v_mfma_f32_16x16x32_bf16 a[96:99], a[176:179], v[176:179], a[96:99]
s_add_u32 m0, s43, 49152
v_exp_f32 v111, v111
v_mfma_f32_16x16x32_bf16 a[96:99], a[180:183], v[192:195], a[96:99]
ds_read_b128 a[128:131], v224 offset:16384
ds_read_b128 a[132:135], v225 offset:16384
v_mfma_f32_16x16x32_bf16 a[100:103], a[180:183], v[196:199], a[100:103]
buffer_load_dwordx4 v240, s[20:23], s41 offen offset:0 lds
v_mfma_f32_16x16x32_bf16 a[100:103], a[176:179], v[180:183], a[100:103]
v_exp_f32 v112, v112
v_mfma_f32_16x16x32_bf16 a[104:107], a[176:179], v[184:187], a[104:107]
v_exp_f32 v113, v113
v_mfma_f32_16x16x32_bf16 a[104:107], a[180:183], v[200:203], a[104:107]
ds_read_b128 a[136:139], v226 offset:16384
ds_read_b128 a[140:143], v227 offset:16384
v_mfma_f32_16x16x32_bf16 a[108:111], a[180:183], v[204:207], a[108:111]
v_exp_f32 v114, v114
v_mfma_f32_16x16x32_bf16 a[108:111], a[176:179], v[188:191], a[108:111]
v_cvt_pk_bf16_f32 v158, v108, v109
v_add_f32 v10, v10, v110
v_mfma_f32_16x16x32_bf16 a[112:115], a[184:187], v[176:179], a[112:115]
v_exp_f32 v115, v115
v_mfma_f32_16x16x32_bf16 a[112:115], a[188:191], v[192:195], a[112:115]
v_add_f32 v11, v11, v111
v_cvt_pk_bf16_f32 v159, v110, v111
v_mfma_f32_16x16x32_bf16 a[116:119], a[188:191], v[196:199], a[116:119]
v_exp_f32 v116, v116
v_mfma_f32_16x16x32_bf16 a[116:119], a[184:187], v[180:183], a[116:119]
v_cvt_pk_bf16_f32 v160, v112, v113
v_cvt_pk_bf16_f32 v161, v114, v115
v_mfma_f32_16x16x32_bf16 a[120:123], a[184:187], v[184:187], a[120:123]
v_exp_f32 v117, v117
v_mfma_f32_16x16x32_bf16 a[120:123], a[188:191], v[200:203], a[120:123]
v_add_f32 v8, v8, v116
v_add_f32 v9, v9, v117
v_mfma_f32_16x16x32_bf16 a[124:127], a[188:191], v[204:207], a[124:127]
buffer_load_dwordx4 v241, s[20:23], s41 offen offset:1024 lds
v_mfma_f32_16x16x32_bf16 a[124:127], a[184:187], v[188:191], a[124:127]
v_exp_f32 v118, v118
v_mfma_f32_16x16x32_bf16 a[192:195], a[208:211], v[176:179], a[192:195]
v_exp_f32 v119, v119
v_mfma_f32_16x16x32_bf16 a[192:195], a[208:211], v[192:195], a[192:195]
ds_read_b128 a[144:147], v224 offset:20480
ds_read_b128 a[148:151], v225 offset:20480
v_mfma_f32_16x16x32_bf16 a[200:203], a[208:211], v[184:187], a[200:203]
v_exp_f32 v120, v120
v_mfma_f32_16x16x32_bf16 a[200:203], a[208:211], v[200:203], a[200:203]
ds_read_b128 a[152:155], v226 offset:20480
s_waitcnt lgkmcnt(3)
s_sub_u32 s44, s44, 1
s_cmp_lg_u32 s44, 0
s_cbranch_scc1 L_k1_loop
L_k1_post:
v_mfma_f32_16x16x32_bf16 v[80:83], a[128:131], v[16:19], v[208:211]
buffer_load_dwordx4 v240, s[20:23], s41 offen offset:2048 lds
v_mfma_f32_16x16x32_bf16 v[80:83], a[132:135], v[20:23], v[80:83]
v_exp_f32 v121, v121
v_mfma_f32_16x16x32_bf16 v[80:83], a[136:139], v[24:27], v[80:83]
v_exp_f32 v122, v122
v_mfma_f32_16x16x32_bf16 v[80:83], a[140:143], v[28:31], v[80:83]
ds_read_b128 a[156:159], v227 offset:20480
v_cvt_pk_bf16_f32 v164, v116, v117
v_mfma_f32_16x16x32_bf16 v[84:87], a[140:143], v[44:47], v[212:215]
v_exp_f32 v123, v123
v_mfma_f32_16x16x32_bf16 v[84:87], a[136:139], v[40:43], v[84:87]
v_add_f32 v8, v8, v118
v_add_f32 v9, v9, v119
v_mfma_f32_16x16x32_bf16 v[84:87], a[132:135], v[36:39], v[84:87]
buffer_load_dwordx4 v241, s[20:23], s41 offen offset:3072 lds
v_mfma_f32_16x16x32_bf16 v[84:87], a[128:131], v[32:35], v[84:87]
s_add_u32 s41, s41, 16384
v_exp_f32 v124, v124
v_mfma_f32_16x16x32_bf16 v[88:91], a[128:131], v[48:51], v[216:219]
s_lshl_b32 s5, s42, 15
v_exp_f32 v125, v125
v_mfma_f32_16x16x32_bf16 v[88:91], a[132:135], v[52:55], v[88:91]
v_cvt_pk_bf16_f32 v165, v118, v119
v_cvt_pk_bf16_f32 v168, v120, v121
v_mfma_f32_16x16x32_bf16 v[88:91], a[136:139], v[56:59], v[88:91]
s_add_u32 s5, s5, 128
v_exp_f32 v126, v126
v_mfma_f32_16x16x32_bf16 v[88:91], a[140:143], v[60:63], v[88:91]
v_cvt_pk_bf16_f32 v169, v122, v123
v_add_f32 v10, v10, v124
v_mfma_f32_16x16x32_bf16 v[92:95], a[140:143], v[76:79], v[220:223]
buffer_load_dwordx4 a[248:251], v242, s[24:27], s5 offen offset:0
v_mfma_f32_16x16x32_bf16 v[92:95], a[136:139], v[72:75], v[92:95]
v_exp_f32 v127, v127
v_mfma_f32_16x16x32_bf16 v[92:95], a[132:135], v[68:71], v[92:95]
v_exp_f32 v128, v128
v_mfma_f32_16x16x32_bf16 v[92:95], a[128:131], v[64:67], v[92:95]
ds_read_b128 a[160:163], v224 offset:24576
s_waitcnt lgkmcnt(1)
v_mfma_f32_16x16x32_bf16 v[96:99], a[144:147], v[16:19], v[208:211]
v_exp_f32 v129, v129
v_mfma_f32_16x16x32_bf16 v[96:99], a[148:151], v[20:23], v[96:99]
ds_read_b128 a[164:167], v225 offset:24576
ds_read_b128 a[168:171], v226 offset:24576
v_mfma_f32_16x16x32_bf16 v[96:99], a[152:155], v[24:27], v[96:99]
buffer_load_dwordx4 a[252:255], v243, s[24:27], s5 offen offset:1024
v_mfma_f32_16x16x32_bf16 v[96:99], a[156:159], v[28:31], v[96:99]
v_exp_f32 v130, v130
v_mfma_f32_16x16x32_bf16 v[100:103], a[156:159], v[44:47], v[212:215]
v_exp_f32 v131, v131
v_mfma_f32_16x16x32_bf16 v[100:103], a[152:155], v[40:43], v[100:103]
ds_read_b128 a[172:175], v227 offset:24576
v_add_f32 v11, v11, v125
v_cvt_pk_bf16_f32 v172, v124, v125
v_mfma_f32_16x16x32_bf16 v[100:103], a[148:151], v[36:39], v[100:103]
v_exp_f32 v132, v132
v_mfma_f32_16x16x32_bf16 v[100:103], a[144:147], v[32:35], v[100:103]
v_add_f32 v10, v10, v126
v_add_f32 v11, v11, v127
v_mfma_f32_16x16x32_bf16 v[104:107], a[144:147], v[48:51], v[216:219]
buffer_load_dwordx4 a[244:247], v244, s[24:27], s5 offen offset:2048
v_mfma_f32_16x16x32_bf16 v[104:107], a[148:151], v[52:55], v[104:107]
v_exp_f32 v133, v133
v_mfma_f32_16x16x32_bf16 v[104:107], a[152:155], v[56:59], v[104:107]
v_exp_f32 v134, v134
v_mfma_f32_16x16x32_bf16 v[104:107], a[156:159], v[60:63], v[104:107]
v_cvt_pk_bf16_f32 v173, v126, v127
v_cvt_pk_bf16_f32 v162, v128, v129
v_cvt_pk_bf16_f32 v163, v130, v131
v_mfma_f32_16x16x32_bf16 v[108:111], a[156:159], v[76:79], v[220:223]
v_exp_f32 v135, v135
v_mfma_f32_16x16x32_bf16 v[108:111], a[152:155], v[72:75], v[108:111]
ds_read_b128 a[176:179], v224 offset:28672
ds_read_b128 a[180:183], v225 offset:28672
v_mfma_f32_16x16x32_bf16 v[108:111], a[148:151], v[68:71], v[108:111]
buffer_load_dwordx4 a[248:251], v245, s[24:27], s5 offen offset:3072
v_mfma_f32_16x16x32_bf16 v[108:111], a[144:147], v[64:67], v[108:111]
s_waitcnt lgkmcnt(2)
v_exp_f32 v136, v136
v_mfma_f32_16x16x32_bf16 v[112:115], a[160:163], v[16:19], v[208:211]
v_exp_f32 v137, v137
v_mfma_f32_16x16x32_bf16 v[112:115], a[164:167], v[20:23], v[112:115]
ds_read_b128 a[184:187], v226 offset:28672
ds_read_b128 a[188:191], v227 offset:28672
v_add_f32 v8, v8, v132
v_mfma_f32_16x16x32_bf16 v[112:115], a[168:171], v[24:27], v[112:115]
v_exp_f32 v138, v138
v_mfma_f32_16x16x32_bf16 v[112:115], a[172:175], v[28:31], v[112:115]
v_add_f32 v9, v9, v133
v_cvt_pk_bf16_f32 v166, v132, v133
v_mfma_f32_16x16x32_bf16 v[116:119], a[172:175], v[44:47], v[212:215]
buffer_load_dwordx4 a[252:255], v246, s[24:27], s5 offen offset:0
v_mfma_f32_16x16x32_bf16 v[116:119], a[168:171], v[40:43], v[116:119]
v_exp_f32 v139, v139
v_mfma_f32_16x16x32_bf16 v[116:119], a[164:167], v[36:39], v[116:119]
v_exp_f32 v140, v140
v_mfma_f32_16x16x32_bf16 v[116:119], a[160:163], v[32:35], v[116:119]
v_add_f32 v8, v8, v134
v_add_f32 v9, v9, v135
v_mfma_f32_16x16x32_bf16 v[120:123], a[160:163], v[48:51], v[216:219]
v_exp_f32 v141, v141
v_mfma_f32_16x16x32_bf16 v[120:123], a[164:167], v[52:55], v[120:123]
v_cvt_pk_bf16_f32 v167, v134, v135
v_cvt_pk_bf16_f32 v170, v136, v137
v_mfma_f32_16x16x32_bf16 v[120:123], a[168:171], v[56:59], v[120:123]
buffer_load_dwordx4 a[244:247], v247, s[24:27], s5 offen offset:1024
v_mfma_f32_16x16x32_bf16 v[120:123], a[172:175], v[60:63], v[120:123]
v_exp_f32 v142, v142
v_mfma_f32_16x16x32_bf16 v[124:127], a[172:175], v[76:79], v[220:223]
ds_read_b64_tr_b16 a[128:129], v228 offset:0
ds_read_b64_tr_b16 a[130:131], v228 offset:4096
v_mfma_f32_16x16x32_bf16 v[124:127], a[168:171], v[72:75], v[124:127]
v_exp_f32 v143, v143
v_mfma_f32_16x16x32_bf16 v[124:127], a[164:167], v[68:71], v[124:127]
ds_read_b64_tr_b16 a[132:133], v228 offset:8192
ds_read_b64_tr_b16 a[134:135], v228 offset:12288
v_cvt_pk_bf16_f32 v171, v138, v139
v_mfma_f32_16x16x32_bf16 v[124:127], a[160:163], v[64:67], v[124:127]
v_add_f32 v10, v10, v140
s_waitcnt lgkmcnt(4)
v_mfma_f32_16x16x32_bf16 v[128:131], a[176:179], v[16:19], v[208:211]
buffer_load_dwordx4 a[248:251], v248, s[24:27], s5 offen offset:2048
v_mfma_f32_16x16x32_bf16 v[128:131], a[180:183], v[20:23], v[128:131]
v_exp_f32 v80, v80
v_mfma_f32_16x16x32_bf16 v[128:131], a[184:187], v[24:27], v[128:131]
v_add_f32 v11, v11, v141
v_cvt_pk_bf16_f32 v174, v140, v141
v_mfma_f32_16x16x32_bf16 v[128:131], a[188:191], v[28:31], v[128:131]
v_exp_f32 v81, v81
v_mfma_f32_16x16x32_bf16 v[132:135], a[188:191], v[44:47], v[212:215]
ds_read_b64_tr_b16 a[136:137], v229 offset:0
ds_read_b64_tr_b16 a[138:139], v229 offset:4096
v_mfma_f32_16x16x32_bf16 v[132:135], a[184:187], v[40:43], v[132:135]
v_exp_f32 v82, v82
v_mfma_f32_16x16x32_bf16 v[132:135], a[180:183], v[36:39], v[132:135]
ds_read_b64_tr_b16 a[140:141], v229 offset:8192
ds_read_b64_tr_b16 a[142:143], v229 offset:12288
v_mfma_f32_16x16x32_bf16 v[132:135], a[176:179], v[32:35], v[132:135]
buffer_load_dwordx4 a[252:255], v249, s[24:27], s5 offen offset:3072
v_mfma_f32_16x16x32_bf16 v[136:139], a[176:179], v[48:51], v[216:219]
s_lshr_b32 s6, s84, 1
v_exp_f32 v83, v83
v_mfma_f32_16x16x32_bf16 v[136:139], a[180:183], v[52:55], v[136:139]
v_add_f32 v10, v10, v142
v_add_f32 v11, v11, v143
v_mfma_f32_16x16x32_bf16 v[136:139], a[184:187], v[56:59], v[136:139]
v_exp_f32 v84, v84
v_mfma_f32_16x16x32_bf16 v[136:139], a[188:191], v[60:63], v[136:139]
v_cvt_pk_bf16_f32 v175, v142, v143
v_cvt_pk_bf16_f32 v176, v80, v81
v_mfma_f32_16x16x32_bf16 v[140:143], a[188:191], v[76:79], v[220:223]
v_exp_f32 v85, v85
v_mfma_f32_16x16x32_bf16 v[140:143], a[184:187], v[72:75], v[140:143]
ds_read_b64_tr_b16 a[144:145], v230 offset:0
ds_read_b64_tr_b16 a[146:147], v230 offset:4096
v_mfma_f32_16x16x32_bf16 v[140:143], a[180:183], v[68:71], v[140:143]
v_exp_f32 v86, v86
v_mfma_f32_16x16x32_bf16 v[140:143], a[176:179], v[64:67], v[140:143]
ds_read_b64_tr_b16 a[148:149], v230 offset:8192
s_waitcnt lgkmcnt(3)
v_mfma_f32_16x16x32_bf16 a[0:3], a[128:131], v[144:147], a[0:3]
v_exp_f32 v87, v87
v_mfma_f32_16x16x32_bf16 a[0:3], a[132:135], v[160:163], a[0:3]
ds_read_b64_tr_b16 a[150:151], v230 offset:12288
v_cvt_pk_bf16_f32 v177, v82, v83
v_add_f32 v8, v8, v84
v_mfma_f32_16x16x32_bf16 a[4:7], a[132:135], v[164:167], a[4:7]
v_exp_f32 v88, v88
v_mfma_f32_16x16x32_bf16 a[4:7], a[128:131], v[148:151], a[4:7]
v_add_f32 v9, v9, v85
v_cvt_pk_bf16_f32 v180, v84, v85
v_mfma_f32_16x16x32_bf16 a[8:11], a[128:131], v[152:155], a[8:11]
v_exp_f32 v89, v89
v_mfma_f32_16x16x32_bf16 a[8:11], a[132:135], v[168:171], a[8:11]
ds_read_b64_tr_b16 a[152:153], v231 offset:0
ds_read_b64_tr_b16 a[154:155], v231 offset:4096
v_mfma_f32_16x16x32_bf16 a[12:15], a[132:135], v[172:175], a[12:15]
v_exp_f32 v90, v90
v_mfma_f32_16x16x32_bf16 a[12:15], a[128:131], v[156:159], a[12:15]
ds_read_b64_tr_b16 a[156:157], v231 offset:8192
ds_read_b64_tr_b16 a[158:159], v231 offset:12288
v_mfma_f32_16x16x32_bf16 a[16:19], a[136:139], v[144:147], a[16:19]
v_exp_f32 v91, v91
v_mfma_f32_16x16x32_bf16 a[16:19], a[140:143], v[160:163], a[16:19]
v_add_f32 v8, v8, v86
v_add_f32 v9, v9, v87
v_mfma_f32_16x16x32_bf16 a[20:23], a[140:143], v[164:167], a[20:23]
v_exp_f32 v92, v92
v_mfma_f32_16x16x32_bf16 a[20:23], a[136:139], v[148:151], a[20:23]
v_cvt_pk_bf16_f32 v181, v86, v87
v_cvt_pk_bf16_f32 v184, v88, v89
v_mfma_f32_16x16x32_bf16 a[24:27], a[136:139], v[152:155], a[24:27]
v_exp_f32 v93, v93
v_mfma_f32_16x16x32_bf16 a[24:27], a[140:143], v[168:171], a[24:27]
ds_read_b64_tr_b16 a[160:161], v232 offset:0
ds_read_b64_tr_b16 a[162:163], v232 offset:4096
v_mfma_f32_16x16x32_bf16 a[28:31], a[140:143], v[172:175], a[28:31]
v_exp_f32 v94, v94
v_mfma_f32_16x16x32_bf16 a[28:31], a[136:139], v[156:159], a[28:31]
ds_read_b64_tr_b16 a[164:165], v232 offset:8192
s_waitcnt lgkmcnt(3)
v_mfma_f32_16x16x32_bf16 a[32:35], a[144:147], v[144:147], a[32:35]
v_exp_f32 v95, v95
v_mfma_f32_16x16x32_bf16 a[32:35], a[148:151], v[160:163], a[32:35]
ds_read_b64_tr_b16 a[166:167], v232 offset:12288
v_cvt_pk_bf16_f32 v185, v90, v91
v_add_f32 v10, v10, v92
v_mfma_f32_16x16x32_bf16 a[36:39], a[148:151], v[164:167], a[36:39]
v_exp_f32 v96, v96
v_mfma_f32_16x16x32_bf16 a[36:39], a[144:147], v[148:151], a[36:39]
v_add_f32 v11, v11, v93
v_cvt_pk_bf16_f32 v188, v92, v93
v_mfma_f32_16x16x32_bf16 a[40:43], a[144:147], v[152:155], a[40:43]
v_exp_f32 v97, v97
v_mfma_f32_16x16x32_bf16 a[40:43], a[148:151], v[168:171], a[40:43]
ds_read_b64_tr_b16 a[168:169], v233 offset:0
ds_read_b64_tr_b16 a[170:171], v233 offset:4096
v_mfma_f32_16x16x32_bf16 a[44:47], a[148:151], v[172:175], a[44:47]
v_exp_f32 v98, v98
v_mfma_f32_16x16x32_bf16 a[44:47], a[144:147], v[156:159], a[44:47]
ds_read_b64_tr_b16 a[172:173], v233 offset:8192
ds_read_b64_tr_b16 a[174:175], v233 offset:12288
v_mfma_f32_16x16x32_bf16 a[48:51], a[152:155], v[144:147], a[48:51]
v_exp_f32 v99, v99
v_mfma_f32_16x16x32_bf16 a[48:51], a[156:159], v[160:163], a[48:51]
v_add_f32 v10, v10, v94
v_add_f32 v11, v11, v95
v_mfma_f32_16x16x32_bf16 a[52:55], a[156:159], v[164:167], a[52:55]
v_exp_f32 v100, v100
v_mfma_f32_16x16x32_bf16 a[52:55], a[152:155], v[148:151], a[52:55]
v_cvt_pk_bf16_f32 v189, v94, v95
v_cvt_pk_bf16_f32 v178, v96, v97
v_mfma_f32_16x16x32_bf16 a[56:59], a[152:155], v[152:155], a[56:59]
v_exp_f32 v101, v101
v_mfma_f32_16x16x32_bf16 a[56:59], a[156:159], v[168:171], a[56:59]
ds_read_b64_tr_b16 a[176:177], v234 offset:0
ds_read_b64_tr_b16 a[178:179], v234 offset:4096
v_mfma_f32_16x16x32_bf16 a[60:63], a[156:159], v[172:175], a[60:63]
v_exp_f32 v102, v102
v_mfma_f32_16x16x32_bf16 a[60:63], a[152:155], v[156:159], a[60:63]
ds_read_b64_tr_b16 a[180:181], v234 offset:8192
s_waitcnt lgkmcnt(3)
v_mfma_f32_16x16x32_bf16 a[64:67], a[160:163], v[144:147], a[64:67]
v_exp_f32 v103, v103
v_mfma_f32_16x16x32_bf16 a[64:67], a[164:167], v[160:163], a[64:67]
ds_read_b64_tr_b16 a[182:183], v234 offset:12288
ds_read_b64_tr_b16 a[184:185], v235 offset:0
v_cvt_pk_bf16_f32 v179, v98, v99
v_mfma_f32_16x16x32_bf16 a[68:71], a[164:167], v[164:167], a[68:71]
v_exp_f32 v104, v104
v_mfma_f32_16x16x32_bf16 a[68:71], a[160:163], v[148:151], a[68:71]
ds_read_b64_tr_b16 a[186:187], v235 offset:4096
ds_read_b64_tr_b16 a[188:189], v235 offset:8192
v_mfma_f32_16x16x32_bf16 a[72:75], a[160:163], v[152:155], a[72:75]
v_exp_f32 v105, v105
v_mfma_f32_16x16x32_bf16 a[72:75], a[164:167], v[168:171], a[72:75]
ds_read_b64_tr_b16 a[190:191], v235 offset:12288
v_add_f32 v8, v8, v100
v_add_f32 v9, v9, v101
v_mfma_f32_16x16x32_bf16 a[76:79], a[164:167], v[172:175], a[76:79]
v_exp_f32 v106, v106
v_mfma_f32_16x16x32_bf16 a[76:79], a[160:163], v[156:159], a[76:79]
v_cvt_pk_bf16_f32 v182, v100, v101
v_add_f32 v8, v8, v102
v_mfma_f32_16x16x32_bf16 a[80:83], a[168:171], v[144:147], a[80:83]
v_exp_f32 v107, v107
v_mfma_f32_16x16x32_bf16 a[80:83], a[172:175], v[160:163], a[80:83]
v_add_f32 v9, v9, v103
v_cvt_pk_bf16_f32 v183, v102, v103
v_mfma_f32_16x16x32_bf16 a[84:87], a[172:175], v[164:167], a[84:87]
v_exp_f32 v108, v108
v_mfma_f32_16x16x32_bf16 a[84:87], a[168:171], v[148:151], a[84:87]
v_cvt_pk_bf16_f32 v186, v104, v105
v_cvt_pk_bf16_f32 v187, v106, v107
v_mfma_f32_16x16x32_bf16 a[88:91], a[168:171], v[152:155], a[88:91]
v_exp_f32 v109, v109
v_mfma_f32_16x16x32_bf16 a[88:91], a[172:175], v[168:171], a[88:91]
v_add_f32 v10, v10, v108
v_add_f32 v11, v11, v109
v_mfma_f32_16x16x32_bf16 a[92:95], a[172:175], v[172:175], a[92:95]
v_exp_f32 v110, v110
v_mfma_f32_16x16x32_bf16 a[92:95], a[168:171], v[156:159], a[92:95]
s_waitcnt vmcnt(20) lgkmcnt(0)
s_barrier
v_mfma_f32_16x16x32_bf16 a[96:99], a[176:179], v[144:147], a[96:99]
s_lshl_b32 s45, s42, 15
v_exp_f32 v111, v111
v_mfma_f32_16x16x32_bf16 a[96:99], a[180:183], v[160:163], a[96:99]
ds_read_b128 a[128:131], v224 offset:32768
ds_read_b128 a[132:135], v225 offset:32768
v_mfma_f32_16x16x32_bf16 a[100:103], a[180:183], v[164:167], a[100:103]
s_add_u32 m0, s39, 131072
v_exp_f32 v112, v112
v_mfma_f32_16x16x32_bf16 a[100:103], a[176:179], v[148:151], a[100:103]
ds_read_b128 a[136:139], v226 offset:32768
ds_read_b128 a[140:143], v227 offset:32768
v_mfma_f32_16x16x32_bf16 a[104:107], a[176:179], v[152:155], a[104:107]
buffer_load_dwordx4 v242, s[24:27], s45 offen offset:0 lds
v_mfma_f32_16x16x32_bf16 a[104:107], a[180:183], v[168:171], a[104:107]
v_exp_f32 v113, v113
v_mfma_f32_16x16x32_bf16 a[108:111], a[180:183], v[172:175], a[108:111]
v_exp_f32 v114, v114
v_mfma_f32_16x16x32_bf16 a[108:111], a[176:179], v[156:159], a[108:111]
v_cvt_pk_bf16_f32 v190, v108, v109
v_add_f32 v10, v10, v110
v_mfma_f32_16x16x32_bf16 a[112:115], a[184:187], v[144:147], a[112:115]
v_exp_f32 v115, v115
v_mfma_f32_16x16x32_bf16 a[112:115], a[188:191], v[160:163], a[112:115]
v_add_f32 v11, v11, v111
v_cvt_pk_bf16_f32 v191, v110, v111
v_mfma_f32_16x16x32_bf16 a[116:119], a[188:191], v[164:167], a[116:119]
buffer_load_dwordx4 v243, s[24:27], s45 offen offset:1024 lds
v_mfma_f32_16x16x32_bf16 a[116:119], a[184:187], v[148:151], a[116:119]
v_exp_f32 v116, v116
v_mfma_f32_16x16x32_bf16 a[120:123], a[184:187], v[152:155], a[120:123]
v_exp_f32 v117, v117
v_mfma_f32_16x16x32_bf16 a[120:123], a[188:191], v[168:171], a[120:123]
v_cvt_pk_bf16_f32 v192, v112, v113
v_cvt_pk_bf16_f32 v193, v114, v115
v_mfma_f32_16x16x32_bf16 a[124:127], a[188:191], v[172:175], a[124:127]
v_exp_f32 v118, v118
v_mfma_f32_16x16x32_bf16 a[124:127], a[184:187], v[156:159], a[124:127]
v_add_f32 v8, v8, v116
v_add_f32 v9, v9, v117
v_mfma_f32_16x16x32_bf16 a[192:195], a[208:211], v[144:147], a[192:195]
buffer_load_dwordx4 v244, s[24:27], s45 offen offset:2048 lds
v_mfma_f32_16x16x32_bf16 a[192:195], a[208:211], v[160:163], a[192:195]
v_exp_f32 v119, v119
v_mfma_f32_16x16x32_bf16 a[200:203], a[208:211], v[152:155], a[200:203]
v_exp_f32 v120, v120
v_mfma_f32_16x16x32_bf16 a[200:203], a[208:211], v[168:171], a[200:203]
ds_read_b128 a[144:147], v224 offset:36864
s_waitcnt lgkmcnt(1)
v_mfma_f32_16x16x32_bf16 v[80:83], a[128:131], v[16:19], v[208:211]
v_exp_f32 v121, v121
v_mfma_f32_16x16x32_bf16 v[80:83], a[132:135], v[20:23], v[80:83]
ds_read_b128 a[148:151], v225 offset:36864
ds_read_b128 a[152:155], v226 offset:36864
v_mfma_f32_16x16x32_bf16 v[80:83], a[136:139], v[24:27], v[80:83]
buffer_load_dwordx4 v245, s[24:27], s45 offen offset:3072 lds
v_mfma_f32_16x16x32_bf16 v[80:83], a[140:143], v[28:31], v[80:83]
s_add_u32 m0, s39, 147456
v_exp_f32 v122, v122
v_mfma_f32_16x16x32_bf16 v[84:87], a[140:143], v[44:47], v[212:215]
v_exp_f32 v123, v123
v_mfma_f32_16x16x32_bf16 v[84:87], a[136:139], v[40:43], v[84:87]
ds_read_b128 a[156:159], v227 offset:36864
v_cvt_pk_bf16_f32 v196, v116, v117
v_mfma_f32_16x16x32_bf16 v[84:87], a[132:135], v[36:39], v[84:87]
v_exp_f32 v124, v124
v_mfma_f32_16x16x32_bf16 v[84:87], a[128:131], v[32:35], v[84:87]
v_add_f32 v8, v8, v118
v_add_f32 v9, v9, v119
v_mfma_f32_16x16x32_bf16 v[88:91], a[128:131], v[48:51], v[216:219]
buffer_load_dwordx4 v246, s[24:27], s45 offen offset:0 lds
v_mfma_f32_16x16x32_bf16 v[88:91], a[132:135], v[52:55], v[88:91]
v_exp_f32 v125, v125
v_mfma_f32_16x16x32_bf16 v[88:91], a[136:139], v[56:59], v[88:91]
v_exp_f32 v126, v126
v_mfma_f32_16x16x32_bf16 v[88:91], a[140:143], v[60:63], v[88:91]
v_cvt_pk_bf16_f32 v197, v118, v119
v_cvt_pk_bf16_f32 v200, v120, v121
v_cvt_pk_bf16_f32 v201, v122, v123
v_mfma_f32_16x16x32_bf16 v[92:95], a[140:143], v[76:79], v[220:223]
v_exp_f32 v127, v127
v_mfma_f32_16x16x32_bf16 v[92:95], a[136:139], v[72:75], v[92:95]
ds_read_b128 a[160:163], v224 offset:40960
ds_read_b128 a[164:167], v225 offset:40960
v_mfma_f32_16x16x32_bf16 v[92:95], a[132:135], v[68:71], v[92:95]
buffer_load_dwordx4 v247, s[24:27], s45 offen offset:1024 lds
v_mfma_f32_16x16x32_bf16 v[92:95], a[128:131], v[64:67], v[92:95]
s_waitcnt lgkmcnt(2)
v_exp_f32 v128, v128
v_mfma_f32_16x16x32_bf16 v[96:99], a[144:147], v[16:19], v[208:211]
v_exp_f32 v129, v129
v_mfma_f32_16x16x32_bf16 v[96:99], a[148:151], v[20:23], v[96:99]
ds_read_b128 a[168:171], v226 offset:40960
ds_read_b128 a[172:175], v227 offset:40960
v_add_f32 v10, v10, v124
v_mfma_f32_16x16x32_bf16 v[96:99], a[152:155], v[24:27], v[96:99]
v_exp_f32 v130, v130
v_mfma_f32_16x16x32_bf16 v[96:99], a[156:159], v[28:31], v[96:99]
v_add_f32 v11, v11, v125
v_cvt_pk_bf16_f32 v204, v124, v125
v_mfma_f32_16x16x32_bf16 v[100:103], a[156:159], v[44:47], v[212:215]
buffer_load_dwordx4 v248, s[24:27], s45 offen offset:2048 lds
v_mfma_f32_16x16x32_bf16 v[100:103], a[152:155], v[40:43], v[100:103]
v_exp_f32 v131, v131
v_mfma_f32_16x16x32_bf16 v[100:103], a[148:151], v[36:39], v[100:103]
v_exp_f32 v132, v132
v_mfma_f32_16x16x32_bf16 v[100:103], a[144:147], v[32:35], v[100:103]
v_add_f32 v10, v10, v126
v_add_f32 v11, v11, v127
v_mfma_f32_16x16x32_bf16 v[104:107], a[144:147], v[48:51], v[216:219]
v_exp_f32 v133, v133
v_mfma_f32_16x16x32_bf16 v[104:107], a[148:151], v[52:55], v[104:107]
v_cvt_pk_bf16_f32 v205, v126, v127
v_cvt_pk_bf16_f32 v194, v128, v129
v_mfma_f32_16x16x32_bf16 v[104:107], a[152:155], v[56:59], v[104:107]
buffer_load_dwordx4 v249, s[24:27], s45 offen offset:3072 lds
v_mfma_f32_16x16x32_bf16 v[104:107], a[156:159], v[60:63], v[104:107]
s_add_u32 s45, s45, 65536
v_exp_f32 v134, v134
v_mfma_f32_16x16x32_bf16 v[108:111], a[156:159], v[76:79], v[220:223]
s_and_b32 s45, s45, 0x7ffff
v_exp_f32 v135, v135
v_mfma_f32_16x16x32_bf16 v[108:111], a[152:155], v[72:75], v[108:111]
ds_read_b128 a[176:179], v224 offset:45056
ds_read_b128 a[180:183], v225 offset:45056
v_cvt_pk_bf16_f32 v195, v130, v131
v_mfma_f32_16x16x32_bf16 v[108:111], a[148:151], v[68:71], v[108:111]
s_lshl_b32 s5, s6, 11
v_exp_f32 v136, v136
v_mfma_f32_16x16x32_bf16 v[108:111], a[144:147], v[64:67], v[108:111]
ds_read_b128 a[184:187], v226 offset:45056
s_waitcnt lgkmcnt(3)
v_mfma_f32_16x16x32_bf16 v[112:115], a[160:163], v[16:19], v[208:211]
s_add_u32 s5, s5, s7
v_exp_f32 v137, v137
v_mfma_f32_16x16x32_bf16 v[112:115], a[164:167], v[20:23], v[112:115]
ds_read_b128 a[188:191], v227 offset:45056
v_add_f32 v8, v8, v132
v_add_f32 v9, v9, v133
v_mfma_f32_16x16x32_bf16 v[112:115], a[168:171], v[24:27], v[112:115]
buffer_load_dwordx4 a[252:255], v251, s[96:99], s5 offen offset:0
v_mfma_f32_16x16x32_bf16 v[112:115], a[172:175], v[28:31], v[112:115]
s_add_u32 s5, s5, 8192
v_exp_f32 v138, v138
v_mfma_f32_16x16x32_bf16 v[116:119], a[172:175], v[44:47], v[212:215]
v_exp_f32 v139, v139
v_mfma_f32_16x16x32_bf16 v[116:119], a[168:171], v[40:43], v[116:119]
v_cvt_pk_bf16_f32 v198, v132, v133
v_add_f32 v8, v8, v134
v_mfma_f32_16x16x32_bf16 v[116:119], a[164:167], v[36:39], v[116:119]
v_exp_f32 v140, v140
v_mfma_f32_16x16x32_bf16 v[116:119], a[160:163], v[32:35], v[116:119]
v_add_f32 v9, v9, v135
v_cvt_pk_bf16_f32 v199, v134, v135
v_mfma_f32_16x16x32_bf16 v[120:123], a[160:163], v[48:51], v[216:219]
buffer_load_dwordx4 a[244:247], v251, s[96:99], s5 offen offset:0
v_mfma_f32_16x16x32_bf16 v[120:123], a[164:167], v[52:55], v[120:123]
v_exp_f32 v141, v141
v_mfma_f32_16x16x32_bf16 v[120:123], a[168:171], v[56:59], v[120:123]
v_exp_f32 v142, v142
v_mfma_f32_16x16x32_bf16 v[120:123], a[172:175], v[60:63], v[120:123]
v_cvt_pk_bf16_f32 v202, v136, v137
v_cvt_pk_bf16_f32 v203, v138, v139
v_mfma_f32_16x16x32_bf16 v[124:127], a[172:175], v[76:79], v[220:223]
v_exp_f32 v143, v143
v_mfma_f32_16x16x32_bf16 v[124:127], a[168:171], v[72:75], v[124:127]
ds_read_b64_tr_b16 a[128:129], v228 offset:16384
ds_read_b64_tr_b16 a[130:131], v228 offset:20480
v_mfma_f32_16x16x32_bf16 v[124:127], a[164:167], v[68:71], v[124:127]
ds_read_b64_tr_b16 a[132:133], v228 offset:24576
ds_read_b64_tr_b16 a[134:135], v228 offset:28672
v_mfma_f32_16x16x32_bf16 v[124:127], a[160:163], v[64:67], v[124:127]
v_add_f32 v10, v10, v140
s_waitcnt lgkmcnt(4)
v_mfma_f32_16x16x32_bf16 v[128:131], a[176:179], v[16:19], v[208:211]
v_exp_f32 v80, v80
v_mfma_f32_16x16x32_bf16 v[128:131], a[180:183], v[20:23], v[128:131]
v_add_f32 v11, v11, v141
v_cvt_pk_bf16_f32 v206, v140, v141
v_mfma_f32_16x16x32_bf16 v[128:131], a[184:187], v[24:27], v[128:131]
v_exp_f32 v81, v81
v_mfma_f32_16x16x32_bf16 v[128:131], a[188:191], v[28:31], v[128:131]
v_add_f32 v10, v10, v142
v_add_f32 v11, v11, v143
v_mfma_f32_16x16x32_bf16 v[132:135], a[188:191], v[44:47], v[212:215]
v_exp_f32 v82, v82
v_mfma_f32_16x16x32_bf16 v[132:135], a[184:187], v[40:43], v[132:135]
ds_read_b64_tr_b16 a[136:137], v229 offset:16384
ds_read_b64_tr_b16 a[138:139], v229 offset:20480
v_mfma_f32_16x16x32_bf16 v[132:135], a[180:183], v[36:39], v[132:135]
v_exp_f32 v83, v83
v_mfma_f32_16x16x32_bf16 v[132:135], a[176:179], v[32:35], v[132:135]
ds_read_b64_tr_b16 a[140:141], v229 offset:24576
ds_read_b64_tr_b16 a[142:143], v229 offset:28672
v_mfma_f32_16x16x32_bf16 v[136:139], a[176:179], v[48:51], v[216:219]
v_exp_f32 v84, v84
v_mfma_f32_16x16x32_bf16 v[136:139], a[180:183], v[52:55], v[136:139]
v_cvt_pk_bf16_f32 v207, v142, v143
v_cvt_pk_bf16_f32 v144, v80, v81
v_mfma_f32_16x16x32_bf16 v[136:139], a[184:187], v[56:59], v[136:139]
v_exp_f32 v85, v85
v_mfma_f32_16x16x32_bf16 v[136:139], a[188:191], v[60:63], v[136:139]
v_cvt_pk_bf16_f32 v145, v82, v83
v_add_f32 v8, v8, v84
v_mfma_f32_16x16x32_bf16 v[140:143], a[188:191], v[76:79], v[220:223]
v_exp_f32 v86, v86
v_mfma_f32_16x16x32_bf16 v[140:143], a[184:187], v[72:75], v[140:143]
ds_read_b64_tr_b16 a[144:145], v230 offset:16384
ds_read_b64_tr_b16 a[146:147], v230 offset:20480
v_mfma_f32_16x16x32_bf16 v[140:143], a[180:183], v[68:71], v[140:143]
v_exp_f32 v87, v87
v_mfma_f32_16x16x32_bf16 v[140:143], a[176:179], v[64:67], v[140:143]
ds_read_b64_tr_b16 a[148:149], v230 offset:24576
s_waitcnt lgkmcnt(3)
v_mfma_f32_16x16x32_bf16 a[0:3], a[128:131], v[176:179], a[0:3]
v_exp_f32 v88, v88
v_mfma_f32_16x16x32_bf16 a[0:3], a[132:135], v[192:195], a[0:3]
ds_read_b64_tr_b16 a[150:151], v230 offset:28672
v_add_f32 v9, v9, v85
v_mfma_f32_16x16x32_bf16 a[4:7], a[132:135], v[196:199], a[4:7]
v_exp_f32 v89, v89
v_mfma_f32_16x16x32_bf16 a[4:7], a[128:131], v[180:183], a[4:7]
v_cvt_pk_bf16_f32 v148, v84, v85
v_add_f32 v8, v8, v86
v_mfma_f32_16x16x32_bf16 a[8:11], a[128:131], v[184:187], a[8:11]
v_exp_f32 v90, v90
v_mfma_f32_16x16x32_bf16 a[8:11], a[132:135], v[200:203], a[8:11]
ds_read_b64_tr_b16 a[152:153], v231 offset:16384
ds_read_b64_tr_b16 a[154:155], v231 offset:20480
v_mfma_f32_16x16x32_bf16 a[12:15], a[132:135], v[204:207], a[12:15]
v_exp_f32 v91, v91
v_mfma_f32_16x16x32_bf16 a[12:15], a[128:131], v[188:191], a[12:15]
ds_read_b64_tr_b16 a[156:157], v231 offset:24576
ds_read_b64_tr_b16 a[158:159], v231 offset:28672
v_mfma_f32_16x16x32_bf16 a[16:19], a[136:139], v[176:179], a[16:19]
v_exp_f32 v92, v92
v_mfma_f32_16x16x32_bf16 a[16:19], a[140:143], v[192:195], a[16:19]
v_add_f32 v9, v9, v87
v_cvt_pk_bf16_f32 v149, v86, v87
v_mfma_f32_16x16x32_bf16 a[20:23], a[140:143], v[196:199], a[20:23]
v_exp_f32 v93, v93
v_mfma_f32_16x16x32_bf16 a[20:23], a[136:139], v[180:183], a[20:23]
v_cvt_pk_bf16_f32 v152, v88, v89
v_cvt_pk_bf16_f32 v153, v90, v91
v_mfma_f32_16x16x32_bf16 a[24:27], a[136:139], v[184:187], a[24:27]
v_exp_f32 v94, v94
v_mfma_f32_16x16x32_bf16 a[24:27], a[140:143], v[200:203], a[24:27]
ds_read_b64_tr_b16 a[160:161], v232 offset:16384
ds_read_b64_tr_b16 a[162:163], v232 offset:20480
v_mfma_f32_16x16x32_bf16 a[28:31], a[140:143], v[204:207], a[28:31]
v_exp_f32 v95, v95
v_mfma_f32_16x16x32_bf16 a[28:31], a[136:139], v[188:191], a[28:31]
ds_read_b64_tr_b16 a[164:165], v232 offset:24576
s_waitcnt lgkmcnt(3)
v_mfma_f32_16x16x32_bf16 a[32:35], a[144:147], v[176:179], a[32:35]
v_exp_f32 v96, v96
v_mfma_f32_16x16x32_bf16 a[32:35], a[148:151], v[192:195], a[32:35]
ds_read_b64_tr_b16 a[166:167], v232 offset:28672
v_add_f32 v10, v10, v92
v_mfma_f32_16x16x32_bf16 a[36:39], a[148:151], v[196:199], a[36:39]
v_exp_f32 v97, v97
v_mfma_f32_16x16x32_bf16 a[36:39], a[144:147], v[180:183], a[36:39]
v_add_f32 v11, v11, v93
v_cvt_pk_bf16_f32 v156, v92, v93
v_mfma_f32_16x16x32_bf16 a[40:43], a[144:147], v[184:187], a[40:43]
v_exp_f32 v98, v98
v_mfma_f32_16x16x32_bf16 a[40:43], a[148:151], v[200:203], a[40:43]
ds_read_b64_tr_b16 a[168:169], v233 offset:16384
ds_read_b64_tr_b16 a[170:171], v233 offset:20480
v_mfma_f32_16x16x32_bf16 a[44:47], a[148:151], v[204:207], a[44:47]
v_exp_f32 v99, v99
v_mfma_f32_16x16x32_bf16 a[44:47], a[144:147], v[188:191], a[44:47]
ds_read_b64_tr_b16 a[172:173], v233 offset:24576
ds_read_b64_tr_b16 a[174:175], v233 offset:28672
v_mfma_f32_16x16x32_bf16 a[48:51], a[152:155], v[176:179], a[48:51]
v_exp_f32 v100, v100
v_mfma_f32_16x16x32_bf16 a[48:51], a[156:159], v[192:195], a[48:51]
v_add_f32 v10, v10, v94
v_add_f32 v11, v11, v95
v_mfma_f32_16x16x32_bf16 a[52:55], a[156:159], v[196:199], a[52:55]
v_exp_f32 v101, v101
v_mfma_f32_16x16x32_bf16 a[52:55], a[152:155], v[180:183], a[52:55]
v_cvt_pk_bf16_f32 v157, v94, v95
v_cvt_pk_bf16_f32 v146, v96, v97
v_mfma_f32_16x16x32_bf16 a[56:59], a[152:155], v[184:187], a[56:59]
v_exp_f32 v102, v102
v_mfma_f32_16x16x32_bf16 a[56:59], a[156:159], v[200:203], a[56:59]
ds_read_b64_tr_b16 a[176:177], v234 offset:16384
ds_read_b64_tr_b16 a[178:179], v234 offset:20480
v_mfma_f32_16x16x32_bf16 a[60:63], a[156:159], v[204:207], a[60:63]
v_exp_f32 v103, v103
v_mfma_f32_16x16x32_bf16 a[60:63], a[152:155], v[188:191], a[60:63]
ds_read_b64_tr_b16 a[180:181], v234 offset:24576
ds_read_b64_tr_b16 a[182:183], v234 offset:28672
s_waitcnt lgkmcnt(4)
v_mfma_f32_16x16x32_bf16 a[64:67], a[160:163], v[176:179], a[64:67]
v_exp_f32 v104, v104
v_mfma_f32_16x16x32_bf16 a[64:67], a[164:167], v[192:195], a[64:67]
ds_read_b64_tr_b16 a[184:185], v235 offset:16384
ds_read_b64_tr_b16 a[186:187], v235 offset:20480
v_cvt_pk_bf16_f32 v147, v98, v99
v_mfma_f32_16x16x32_bf16 a[68:71], a[164:167], v[196:199], a[68:71]
v_exp_f32 v105, v105
v_mfma_f32_16x16x32_bf16 a[68:71], a[160:163], v[180:183], a[68:71]
ds_read_b64_tr_b16 a[188:189], v235 offset:24576
ds_read_b64_tr_b16 a[190:191], v235 offset:28672
v_add_f32 v8, v8, v100
v_mfma_f32_16x16x32_bf16 a[72:75], a[160:163], v[184:187], a[72:75]
v_exp_f32 v106, v106
v_mfma_f32_16x16x32_bf16 a[72:75], a[164:167], v[200:203], a[72:75]
v_add_f32 v9, v9, v101
v_cvt_pk_bf16_f32 v150, v100, v101
v_mfma_f32_16x16x32_bf16 a[76:79], a[164:167], v[204:207], a[76:79]
v_exp_f32 v107, v107
v_mfma_f32_16x16x32_bf16 a[76:79], a[160:163], v[188:191], a[76:79]
v_add_f32 v8, v8, v102
v_add_f32 v9, v9, v103
v_mfma_f32_16x16x32_bf16 a[80:83], a[168:171], v[176:179], a[80:83]
v_exp_f32 v108, v108
v_mfma_f32_16x16x32_bf16 a[80:83], a[172:175], v[192:195], a[80:83]
v_cvt_pk_bf16_f32 v151, v102, v103
v_cvt_pk_bf16_f32 v154, v104, v105
v_mfma_f32_16x16x32_bf16 a[84:87], a[172:175], v[196:199], a[84:87]
v_exp_f32 v109, v109
v_mfma_f32_16x16x32_bf16 a[84:87], a[168:171], v[180:183], a[84:87]
v_cvt_pk_bf16_f32 v155, v106, v107
v_add_f32 v10, v10, v108
v_mfma_f32_16x16x32_bf16 a[88:91], a[168:171], v[184:187], a[88:91]
v_exp_f32 v110, v110
v_mfma_f32_16x16x32_bf16 a[88:91], a[172:175], v[200:203], a[88:91]
v_add_f32 v11, v11, v109
v_cvt_pk_bf16_f32 v158, v108, v109
v_mfma_f32_16x16x32_bf16 a[92:95], a[172:175], v[204:207], a[92:95]
v_exp_f32 v111, v111
v_mfma_f32_16x16x32_bf16 a[92:95], a[168:171], v[188:191], a[92:95]
s_waitcnt vmcnt(22) lgkmcnt(0)
s_barrier
v_mfma_f32_16x16x32_bf16 a[96:99], a[176:179], v[176:179], a[96:99]
s_add_u32 m0, s39, 0
v_exp_f32 v112, v112
v_mfma_f32_16x16x32_bf16 a[96:99], a[180:183], v[192:195], a[96:99]
ds_read_b128 a[128:131], v224 offset:49152
ds_read_b128 a[132:135], v225 offset:49152
v_mfma_f32_16x16x32_bf16 a[100:103], a[180:183], v[196:199], a[100:103]
buffer_load_dwordx4 v242, s[24:27], s45 offen offset:0 lds
v_mfma_f32_16x16x32_bf16 a[100:103], a[176:179], v[180:183], a[100:103]
v_exp_f32 v113, v113
v_mfma_f32_16x16x32_bf16 a[104:107], a[176:179], v[184:187], a[104:107]
ds_read_b128 a[136:139], v226 offset:49152
ds_read_b128 a[140:143], v227 offset:49152
v_mfma_f32_16x16x32_bf16 a[104:107], a[180:183], v[200:203], a[104:107]
v_exp_f32 v114, v114
v_mfma_f32_16x16x32_bf16 a[108:111], a[180:183], v[204:207], a[108:111]
v_add_f32 v10, v10, v110
v_add_f32 v11, v11, v111
v_mfma_f32_16x16x32_bf16 a[108:111], a[176:179], v[188:191], a[108:111]
v_exp_f32 v115, v115
v_mfma_f32_16x16x32_bf16 a[112:115], a[184:187], v[176:179], a[112:115]
v_cvt_pk_bf16_f32 v159, v110, v111
v_cvt_pk_bf16_f32 v160, v112, v113
v_mfma_f32_16x16x32_bf16 a[112:115], a[188:191], v[192:195], a[112:115]
buffer_load_dwordx4 v243, s[24:27], s45 offen offset:1024 lds
v_mfma_f32_16x16x32_bf16 a[116:119], a[188:191], v[196:199], a[116:119]
v_exp_f32 v116, v116
v_mfma_f32_16x16x32_bf16 a[116:119], a[184:187], v[180:183], a[116:119]
v_cvt_pk_bf16_f32 v161, v114, v115
v_add_f32 v8, v8, v116
v_mfma_f32_16x16x32_bf16 a[120:123], a[184:187], v[184:187], a[120:123]
v_exp_f32 v117, v117
v_mfma_f32_16x16x32_bf16 a[120:123], a[188:191], v[200:203], a[120:123]
v_add_f32 v9, v9, v117
v_cvt_pk_bf16_f32 v164, v116, v117
v_mfma_f32_16x16x32_bf16 a[124:127], a[188:191], v[204:207], a[124:127]
v_exp_f32 v118, v118
v_mfma_f32_16x16x32_bf16 a[124:127], a[184:187], v[188:191], a[124:127]
v_add_f32 v8, v8, v118
v_mfma_f32_16x16x32_bf16 a[192:195], a[208:211], v[176:179], a[192:195]
buffer_load_dwordx4 v244, s[24:27], s45 offen offset:2048 lds
v_mfma_f32_16x16x32_bf16 a[192:195], a[208:211], v[192:195], a[192:195]
v_exp_f32 v119, v119
v_mfma_f32_16x16x32_bf16 a[200:203], a[208:211], v[184:187], a[200:203]
v_exp_f32 v120, v120
v_mfma_f32_16x16x32_bf16 a[200:203], a[208:211], v[200:203], a[200:203]
ds_read_b128 a[144:147], v224 offset:53248
s_waitcnt lgkmcnt(1)
v_mfma_f32_16x16x32_bf16 v[80:83], a[128:131], v[16:19], v[208:211]
v_exp_f32 v121, v121
v_mfma_f32_16x16x32_bf16 v[80:83], a[132:135], v[20:23], v[80:83]
ds_read_b128 a[148:151], v225 offset:53248
ds_read_b128 a[152:155], v226 offset:53248
v_mfma_f32_16x16x32_bf16 v[80:83], a[136:139], v[24:27], v[80:83]
buffer_load_dwordx4 v245, s[24:27], s45 offen offset:3072 lds
v_mfma_f32_16x16x32_bf16 v[80:83], a[140:143], v[28:31], v[80:83]
s_add_u32 m0, s39, 16384
v_exp_f32 v122, v122
v_mfma_f32_16x16x32_bf16 v[84:87], a[140:143], v[44:47], v[212:215]
v_exp_f32 v123, v123
v_mfma_f32_16x16x32_bf16 v[84:87], a[136:139], v[40:43], v[84:87]
ds_read_b128 a[156:159], v227 offset:53248
v_add_f32 v9, v9, v119
v_mfma_f32_16x16x32_bf16 v[84:87], a[132:135], v[36:39], v[84:87]
v_exp_f32 v124, v124
v_mfma_f32_16x16x32_bf16 v[84:87], a[128:131], v[32:35], v[84:87]
v_cvt_pk_bf16_f32 v165, v118, v119
v_cvt_pk_bf16_f32 v168, v120, v121
v_mfma_f32_16x16x32_bf16 v[88:91], a[128:131], v[48:51], v[216:219]
buffer_load_dwordx4 v246, s[24:27], s45 offen offset:0 lds
v_mfma_f32_16x16x32_bf16 v[88:91], a[132:135], v[52:55], v[88:91]
v_exp_f32 v125, v125
v_mfma_f32_16x16x32_bf16 v[88:91], a[136:139], v[56:59], v[88:91]
v_exp_f32 v126, v126
v_mfma_f32_16x16x32_bf16 v[88:91], a[140:143], v[60:63], v[88:91]
v_cvt_pk_bf16_f32 v169, v122, v123
v_add_f32 v10, v10, v124
v_mfma_f32_16x16x32_bf16 v[92:95], a[140:143], v[76:79], v[220:223]
v_exp_f32 v127, v127
v_mfma_f32_16x16x32_bf16 v[92:95], a[136:139], v[72:75], v[92:95]
ds_read_b128 a[160:163], v224 offset:57344
ds_read_b128 a[164:167], v225 offset:57344
v_mfma_f32_16x16x32_bf16 v[92:95], a[132:135], v[68:71], v[92:95]
buffer_load_dwordx4 v247, s[24:27], s45 offen offset:1024 lds
v_mfma_f32_16x16x32_bf16 v[92:95], a[128:131], v[64:67], v[92:95]
s_waitcnt lgkmcnt(2)
v_exp_f32 v128, v128
v_mfma_f32_16x16x32_bf16 v[96:99], a[144:147], v[16:19], v[208:211]
v_exp_f32 v129, v129
v_mfma_f32_16x16x32_bf16 v[96:99], a[148:151], v[20:23], v[96:99]
ds_read_b128 a[168:171], v226 offset:57344
ds_read_b128 a[172:175], v227 offset:57344
v_mfma_f32_16x16x32_bf16 v[96:99], a[152:155], v[24:27], v[96:99]
v_exp_f32 v130, v130
v_mfma_f32_16x16x32_bf16 v[96:99], a[156:159], v[28:31], v[96:99]
v_add_f32 v11, v11, v125
v_cvt_pk_bf16_f32 v172, v124, v125
v_mfma_f32_16x16x32_bf16 v[100:103], a[156:159], v[44:47], v[212:215]
buffer_load_dwordx4 v248, s[24:27], s45 offen offset:2048 lds
v_mfma_f32_16x16x32_bf16 v[100:103], a[152:155], v[40:43], v[100:103]
v_exp_f32 v131, v131
v_mfma_f32_16x16x32_bf16 v[100:103], a[148:151], v[36:39], v[100:103]
v_exp_f32 v132, v132
v_mfma_f32_16x16x32_bf16 v[100:103], a[144:147], v[32:35], v[100:103]
v_add_f32 v10, v10, v126
v_add_f32 v11, v11, v127
v_mfma_f32_16x16x32_bf16 v[104:107], a[144:147], v[48:51], v[216:219]
v_exp_f32 v133, v133
v_mfma_f32_16x16x32_bf16 v[104:107], a[148:151], v[52:55], v[104:107]
v_cvt_pk_bf16_f32 v173, v126, v127
v_cvt_pk_bf16_f32 v162, v128, v129
v_mfma_f32_16x16x32_bf16 v[104:107], a[152:155], v[56:59], v[104:107]
buffer_load_dwordx4 v249, s[24:27], s45 offen offset:3072 lds
v_mfma_f32_16x16x32_bf16 v[104:107], a[156:159], v[60:63], v[104:107]
s_add_u32 s45, s45, 65536
v_exp_f32 v134, v134
v_mfma_f32_16x16x32_bf16 v[108:111], a[156:159], v[76:79], v[220:223]
s_and_b32 s45, s45, 0x7ffff
v_exp_f32 v135, v135
v_mfma_f32_16x16x32_bf16 v[108:111], a[152:155], v[72:75], v[108:111]
ds_read_b128 a[176:179], v224 offset:61440
ds_read_b128 a[180:183], v225 offset:61440
v_cvt_pk_bf16_f32 v163, v130, v131
v_mfma_f32_16x16x32_bf16 v[108:111], a[148:151], v[68:71], v[108:111]
s_add_u32 s5, s4, 0
v_exp_f32 v136, v136
v_mfma_f32_16x16x32_bf16 v[108:111], a[144:147], v[64:67], v[108:111]
ds_read_b128 a[184:187], v226 offset:61440
s_waitcnt lgkmcnt(3)
v_mfma_f32_16x16x32_bf16 v[112:115], a[160:163], v[16:19], v[208:211]
buffer_load_dwordx4 a[244:247], v252, s[92:95], s5 offen offset:0
v_mfma_f32_16x16x32_bf16 v[112:115], a[164:167], v[20:23], v[112:115]
v_exp_f32 v137, v137
v_mfma_f32_16x16x32_bf16 v[112:115], a[168:171], v[24:27], v[112:115]
v_exp_f32 v138, v138
v_mfma_f32_16x16x32_bf16 v[112:115], a[172:175], v[28:31], v[112:115]
ds_read_b128 a[188:191], v227 offset:61440
v_add_f32 v8, v8, v132
v_add_f32 v9, v9, v133
v_mfma_f32_16x16x32_bf16 v[116:119], a[172:175], v[44:47], v[212:215]
v_exp_f32 v139, v139
v_mfma_f32_16x16x32_bf16 v[116:119], a[168:171], v[40:43], v[116:119]
v_cvt_pk_bf16_f32 v166, v132, v133
v_add_f32 v8, v8, v134
v_mfma_f32_16x16x32_bf16 v[116:119], a[164:167], v[36:39], v[116:119]
buffer_load_dwordx4 a[248:251], v252, s[92:95], s5 offen offset:768
v_mfma_f32_16x16x32_bf16 v[116:119], a[160:163], v[32:35], v[116:119]
s_add_u32 s5, s4, 3584
v_exp_f32 v140, v140
v_mfma_f32_16x16x32_bf16 v[120:123], a[160:163], v[48:51], v[216:219]
v_exp_f32 v141, v141
v_mfma_f32_16x16x32_bf16 v[120:123], a[164:167], v[52:55], v[120:123]
v_add_f32 v9, v9, v135
v_cvt_pk_bf16_f32 v167, v134, v135
v_cvt_pk_bf16_f32 v170, v136, v137
v_mfma_f32_16x16x32_bf16 v[120:123], a[168:171], v[56:59], v[120:123]
v_exp_f32 v142, v142
v_mfma_f32_16x16x32_bf16 v[120:123], a[172:175], v[60:63], v[120:123]
v_cvt_pk_bf16_f32 v171, v138, v139
v_add_f32 v10, v10, v140
v_mfma_f32_16x16x32_bf16 v[124:127], a[172:175], v[76:79], v[220:223]
buffer_load_dwordx4 a[252:255], v252, s[92:95], s5 offen offset:0
v_mfma_f32_16x16x32_bf16 v[124:127], a[168:171], v[72:75], v[124:127]
v_exp_f32 v143, v143
v_mfma_f32_16x16x32_bf16 v[124:127], a[164:167], v[68:71], v[124:127]
ds_read_b64_tr_b16 a[128:129], v228 offset:32768
ds_read_b64_tr_b16 a[130:131], v228 offset:36864
v_mfma_f32_16x16x32_bf16 v[124:127], a[160:163], v[64:67], v[124:127]
ds_read_b64_tr_b16 a[132:133], v228 offset:40960
s_waitcnt lgkmcnt(3)
v_mfma_f32_16x16x32_bf16 v[128:131], a[176:179], v[16:19], v[208:211]
v_exp_f32 v80, v80
v_mfma_f32_16x16x32_bf16 v[128:131], a[180:183], v[20:23], v[128:131]
ds_read_b64_tr_b16 a[134:135], v228 offset:45056
v_add_f32 v11, v11, v141
v_mfma_f32_16x16x32_bf16 v[128:131], a[184:187], v[24:27], v[128:131]
buffer_load_dwordx4 a[244:247], v252, s[92:95], s5 offen offset:768
v_mfma_f32_16x16x32_bf16 v[128:131], a[188:191], v[28:31], v[128:131]
s_add_u32 s5, s4, 7168
v_exp_f32 v81, v81
v_mfma_f32_16x16x32_bf16 v[132:135], a[188:191], v[44:47], v[212:215]
ds_read_b64_tr_b16 a[136:137], v229 offset:32768
ds_read_b64_tr_b16 a[138:139], v229 offset:36864
v_mfma_f32_16x16x32_bf16 v[132:135], a[184:187], v[40:43], v[132:135]
v_exp_f32 v82, v82
v_mfma_f32_16x16x32_bf16 v[132:135], a[180:183], v[36:39], v[132:135]
ds_read_b64_tr_b16 a[140:141], v229 offset:40960
ds_read_b64_tr_b16 a[142:143], v229 offset:45056
v_mfma_f32_16x16x32_bf16 v[132:135], a[176:179], v[32:35], v[132:135]
v_exp_f32 v83, v83
v_mfma_f32_16x16x32_bf16 v[136:139], a[176:179], v[48:51], v[216:219]
v_cvt_pk_bf16_f32 v174, v140, v141
v_add_f32 v10, v10, v142
v_mfma_f32_16x16x32_bf16 v[136:139], a[180:183], v[52:55], v[136:139]
buffer_load_dwordx4 a[248:251], v252, s[92:95], s5 offen offset:0
v_mfma_f32_16x16x32_bf16 v[136:139], a[184:187], v[56:59], v[136:139]
v_exp_f32 v84, v84
v_mfma_f32_16x16x32_bf16 v[136:139], a[188:191], v[60:63], v[136:139]
v_add_f32 v11, v11, v143
v_cvt_pk_bf16_f32 v175, v142, v143
v_mfma_f32_16x16x32_bf16 v[140:143], a[188:191], v[76:79], v[220:223]
v_exp_f32 v85, v85
v_mfma_f32_16x16x32_bf16 v[140:143], a[184:187], v[72:75], v[140:143]
ds_read_b64_tr_b16 a[144:145], v230 offset:32768
ds_read_b64_tr_b16 a[146:147], v230 offset:36864
v_mfma_f32_16x16x32_bf16 v[140:143], a[180:183], v[68:71], v[140:143]
v_exp_f32 v86, v86
v_mfma_f32_16x16x32_bf16 v[140:143], a[176:179], v[64:67], v[140:143]
ds_read_b64_tr_b16 a[148:149], v230 offset:40960
s_waitcnt lgkmcnt(3)
v_mfma_f32_16x16x32_bf16 a[0:3], a[128:131], v[144:147], a[0:3]
buffer_load_dwordx4 a[252:255], v252, s[92:95], s5 offen offset:768
v_mfma_f32_16x16x32_bf16 a[0:3], a[132:135], v[160:163], a[0:3]
s_add_u32 s5, s4, 10752
v_exp_f32 v87, v87
v_mfma_f32_16x16x32_bf16 a[4:7], a[132:135], v[164:167], a[4:7]
v_exp_f32 v88, v88
v_mfma_f32_16x16x32_bf16 a[4:7], a[128:131], v[148:151], a[4:7]
ds_read_b64_tr_b16 a[150:151], v230 offset:45056
v_cvt_pk_bf16_f32 v176, v80, v81
v_cvt_pk_bf16_f32 v177, v82, v83
v_mfma_f32_16x16x32_bf16 a[8:11], a[128:131], v[152:155], a[8:11]
v_exp_f32 v89, v89
v_mfma_f32_16x16x32_bf16 a[8:11], a[132:135], v[168:171], a[8:11]
ds_read_b64_tr_b16 a[152:153], v231 offset:32768
ds_read_b64_tr_b16 a[154:155], v231 offset:36864
v_add_f32 v8, v8, v84
v_mfma_f32_16x16x32_bf16 a[12:15], a[132:135], v[172:175], a[12:15]
buffer_load_dwordx4 a[244:247], v252, s[92:95], s5 offen offset:0
v_mfma_f32_16x16x32_bf16 a[12:15], a[128:131], v[156:159], a[12:15]
v_exp_f32 v90, v90
v_mfma_f32_16x16x32_bf16 a[16:19], a[136:139], v[144:147], a[16:19]
v_exp_f32 v91, v91
v_mfma_f32_16x16x32_bf16 a[16:19], a[140:143], v[160:163], a[16:19]
ds_read_b64_tr_b16 a[156:157], v231 offset:40960
ds_read_b64_tr_b16 a[158:159], v231 offset:45056
v_add_f32 v9, v9, v85
v_mfma_f32_16x16x32_bf16 a[20:23], a[140:143], v[164:167], a[20:23]
v_exp_f32 v92, v92
v_mfma_f32_16x16x32_bf16 a[20:23], a[136:139], v[148:151], a[20:23]
v_cvt_pk_bf16_f32 v180, v84, v85
v_add_f32 v8, v8, v86
v_add_f32 v9, v9, v87
v_mfma_f32_16x16x32_bf16 a[24:27], a[136:139], v[152:155], a[24:27]
buffer_load_dwordx4 a[248:251], v252, s[92:95], s5 offen offset:768
v_mfma_f32_16x16x32_bf16 a[24:27], a[140:143], v[168:171], a[24:27]
v_exp_f32 v93, v93
v_mfma_f32_16x16x32_bf16 a[28:31], a[140:143], v[172:175], a[28:31]
v_exp_f32 v94, v94
v_mfma_f32_16x16x32_bf16 a[28:31], a[136:139], v[156:159], a[28:31]
ds_read_b64_tr_b16 a[160:161], v232 offset:32768
ds_read_b64_tr_b16 a[162:163], v232 offset:36864
s_waitcnt lgkmcnt(2)
v_mfma_f32_16x16x32_bf16 a[32:35], a[144:147], v[144:147], a[32:35]
v_exp_f32 v95, v95
v_mfma_f32_16x16x32_bf16 a[32:35], a[148:151], v[160:163], a[32:35]
ds_read_b64_tr_b16 a[164:165], v232 offset:40960
ds_read_b64_tr_b16 a[166:167], v232 offset:45056
v_cvt_pk_bf16_f32 v181, v86, v87
v_mfma_f32_16x16x32_bf16 a[36:39], a[148:151], v[164:167], a[36:39]
v_exp_f32 v96, v96
v_mfma_f32_16x16x32_bf16 a[36:39], a[144:147], v[148:151], a[36:39]
v_cvt_pk_bf16_f32 v184, v88, v89
v_cvt_pk_bf16_f32 v185, v90, v91
v_add_f32 v10, v10, v92
v_mfma_f32_16x16x32_bf16 a[40:43], a[144:147], v[152:155], a[40:43]
v_exp_f32 v97, v97
v_mfma_f32_16x16x32_bf16 a[40:43], a[148:151], v[168:171], a[40:43]
ds_read_b64_tr_b16 a[168:169], v233 offset:32768
ds_read_b64_tr_b16 a[170:171], v233 offset:36864
v_mfma_f32_16x16x32_bf16 a[44:47], a[148:151], v[172:175], a[44:47]
v_exp_f32 v98, v98
v_mfma_f32_16x16x32_bf16 a[44:47], a[144:147], v[156:159], a[44:47]
ds_read_b64_tr_b16 a[172:173], v233 offset:40960
ds_read_b64_tr_b16 a[174:175], v233 offset:45056
v_mfma_f32_16x16x32_bf16 a[48:51], a[152:155], v[144:147], a[48:51]
v_exp_f32 v99, v99
v_mfma_f32_16x16x32_bf16 a[48:51], a[156:159], v[160:163], a[48:51]
v_add_f32 v11, v11, v93
v_cvt_pk_bf16_f32 v188, v92, v93
v_add_f32 v10, v10, v94
v_mfma_f32_16x16x32_bf16 a[52:55], a[156:159], v[164:167], a[52:55]
v_exp_f32 v100, v100
v_mfma_f32_16x16x32_bf16 a[52:55], a[152:155], v[148:151], a[52:55]
v_add_f32 v11, v11, v95
v_cvt_pk_bf16_f32 v189, v94, v95
v_mfma_f32_16x16x32_bf16 a[56:59], a[152:155], v[152:155], a[56:59]
v_exp_f32 v101, v101
v_mfma_f32_16x16x32_bf16 a[56:59], a[156:159], v[168:171], a[56:59]
ds_read_b64_tr_b16 a[176:177], v234 offset:32768
ds_read_b64_tr_b16 a[178:179], v234 offset:36864
v_mfma_f32_16x16x32_bf16 a[60:63], a[156:159], v[172:175], a[60:63]
v_exp_f32 v102, v102
v_mfma_f32_16x16x32_bf16 a[60:63], a[152:155], v[156:159], a[60:63]
ds_read_b64_tr_b16 a[180:181], v234 offset:40960
s_waitcnt lgkmcnt(3)
v_mfma_f32_16x16x32_bf16 a[64:67], a[160:163], v[144:147], a[64:67]
v_exp_f32 v103, v103
v_mfma_f32_16x16x32_bf16 a[64:67], a[164:167], v[160:163], a[64:67]
ds_read_b64_tr_b16 a[182:183], v234 offset:45056
ds_read_b64_tr_b16 a[184:185], v235 offset:32768
v_cvt_pk_bf16_f32 v178, v96, v97
v_mfma_f32_16x16x32_bf16 a[68:71], a[164:167], v[164:167], a[68:71]
v_exp_f32 v104, v104
v_mfma_f32_16x16x32_bf16 a[68:71], a[160:163], v[148:151], a[68:71]
ds_read_b64_tr_b16 a[186:187], v235 offset:36864
ds_read_b64_tr_b16 a[188:189], v235 offset:40960
v_cvt_pk_bf16_f32 v179, v98, v99
v_mfma_f32_16x16x32_bf16 a[72:75], a[160:163], v[152:155], a[72:75]
v_exp_f32 v105, v105
v_mfma_f32_16x16x32_bf16 a[72:75], a[164:167], v[168:171], a[72:75]
ds_read_b64_tr_b16 a[190:191], v235 offset:45056
v_add_f32 v8, v8, v100
v_add_f32 v9, v9, v101
v_mfma_f32_16x16x32_bf16 a[76:79], a[164:167], v[172:175], a[76:79]
v_exp_f32 v106, v106
v_mfma_f32_16x16x32_bf16 a[76:79], a[160:163], v[156:159], a[76:79]
v_cvt_pk_bf16_f32 v182, v100, v101
v_add_f32 v8, v8, v102
v_mfma_f32_16x16x32_bf16 a[80:83], a[168:171], v[144:147], a[80:83]
v_exp_f32 v107, v107
v_mfma_f32_16x16x32_bf16 a[80:83], a[172:175], v[160:163], a[80:83]
v_add_f32 v9, v9, v103
v_cvt_pk_bf16_f32 v183, v102, v103
v_mfma_f32_16x16x32_bf16 a[84:87], a[172:175], v[164:167], a[84:87]
v_exp_f32 v108, v108
v_mfma_f32_16x16x32_bf16 a[84:87], a[168:171], v[148:151], a[84:87]
v_cvt_pk_bf16_f32 v186, v104, v105
v_cvt_pk_bf16_f32 v187, v106, v107
v_mfma_f32_16x16x32_bf16 a[88:91], a[168:171], v[152:155], a[88:91]
v_exp_f32 v109, v109
v_mfma_f32_16x16x32_bf16 a[88:91], a[172:175], v[168:171], a[88:91]
v_add_f32 v10, v10, v108
v_add_f32 v11, v11, v109
v_mfma_f32_16x16x32_bf16 a[92:95], a[172:175], v[172:175], a[92:95]
v_exp_f32 v110, v110
v_mfma_f32_16x16x32_bf16 a[92:95], a[168:171], v[156:159], a[92:95]
s_waitcnt vmcnt(34) lgkmcnt(0)
s_barrier
v_mfma_f32_16x16x32_bf16 a[96:99], a[176:179], v[144:147], a[96:99]
global_load_dwordx4 a[244:247], v[12:13], off
v_mfma_f32_16x16x32_bf16 a[96:99], a[180:183], v[160:163], a[96:99]
v_exp_f32 v111, v111
v_mfma_f32_16x16x32_bf16 a[100:103], a[180:183], v[164:167], a[100:103]
v_exp_f32 v112, v112
v_mfma_f32_16x16x32_bf16 a[100:103], a[176:179], v[148:151], a[100:103]
v_cvt_pk_bf16_f32 v190, v108, v109
v_add_f32 v10, v10, v110
v_mfma_f32_16x16x32_bf16 a[104:107], a[176:179], v[152:155], a[104:107]
v_exp_f32 v113, v113
v_mfma_f32_16x16x32_bf16 a[104:107], a[180:183], v[168:171], a[104:107]
v_add_f32 v11, v11, v111
v_cvt_pk_bf16_f32 v191, v110, v111
v_mfma_f32_16x16x32_bf16 a[108:111], a[180:183], v[172:175], a[108:111]
v_exp_f32 v114, v114
v_mfma_f32_16x16x32_bf16 a[108:111], a[176:179], v[156:159], a[108:111]
ds_read_b64_tr_b16 a[128:129], v228 offset:49152
ds_read_b64_tr_b16 a[130:131], v228 offset:53248
v_mfma_f32_16x16x32_bf16 a[112:115], a[184:187], v[144:147], a[112:115]
v_exp_f32 v115, v115
v_mfma_f32_16x16x32_bf16 a[112:115], a[188:191], v[160:163], a[112:115]
v_cvt_pk_bf16_f32 v192, v112, v113
v_cvt_pk_bf16_f32 v193, v114, v115
v_mfma_f32_16x16x32_bf16 a[116:119], a[188:191], v[164:167], a[116:119]
v_exp_f32 v116, v116
v_mfma_f32_16x16x32_bf16 a[116:119], a[184:187], v[148:151], a[116:119]
ds_read_b64_tr_b16 a[132:133], v229 offset:49152
ds_read_b64_tr_b16 a[134:135], v229 offset:53248
v_mfma_f32_16x16x32_bf16 a[120:123], a[184:187], v[152:155], a[120:123]
v_exp_f32 v117, v117
v_mfma_f32_16x16x32_bf16 a[120:123], a[188:191], v[168:171], a[120:123]
v_add_f32 v8, v8, v116
v_add_f32 v9, v9, v117
v_mfma_f32_16x16x32_bf16 a[124:127], a[188:191], v[172:175], a[124:127]
v_exp_f32 v118, v118
v_mfma_f32_16x16x32_bf16 a[124:127], a[184:187], v[156:159], a[124:127]
ds_read_b64_tr_b16 a[136:137], v230 offset:49152
ds_read_b64_tr_b16 a[138:139], v230 offset:53248
v_mfma_f32_16x16x32_bf16 a[192:195], a[208:211], v[144:147], a[192:195]
v_exp_f32 v119, v119
v_mfma_f32_16x16x32_bf16 a[192:195], a[208:211], v[160:163], a[192:195]
v_cvt_pk_bf16_f32 v196, v116, v117
v_add_f32 v8, v8, v118
v_mfma_f32_16x16x32_bf16 a[200:203], a[208:211], v[152:155], a[200:203]
v_exp_f32 v120, v120
v_mfma_f32_16x16x32_bf16 a[200:203], a[208:211], v[168:171], a[200:203]
ds_read_b64_tr_b16 a[140:141], v231 offset:49152
s_waitcnt lgkmcnt(3)
v_mfma_f32_16x16x32_bf16 a[0:3], a[128:131], v[176:179], a[0:3]
v_exp_f32 v121, v121
ds_read_b64_tr_b16 a[142:143], v231 offset:53248
v_add_f32 v9, v9, v119
v_mfma_f32_16x16x32_bf16 a[4:7], a[128:131], v[180:183], a[4:7]
v_exp_f32 v122, v122
v_cvt_pk_bf16_f32 v197, v118, v119
v_cvt_pk_bf16_f32 v200, v120, v121
v_mfma_f32_16x16x32_bf16 a[8:11], a[128:131], v[184:187], a[8:11]
v_exp_f32 v123, v123
ds_read_b64_tr_b16 a[144:145], v232 offset:49152
ds_read_b64_tr_b16 a[146:147], v232 offset:53248
v_mfma_f32_16x16x32_bf16 a[12:15], a[128:131], v[188:191], a[12:15]
v_exp_f32 v124, v124
v_cvt_pk_bf16_f32 v201, v122, v123
v_mfma_f32_16x16x32_bf16 a[16:19], a[132:135], v[176:179], a[16:19]
v_exp_f32 v125, v125
v_add_f32 v10, v10, v124
v_mfma_f32_16x16x32_bf16 a[20:23], a[132:135], v[180:183], a[20:23]
v_exp_f32 v126, v126
v_add_f32 v11, v11, v125
v_cvt_pk_bf16_f32 v204, v124, v125
v_mfma_f32_16x16x32_bf16 a[24:27], a[132:135], v[184:187], a[24:27]
v_exp_f32 v127, v127
ds_read_b64_tr_b16 a[148:149], v233 offset:49152
ds_read_b64_tr_b16 a[150:151], v233 offset:53248
v_mfma_f32_16x16x32_bf16 a[28:31], a[132:135], v[188:191], a[28:31]
v_exp_f32 v128, v128
v_add_f32 v10, v10, v126
s_waitcnt lgkmcnt(4)
v_mfma_f32_16x16x32_bf16 a[32:35], a[136:139], v[176:179], a[32:35]
v_exp_f32 v129, v129
v_add_f32 v11, v11, v127
v_cvt_pk_bf16_f32 v205, v126, v127
v_mfma_f32_16x16x32_bf16 a[36:39], a[136:139], v[180:183], a[36:39]
v_exp_f32 v130, v130
v_cvt_pk_bf16_f32 v194, v128, v129
v_mfma_f32_16x16x32_bf16 a[40:43], a[136:139], v[184:187], a[40:43]
v_exp_f32 v131, v131
ds_read_b64_tr_b16 a[152:153], v234 offset:49152
ds_read_b64_tr_b16 a[154:155], v234 offset:53248
v_mfma_f32_16x16x32_bf16 a[44:47], a[136:139], v[188:191], a[44:47]
v_exp_f32 v132, v132
v_cvt_pk_bf16_f32 v195, v130, v131
v_mfma_f32_16x16x32_bf16 a[48:51], a[140:143], v[176:179], a[48:51]
v_exp_f32 v133, v133
v_add_f32 v8, v8, v132
v_mfma_f32_16x16x32_bf16 a[52:55], a[140:143], v[180:183], a[52:55]
v_exp_f32 v134, v134
v_add_f32 v9, v9, v133
v_cvt_pk_bf16_f32 v198, v132, v133
v_mfma_f32_16x16x32_bf16 a[56:59], a[140:143], v[184:187], a[56:59]
v_exp_f32 v135, v135
ds_read_b64_tr_b16 a[156:157], v235 offset:49152
ds_read_b64_tr_b16 a[158:159], v235 offset:53248
v_mfma_f32_16x16x32_bf16 a[60:63], a[140:143], v[188:191], a[60:63]
v_exp_f32 v136, v136
v_add_f32 v8, v8, v134
s_waitcnt lgkmcnt(4)
v_mfma_f32_16x16x32_bf16 a[64:67], a[144:147], v[176:179], a[64:67]
v_exp_f32 v137, v137
v_add_f32 v9, v9, v135
v_cvt_pk_bf16_f32 v199, v134, v135
v_mfma_f32_16x16x32_bf16 a[68:71], a[144:147], v[180:183], a[68:71]
v_exp_f32 v138, v138
v_cvt_pk_bf16_f32 v202, v136, v137
v_mfma_f32_16x16x32_bf16 a[72:75], a[144:147], v[184:187], a[72:75]
v_exp_f32 v139, v139
v_mfma_f32_16x16x32_bf16 a[76:79], a[144:147], v[188:191], a[76:79]
v_exp_f32 v140, v140
v_cvt_pk_bf16_f32 v203, v138, v139
v_mfma_f32_16x16x32_bf16 a[80:83], a[148:151], v[176:179], a[80:83]
v_exp_f32 v141, v141
ds_read_b64_tr_b16 a[160:161], v228 offset:57344
ds_read_b64_tr_b16 a[162:163], v228 offset:61440
v_mfma_f32_16x16x32_bf16 a[84:87], a[148:151], v[180:183], a[84:87]
v_exp_f32 v142, v142
v_add_f32 v10, v10, v140
v_add_f32 v11, v11, v141
v_mfma_f32_16x16x32_bf16 a[88:91], a[148:151], v[184:187], a[88:91]
v_exp_f32 v143, v143
v_cvt_pk_bf16_f32 v206, v140, v141
v_add_f32 v10, v10, v142
v_mfma_f32_16x16x32_bf16 a[92:95], a[148:151], v[188:191], a[92:95]
v_add_f32 v11, v11, v143
s_waitcnt lgkmcnt(2)
v_mfma_f32_16x16x32_bf16 a[96:99], a[152:155], v[176:179], a[96:99]
ds_read_b64_tr_b16 a[164:165], v229 offset:57344
ds_read_b64_tr_b16 a[166:167], v229 offset:61440
v_mfma_f32_16x16x32_bf16 a[100:103], a[152:155], v[180:183], a[100:103]
v_cvt_pk_bf16_f32 v207, v142, v143
v_mfma_f32_16x16x32_bf16 a[104:107], a[152:155], v[184:187], a[104:107]
v_mfma_f32_16x16x32_bf16 a[108:111], a[152:155], v[188:191], a[108:111]
v_mfma_f32_16x16x32_bf16 a[112:115], a[156:159], v[176:179], a[112:115]
ds_read_b64_tr_b16 a[168:169], v230 offset:57344
ds_read_b64_tr_b16 a[170:171], v230 offset:61440
v_mfma_f32_16x16x32_bf16 a[116:119], a[156:159], v[180:183], a[116:119]
v_mfma_f32_16x16x32_bf16 a[120:123], a[156:159], v[184:187], a[120:123]
v_mfma_f32_16x16x32_bf16 a[124:127], a[156:159], v[188:191], a[124:127]
v_mfma_f32_16x16x32_bf16 a[192:195], a[208:211], v[176:179], a[192:195]
ds_read_b64_tr_b16 a[172:173], v231 offset:57344
ds_read_b64_tr_b16 a[174:175], v231 offset:61440
v_mfma_f32_16x16x32_bf16 a[200:203], a[208:211], v[184:187], a[200:203]
s_waitcnt lgkmcnt(4)
v_mfma_f32_16x16x32_bf16 a[0:3], a[160:163], v[192:195], a[0:3]
v_lshrrev_b32 v5, 2, v1
v_lshl_add_u32 v5, v2, 2, v5
v_mfma_f32_16x16x32_bf16 a[4:7], a[160:163], v[196:199], a[4:7]
v_bfe_u32 v6, v5, 1, 2
v_and_b32 v7, 3, v1
v_mfma_f32_16x16x32_bf16 a[8:11], a[160:163], v[200:203], a[8:11]
ds_read_b64_tr_b16 a[176:177], v232 offset:57344
ds_read_b64_tr_b16 a[178:179], v232 offset:61440
v_mfma_f32_16x16x32_bf16 a[12:15], a[160:163], v[204:207], a[12:15]
v_lshlrev_b32 v7, 3, v7
v_lshl_add_u32 v7, v5, 7, v7
v_mfma_f32_16x16x32_bf16 a[16:19], a[164:167], v[192:195], a[16:19]
v_add_u32 v7, s39, v7
v_xor_b32 v5, 0, v6
v_mfma_f32_16x16x32_bf16 a[20:23], a[164:167], v[196:199], a[20:23]
v_lshl_add_u32 v208, v5, 5, v7
v_add_u32 v212, 98304, v208
v_mfma_f32_16x16x32_bf16 a[24:27], a[164:167], v[200:203], a[24:27]
ds_read_b64_tr_b16 a[180:181], v233 offset:57344
ds_read_b64_tr_b16 a[182:183], v233 offset:61440
v_mfma_f32_16x16x32_bf16 a[28:31], a[164:167], v[204:207], a[28:31]
v_xor_b32 v5, 1, v6
s_waitcnt lgkmcnt(4)
v_mfma_f32_16x16x32_bf16 a[32:35], a[168:171], v[192:195], a[32:35]
v_lshl_add_u32 v209, v5, 5, v7
v_add_u32 v213, 98304, v209
v_mfma_f32_16x16x32_bf16 a[36:39], a[168:171], v[196:199], a[36:39]
v_xor_b32 v5, 2, v6
v_lshl_add_u32 v210, v5, 5, v7
v_mfma_f32_16x16x32_bf16 a[40:43], a[168:171], v[200:203], a[40:43]
ds_read_b64_tr_b16 a[184:185], v234 offset:57344
ds_read_b64_tr_b16 a[186:187], v234 offset:61440
v_mfma_f32_16x16x32_bf16 a[44:47], a[168:171], v[204:207], a[44:47]
v_add_u32 v214, 98304, v210
v_xor_b32 v5, 3, v6
v_mfma_f32_16x16x32_bf16 a[48:51], a[172:175], v[192:195], a[48:51]
v_lshl_add_u32 v211, v5, 5, v7
v_add_u32 v215, 98304, v211
v_mfma_f32_16x16x32_bf16 a[52:55], a[172:175], v[196:199], a[52:55]
v_and_b32 v15, 3, v0
v_lshlrev_b32 v15, 12, v15
v_mfma_f32_16x16x32_bf16 a[56:59], a[172:175], v[200:203], a[56:59]
ds_read_b64_tr_b16 a[188:189], v235 offset:57344
ds_read_b64_tr_b16 a[190:191], v235 offset:61440
v_mfma_f32_16x16x32_bf16 a[60:63], a[172:175], v[204:207], a[60:63]
s_lshl_b32 s62, s38, 2
s_waitcnt lgkmcnt(4)
v_mfma_f32_16x16x32_bf16 a[64:67], a[176:179], v[192:195], a[64:67]
s_add_u32 s62, s62, 98304
v_add_u32 v15, s62, v15
v_mfma_f32_16x16x32_bf16 a[68:71], a[176:179], v[196:199], a[68:71]
v_lshlrev_b32 v14, 4, v0
s_lshl_b32 s61, s38, 2
v_mfma_f32_16x16x32_bf16 a[72:75], a[176:179], v[200:203], a[72:75]
s_sub_u32 s61, s61, s42
s_add_u32 s62, s61, 0
v_mfma_f32_16x16x32_bf16 a[76:79], a[176:179], v[204:207], a[76:79]
s_and_b32 s62, s62, 15
s_lshl_b32 s62, s62, 12
v_mfma_f32_16x16x32_bf16 a[80:83], a[180:183], v[192:195], a[80:83]
s_add_u32 s62, s62, 32768
v_add_u32 v144, s62, v14
v_mfma_f32_16x16x32_bf16 a[84:87], a[180:183], v[196:199], a[84:87]
s_add_u32 s62, s61, 1
s_and_b32 s62, s62, 15
v_mfma_f32_16x16x32_bf16 a[88:91], a[180:183], v[200:203], a[88:91]
s_lshl_b32 s62, s62, 12
s_add_u32 s62, s62, 32768
v_mfma_f32_16x16x32_bf16 a[92:95], a[180:183], v[204:207], a[92:95]
v_add_u32 v145, s62, v14
s_waitcnt lgkmcnt(0)
v_mfma_f32_16x16x32_bf16 a[96:99], a[184:187], v[192:195], a[96:99]
s_add_u32 s62, s61, 2
s_and_b32 s62, s62, 15
v_mfma_f32_16x16x32_bf16 a[100:103], a[184:187], v[196:199], a[100:103]
s_lshl_b32 s62, s62, 12
s_add_u32 s62, s62, 32768
v_mfma_f32_16x16x32_bf16 a[104:107], a[184:187], v[200:203], a[104:107]
v_add_u32 v146, s62, v14
s_add_u32 s62, s61, 3
v_mfma_f32_16x16x32_bf16 a[108:111], a[184:187], v[204:207], a[108:111]
s_and_b32 s62, s62, 15
s_lshl_b32 s62, s62, 12
v_mfma_f32_16x16x32_bf16 a[112:115], a[188:191], v[192:195], a[112:115]
s_add_u32 s62, s62, 32768
v_add_u32 v147, s62, v14
v_mfma_f32_16x16x32_bf16 a[116:119], a[188:191], v[196:199], a[116:119]
v_mfma_f32_16x16x32_bf16 a[120:123], a[188:191], v[200:203], a[120:123]
v_mfma_f32_16x16x32_bf16 a[124:127], a[188:191], v[204:207], a[124:127]
v_mfma_f32_16x16x32_bf16 a[192:195], a[208:211], v[192:195], a[192:195]
v_mfma_f32_16x16x32_bf16 a[200:203], a[208:211], v[200:203], a[200:203]
s_setreg_imm32_b32 hwreg(HW_REG_MODE, 4, 2), 3
s_nop 4
v_add_f32 v80, v8, v9
v_add_f32 v81, v10, v11
v_mov_b32 v84, v80
v_mov_b32 v85, v81
s_nop 1
v_permlane32_swap_b32 v84, v80
v_permlane32_swap_b32 v85, v81
v_add_f32 v80, v80, v84
v_add_f32 v81, v81, v85
v_mov_b32 v84, v80
v_mov_b32 v85, v81
s_nop 1
v_permlane16_swap_b32 v84, v80
v_permlane16_swap_b32 v85, v81
v_add_f32 v80, v80, v84
v_add_f32_e64 v81, v81, v85
v_accvgpr_read_b32 v4, a192
v_mov_b32_e64 v5, v80
v_accvgpr_read_b32 v6, a200
v_mov_b32_e64 v7, v81
v_mov_b32 v88, 0x5f800000
v_max3_f32 v8, v4, v5, v6
v_max_f32_e64 v8, v8, v7
v_add_f32 v9, v4, 0
v_add_f32 v9, v5, v9
v_add_f32 v9, v6, v9
v_add_f32 v9, v7, v9
v_cmp_nlt_f32 vcc, v8, v88
v_cmp_u_f32 s[62:63], v9, v9
v_rcp_f32 v4, v4
v_rcp_f32 v5, v5
v_rcp_f32 v6, v6
v_rcp_f32 v7, v7
s_or_b64 vcc, vcc, s[62:63]
s_cmp_lg_u64 vcc, 0
s_cselect_b32 s61, 1, 0
v_mov_b32 v11, s61
ds_write_b32 v15, v11
v_accvgpr_read_b32 v80, a0
v_accvgpr_read_b32 v81, a1
v_accvgpr_read_b32 v82, a2
v_accvgpr_read_b32 v83, a3
v_accvgpr_read_b32 v84, a16
v_accvgpr_read_b32 v85, a17
v_accvgpr_read_b32 v86, a18
v_accvgpr_read_b32 v87, a19
v_pk_mul_f32 v[80:81], v[80:81], v[4:5] op_sel_hi:[1,0]
v_pk_mul_f32 v[82:83], v[82:83], v[4:5] op_sel_hi:[1,0]
v_pk_mul_f32 v[84:85], v[84:85], v[4:5] op_sel_hi:[1,0]
v_pk_mul_f32 v[86:87], v[86:87], v[4:5] op_sel_hi:[1,0]
v_cvt_pk_bf16_f32 v88, v80, v81
v_cvt_pk_bf16_f32 v89, v82, v83
v_cvt_pk_bf16_f32 v90, v84, v85
v_cvt_pk_bf16_f32 v91, v86, v87
v_accvgpr_read_b32 v96, a32
v_accvgpr_read_b32 v97, a33
v_accvgpr_read_b32 v98, a34
v_accvgpr_read_b32 v99, a35
ds_write_b128 v144, v[88:91] offset:0
v_accvgpr_read_b32 v100, a48
v_accvgpr_read_b32 v101, a49
v_accvgpr_read_b32 v102, a50
v_accvgpr_read_b32 v103, a51
v_pk_mul_f32 v[96:97], v[96:97], v[4:5] op_sel_hi:[1,0]
v_pk_mul_f32 v[98:99], v[98:99], v[4:5] op_sel_hi:[1,0]
v_pk_mul_f32 v[100:101], v[100:101], v[4:5] op_sel_hi:[1,0]
v_pk_mul_f32 v[102:103], v[102:103], v[4:5] op_sel_hi:[1,0]
v_cvt_pk_bf16_f32 v104, v96, v97
v_cvt_pk_bf16_f32 v105, v98, v99
v_cvt_pk_bf16_f32 v106, v100, v101
v_cvt_pk_bf16_f32 v107, v102, v103
v_accvgpr_read_b32 v112, a64
v_accvgpr_read_b32 v113, a65
v_accvgpr_read_b32 v114, a66
v_accvgpr_read_b32 v115, a67
ds_write_b128 v145, v[104:107] offset:0
v_accvgpr_read_b32 v116, a80
v_accvgpr_read_b32 v117, a81
v_accvgpr_read_b32 v118, a82
v_accvgpr_read_b32 v119, a83
v_pk_mul_f32 v[112:113], v[112:113], v[4:5] op_sel_hi:[1,0]
v_pk_mul_f32 v[114:115], v[114:115], v[4:5] op_sel_hi:[1,0]
v_pk_mul_f32 v[116:117], v[116:117], v[4:5] op_sel_hi:[1,0]
v_pk_mul_f32 v[118:119], v[118:119], v[4:5] op_sel_hi:[1,0]
v_cvt_pk_bf16_f32 v120, v112, v113
v_cvt_pk_bf16_f32 v121, v114, v115
v_cvt_pk_bf16_f32 v122, v116, v117
v_cvt_pk_bf16_f32 v123, v118, v119
v_accvgpr_read_b32 v128, a96
v_accvgpr_read_b32 v129, a97
v_accvgpr_read_b32 v130, a98
v_accvgpr_read_b32 v131, a99
ds_write_b128 v146, v[120:123] offset:0
v_accvgpr_read_b32 v132, a112
v_accvgpr_read_b32 v133, a113
v_accvgpr_read_b32 v134, a114
v_accvgpr_read_b32 v135, a115
v_pk_mul_f32 v[128:129], v[128:129], v[4:5] op_sel_hi:[1,0]
v_pk_mul_f32 v[130:131], v[130:131], v[4:5] op_sel_hi:[1,0]
v_pk_mul_f32 v[132:133], v[132:133], v[4:5] op_sel_hi:[1,0]
v_pk_mul_f32 v[134:135], v[134:135], v[4:5] op_sel_hi:[1,0]
v_cvt_pk_bf16_f32 v136, v128, v129
v_cvt_pk_bf16_f32 v137, v130, v131
v_cvt_pk_bf16_f32 v138, v132, v133
v_cvt_pk_bf16_f32 v139, v134, v135
v_accvgpr_read_b32 v80, a4
v_accvgpr_read_b32 v81, a5
v_accvgpr_read_b32 v82, a6
v_accvgpr_read_b32 v83, a7
ds_write_b128 v147, v[136:139] offset:0
v_accvgpr_read_b32 v84, a20
v_accvgpr_read_b32 v85, a21
v_accvgpr_read_b32 v86, a22
v_accvgpr_read_b32 v87, a23
v_pk_mul_f32 v[80:81], v[80:81], v[4:5] op_sel:[0,1] op_sel_hi:[1,1]
v_pk_mul_f32 v[82:83], v[82:83], v[4:5] op_sel:[0,1] op_sel_hi:[1,1]
v_pk_mul_f32 v[84:85], v[84:85], v[4:5] op_sel:[0,1] op_sel_hi:[1,1]
v_pk_mul_f32 v[86:87], v[86:87], v[4:5] op_sel:[0,1] op_sel_hi:[1,1]
v_cvt_pk_bf16_f32 v88, v80, v81
v_cvt_pk_bf16_f32 v89, v82, v83
v_cvt_pk_bf16_f32 v90, v84, v85
v_cvt_pk_bf16_f32 v91, v86, v87
v_accvgpr_read_b32 v96, a36
v_accvgpr_read_b32 v97, a37
v_accvgpr_read_b32 v98, a38
v_accvgpr_read_b32 v99, a39
ds_write_b128 v144, v[88:91] offset:1024
v_accvgpr_read_b32 v100, a52
v_accvgpr_read_b32 v101, a53
v_accvgpr_read_b32 v102, a54
v_accvgpr_read_b32 v103, a55
v_pk_mul_f32 v[96:97], v[96:97], v[4:5] op_sel:[0,1] op_sel_hi:[1,1]
v_pk_mul_f32 v[98:99], v[98:99], v[4:5] op_sel:[0,1] op_sel_hi:[1,1]
v_pk_mul_f32 v[100:101], v[100:101], v[4:5] op_sel:[0,1] op_sel_hi:[1,1]
v_pk_mul_f32 v[102:103], v[102:103], v[4:5] op_sel:[0,1] op_sel_hi:[1,1]
v_cvt_pk_bf16_f32 v104, v96, v97
v_cvt_pk_bf16_f32 v105, v98, v99
v_cvt_pk_bf16_f32 v106, v100, v101
v_cvt_pk_bf16_f32 v107, v102, v103
v_accvgpr_read_b32 v112, a68
v_accvgpr_read_b32 v113, a69
v_accvgpr_read_b32 v114, a70
v_accvgpr_read_b32 v115, a71
ds_write_b128 v145, v[104:107] offset:1024
v_accvgpr_read_b32 v116, a84
v_accvgpr_read_b32 v117, a85
v_accvgpr_read_b32 v118, a86
v_accvgpr_read_b32 v119, a87
v_pk_mul_f32 v[112:113], v[112:113], v[4:5] op_sel:[0,1] op_sel_hi:[1,1]
v_pk_mul_f32 v[114:115], v[114:115], v[4:5] op_sel:[0,1] op_sel_hi:[1,1]
v_pk_mul_f32 v[116:117], v[116:117], v[4:5] op_sel:[0,1] op_sel_hi:[1,1]
v_pk_mul_f32 v[118:119], v[118:119], v[4:5] op_sel:[0,1] op_sel_hi:[1,1]
v_cvt_pk_bf16_f32 v120, v112, v113
v_cvt_pk_bf16_f32 v121, v114, v115
v_cvt_pk_bf16_f32 v122, v116, v117
v_cvt_pk_bf16_f32 v123, v118, v119
v_accvgpr_read_b32 v128, a100
v_accvgpr_read_b32 v129, a101
v_accvgpr_read_b32 v130, a102
v_accvgpr_read_b32 v131, a103
ds_write_b128 v146, v[120:123] offset:1024
v_accvgpr_read_b32 v132, a116
v_accvgpr_read_b32 v133, a117
v_accvgpr_read_b32 v134, a118
v_accvgpr_read_b32 v135, a119
v_pk_mul_f32 v[128:129], v[128:129], v[4:5] op_sel:[0,1] op_sel_hi:[1,1]
v_pk_mul_f32 v[130:131], v[130:131], v[4:5] op_sel:[0,1] op_sel_hi:[1,1]
v_pk_mul_f32 v[132:133], v[132:133], v[4:5] op_sel:[0,1] op_sel_hi:[1,1]
v_pk_mul_f32 v[134:135], v[134:135], v[4:5] op_sel:[0,1] op_sel_hi:[1,1]
v_cvt_pk_bf16_f32 v136, v128, v129
v_cvt_pk_bf16_f32 v137, v130, v131
v_cvt_pk_bf16_f32 v138, v132, v133
v_cvt_pk_bf16_f32 v139, v134, v135
v_accvgpr_read_b32 v80, a8
v_accvgpr_read_b32 v81, a9
v_accvgpr_read_b32 v82, a10
v_accvgpr_read_b32 v83, a11
ds_write_b128 v147, v[136:139] offset:1024
v_accvgpr_read_b32 v84, a24
v_accvgpr_read_b32 v85, a25
v_accvgpr_read_b32 v86, a26
v_accvgpr_read_b32 v87, a27
v_pk_mul_f32 v[80:81], v[80:81], v[6:7] op_sel_hi:[1,0]
v_pk_mul_f32 v[82:83], v[82:83], v[6:7] op_sel_hi:[1,0]
v_pk_mul_f32 v[84:85], v[84:85], v[6:7] op_sel_hi:[1,0]
v_pk_mul_f32 v[86:87], v[86:87], v[6:7] op_sel_hi:[1,0]
v_cvt_pk_bf16_f32 v88, v80, v81
v_cvt_pk_bf16_f32 v89, v82, v83
v_cvt_pk_bf16_f32 v90, v84, v85
v_cvt_pk_bf16_f32 v91, v86, v87
v_accvgpr_read_b32 v96, a40
v_accvgpr_read_b32 v97, a41
v_accvgpr_read_b32 v98, a42
v_accvgpr_read_b32 v99, a43
ds_write_b128 v144, v[88:91] offset:2048
v_accvgpr_read_b32 v100, a56
v_accvgpr_read_b32 v101, a57
v_accvgpr_read_b32 v102, a58
v_accvgpr_read_b32 v103, a59
v_pk_mul_f32 v[96:97], v[96:97], v[6:7] op_sel_hi:[1,0]
v_pk_mul_f32 v[98:99], v[98:99], v[6:7] op_sel_hi:[1,0]
v_pk_mul_f32 v[100:101], v[100:101], v[6:7] op_sel_hi:[1,0]
v_pk_mul_f32 v[102:103], v[102:103], v[6:7] op_sel_hi:[1,0]
v_cvt_pk_bf16_f32 v104, v96, v97
v_cvt_pk_bf16_f32 v105, v98, v99
v_cvt_pk_bf16_f32 v106, v100, v101
v_cvt_pk_bf16_f32 v107, v102, v103
v_accvgpr_read_b32 v112, a72
v_accvgpr_read_b32 v113, a73
v_accvgpr_read_b32 v114, a74
v_accvgpr_read_b32 v115, a75
ds_write_b128 v145, v[104:107] offset:2048
v_accvgpr_read_b32 v116, a88
v_accvgpr_read_b32 v117, a89
v_accvgpr_read_b32 v118, a90
v_accvgpr_read_b32 v119, a91
v_pk_mul_f32 v[112:113], v[112:113], v[6:7] op_sel_hi:[1,0]
v_pk_mul_f32 v[114:115], v[114:115], v[6:7] op_sel_hi:[1,0]
v_pk_mul_f32 v[116:117], v[116:117], v[6:7] op_sel_hi:[1,0]
v_pk_mul_f32 v[118:119], v[118:119], v[6:7] op_sel_hi:[1,0]
v_cvt_pk_bf16_f32 v120, v112, v113
v_cvt_pk_bf16_f32 v121, v114, v115
v_cvt_pk_bf16_f32 v122, v116, v117
v_cvt_pk_bf16_f32 v123, v118, v119
v_accvgpr_read_b32 v128, a104
v_accvgpr_read_b32 v129, a105
v_accvgpr_read_b32 v130, a106
v_accvgpr_read_b32 v131, a107
ds_write_b128 v146, v[120:123] offset:2048
v_accvgpr_read_b32 v132, a120
v_accvgpr_read_b32 v133, a121
v_accvgpr_read_b32 v134, a122
v_accvgpr_read_b32 v135, a123
v_pk_mul_f32 v[128:129], v[128:129], v[6:7] op_sel_hi:[1,0]
v_pk_mul_f32 v[130:131], v[130:131], v[6:7] op_sel_hi:[1,0]
v_pk_mul_f32 v[132:133], v[132:133], v[6:7] op_sel_hi:[1,0]
v_pk_mul_f32 v[134:135], v[134:135], v[6:7] op_sel_hi:[1,0]
v_cvt_pk_bf16_f32 v136, v128, v129
v_cvt_pk_bf16_f32 v137, v130, v131
v_cvt_pk_bf16_f32 v138, v132, v133
v_cvt_pk_bf16_f32 v139, v134, v135
v_accvgpr_read_b32 v80, a12
v_accvgpr_read_b32 v81, a13
v_accvgpr_read_b32 v82, a14
v_accvgpr_read_b32 v83, a15
ds_write_b128 v147, v[136:139] offset:2048
v_accvgpr_read_b32 v84, a28
v_accvgpr_read_b32 v85, a29
v_accvgpr_read_b32 v86, a30
v_accvgpr_read_b32 v87, a31
v_pk_mul_f32 v[80:81], v[80:81], v[6:7] op_sel:[0,1] op_sel_hi:[1,1]
v_pk_mul_f32 v[82:83], v[82:83], v[6:7] op_sel:[0,1] op_sel_hi:[1,1]
v_pk_mul_f32 v[84:85], v[84:85], v[6:7] op_sel:[0,1] op_sel_hi:[1,1]
v_pk_mul_f32 v[86:87], v[86:87], v[6:7] op_sel:[0,1] op_sel_hi:[1,1]
v_cvt_pk_bf16_f32 v88, v80, v81
v_cvt_pk_bf16_f32 v89, v82, v83
v_cvt_pk_bf16_f32 v90, v84, v85
v_cvt_pk_bf16_f32 v91, v86, v87
v_accvgpr_read_b32 v96, a44
v_accvgpr_read_b32 v97, a45
v_accvgpr_read_b32 v98, a46
v_accvgpr_read_b32 v99, a47
ds_write_b128 v144, v[88:91] offset:3072
v_accvgpr_read_b32 v100, a60
v_accvgpr_read_b32 v101, a61
v_accvgpr_read_b32 v102, a62
v_accvgpr_read_b32 v103, a63
v_pk_mul_f32 v[96:97], v[96:97], v[6:7] op_sel:[0,1] op_sel_hi:[1,1]
v_pk_mul_f32 v[98:99], v[98:99], v[6:7] op_sel:[0,1] op_sel_hi:[1,1]
v_pk_mul_f32 v[100:101], v[100:101], v[6:7] op_sel:[0,1] op_sel_hi:[1,1]
v_pk_mul_f32 v[102:103], v[102:103], v[6:7] op_sel:[0,1] op_sel_hi:[1,1]
v_cvt_pk_bf16_f32 v104, v96, v97
v_cvt_pk_bf16_f32 v105, v98, v99
v_cvt_pk_bf16_f32 v106, v100, v101
v_cvt_pk_bf16_f32 v107, v102, v103
v_accvgpr_read_b32 v112, a76
v_accvgpr_read_b32 v113, a77
v_accvgpr_read_b32 v114, a78
v_accvgpr_read_b32 v115, a79
ds_write_b128 v145, v[104:107] offset:3072
v_accvgpr_read_b32 v116, a92
v_accvgpr_read_b32 v117, a93
v_accvgpr_read_b32 v118, a94
v_accvgpr_read_b32 v119, a95
v_pk_mul_f32 v[112:113], v[112:113], v[6:7] op_sel:[0,1] op_sel_hi:[1,1]
v_pk_mul_f32 v[114:115], v[114:115], v[6:7] op_sel:[0,1] op_sel_hi:[1,1]
v_pk_mul_f32 v[116:117], v[116:117], v[6:7] op_sel:[0,1] op_sel_hi:[1,1]
v_pk_mul_f32 v[118:119], v[118:119], v[6:7] op_sel:[0,1] op_sel_hi:[1,1]
v_cvt_pk_bf16_f32 v120, v112, v113
v_cvt_pk_bf16_f32 v121, v114, v115
v_cvt_pk_bf16_f32 v122, v116, v117
v_cvt_pk_bf16_f32 v123, v118, v119
v_accvgpr_read_b32 v128, a108
v_accvgpr_read_b32 v129, a109
v_accvgpr_read_b32 v130, a110
v_accvgpr_read_b32 v131, a111
ds_write_b128 v146, v[120:123] offset:3072
v_accvgpr_read_b32 v132, a124
v_accvgpr_read_b32 v133, a125
v_accvgpr_read_b32 v134, a126
v_accvgpr_read_b32 v135, a127
v_pk_mul_f32 v[128:129], v[128:129], v[6:7] op_sel:[0,1] op_sel_hi:[1,1]
v_pk_mul_f32 v[130:131], v[130:131], v[6:7] op_sel:[0,1] op_sel_hi:[1,1]
v_pk_mul_f32 v[132:133], v[132:133], v[6:7] op_sel:[0,1] op_sel_hi:[1,1]
v_pk_mul_f32 v[134:135], v[134:135], v[6:7] op_sel:[0,1] op_sel_hi:[1,1]
v_cvt_pk_bf16_f32 v136, v128, v129
v_cvt_pk_bf16_f32 v137, v130, v131
v_cvt_pk_bf16_f32 v138, v132, v133
v_cvt_pk_bf16_f32 v139, v134, v135
ds_write_b128 v147, v[136:139] offset:3072
v_add_u32 v250, 32768, v14
s_add_u32 s61, s39, 98304
v_mov_b32 v10, s61
s_waitcnt lgkmcnt(0)
s_barrier
ds_read_b128 v[4:7], v10
s_waitcnt lgkmcnt(0)
v_or3_b32 v4, v4, v5, v6
v_or_b32 v4, v4, v7
s_nop 0
v_readfirstlane_b32 s61, v4
s_nop 3
s_andn2_b32 s61, s61, s46
s_cbranch_scc1 L_k1_slow
s_mov_b32 s61, 28672
s_cmp_lg_u32 s38, 0
s_cbranch_scc1 L_f_sigb
s_mov_b64 exec, 1
v_mov_b32 v4, 0
v_mov_b32_e64 v5, 1
buffer_atomic_add v5, v4, s[28:31], s61 offen sc1
s_mov_b64 exec, -1
L_f_sigb:
ds_read_b128 a[128:131], v250 offset:0
ds_read_b128 a[144:147], v250 offset:4096
ds_read_b128 a[132:135], v250 offset:1024
ds_read_b128 a[148:151], v250 offset:5120
ds_read_b128 a[136:139], v250 offset:2048
ds_read_b128 a[152:155], v250 offset:6144
ds_read_b128 a[140:143], v250 offset:3072
ds_read_b128 a[156:159], v250 offset:7168
s_waitcnt vmcnt(19)
ds_read_b64_tr_b16 a[212:213], v212 offset:32768
ds_read_b64_tr_b16 a[214:215], v212 offset:34816
ds_read_b64_tr_b16 a[216:217], v212 offset:49152
ds_read_b64_tr_b16 a[218:219], v212 offset:51200
ds_read_b64_tr_b16 a[220:221], v213 offset:32768
ds_read_b64_tr_b16 a[222:223], v213 offset:34816
ds_read_b64_tr_b16 a[224:225], v213 offset:49152
ds_read_b64_tr_b16 a[226:227], v213 offset:51200
s_waitcnt lgkmcnt(4)
v_mfma_f32_16x16x32_bf16 v[80:83], a[212:215], a[128:131], 0
s_add_u32 m0, s39, 98304
v_lshrrev_b32 v4, 1, v1
v_mfma_f32_16x16x32_bf16 v[80:83], a[216:219], a[144:147], v[80:83]
buffer_load_dwordx4 v242, s[24:27], s45 offen offset:0 lds
v_mfma_f32_16x16x32_bf16 v[84:87], a[216:219], a[148:151], 0
buffer_load_dwordx4 v243, s[24:27], s45 offen offset:1024 lds
v_mfma_f32_16x16x32_bf16 v[84:87], a[212:215], a[132:135], v[84:87]
buffer_load_dwordx4 v244, s[24:27], s45 offen offset:2048 lds
v_mfma_f32_16x16x32_bf16 v[88:91], a[212:215], a[136:139], 0
buffer_load_dwordx4 v245, s[24:27], s45 offen offset:3072 lds
v_mfma_f32_16x16x32_bf16 v[88:91], a[216:219], a[152:155], v[88:91]
ds_read_b64_tr_b16 a[228:229], v214 offset:32768
ds_read_b64_tr_b16 a[230:231], v214 offset:34816
v_mfma_f32_16x16x32_bf16 v[92:95], a[216:219], a[156:159], 0
ds_read_b64_tr_b16 a[232:233], v214 offset:49152
ds_read_b64_tr_b16 a[234:235], v214 offset:51200
v_mfma_f32_16x16x32_bf16 v[92:95], a[212:215], a[140:143], v[92:95]
ds_read_b128 a[160:163], v250 offset:8192
s_waitcnt lgkmcnt(5)
v_mfma_f32_16x16x32_bf16 v[96:99], a[220:223], a[128:131], 0
ds_read_b128 a[176:179], v250 offset:12288
ds_read_b128 a[164:167], v250 offset:9216
v_mfma_f32_16x16x32_bf16 v[96:99], a[224:227], a[144:147], v[96:99]
ds_read_b128 a[180:183], v250 offset:13312
ds_read_b128 a[168:171], v250 offset:10240
v_mfma_f32_16x16x32_bf16 v[100:103], a[224:227], a[148:151], 0
ds_read_b128 a[184:187], v250 offset:14336
ds_read_b128 a[172:175], v250 offset:11264
v_mfma_f32_16x16x32_bf16 v[100:103], a[220:223], a[132:135], v[100:103]
ds_read_b128 a[188:191], v250 offset:15360
ds_read_b64_tr_b16 a[236:237], v215 offset:32768
v_mfma_f32_16x16x32_bf16 v[104:107], a[220:223], a[136:139], 0
ds_read_b64_tr_b16 a[238:239], v215 offset:34816
ds_read_b64_tr_b16 a[240:241], v215 offset:49152
v_mfma_f32_16x16x32_bf16 v[104:107], a[224:227], a[152:155], v[104:107]
ds_read_b64_tr_b16 a[242:243], v215 offset:51200
s_add_u32 m0, s39, 114688
v_mfma_f32_16x16x32_bf16 v[108:111], a[224:227], a[156:159], 0
buffer_load_dwordx4 v246, s[24:27], s45 offen offset:0 lds
v_mfma_f32_16x16x32_bf16 v[108:111], a[220:223], a[140:143], v[108:111]
s_waitcnt lgkmcnt(12)
buffer_load_dwordx4 v247, s[24:27], s45 offen offset:1024 lds
v_mfma_f32_16x16x32_bf16 v[112:115], a[228:231], a[128:131], 0
buffer_load_dwordx4 v248, s[24:27], s45 offen offset:2048 lds
v_mfma_f32_16x16x32_bf16 v[112:115], a[232:235], a[144:147], v[112:115]
buffer_load_dwordx4 v249, s[24:27], s45 offen offset:3072 lds
v_mfma_f32_16x16x32_bf16 v[116:119], a[232:235], a[148:151], 0
s_waitcnt vmcnt(17)
ds_read_b64_tr_b16 a[212:213], v208 offset:0
v_mfma_f32_16x16x32_bf16 v[116:119], a[228:231], a[132:135], v[116:119]
ds_read_b64_tr_b16 a[214:215], v208 offset:2048
ds_read_b64_tr_b16 a[216:217], v208 offset:16384
v_mfma_f32_16x16x32_bf16 v[120:123], a[228:231], a[136:139], 0
ds_read_b64_tr_b16 a[218:219], v208 offset:18432
s_add_u32 s45, s45, 65536
v_mfma_f32_16x16x32_bf16 v[120:123], a[232:235], a[152:155], v[120:123]
s_and_b32 s45, s45, 0x7ffff
v_lshlrev_b32 v4, 11, v4
v_mfma_f32_16x16x32_bf16 v[124:127], a[232:235], a[156:159], 0
v_lshl_add_u32 v4, v3, 5, v4
v_and_b32 v5, 1, v1
v_mfma_f32_16x16x32_bf16 v[124:127], a[228:231], a[140:143], v[124:127]
v_lshl_add_u32 v4, v5, 4, v4
s_waitcnt lgkmcnt(4)
v_mfma_f32_16x16x32_bf16 v[128:131], a[236:239], a[128:131], 0
s_add_u32 m0, s39, 131072
s_lshl_b32 s48, s37, 16
v_mfma_f32_16x16x32_bf16 v[128:131], a[240:243], a[144:147], v[128:131]
buffer_load_dwordx4 v242, s[24:27], s45 offen offset:0 lds
v_mfma_f32_16x16x32_bf16 v[132:135], a[240:243], a[148:151], 0
buffer_load_dwordx4 v243, s[24:27], s45 offen offset:1024 lds
v_mfma_f32_16x16x32_bf16 v[132:135], a[236:239], a[132:135], v[132:135]
buffer_load_dwordx4 v244, s[24:27], s45 offen offset:2048 lds
v_mfma_f32_16x16x32_bf16 v[136:139], a[236:239], a[136:139], 0
buffer_load_dwordx4 v245, s[24:27], s45 offen offset:3072 lds
v_mfma_f32_16x16x32_bf16 v[136:139], a[240:243], a[152:155], v[136:139]
ds_read_b64_tr_b16 a[220:221], v209 offset:0
ds_read_b64_tr_b16 a[222:223], v209 offset:2048
v_mfma_f32_16x16x32_bf16 v[140:143], a[240:243], a[156:159], 0
ds_read_b64_tr_b16 a[224:225], v209 offset:16384
ds_read_b64_tr_b16 a[226:227], v209 offset:18432
v_mfma_f32_16x16x32_bf16 v[140:143], a[236:239], a[140:143], v[140:143]
s_add_u32 m0, s39, 147456
s_waitcnt lgkmcnt(4)
v_mfma_f32_16x16x32_bf16 v[80:83], a[212:215], a[160:163], v[80:83]
buffer_load_dwordx4 v246, s[24:27], s45 offen offset:0 lds
v_mfma_f32_16x16x32_bf16 v[80:83], a[216:219], a[176:179], v[80:83]
buffer_load_dwordx4 v247, s[24:27], s45 offen offset:1024 lds
v_mfma_f32_16x16x32_bf16 v[84:87], a[216:219], a[180:183], v[84:87]
buffer_load_dwordx4 v248, s[24:27], s45 offen offset:2048 lds
v_mfma_f32_16x16x32_bf16 v[84:87], a[212:215], a[164:167], v[84:87]
buffer_load_dwordx4 v249, s[24:27], s45 offen offset:3072 lds
v_mfma_f32_16x16x32_bf16 v[88:91], a[212:215], a[168:171], v[88:91]
ds_read_b64_tr_b16 a[228:229], v210 offset:0
ds_read_b64_tr_b16 a[230:231], v210 offset:2048
v_mfma_f32_16x16x32_bf16 v[88:91], a[216:219], a[184:187], v[88:91]
ds_read_b64_tr_b16 a[232:233], v210 offset:16384
ds_read_b64_tr_b16 a[234:235], v210 offset:18432
v_mfma_f32_16x16x32_bf16 v[92:95], a[216:219], a[188:191], v[92:95]
ds_read_b128 a[128:131], v250 offset:16384
ds_read_b128 a[144:147], v250 offset:20480
v_mfma_f32_16x16x32_bf16 v[92:95], a[212:215], a[172:175], v[92:95]
ds_read_b128 a[132:135], v250 offset:17408
s_waitcnt lgkmcnt(7)
v_mfma_f32_16x16x32_bf16 v[96:99], a[220:223], a[160:163], v[96:99]
ds_read_b128 a[148:151], v250 offset:21504
ds_read_b128 a[136:139], v250 offset:18432
v_mfma_f32_16x16x32_bf16 v[96:99], a[224:227], a[176:179], v[96:99]
ds_read_b128 a[152:155], v250 offset:22528
ds_read_b128 a[140:143], v250 offset:19456
v_mfma_f32_16x16x32_bf16 v[100:103], a[224:227], a[180:183], v[100:103]
ds_read_b128 a[156:159], v250 offset:23552
ds_read_b64_tr_b16 a[236:237], v211 offset:0
v_mfma_f32_16x16x32_bf16 v[100:103], a[220:223], a[164:167], v[100:103]
ds_read_b64_tr_b16 a[238:239], v211 offset:2048
ds_read_b64_tr_b16 a[240:241], v211 offset:16384
v_mfma_f32_16x16x32_bf16 v[104:107], a[220:223], a[168:171], v[104:107]
ds_read_b64_tr_b16 a[242:243], v211 offset:18432
s_add_u32 s45, s45, 65536
v_mfma_f32_16x16x32_bf16 v[104:107], a[224:227], a[184:187], v[104:107]
s_and_b32 s45, s45, 0x7ffff
s_lshl_b32 s62, s38, 9
v_mfma_f32_16x16x32_bf16 v[108:111], a[224:227], a[188:191], v[108:111]
s_add_u32 s48, s48, s62
s_add_u32 s49, s48, 16384
v_mfma_f32_16x16x32_bf16 v[108:111], a[220:223], a[172:175], v[108:111]
s_add_u32 s50, s48, 32768
s_waitcnt lgkmcnt(12)
v_mfma_f32_16x16x32_bf16 v[112:115], a[228:231], a[160:163], v[112:115]
s_add_u32 s51, s48, 49152
s_min_u32 s52, s38, 1
v_mfma_f32_16x16x32_bf16 v[112:115], a[232:235], a[176:179], v[112:115]
s_mul_i32 s52, s52, 0x7fff0000
s_add_u32 s52, s52, 28672
v_mfma_f32_16x16x32_bf16 v[116:119], a[232:235], a[180:183], v[116:119]
s_waitcnt vmcnt(8)
ds_read_b64_tr_b16 a[212:213], v212 offset:0
v_mfma_f32_16x16x32_bf16 v[116:119], a[228:231], a[164:167], v[116:119]
ds_read_b64_tr_b16 a[214:215], v212 offset:2048
ds_read_b64_tr_b16 a[216:217], v212 offset:16384
v_mfma_f32_16x16x32_bf16 v[120:123], a[228:231], a[168:171], v[120:123]
ds_read_b64_tr_b16 a[218:219], v212 offset:18432
v_mov_b32 v6, 0
v_mfma_f32_16x16x32_bf16 v[120:123], a[232:235], a[184:187], v[120:123]
v_mfma_f32_16x16x32_bf16 v[124:127], a[232:235], a[188:191], v[124:127]
v_mfma_f32_16x16x32_bf16 v[124:127], a[228:231], a[172:175], v[124:127]
s_waitcnt lgkmcnt(4)
v_mfma_f32_16x16x32_bf16 v[128:131], a[236:239], a[160:163], v[128:131]
s_add_u32 m0, s39, 0
v_mfma_f32_16x16x32_bf16 v[128:131], a[240:243], a[176:179], v[128:131]
buffer_load_dwordx4 v242, s[24:27], s45 offen offset:0 lds
v_mfma_f32_16x16x32_bf16 v[132:135], a[240:243], a[180:183], v[132:135]
buffer_load_dwordx4 v243, s[24:27], s45 offen offset:1024 lds
v_mfma_f32_16x16x32_bf16 v[132:135], a[236:239], a[164:167], v[132:135]
buffer_load_dwordx4 v244, s[24:27], s45 offen offset:2048 lds
v_mfma_f32_16x16x32_bf16 v[136:139], a[236:239], a[168:171], v[136:139]
buffer_load_dwordx4 v245, s[24:27], s45 offen offset:3072 lds
v_mfma_f32_16x16x32_bf16 v[136:139], a[240:243], a[184:187], v[136:139]
ds_read_b64_tr_b16 a[220:221], v213 offset:0
ds_read_b64_tr_b16 a[222:223], v213 offset:2048
v_mfma_f32_16x16x32_bf16 v[140:143], a[240:243], a[188:191], v[140:143]
ds_read_b64_tr_b16 a[224:225], v213 offset:16384
ds_read_b64_tr_b16 a[226:227], v213 offset:18432
v_mfma_f32_16x16x32_bf16 v[140:143], a[236:239], a[172:175], v[140:143]
s_add_u32 m0, s39, 16384
s_waitcnt lgkmcnt(4)
v_mfma_f32_16x16x32_bf16 v[80:83], a[212:215], a[128:131], v[80:83]
buffer_load_dwordx4 v246, s[24:27], s45 offen offset:0 lds
v_mfma_f32_16x16x32_bf16 v[80:83], a[216:219], a[144:147], v[80:83]
buffer_load_dwordx4 v247, s[24:27], s45 offen offset:1024 lds
v_mfma_f32_16x16x32_bf16 v[84:87], a[216:219], a[148:151], v[84:87]
buffer_load_dwordx4 v248, s[24:27], s45 offen offset:2048 lds
v_mfma_f32_16x16x32_bf16 v[84:87], a[212:215], a[132:135], v[84:87]
buffer_load_dwordx4 v249, s[24:27], s45 offen offset:3072 lds
v_mfma_f32_16x16x32_bf16 v[88:91], a[212:215], a[136:139], v[88:91]
ds_read_b64_tr_b16 a[228:229], v214 offset:0
ds_read_b64_tr_b16 a[230:231], v214 offset:2048
v_mfma_f32_16x16x32_bf16 v[88:91], a[216:219], a[152:155], v[88:91]
ds_read_b64_tr_b16 a[232:233], v214 offset:16384
ds_read_b64_tr_b16 a[234:235], v214 offset:18432
v_mfma_f32_16x16x32_bf16 v[92:95], a[216:219], a[156:159], v[92:95]
ds_read_b128 a[160:163], v250 offset:24576
ds_read_b128 a[176:179], v250 offset:28672
v_mfma_f32_16x16x32_bf16 v[92:95], a[212:215], a[140:143], v[92:95]
ds_read_b128 a[164:167], v250 offset:25600
s_waitcnt lgkmcnt(7)
v_mfma_f32_16x16x32_bf16 v[96:99], a[220:223], a[128:131], v[96:99]
ds_read_b128 a[180:183], v250 offset:29696
ds_read_b128 a[168:171], v250 offset:26624
v_mfma_f32_16x16x32_bf16 v[96:99], a[224:227], a[144:147], v[96:99]
ds_read_b128 a[184:187], v250 offset:30720
ds_read_b128 a[172:175], v250 offset:27648
v_mfma_f32_16x16x32_bf16 v[100:103], a[224:227], a[148:151], v[100:103]
ds_read_b128 a[188:191], v250 offset:31744
ds_read_b64_tr_b16 a[236:237], v215 offset:0
v_mfma_f32_16x16x32_bf16 v[100:103], a[220:223], a[132:135], v[100:103]
ds_read_b64_tr_b16 a[238:239], v215 offset:2048
ds_read_b64_tr_b16 a[240:241], v215 offset:16384
v_mfma_f32_16x16x32_bf16 v[104:107], a[220:223], a[136:139], v[104:107]
ds_read_b64_tr_b16 a[242:243], v215 offset:18432
s_add_u32 s45, s45, 65536
v_mfma_f32_16x16x32_bf16 v[104:107], a[224:227], a[152:155], v[104:107]
s_and_b32 s45, s45, 0x7ffff
v_mfma_f32_16x16x32_bf16 v[108:111], a[224:227], a[156:159], v[108:111]
v_mfma_f32_16x16x32_bf16 v[108:111], a[220:223], a[140:143], v[108:111]
s_waitcnt lgkmcnt(12)
v_mfma_f32_16x16x32_bf16 v[112:115], a[228:231], a[128:131], v[112:115]
v_mfma_f32_16x16x32_bf16 v[112:115], a[232:235], a[144:147], v[112:115]
v_mfma_f32_16x16x32_bf16 v[116:119], a[232:235], a[148:151], v[116:119]
s_waitcnt vmcnt(8)
ds_read_b64_tr_b16 a[212:213], v212 offset:32768
v_mfma_f32_16x16x32_bf16 v[116:119], a[228:231], a[132:135], v[116:119]
ds_read_b64_tr_b16 a[214:215], v212 offset:34816
ds_read_b64_tr_b16 a[216:217], v212 offset:49152
v_mfma_f32_16x16x32_bf16 v[120:123], a[228:231], a[136:139], v[120:123]
ds_read_b64_tr_b16 a[218:219], v212 offset:51200
v_mfma_f32_16x16x32_bf16 v[120:123], a[232:235], a[152:155], v[120:123]
v_mfma_f32_16x16x32_bf16 v[124:127], a[232:235], a[156:159], v[124:127]
v_mfma_f32_16x16x32_bf16 v[124:127], a[228:231], a[140:143], v[124:127]
s_waitcnt lgkmcnt(4)
v_mfma_f32_16x16x32_bf16 v[128:131], a[236:239], a[128:131], v[128:131]
s_add_u32 m0, s39, 98304
v_mfma_f32_16x16x32_bf16 v[128:131], a[240:243], a[144:147], v[128:131]
buffer_load_dwordx4 v242, s[24:27], s45 offen offset:0 lds
v_mfma_f32_16x16x32_bf16 v[132:135], a[240:243], a[148:151], v[132:135]
buffer_load_dwordx4 v243, s[24:27], s45 offen offset:1024 lds
v_mfma_f32_16x16x32_bf16 v[132:135], a[236:239], a[132:135], v[132:135]
buffer_load_dwordx4 v244, s[24:27], s45 offen offset:2048 lds
v_mfma_f32_16x16x32_bf16 v[136:139], a[236:239], a[136:139], v[136:139]
buffer_load_dwordx4 v245, s[24:27], s45 offen offset:3072 lds
v_mfma_f32_16x16x32_bf16 v[136:139], a[240:243], a[152:155], v[136:139]
ds_read_b64_tr_b16 a[220:221], v213 offset:32768
ds_read_b64_tr_b16 a[222:223], v213 offset:34816
v_mfma_f32_16x16x32_bf16 v[140:143], a[240:243], a[156:159], v[140:143]
ds_read_b64_tr_b16 a[224:225], v213 offset:49152
ds_read_b64_tr_b16 a[226:227], v213 offset:51200
v_mfma_f32_16x16x32_bf16 v[140:143], a[236:239], a[140:143], v[140:143]
s_add_u32 m0, s39, 114688
s_waitcnt lgkmcnt(4)
v_mfma_f32_16x16x32_bf16 v[80:83], a[212:215], a[160:163], v[80:83]
buffer_load_dwordx4 v246, s[24:27], s45 offen offset:0 lds
v_mfma_f32_16x16x32_bf16 v[80:83], a[216:219], a[176:179], v[80:83]
buffer_load_dwordx4 v247, s[24:27], s45 offen offset:1024 lds
v_mfma_f32_16x16x32_bf16 v[84:87], a[216:219], a[180:183], v[84:87]
buffer_load_dwordx4 v248, s[24:27], s45 offen offset:2048 lds
v_mfma_f32_16x16x32_bf16 v[84:87], a[212:215], a[164:167], v[84:87]
buffer_load_dwordx4 v249, s[24:27], s45 offen offset:3072 lds
v_mfma_f32_16x16x32_bf16 v[88:91], a[212:215], a[168:171], v[88:91]
ds_read_b64_tr_b16 a[228:229], v214 offset:32768
ds_read_b64_tr_b16 a[230:231], v214 offset:34816
v_mfma_f32_16x16x32_bf16 v[88:91], a[216:219], a[184:187], v[88:91]
ds_read_b64_tr_b16 a[232:233], v214 offset:49152
ds_read_b64_tr_b16 a[234:235], v214 offset:51200
v_mfma_f32_16x16x32_bf16 v[92:95], a[216:219], a[188:191], v[92:95]
ds_read_b128 a[128:131], v250 offset:32768
ds_read_b128 a[144:147], v250 offset:36864
v_mfma_f32_16x16x32_bf16 v[92:95], a[212:215], a[172:175], v[92:95]
ds_read_b128 a[132:135], v250 offset:33792
s_waitcnt lgkmcnt(7)
v_mfma_f32_16x16x32_bf16 v[96:99], a[220:223], a[160:163], v[96:99]
ds_read_b128 a[148:151], v250 offset:37888
ds_read_b128 a[136:139], v250 offset:34816
v_mfma_f32_16x16x32_bf16 v[96:99], a[224:227], a[176:179], v[96:99]
ds_read_b128 a[152:155], v250 offset:38912
ds_read_b128 a[140:143], v250 offset:35840
v_mfma_f32_16x16x32_bf16 v[100:103], a[224:227], a[180:183], v[100:103]
ds_read_b128 a[156:159], v250 offset:39936
ds_read_b64_tr_b16 a[236:237], v215 offset:32768
v_mfma_f32_16x16x32_bf16 v[100:103], a[220:223], a[164:167], v[100:103]
ds_read_b64_tr_b16 a[238:239], v215 offset:34816
ds_read_b64_tr_b16 a[240:241], v215 offset:49152
v_mfma_f32_16x16x32_bf16 v[104:107], a[220:223], a[168:171], v[104:107]
ds_read_b64_tr_b16 a[242:243], v215 offset:51200
s_add_u32 s45, s45, 65536
v_mfma_f32_16x16x32_bf16 v[104:107], a[224:227], a[184:187], v[104:107]
s_and_b32 s45, s45, 0x7ffff
v_mfma_f32_16x16x32_bf16 v[108:111], a[224:227], a[188:191], v[108:111]
v_mfma_f32_16x16x32_bf16 v[108:111], a[220:223], a[172:175], v[108:111]
s_waitcnt lgkmcnt(12)
v_mfma_f32_16x16x32_bf16 v[112:115], a[228:231], a[160:163], v[112:115]
v_mfma_f32_16x16x32_bf16 v[112:115], a[232:235], a[176:179], v[112:115]
v_mfma_f32_16x16x32_bf16 v[116:119], a[232:235], a[180:183], v[116:119]
s_waitcnt vmcnt(8)
ds_read_b64_tr_b16 a[212:213], v208 offset:0
v_mfma_f32_16x16x32_bf16 v[116:119], a[228:231], a[164:167], v[116:119]
ds_read_b64_tr_b16 a[214:215], v208 offset:2048
ds_read_b64_tr_b16 a[216:217], v208 offset:16384
v_mfma_f32_16x16x32_bf16 v[120:123], a[228:231], a[168:171], v[120:123]
ds_read_b64_tr_b16 a[218:219], v208 offset:18432
v_mfma_f32_16x16x32_bf16 v[120:123], a[232:235], a[184:187], v[120:123]
v_mfma_f32_16x16x32_bf16 v[124:127], a[232:235], a[188:191], v[124:127]
v_mfma_f32_16x16x32_bf16 v[124:127], a[228:231], a[172:175], v[124:127]
s_waitcnt lgkmcnt(4)
v_mfma_f32_16x16x32_bf16 v[128:131], a[236:239], a[160:163], v[128:131]
s_add_u32 m0, s39, 131072
v_mfma_f32_16x16x32_bf16 v[128:131], a[240:243], a[176:179], v[128:131]
buffer_load_dwordx4 v242, s[24:27], s45 offen offset:0 lds
v_mfma_f32_16x16x32_bf16 v[132:135], a[240:243], a[180:183], v[132:135]
buffer_load_dwordx4 v243, s[24:27], s45 offen offset:1024 lds
v_mfma_f32_16x16x32_bf16 v[132:135], a[236:239], a[164:167], v[132:135]
buffer_load_dwordx4 v244, s[24:27], s45 offen offset:2048 lds
v_mfma_f32_16x16x32_bf16 v[136:139], a[236:239], a[168:171], v[136:139]
buffer_load_dwordx4 v245, s[24:27], s45 offen offset:3072 lds
v_mfma_f32_16x16x32_bf16 v[136:139], a[240:243], a[184:187], v[136:139]
ds_read_b64_tr_b16 a[220:221], v209 offset:0
ds_read_b64_tr_b16 a[222:223], v209 offset:2048
v_mfma_f32_16x16x32_bf16 v[140:143], a[240:243], a[188:191], v[140:143]
ds_read_b64_tr_b16 a[224:225], v209 offset:16384
ds_read_b64_tr_b16 a[226:227], v209 offset:18432
v_mfma_f32_16x16x32_bf16 v[140:143], a[236:239], a[172:175], v[140:143]
s_add_u32 m0, s39, 147456
s_waitcnt lgkmcnt(4)
v_mfma_f32_16x16x32_bf16 v[80:83], a[212:215], a[128:131], v[80:83]
buffer_load_dwordx4 v246, s[24:27], s45 offen offset:0 lds
v_mfma_f32_16x16x32_bf16 v[80:83], a[216:219], a[144:147], v[80:83]
buffer_load_dwordx4 v247, s[24:27], s45 offen offset:1024 lds
v_mfma_f32_16x16x32_bf16 v[84:87], a[216:219], a[148:151], v[84:87]
buffer_load_dwordx4 v248, s[24:27], s45 offen offset:2048 lds
v_mfma_f32_16x16x32_bf16 v[84:87], a[212:215], a[132:135], v[84:87]
buffer_load_dwordx4 v249, s[24:27], s45 offen offset:3072 lds
v_mfma_f32_16x16x32_bf16 v[88:91], a[212:215], a[136:139], v[88:91]
ds_read_b64_tr_b16 a[228:229], v210 offset:0
ds_read_b64_tr_b16 a[230:231], v210 offset:2048
v_mfma_f32_16x16x32_bf16 v[88:91], a[216:219], a[152:155], v[88:91]
ds_read_b64_tr_b16 a[232:233], v210 offset:16384
ds_read_b64_tr_b16 a[234:235], v210 offset:18432
v_mfma_f32_16x16x32_bf16 v[92:95], a[216:219], a[156:159], v[92:95]
ds_read_b128 a[160:163], v250 offset:40960
ds_read_b128 a[176:179], v250 offset:45056
v_mfma_f32_16x16x32_bf16 v[92:95], a[212:215], a[140:143], v[92:95]
ds_read_b128 a[164:167], v250 offset:41984
s_waitcnt lgkmcnt(7)
v_mfma_f32_16x16x32_bf16 v[96:99], a[220:223], a[128:131], v[96:99]
ds_read_b128 a[180:183], v250 offset:46080
ds_read_b128 a[168:171], v250 offset:43008
v_mfma_f32_16x16x32_bf16 v[96:99], a[224:227], a[144:147], v[96:99]
ds_read_b128 a[184:187], v250 offset:47104
ds_read_b128 a[172:175], v250 offset:44032
v_mfma_f32_16x16x32_bf16 v[100:103], a[224:227], a[148:151], v[100:103]
ds_read_b128 a[188:191], v250 offset:48128
ds_read_b64_tr_b16 a[236:237], v211 offset:0
v_mfma_f32_16x16x32_bf16 v[100:103], a[220:223], a[132:135], v[100:103]
ds_read_b64_tr_b16 a[238:239], v211 offset:2048
ds_read_b64_tr_b16 a[240:241], v211 offset:16384
v_mfma_f32_16x16x32_bf16 v[104:107], a[220:223], a[136:139], v[104:107]
ds_read_b64_tr_b16 a[242:243], v211 offset:18432
s_add_u32 s45, s45, 65536
v_mfma_f32_16x16x32_bf16 v[104:107], a[224:227], a[152:155], v[104:107]
s_and_b32 s45, s45, 0x7ffff
v_mfma_f32_16x16x32_bf16 v[108:111], a[224:227], a[156:159], v[108:111]
v_mfma_f32_16x16x32_bf16 v[108:111], a[220:223], a[140:143], v[108:111]
s_waitcnt lgkmcnt(12)
v_mfma_f32_16x16x32_bf16 v[112:115], a[228:231], a[128:131], v[112:115]
v_mfma_f32_16x16x32_bf16 v[112:115], a[232:235], a[144:147], v[112:115]
v_mfma_f32_16x16x32_bf16 v[116:119], a[232:235], a[148:151], v[116:119]
s_waitcnt vmcnt(8)
ds_read_b64_tr_b16 a[212:213], v212 offset:0
v_mfma_f32_16x16x32_bf16 v[116:119], a[228:231], a[132:135], v[116:119]
ds_read_b64_tr_b16 a[214:215], v212 offset:2048
ds_read_b64_tr_b16 a[216:217], v212 offset:16384
v_mfma_f32_16x16x32_bf16 v[120:123], a[228:231], a[136:139], v[120:123]
ds_read_b64_tr_b16 a[218:219], v212 offset:18432
v_mfma_f32_16x16x32_bf16 v[120:123], a[232:235], a[152:155], v[120:123]
v_mfma_f32_16x16x32_bf16 v[124:127], a[232:235], a[156:159], v[124:127]
v_mfma_f32_16x16x32_bf16 v[124:127], a[228:231], a[140:143], v[124:127]
s_waitcnt lgkmcnt(4)
v_mfma_f32_16x16x32_bf16 v[128:131], a[236:239], a[128:131], v[128:131]
s_add_u32 m0, s39, 0
v_mfma_f32_16x16x32_bf16 v[128:131], a[240:243], a[144:147], v[128:131]
buffer_load_dwordx4 v242, s[24:27], s45 offen offset:0 lds
v_mfma_f32_16x16x32_bf16 v[132:135], a[240:243], a[148:151], v[132:135]
buffer_load_dwordx4 v243, s[24:27], s45 offen offset:1024 lds
v_mfma_f32_16x16x32_bf16 v[132:135], a[236:239], a[132:135], v[132:135]
buffer_load_dwordx4 v244, s[24:27], s45 offen offset:2048 lds
v_mfma_f32_16x16x32_bf16 v[136:139], a[236:239], a[136:139], v[136:139]
buffer_load_dwordx4 v245, s[24:27], s45 offen offset:3072 lds
v_mfma_f32_16x16x32_bf16 v[136:139], a[240:243], a[152:155], v[136:139]
ds_read_b64_tr_b16 a[220:221], v213 offset:0
ds_read_b64_tr_b16 a[222:223], v213 offset:2048
v_mfma_f32_16x16x32_bf16 v[140:143], a[240:243], a[156:159], v[140:143]
ds_read_b64_tr_b16 a[224:225], v213 offset:16384
ds_read_b64_tr_b16 a[226:227], v213 offset:18432
v_mfma_f32_16x16x32_bf16 v[140:143], a[236:239], a[140:143], v[140:143]
s_add_u32 m0, s39, 16384
s_waitcnt lgkmcnt(4)
v_mfma_f32_16x16x32_bf16 v[80:83], a[212:215], a[160:163], v[80:83]
buffer_load_dwordx4 v246, s[24:27], s45 offen offset:0 lds
v_mfma_f32_16x16x32_bf16 v[80:83], a[216:219], a[176:179], v[80:83]
buffer_load_dwordx4 v247, s[24:27], s45 offen offset:1024 lds
v_mfma_f32_16x16x32_bf16 v[84:87], a[216:219], a[180:183], v[84:87]
buffer_load_dwordx4 v248, s[24:27], s45 offen offset:2048 lds
v_mfma_f32_16x16x32_bf16 v[84:87], a[212:215], a[164:167], v[84:87]
buffer_load_dwordx4 v249, s[24:27], s45 offen offset:3072 lds
v_mfma_f32_16x16x32_bf16 v[88:91], a[212:215], a[168:171], v[88:91]
ds_read_b64_tr_b16 a[228:229], v214 offset:0
ds_read_b64_tr_b16 a[230:231], v214 offset:2048
v_mfma_f32_16x16x32_bf16 v[88:91], a[216:219], a[184:187], v[88:91]
ds_read_b64_tr_b16 a[232:233], v214 offset:16384
ds_read_b64_tr_b16 a[234:235], v214 offset:18432
v_mfma_f32_16x16x32_bf16 v[92:95], a[216:219], a[188:191], v[92:95]
ds_read_b128 a[128:131], v250 offset:49152
ds_read_b128 a[144:147], v250 offset:53248
v_mfma_f32_16x16x32_bf16 v[92:95], a[212:215], a[172:175], v[92:95]
ds_read_b128 a[132:135], v250 offset:50176
s_waitcnt lgkmcnt(7)
v_mfma_f32_16x16x32_bf16 v[96:99], a[220:223], a[160:163], v[96:99]
ds_read_b128 a[148:151], v250 offset:54272
ds_read_b128 a[136:139], v250 offset:51200
v_mfma_f32_16x16x32_bf16 v[96:99], a[224:227], a[176:179], v[96:99]
ds_read_b128 a[152:155], v250 offset:55296
ds_read_b128 a[140:143], v250 offset:52224
v_mfma_f32_16x16x32_bf16 v[100:103], a[224:227], a[180:183], v[100:103]
ds_read_b128 a[156:159], v250 offset:56320
ds_read_b64_tr_b16 a[236:237], v215 offset:0
v_mfma_f32_16x16x32_bf16 v[100:103], a[220:223], a[164:167], v[100:103]
ds_read_b64_tr_b16 a[238:239], v215 offset:2048
ds_read_b64_tr_b16 a[240:241], v215 offset:16384
v_mfma_f32_16x16x32_bf16 v[104:107], a[220:223], a[168:171], v[104:107]
ds_read_b64_tr_b16 a[242:243], v215 offset:18432
s_add_u32 s45, s45, 65664
v_mfma_f32_16x16x32_bf16 v[104:107], a[224:227], a[184:187], v[104:107]
s_and_b32 s45, s45, 0x7ffff
v_mfma_f32_16x16x32_bf16 v[108:111], a[224:227], a[188:191], v[108:111]
v_mfma_f32_16x16x32_bf16 v[108:111], a[220:223], a[172:175], v[108:111]
s_waitcnt lgkmcnt(12)
v_mfma_f32_16x16x32_bf16 v[112:115], a[228:231], a[160:163], v[112:115]
v_mfma_f32_16x16x32_bf16 v[112:115], a[232:235], a[176:179], v[112:115]
v_mfma_f32_16x16x32_bf16 v[116:119], a[232:235], a[180:183], v[116:119]
s_waitcnt vmcnt(8)
ds_read_b64_tr_b16 a[212:213], v212 offset:32768
v_mfma_f32_16x16x32_bf16 v[116:119], a[228:231], a[164:167], v[116:119]
ds_read_b64_tr_b16 a[214:215], v212 offset:34816
ds_read_b64_tr_b16 a[216:217], v212 offset:49152
v_mfma_f32_16x16x32_bf16 v[120:123], a[228:231], a[168:171], v[120:123]
ds_read_b64_tr_b16 a[218:219], v212 offset:51200
v_mfma_f32_16x16x32_bf16 v[120:123], a[232:235], a[184:187], v[120:123]
v_mfma_f32_16x16x32_bf16 v[124:127], a[232:235], a[188:191], v[124:127]
v_mfma_f32_16x16x32_bf16 v[124:127], a[228:231], a[172:175], v[124:127]
s_waitcnt lgkmcnt(4)
v_mfma_f32_16x16x32_bf16 v[128:131], a[236:239], a[160:163], v[128:131]
s_add_u32 m0, s39, 98304
v_mfma_f32_16x16x32_bf16 v[128:131], a[240:243], a[176:179], v[128:131]
buffer_load_dwordx4 v242, s[24:27], s45 offen offset:0 lds
v_mfma_f32_16x16x32_bf16 v[132:135], a[240:243], a[180:183], v[132:135]
buffer_load_dwordx4 v243, s[24:27], s45 offen offset:1024 lds
v_mfma_f32_16x16x32_bf16 v[132:135], a[236:239], a[164:167], v[132:135]
buffer_load_dwordx4 v244, s[24:27], s45 offen offset:2048 lds
v_mfma_f32_16x16x32_bf16 v[136:139], a[236:239], a[168:171], v[136:139]
buffer_load_dwordx4 v245, s[24:27], s45 offen offset:3072 lds
v_mfma_f32_16x16x32_bf16 v[136:139], a[240:243], a[184:187], v[136:139]
ds_read_b64_tr_b16 a[220:221], v213 offset:32768
ds_read_b64_tr_b16 a[222:223], v213 offset:34816
v_mfma_f32_16x16x32_bf16 v[140:143], a[240:243], a[188:191], v[140:143]
ds_read_b64_tr_b16 a[224:225], v213 offset:49152
ds_read_b64_tr_b16 a[226:227], v213 offset:51200
v_mfma_f32_16x16x32_bf16 v[140:143], a[236:239], a[172:175], v[140:143]
s_add_u32 m0, s39, 114688
s_waitcnt lgkmcnt(4)
v_mfma_f32_16x16x32_bf16 v[80:83], a[212:215], a[128:131], v[80:83]
buffer_load_dwordx4 v246, s[24:27], s45 offen offset:0 lds
v_mfma_f32_16x16x32_bf16 v[80:83], a[216:219], a[144:147], v[80:83]
buffer_load_dwordx4 v247, s[24:27], s45 offen offset:1024 lds
v_mfma_f32_16x16x32_bf16 v[84:87], a[216:219], a[148:151], v[84:87]
buffer_load_dwordx4 v248, s[24:27], s45 offen offset:2048 lds
v_mfma_f32_16x16x32_bf16 v[84:87], a[212:215], a[132:135], v[84:87]
buffer_load_dwordx4 v249, s[24:27], s45 offen offset:3072 lds
v_mfma_f32_16x16x32_bf16 v[88:91], a[212:215], a[136:139], v[88:91]
ds_read_b64_tr_b16 a[228:229], v214 offset:32768
ds_read_b64_tr_b16 a[230:231], v214 offset:34816
v_mfma_f32_16x16x32_bf16 v[88:91], a[216:219], a[152:155], v[88:91]
ds_read_b64_tr_b16 a[232:233], v214 offset:49152
ds_read_b64_tr_b16 a[234:235], v214 offset:51200
v_mfma_f32_16x16x32_bf16 v[92:95], a[216:219], a[156:159], v[92:95]
ds_read_b128 a[160:163], v250 offset:57344
ds_read_b128 a[176:179], v250 offset:61440
v_mfma_f32_16x16x32_bf16 v[92:95], a[212:215], a[140:143], v[92:95]
ds_read_b128 a[164:167], v250 offset:58368
s_waitcnt lgkmcnt(7)
v_mfma_f32_16x16x32_bf16 v[96:99], a[220:223], a[128:131], v[96:99]
ds_read_b128 a[180:183], v250 offset:62464
ds_read_b128 a[168:171], v250 offset:59392
v_mfma_f32_16x16x32_bf16 v[96:99], a[224:227], a[144:147], v[96:99]
ds_read_b128 a[184:187], v250 offset:63488
ds_read_b128 a[172:175], v250 offset:60416
v_mfma_f32_16x16x32_bf16 v[100:103], a[224:227], a[148:151], v[100:103]
ds_read_b128 a[188:191], v250 offset:64512
ds_read_b64_tr_b16 a[236:237], v215 offset:32768
v_mfma_f32_16x16x32_bf16 v[100:103], a[220:223], a[132:135], v[100:103]
ds_read_b64_tr_b16 a[238:239], v215 offset:34816
ds_read_b64_tr_b16 a[240:241], v215 offset:49152
v_mfma_f32_16x16x32_bf16 v[104:107], a[220:223], a[136:139], v[104:107]
ds_read_b64_tr_b16 a[242:243], v215 offset:51200
s_add_u32 s45, s45, 65536
v_mfma_f32_16x16x32_bf16 v[104:107], a[224:227], a[152:155], v[104:107]
s_and_b32 s45, s45, 0x7ffff
v_mfma_f32_16x16x32_bf16 v[108:111], a[224:227], a[156:159], v[108:111]
v_mfma_f32_16x16x32_bf16 v[108:111], a[220:223], a[140:143], v[108:111]
s_waitcnt lgkmcnt(12)
v_mfma_f32_16x16x32_bf16 v[112:115], a[228:231], a[128:131], v[112:115]
v_mfma_f32_16x16x32_bf16 v[112:115], a[232:235], a[144:147], v[112:115]
v_mfma_f32_16x16x32_bf16 v[116:119], a[232:235], a[148:151], v[116:119]
s_waitcnt vmcnt(8)
ds_read_b64_tr_b16 a[212:213], v208 offset:0
v_mfma_f32_16x16x32_bf16 v[116:119], a[228:231], a[132:135], v[116:119]
ds_read_b64_tr_b16 a[214:215], v208 offset:2048
ds_read_b64_tr_b16 a[216:217], v208 offset:16384
v_mfma_f32_16x16x32_bf16 v[120:123], a[228:231], a[136:139], v[120:123]
ds_read_b64_tr_b16 a[218:219], v208 offset:18432
v_mfma_f32_16x16x32_bf16 v[120:123], a[232:235], a[152:155], v[120:123]
v_mfma_f32_16x16x32_bf16 v[124:127], a[232:235], a[156:159], v[124:127]
v_mfma_f32_16x16x32_bf16 v[124:127], a[228:231], a[140:143], v[124:127]
s_waitcnt lgkmcnt(4)
v_mfma_f32_16x16x32_bf16 v[128:131], a[236:239], a[128:131], v[128:131]
s_add_u32 m0, s39, 131072
v_mfma_f32_16x16x32_bf16 v[128:131], a[240:243], a[144:147], v[128:131]
buffer_load_dwordx4 v242, s[24:27], s45 offen offset:0 lds
v_mfma_f32_16x16x32_bf16 v[132:135], a[240:243], a[148:151], v[132:135]
buffer_load_dwordx4 v243, s[24:27], s45 offen offset:1024 lds
v_mfma_f32_16x16x32_bf16 v[132:135], a[236:239], a[132:135], v[132:135]
buffer_load_dwordx4 v244, s[24:27], s45 offen offset:2048 lds
v_mfma_f32_16x16x32_bf16 v[136:139], a[236:239], a[136:139], v[136:139]
buffer_load_dwordx4 v245, s[24:27], s45 offen offset:3072 lds
v_mfma_f32_16x16x32_bf16 v[136:139], a[240:243], a[152:155], v[136:139]
ds_read_b64_tr_b16 a[220:221], v209 offset:0
ds_read_b64_tr_b16 a[222:223], v209 offset:2048
v_mfma_f32_16x16x32_bf16 v[140:143], a[240:243], a[156:159], v[140:143]
ds_read_b64_tr_b16 a[224:225], v209 offset:16384
ds_read_b64_tr_b16 a[226:227], v209 offset:18432
v_mfma_f32_16x16x32_bf16 v[140:143], a[236:239], a[140:143], v[140:143]
s_add_u32 m0, s39, 147456
s_waitcnt lgkmcnt(4)
v_mfma_f32_16x16x32_bf16 v[80:83], a[212:215], a[160:163], v[80:83]
buffer_load_dwordx4 v246, s[24:27], s45 offen offset:0 lds
v_mfma_f32_16x16x32_bf16 v[80:83], a[216:219], a[176:179], v[80:83]
buffer_load_dwordx4 v247, s[24:27], s45 offen offset:1024 lds
v_mfma_f32_16x16x32_bf16 v[84:87], a[216:219], a[180:183], v[84:87]
buffer_load_dwordx4 v248, s[24:27], s45 offen offset:2048 lds
v_mfma_f32_16x16x32_bf16 v[84:87], a[212:215], a[164:167], v[84:87]
buffer_load_dwordx4 v249, s[24:27], s45 offen offset:3072 lds
v_mfma_f32_16x16x32_bf16 v[88:91], a[212:215], a[168:171], v[88:91]
ds_read_b64_tr_b16 a[228:229], v210 offset:0
ds_read_b64_tr_b16 a[230:231], v210 offset:2048
v_mfma_f32_16x16x32_bf16 v[88:91], a[216:219], a[184:187], v[88:91]
ds_read_b64_tr_b16 a[232:233], v210 offset:16384
ds_read_b64_tr_b16 a[234:235], v210 offset:18432
v_mfma_f32_16x16x32_bf16 v[92:95], a[216:219], a[188:191], v[92:95]
ds_read_b128 a[128:131], v250 offset:0
ds_read_b128 a[144:147], v250 offset:4096
v_mfma_f32_16x16x32_bf16 v[92:95], a[212:215], a[172:175], v[92:95]
ds_read_b128 a[132:135], v250 offset:1024
s_waitcnt lgkmcnt(7)
v_mfma_f32_16x16x32_bf16 v[96:99], a[220:223], a[160:163], v[96:99]
ds_read_b128 a[148:151], v250 offset:5120
ds_read_b128 a[136:139], v250 offset:2048
v_mfma_f32_16x16x32_bf16 v[96:99], a[224:227], a[176:179], v[96:99]
ds_read_b128 a[152:155], v250 offset:6144
ds_read_b128 a[140:143], v250 offset:3072
v_mfma_f32_16x16x32_bf16 v[100:103], a[224:227], a[180:183], v[100:103]
ds_read_b128 a[156:159], v250 offset:7168
ds_read_b64_tr_b16 a[236:237], v211 offset:0
v_mfma_f32_16x16x32_bf16 v[100:103], a[220:223], a[164:167], v[100:103]
ds_read_b64_tr_b16 a[238:239], v211 offset:2048
ds_read_b64_tr_b16 a[240:241], v211 offset:16384
v_mfma_f32_16x16x32_bf16 v[104:107], a[220:223], a[168:171], v[104:107]
ds_read_b64_tr_b16 a[242:243], v211 offset:18432
s_add_u32 s45, s45, 65536
v_mfma_f32_16x16x32_bf16 v[104:107], a[224:227], a[184:187], v[104:107]
s_and_b32 s45, s45, 0x7ffff
v_mfma_f32_16x16x32_bf16 v[108:111], a[224:227], a[188:191], v[108:111]
v_mfma_f32_16x16x32_bf16 v[108:111], a[220:223], a[172:175], v[108:111]
s_waitcnt lgkmcnt(12)
v_mfma_f32_16x16x32_bf16 v[112:115], a[228:231], a[160:163], v[112:115]
v_mfma_f32_16x16x32_bf16 v[112:115], a[232:235], a[176:179], v[112:115]
v_mfma_f32_16x16x32_bf16 v[116:119], a[232:235], a[180:183], v[116:119]
s_waitcnt vmcnt(8)
ds_read_b64_tr_b16 a[212:213], v212 offset:0
v_mfma_f32_16x16x32_bf16 v[116:119], a[228:231], a[164:167], v[116:119]
ds_read_b64_tr_b16 a[214:215], v212 offset:2048
ds_read_b64_tr_b16 a[216:217], v212 offset:16384
v_mfma_f32_16x16x32_bf16 v[120:123], a[228:231], a[168:171], v[120:123]
ds_read_b64_tr_b16 a[218:219], v212 offset:18432
v_mfma_f32_16x16x32_bf16 v[120:123], a[232:235], a[184:187], v[120:123]
v_mfma_f32_16x16x32_bf16 v[124:127], a[232:235], a[188:191], v[124:127]
v_mfma_f32_16x16x32_bf16 v[124:127], a[228:231], a[172:175], v[124:127]
s_waitcnt lgkmcnt(4)
v_mfma_f32_16x16x32_bf16 v[128:131], a[236:239], a[160:163], v[128:131]
s_add_u32 m0, s39, 0
v_mfma_f32_16x16x32_bf16 v[128:131], a[240:243], a[176:179], v[128:131]
buffer_load_dwordx4 v242, s[24:27], s45 offen offset:0 lds
v_mfma_f32_16x16x32_bf16 v[132:135], a[240:243], a[180:183], v[132:135]
buffer_load_dwordx4 v243, s[24:27], s45 offen offset:1024 lds
v_mfma_f32_16x16x32_bf16 v[132:135], a[236:239], a[164:167], v[132:135]
buffer_load_dwordx4 v244, s[24:27], s45 offen offset:2048 lds
v_mfma_f32_16x16x32_bf16 v[136:139], a[236:239], a[168:171], v[136:139]
buffer_load_dwordx4 v245, s[24:27], s45 offen offset:3072 lds
v_mfma_f32_16x16x32_bf16 v[136:139], a[240:243], a[184:187], v[136:139]
ds_read_b64_tr_b16 a[220:221], v213 offset:0
ds_read_b64_tr_b16 a[222:223], v213 offset:2048
v_mfma_f32_16x16x32_bf16 v[140:143], a[240:243], a[188:191], v[140:143]
ds_read_b64_tr_b16 a[224:225], v213 offset:16384
ds_read_b64_tr_b16 a[226:227], v213 offset:18432
v_mfma_f32_16x16x32_bf16 v[140:143], a[236:239], a[172:175], v[140:143]
s_add_u32 m0, s39, 16384
s_waitcnt lgkmcnt(4)
v_mfma_f32_16x16x32_bf16 v[144:147], a[212:215], a[128:131], 0
buffer_load_dwordx4 v246, s[24:27], s45 offen offset:0 lds
v_mfma_f32_16x16x32_bf16 v[144:147], a[216:219], a[144:147], v[144:147]
buffer_load_dwordx4 v247, s[24:27], s45 offen offset:1024 lds
v_mfma_f32_16x16x32_bf16 v[148:151], a[216:219], a[148:151], 0
buffer_load_dwordx4 v248, s[24:27], s45 offen offset:2048 lds
v_mfma_f32_16x16x32_bf16 v[148:151], a[212:215], a[132:135], v[148:151]
buffer_load_dwordx4 v249, s[24:27], s45 offen offset:3072 lds
v_mfma_f32_16x16x32_bf16 v[152:155], a[212:215], a[136:139], 0
ds_read_b64_tr_b16 a[228:229], v214 offset:0
ds_read_b64_tr_b16 a[230:231], v214 offset:2048
v_mfma_f32_16x16x32_bf16 v[152:155], a[216:219], a[152:155], v[152:155]
ds_read_b64_tr_b16 a[232:233], v214 offset:16384
ds_read_b64_tr_b16 a[234:235], v214 offset:18432
v_mfma_f32_16x16x32_bf16 v[156:159], a[216:219], a[156:159], 0
ds_read_b128 a[160:163], v250 offset:8192
ds_read_b128 a[176:179], v250 offset:12288
v_mfma_f32_16x16x32_bf16 v[156:159], a[212:215], a[140:143], v[156:159]
ds_read_b128 a[164:167], v250 offset:9216
s_waitcnt lgkmcnt(7)
v_mfma_f32_16x16x32_bf16 v[160:163], a[220:223], a[128:131], 0
ds_read_b128 a[180:183], v250 offset:13312
ds_read_b128 a[168:171], v250 offset:10240
v_mfma_f32_16x16x32_bf16 v[160:163], a[224:227], a[144:147], v[160:163]
ds_read_b128 a[184:187], v250 offset:14336
ds_read_b128 a[172:175], v250 offset:11264
v_mfma_f32_16x16x32_bf16 v[164:167], a[224:227], a[148:151], 0
ds_read_b128 a[188:191], v250 offset:15360
ds_read_b64_tr_b16 a[236:237], v215 offset:0
v_mfma_f32_16x16x32_bf16 v[164:167], a[220:223], a[132:135], v[164:167]
ds_read_b64_tr_b16 a[238:239], v215 offset:2048
ds_read_b64_tr_b16 a[240:241], v215 offset:16384
v_mfma_f32_16x16x32_bf16 v[168:171], a[220:223], a[136:139], 0
ds_read_b64_tr_b16 a[242:243], v215 offset:18432
s_add_u32 s45, s45, 65536
v_mfma_f32_16x16x32_bf16 v[168:171], a[224:227], a[152:155], v[168:171]
s_and_b32 s45, s45, 0x7ffff
v_mfma_f32_16x16x32_bf16 v[172:175], a[224:227], a[156:159], 0
v_mfma_f32_16x16x32_bf16 v[172:175], a[220:223], a[140:143], v[172:175]
s_waitcnt lgkmcnt(12)
v_mfma_f32_16x16x32_bf16 v[176:179], a[228:231], a[128:131], 0
v_mfma_f32_16x16x32_bf16 v[176:179], a[232:235], a[144:147], v[176:179]
v_mfma_f32_16x16x32_bf16 v[180:183], a[232:235], a[148:151], 0
s_waitcnt vmcnt(8)
ds_read_b64_tr_b16 a[212:213], v212 offset:32768
v_mfma_f32_16x16x32_bf16 v[180:183], a[228:231], a[132:135], v[180:183]
ds_read_b64_tr_b16 a[214:215], v212 offset:34816
ds_read_b64_tr_b16 a[216:217], v212 offset:49152
v_mfma_f32_16x16x32_bf16 v[184:187], a[228:231], a[136:139], 0
ds_read_b64_tr_b16 a[218:219], v212 offset:51200
v_mfma_f32_16x16x32_bf16 v[184:187], a[232:235], a[152:155], v[184:187]
v_mfma_f32_16x16x32_bf16 v[188:191], a[232:235], a[156:159], 0
v_mfma_f32_16x16x32_bf16 v[188:191], a[228:231], a[140:143], v[188:191]
s_waitcnt lgkmcnt(4)
v_mfma_f32_16x16x32_bf16 v[192:195], a[236:239], a[128:131], 0
s_add_u32 m0, s39, 98304
v_mfma_f32_16x16x32_bf16 v[192:195], a[240:243], a[144:147], v[192:195]
buffer_load_dwordx4 v242, s[24:27], s45 offen offset:0 lds
v_mfma_f32_16x16x32_bf16 v[196:199], a[240:243], a[148:151], 0
buffer_load_dwordx4 v243, s[24:27], s45 offen offset:1024 lds
v_mfma_f32_16x16x32_bf16 v[196:199], a[236:239], a[132:135], v[196:199]
buffer_load_dwordx4 v244, s[24:27], s45 offen offset:2048 lds
v_mfma_f32_16x16x32_bf16 v[200:203], a[236:239], a[136:139], 0
buffer_load_dwordx4 v245, s[24:27], s45 offen offset:3072 lds
v_mfma_f32_16x16x32_bf16 v[200:203], a[240:243], a[152:155], v[200:203]
ds_read_b64_tr_b16 a[220:221], v213 offset:32768
ds_read_b64_tr_b16 a[222:223], v213 offset:34816
v_mfma_f32_16x16x32_bf16 v[204:207], a[240:243], a[156:159], 0
ds_read_b64_tr_b16 a[224:225], v213 offset:49152
ds_read_b64_tr_b16 a[226:227], v213 offset:51200
v_mfma_f32_16x16x32_bf16 v[204:207], a[236:239], a[140:143], v[204:207]
s_add_u32 m0, s39, 114688
s_waitcnt lgkmcnt(4)
v_mfma_f32_16x16x32_bf16 v[144:147], a[212:215], a[160:163], v[144:147]
buffer_load_dwordx4 v246, s[24:27], s45 offen offset:0 lds
v_mfma_f32_16x16x32_bf16 v[144:147], a[216:219], a[176:179], v[144:147]
buffer_load_dwordx4 v247, s[24:27], s45 offen offset:1024 lds
v_mfma_f32_16x16x32_bf16 v[148:151], a[216:219], a[180:183], v[148:151]
buffer_load_dwordx4 v248, s[24:27], s45 offen offset:2048 lds
v_mfma_f32_16x16x32_bf16 v[148:151], a[212:215], a[164:167], v[148:151]
buffer_load_dwordx4 v249, s[24:27], s45 offen offset:3072 lds
v_mfma_f32_16x16x32_bf16 v[152:155], a[212:215], a[168:171], v[152:155]
ds_read_b64_tr_b16 a[228:229], v214 offset:32768
ds_read_b64_tr_b16 a[230:231], v214 offset:34816
v_mfma_f32_16x16x32_bf16 v[152:155], a[216:219], a[184:187], v[152:155]
ds_read_b64_tr_b16 a[232:233], v214 offset:49152
ds_read_b64_tr_b16 a[234:235], v214 offset:51200
v_mfma_f32_16x16x32_bf16 v[156:159], a[216:219], a[188:191], v[156:159]
ds_read_b128 a[128:131], v250 offset:16384
ds_read_b128 a[144:147], v250 offset:20480
v_mfma_f32_16x16x32_bf16 v[156:159], a[212:215], a[172:175], v[156:159]
ds_read_b128 a[132:135], v250 offset:17408
s_waitcnt lgkmcnt(7)
v_mfma_f32_16x16x32_bf16 v[160:163], a[220:223], a[160:163], v[160:163]
ds_read_b128 a[148:151], v250 offset:21504
ds_read_b128 a[136:139], v250 offset:18432
v_mfma_f32_16x16x32_bf16 v[160:163], a[224:227], a[176:179], v[160:163]
ds_read_b128 a[152:155], v250 offset:22528
ds_read_b128 a[140:143], v250 offset:19456
v_mfma_f32_16x16x32_bf16 v[164:167], a[224:227], a[180:183], v[164:167]
ds_read_b128 a[156:159], v250 offset:23552
ds_read_b64_tr_b16 a[236:237], v215 offset:32768
v_mfma_f32_16x16x32_bf16 v[164:167], a[220:223], a[164:167], v[164:167]
ds_read_b64_tr_b16 a[238:239], v215 offset:34816
ds_read_b64_tr_b16 a[240:241], v215 offset:49152
v_mfma_f32_16x16x32_bf16 v[168:171], a[220:223], a[168:171], v[168:171]
ds_read_b64_tr_b16 a[242:243], v215 offset:51200
s_add_u32 s45, s45, 65536
v_mfma_f32_16x16x32_bf16 v[168:171], a[224:227], a[184:187], v[168:171]
s_and_b32 s45, s45, 0x7ffff
v_mfma_f32_16x16x32_bf16 v[172:175], a[224:227], a[188:191], v[172:175]
v_mfma_f32_16x16x32_bf16 v[172:175], a[220:223], a[172:175], v[172:175]
s_waitcnt lgkmcnt(12)
v_mfma_f32_16x16x32_bf16 v[176:179], a[228:231], a[160:163], v[176:179]
v_mfma_f32_16x16x32_bf16 v[176:179], a[232:235], a[176:179], v[176:179]
v_mfma_f32_16x16x32_bf16 v[180:183], a[232:235], a[180:183], v[180:183]
s_waitcnt vmcnt(8)
ds_read_b64_tr_b16 a[212:213], v208 offset:0
v_mfma_f32_16x16x32_bf16 v[180:183], a[228:231], a[164:167], v[180:183]
ds_read_b64_tr_b16 a[214:215], v208 offset:2048
ds_read_b64_tr_b16 a[216:217], v208 offset:16384
v_mfma_f32_16x16x32_bf16 v[184:187], a[228:231], a[168:171], v[184:187]
ds_read_b64_tr_b16 a[218:219], v208 offset:18432
v_mfma_f32_16x16x32_bf16 v[184:187], a[232:235], a[184:187], v[184:187]
v_mfma_f32_16x16x32_bf16 v[188:191], a[232:235], a[188:191], v[188:191]
v_mfma_f32_16x16x32_bf16 v[188:191], a[228:231], a[172:175], v[188:191]
s_waitcnt lgkmcnt(4)
v_mfma_f32_16x16x32_bf16 v[192:195], a[236:239], a[160:163], v[192:195]
s_add_u32 m0, s39, 131072
v_mfma_f32_16x16x32_bf16 v[192:195], a[240:243], a[176:179], v[192:195]
buffer_load_dwordx4 v242, s[24:27], s45 offen offset:0 lds
v_mfma_f32_16x16x32_bf16 v[196:199], a[240:243], a[180:183], v[196:199]
buffer_load_dwordx4 v243, s[24:27], s45 offen offset:1024 lds
v_mfma_f32_16x16x32_bf16 v[196:199], a[236:239], a[164:167], v[196:199]
buffer_load_dwordx4 v244, s[24:27], s45 offen offset:2048 lds
v_mfma_f32_16x16x32_bf16 v[200:203], a[236:239], a[168:171], v[200:203]
buffer_load_dwordx4 v245, s[24:27], s45 offen offset:3072 lds
v_mfma_f32_16x16x32_bf16 v[200:203], a[240:243], a[184:187], v[200:203]
ds_read_b64_tr_b16 a[220:221], v209 offset:0
ds_read_b64_tr_b16 a[222:223], v209 offset:2048
v_mfma_f32_16x16x32_bf16 v[204:207], a[240:243], a[188:191], v[204:207]
ds_read_b64_tr_b16 a[224:225], v209 offset:16384
ds_read_b64_tr_b16 a[226:227], v209 offset:18432
v_mfma_f32_16x16x32_bf16 v[204:207], a[236:239], a[172:175], v[204:207]
s_add_u32 m0, s39, 147456
s_waitcnt lgkmcnt(4)
v_mfma_f32_16x16x32_bf16 v[144:147], a[212:215], a[128:131], v[144:147]
buffer_load_dwordx4 v246, s[24:27], s45 offen offset:0 lds
v_mfma_f32_16x16x32_bf16 v[144:147], a[216:219], a[144:147], v[144:147]
buffer_load_dwordx4 v247, s[24:27], s45 offen offset:1024 lds
v_mfma_f32_16x16x32_bf16 v[148:151], a[216:219], a[148:151], v[148:151]
buffer_load_dwordx4 v248, s[24:27], s45 offen offset:2048 lds
v_mfma_f32_16x16x32_bf16 v[148:151], a[212:215], a[132:135], v[148:151]
buffer_load_dwordx4 v249, s[24:27], s45 offen offset:3072 lds
v_mfma_f32_16x16x32_bf16 v[152:155], a[212:215], a[136:139], v[152:155]
ds_read_b64_tr_b16 a[228:229], v210 offset:0
ds_read_b64_tr_b16 a[230:231], v210 offset:2048
v_mfma_f32_16x16x32_bf16 v[152:155], a[216:219], a[152:155], v[152:155]
ds_read_b64_tr_b16 a[232:233], v210 offset:16384
ds_read_b64_tr_b16 a[234:235], v210 offset:18432
v_mfma_f32_16x16x32_bf16 v[156:159], a[216:219], a[156:159], v[156:159]
ds_read_b128 a[160:163], v250 offset:24576
ds_read_b128 a[176:179], v250 offset:28672
v_mfma_f32_16x16x32_bf16 v[156:159], a[212:215], a[140:143], v[156:159]
ds_read_b128 a[164:167], v250 offset:25600
s_waitcnt lgkmcnt(7)
v_mfma_f32_16x16x32_bf16 v[160:163], a[220:223], a[128:131], v[160:163]
ds_read_b128 a[180:183], v250 offset:29696
ds_read_b128 a[168:171], v250 offset:26624
v_mfma_f32_16x16x32_bf16 v[160:163], a[224:227], a[144:147], v[160:163]
ds_read_b128 a[184:187], v250 offset:30720
ds_read_b128 a[172:175], v250 offset:27648
v_mfma_f32_16x16x32_bf16 v[164:167], a[224:227], a[148:151], v[164:167]
ds_read_b128 a[188:191], v250 offset:31744
ds_read_b64_tr_b16 a[236:237], v211 offset:0
v_mfma_f32_16x16x32_bf16 v[164:167], a[220:223], a[132:135], v[164:167]
ds_read_b64_tr_b16 a[238:239], v211 offset:2048
ds_read_b64_tr_b16 a[240:241], v211 offset:16384
v_mfma_f32_16x16x32_bf16 v[168:171], a[220:223], a[136:139], v[168:171]
ds_read_b64_tr_b16 a[242:243], v211 offset:18432
s_add_u32 s45, s45, 65536
v_mfma_f32_16x16x32_bf16 v[168:171], a[224:227], a[152:155], v[168:171]
s_and_b32 s45, s45, 0x7ffff
v_mfma_f32_16x16x32_bf16 v[172:175], a[224:227], a[156:159], v[172:175]
v_mfma_f32_16x16x32_bf16 v[172:175], a[220:223], a[140:143], v[172:175]
s_waitcnt lgkmcnt(12)
v_mfma_f32_16x16x32_bf16 v[176:179], a[228:231], a[128:131], v[176:179]
v_mfma_f32_16x16x32_bf16 v[176:179], a[232:235], a[144:147], v[176:179]
v_mfma_f32_16x16x32_bf16 v[180:183], a[232:235], a[148:151], v[180:183]
s_waitcnt vmcnt(8)
ds_read_b64_tr_b16 a[212:213], v212 offset:0
v_mfma_f32_16x16x32_bf16 v[180:183], a[228:231], a[132:135], v[180:183]
ds_read_b64_tr_b16 a[214:215], v212 offset:2048
ds_read_b64_tr_b16 a[216:217], v212 offset:16384
v_mfma_f32_16x16x32_bf16 v[184:187], a[228:231], a[136:139], v[184:187]
ds_read_b64_tr_b16 a[218:219], v212 offset:18432
v_mfma_f32_16x16x32_bf16 v[184:187], a[232:235], a[152:155], v[184:187]
v_mfma_f32_16x16x32_bf16 v[188:191], a[232:235], a[156:159], v[188:191]
v_mfma_f32_16x16x32_bf16 v[188:191], a[228:231], a[140:143], v[188:191]
s_waitcnt lgkmcnt(4)
v_mfma_f32_16x16x32_bf16 v[192:195], a[236:239], a[128:131], v[192:195]
s_add_u32 m0, s39, 0
v_mfma_f32_16x16x32_bf16 v[192:195], a[240:243], a[144:147], v[192:195]
buffer_load_dwordx4 v242, s[24:27], s45 offen offset:0 lds
v_mfma_f32_16x16x32_bf16 v[196:199], a[240:243], a[148:151], v[196:199]
buffer_load_dwordx4 v243, s[24:27], s45 offen offset:1024 lds
v_mfma_f32_16x16x32_bf16 v[196:199], a[236:239], a[132:135], v[196:199]
buffer_load_dwordx4 v244, s[24:27], s45 offen offset:2048 lds
v_mfma_f32_16x16x32_bf16 v[200:203], a[236:239], a[136:139], v[200:203]
buffer_load_dwordx4 v245, s[24:27], s45 offen offset:3072 lds
v_mfma_f32_16x16x32_bf16 v[200:203], a[240:243], a[152:155], v[200:203]
ds_read_b64_tr_b16 a[220:221], v213 offset:0
ds_read_b64_tr_b16 a[222:223], v213 offset:2048
v_mfma_f32_16x16x32_bf16 v[204:207], a[240:243], a[156:159], v[204:207]
ds_read_b64_tr_b16 a[224:225], v213 offset:16384
ds_read_b64_tr_b16 a[226:227], v213 offset:18432
v_mfma_f32_16x16x32_bf16 v[204:207], a[236:239], a[140:143], v[204:207]
s_add_u32 m0, s39, 16384
s_waitcnt lgkmcnt(4)
v_mfma_f32_16x16x32_bf16 v[144:147], a[212:215], a[160:163], v[144:147]
buffer_load_dwordx4 v246, s[24:27], s45 offen offset:0 lds
v_mfma_f32_16x16x32_bf16 v[144:147], a[216:219], a[176:179], v[144:147]
buffer_load_dwordx4 v247, s[24:27], s45 offen offset:1024 lds
v_mfma_f32_16x16x32_bf16 v[148:151], a[216:219], a[180:183], v[148:151]
buffer_load_dwordx4 v248, s[24:27], s45 offen offset:2048 lds
v_mfma_f32_16x16x32_bf16 v[148:151], a[212:215], a[164:167], v[148:151]
buffer_load_dwordx4 v249, s[24:27], s45 offen offset:3072 lds
v_mfma_f32_16x16x32_bf16 v[152:155], a[212:215], a[168:171], v[152:155]
ds_read_b64_tr_b16 a[228:229], v214 offset:0
ds_read_b64_tr_b16 a[230:231], v214 offset:2048
v_mfma_f32_16x16x32_bf16 v[152:155], a[216:219], a[184:187], v[152:155]
ds_read_b64_tr_b16 a[232:233], v214 offset:16384
ds_read_b64_tr_b16 a[234:235], v214 offset:18432
v_mfma_f32_16x16x32_bf16 v[156:159], a[216:219], a[188:191], v[156:159]
ds_read_b128 a[128:131], v250 offset:32768
ds_read_b128 a[144:147], v250 offset:36864
v_mfma_f32_16x16x32_bf16 v[156:159], a[212:215], a[172:175], v[156:159]
ds_read_b128 a[132:135], v250 offset:33792
s_waitcnt lgkmcnt(7)
v_mfma_f32_16x16x32_bf16 v[160:163], a[220:223], a[160:163], v[160:163]
ds_read_b128 a[148:151], v250 offset:37888
ds_read_b128 a[136:139], v250 offset:34816
v_mfma_f32_16x16x32_bf16 v[160:163], a[224:227], a[176:179], v[160:163]
ds_read_b128 a[152:155], v250 offset:38912
ds_read_b128 a[140:143], v250 offset:35840
v_mfma_f32_16x16x32_bf16 v[164:167], a[224:227], a[180:183], v[164:167]
ds_read_b128 a[156:159], v250 offset:39936
ds_read_b64_tr_b16 a[236:237], v215 offset:0
v_mfma_f32_16x16x32_bf16 v[164:167], a[220:223], a[164:167], v[164:167]
ds_read_b64_tr_b16 a[238:239], v215 offset:2048
ds_read_b64_tr_b16 a[240:241], v215 offset:16384
v_mfma_f32_16x16x32_bf16 v[168:171], a[220:223], a[168:171], v[168:171]
ds_read_b64_tr_b16 a[242:243], v215 offset:18432
s_add_u32 s45, s45, 65536
v_mfma_f32_16x16x32_bf16 v[168:171], a[224:227], a[184:187], v[168:171]
s_and_b32 s45, s45, 0x7ffff
v_mfma_f32_16x16x32_bf16 v[172:175], a[224:227], a[188:191], v[172:175]
v_mfma_f32_16x16x32_bf16 v[172:175], a[220:223], a[172:175], v[172:175]
s_waitcnt lgkmcnt(12)
v_mfma_f32_16x16x32_bf16 v[176:179], a[228:231], a[160:163], v[176:179]
v_mfma_f32_16x16x32_bf16 v[176:179], a[232:235], a[176:179], v[176:179]
v_mfma_f32_16x16x32_bf16 v[180:183], a[232:235], a[180:183], v[180:183]
s_waitcnt vmcnt(8)
ds_read_b64_tr_b16 a[212:213], v212 offset:32768
v_mfma_f32_16x16x32_bf16 v[180:183], a[228:231], a[164:167], v[180:183]
ds_read_b64_tr_b16 a[214:215], v212 offset:34816
ds_read_b64_tr_b16 a[216:217], v212 offset:49152
v_mfma_f32_16x16x32_bf16 v[184:187], a[228:231], a[168:171], v[184:187]
ds_read_b64_tr_b16 a[218:219], v212 offset:51200
v_mfma_f32_16x16x32_bf16 v[184:187], a[232:235], a[184:187], v[184:187]
v_mfma_f32_16x16x32_bf16 v[188:191], a[232:235], a[188:191], v[188:191]
v_mfma_f32_16x16x32_bf16 v[188:191], a[228:231], a[172:175], v[188:191]
s_waitcnt lgkmcnt(4)
v_mfma_f32_16x16x32_bf16 v[192:195], a[236:239], a[160:163], v[192:195]
s_add_u32 m0, s39, 98304
v_mfma_f32_16x16x32_bf16 v[192:195], a[240:243], a[176:179], v[192:195]
buffer_load_dwordx4 v242, s[24:27], s45 offen offset:0 lds
v_mfma_f32_16x16x32_bf16 v[196:199], a[240:243], a[180:183], v[196:199]
buffer_load_dwordx4 v243, s[24:27], s45 offen offset:1024 lds
v_mfma_f32_16x16x32_bf16 v[196:199], a[236:239], a[164:167], v[196:199]
buffer_load_dwordx4 v244, s[24:27], s45 offen offset:2048 lds
v_mfma_f32_16x16x32_bf16 v[200:203], a[236:239], a[168:171], v[200:203]
buffer_load_dwordx4 v245, s[24:27], s45 offen offset:3072 lds
v_mfma_f32_16x16x32_bf16 v[200:203], a[240:243], a[184:187], v[200:203]
ds_read_b64_tr_b16 a[220:221], v213 offset:32768
ds_read_b64_tr_b16 a[222:223], v213 offset:34816
v_mfma_f32_16x16x32_bf16 v[204:207], a[240:243], a[188:191], v[204:207]
ds_read_b64_tr_b16 a[224:225], v213 offset:49152
ds_read_b64_tr_b16 a[226:227], v213 offset:51200
v_mfma_f32_16x16x32_bf16 v[204:207], a[236:239], a[172:175], v[204:207]
s_add_u32 m0, s39, 114688
s_waitcnt lgkmcnt(4)
v_mfma_f32_16x16x32_bf16 v[144:147], a[212:215], a[128:131], v[144:147]
buffer_load_dwordx4 v246, s[24:27], s45 offen offset:0 lds
v_mfma_f32_16x16x32_bf16 v[144:147], a[216:219], a[144:147], v[144:147]
buffer_load_dwordx4 v247, s[24:27], s45 offen offset:1024 lds
v_mfma_f32_16x16x32_bf16 v[148:151], a[216:219], a[148:151], v[148:151]
buffer_load_dwordx4 v248, s[24:27], s45 offen offset:2048 lds
v_mfma_f32_16x16x32_bf16 v[148:151], a[212:215], a[132:135], v[148:151]
buffer_load_dwordx4 v249, s[24:27], s45 offen offset:3072 lds
v_mfma_f32_16x16x32_bf16 v[152:155], a[212:215], a[136:139], v[152:155]
ds_read_b64_tr_b16 a[228:229], v214 offset:32768
ds_read_b64_tr_b16 a[230:231], v214 offset:34816
v_mfma_f32_16x16x32_bf16 v[152:155], a[216:219], a[152:155], v[152:155]
ds_read_b64_tr_b16 a[232:233], v214 offset:49152
ds_read_b64_tr_b16 a[234:235], v214 offset:51200
v_mfma_f32_16x16x32_bf16 v[156:159], a[216:219], a[156:159], v[156:159]
ds_read_b128 a[160:163], v250 offset:40960
ds_read_b128 a[176:179], v250 offset:45056
v_mfma_f32_16x16x32_bf16 v[156:159], a[212:215], a[140:143], v[156:159]
ds_read_b128 a[164:167], v250 offset:41984
s_waitcnt lgkmcnt(7)
v_mfma_f32_16x16x32_bf16 v[160:163], a[220:223], a[128:131], v[160:163]
ds_read_b128 a[180:183], v250 offset:46080
ds_read_b128 a[168:171], v250 offset:43008
v_mfma_f32_16x16x32_bf16 v[160:163], a[224:227], a[144:147], v[160:163]
ds_read_b128 a[184:187], v250 offset:47104
ds_read_b128 a[172:175], v250 offset:44032
v_mfma_f32_16x16x32_bf16 v[164:167], a[224:227], a[148:151], v[164:167]
ds_read_b128 a[188:191], v250 offset:48128
ds_read_b64_tr_b16 a[236:237], v215 offset:32768
v_mfma_f32_16x16x32_bf16 v[164:167], a[220:223], a[132:135], v[164:167]
ds_read_b64_tr_b16 a[238:239], v215 offset:34816
ds_read_b64_tr_b16 a[240:241], v215 offset:49152
v_mfma_f32_16x16x32_bf16 v[168:171], a[220:223], a[136:139], v[168:171]
ds_read_b64_tr_b16 a[242:243], v215 offset:51200
s_add_u32 s45, s45, 65536
v_mfma_f32_16x16x32_bf16 v[168:171], a[224:227], a[152:155], v[168:171]
s_and_b32 s45, s45, 0x7ffff
v_mfma_f32_16x16x32_bf16 v[172:175], a[224:227], a[156:159], v[172:175]
v_mfma_f32_16x16x32_bf16 v[172:175], a[220:223], a[140:143], v[172:175]
s_waitcnt lgkmcnt(12)
v_mfma_f32_16x16x32_bf16 v[176:179], a[228:231], a[128:131], v[176:179]
v_mfma_f32_16x16x32_bf16 v[176:179], a[232:235], a[144:147], v[176:179]
v_mfma_f32_16x16x32_bf16 v[180:183], a[232:235], a[148:151], v[180:183]
s_waitcnt vmcnt(8)
ds_read_b64_tr_b16 a[212:213], v208 offset:0
v_mfma_f32_16x16x32_bf16 v[180:183], a[228:231], a[132:135], v[180:183]
ds_read_b64_tr_b16 a[214:215], v208 offset:2048
ds_read_b64_tr_b16 a[216:217], v208 offset:16384
v_mfma_f32_16x16x32_bf16 v[184:187], a[228:231], a[136:139], v[184:187]
ds_read_b64_tr_b16 a[218:219], v208 offset:18432
v_mfma_f32_16x16x32_bf16 v[184:187], a[232:235], a[152:155], v[184:187]
v_mfma_f32_16x16x32_bf16 v[188:191], a[232:235], a[156:159], v[188:191]
v_mfma_f32_16x16x32_bf16 v[188:191], a[228:231], a[140:143], v[188:191]
s_waitcnt lgkmcnt(4)
v_mfma_f32_16x16x32_bf16 v[192:195], a[236:239], a[128:131], v[192:195]
s_add_u32 m0, s39, 131072
buffer_load_dword v255, v6, s[28:31], s52 offen sc1
v_mfma_f32_16x16x32_bf16 v[192:195], a[240:243], a[144:147], v[192:195]
buffer_load_dwordx4 v242, s[24:27], s45 offen offset:0 lds
v_mfma_f32_16x16x32_bf16 v[196:199], a[240:243], a[148:151], v[196:199]
buffer_load_dwordx4 v243, s[24:27], s45 offen offset:1024 lds
v_mfma_f32_16x16x32_bf16 v[196:199], a[236:239], a[132:135], v[196:199]
buffer_load_dwordx4 v244, s[24:27], s45 offen offset:2048 lds
v_mfma_f32_16x16x32_bf16 v[200:203], a[236:239], a[136:139], v[200:203]
buffer_load_dwordx4 v245, s[24:27], s45 offen offset:3072 lds
v_mfma_f32_16x16x32_bf16 v[200:203], a[240:243], a[152:155], v[200:203]
ds_read_b64_tr_b16 a[220:221], v209 offset:0
ds_read_b64_tr_b16 a[222:223], v209 offset:2048
v_mfma_f32_16x16x32_bf16 v[204:207], a[240:243], a[156:159], v[204:207]
ds_read_b64_tr_b16 a[224:225], v209 offset:16384
ds_read_b64_tr_b16 a[226:227], v209 offset:18432
v_mfma_f32_16x16x32_bf16 v[204:207], a[236:239], a[140:143], v[204:207]
s_add_u32 m0, s39, 147456
s_waitcnt lgkmcnt(4)
v_mfma_f32_16x16x32_bf16 v[144:147], a[212:215], a[160:163], v[144:147]
buffer_load_dwordx4 v246, s[24:27], s45 offen offset:0 lds
v_mfma_f32_16x16x32_bf16 v[144:147], a[216:219], a[176:179], v[144:147]
buffer_load_dwordx4 v247, s[24:27], s45 offen offset:1024 lds
v_mfma_f32_16x16x32_bf16 v[148:151], a[216:219], a[180:183], v[148:151]
buffer_load_dwordx4 v248, s[24:27], s45 offen offset:2048 lds
v_mfma_f32_16x16x32_bf16 v[148:151], a[212:215], a[164:167], v[148:151]
buffer_load_dwordx4 v249, s[24:27], s45 offen offset:3072 lds
v_mfma_f32_16x16x32_bf16 v[152:155], a[212:215], a[168:171], v[152:155]
ds_read_b64_tr_b16 a[228:229], v210 offset:0
ds_read_b64_tr_b16 a[230:231], v210 offset:2048
v_mfma_f32_16x16x32_bf16 v[152:155], a[216:219], a[184:187], v[152:155]
ds_read_b64_tr_b16 a[232:233], v210 offset:16384
ds_read_b64_tr_b16 a[234:235], v210 offset:18432
v_mfma_f32_16x16x32_bf16 v[156:159], a[216:219], a[188:191], v[156:159]
ds_read_b128 a[128:131], v250 offset:49152
ds_read_b128 a[144:147], v250 offset:53248
v_mfma_f32_16x16x32_bf16 v[156:159], a[212:215], a[172:175], v[156:159]
ds_read_b128 a[132:135], v250 offset:50176
s_waitcnt lgkmcnt(7)
v_mfma_f32_16x16x32_bf16 v[160:163], a[220:223], a[160:163], v[160:163]
ds_read_b128 a[148:151], v250 offset:54272
ds_read_b128 a[136:139], v250 offset:51200
v_mfma_f32_16x16x32_bf16 v[160:163], a[224:227], a[176:179], v[160:163]
ds_read_b128 a[152:155], v250 offset:55296
ds_read_b128 a[140:143], v250 offset:52224
v_mfma_f32_16x16x32_bf16 v[164:167], a[224:227], a[180:183], v[164:167]
ds_read_b128 a[156:159], v250 offset:56320
ds_read_b64_tr_b16 a[236:237], v211 offset:0
v_mfma_f32_16x16x32_bf16 v[164:167], a[220:223], a[164:167], v[164:167]
ds_read_b64_tr_b16 a[238:239], v211 offset:2048
ds_read_b64_tr_b16 a[240:241], v211 offset:16384
v_mfma_f32_16x16x32_bf16 v[168:171], a[220:223], a[168:171], v[168:171]
ds_read_b64_tr_b16 a[242:243], v211 offset:18432
s_add_u32 s45, s45, 65536
v_mfma_f32_16x16x32_bf16 v[168:171], a[224:227], a[184:187], v[168:171]
s_and_b32 s45, s45, 0x7ffff
v_cvt_pk_bf16_f32 v16, v80, v81
v_mfma_f32_16x16x32_bf16 v[172:175], a[224:227], a[188:191], v[172:175]
v_cvt_pk_bf16_f32 v17, v82, v83
v_cvt_pk_bf16_f32 v18, v96, v97
v_mfma_f32_16x16x32_bf16 v[172:175], a[220:223], a[172:175], v[172:175]
v_cvt_pk_bf16_f32 v19, v98, v99
s_waitcnt lgkmcnt(12)
v_mfma_f32_16x16x32_bf16 v[176:179], a[228:231], a[160:163], v[176:179]
v_cvt_pk_bf16_f32 v20, v112, v113
v_cvt_pk_bf16_f32 v21, v114, v115
v_mfma_f32_16x16x32_bf16 v[176:179], a[232:235], a[176:179], v[176:179]
v_cvt_pk_bf16_f32 v22, v128, v129
v_cvt_pk_bf16_f32 v23, v130, v131
v_mfma_f32_16x16x32_bf16 v[180:183], a[232:235], a[180:183], v[180:183]
s_waitcnt vmcnt(9)
ds_read_b64_tr_b16 a[212:213], v212 offset:0
v_mfma_f32_16x16x32_bf16 v[180:183], a[228:231], a[164:167], v[180:183]
ds_read_b64_tr_b16 a[214:215], v212 offset:2048
ds_read_b64_tr_b16 a[216:217], v212 offset:16384
v_mfma_f32_16x16x32_bf16 v[184:187], a[228:231], a[168:171], v[184:187]
ds_read_b64_tr_b16 a[218:219], v212 offset:18432
v_permlane16_swap_b32 v16, v18
v_mfma_f32_16x16x32_bf16 v[184:187], a[232:235], a[184:187], v[184:187]
v_permlane16_swap_b32 v17, v19
v_permlane16_swap_b32 v20, v22
v_mfma_f32_16x16x32_bf16 v[188:191], a[232:235], a[188:191], v[188:191]
v_permlane16_swap_b32 v21, v23
v_mfma_f32_16x16x32_bf16 v[188:191], a[228:231], a[172:175], v[188:191]
buffer_store_dwordx4 v[16:19], v4, s[32:35], s48 offen offset:0 sc0 sc1
s_waitcnt lgkmcnt(4)
v_mfma_f32_16x16x32_bf16 v[192:195], a[236:239], a[160:163], v[192:195]
buffer_store_dwordx4 v[20:23], v4, s[32:35], s48 offen offset:128 sc0 sc1
v_cvt_pk_bf16_f32 v32, v84, v85
v_mfma_f32_16x16x32_bf16 v[192:195], a[240:243], a[176:179], v[192:195]
v_cvt_pk_bf16_f32 v33, v86, v87
v_cvt_pk_bf16_f32 v34, v100, v101
v_mfma_f32_16x16x32_bf16 v[196:199], a[240:243], a[180:183], v[196:199]
ds_read_b64_tr_b16 a[220:221], v213 offset:0
ds_read_b64_tr_b16 a[222:223], v213 offset:2048
v_mfma_f32_16x16x32_bf16 v[196:199], a[236:239], a[164:167], v[196:199]
ds_read_b64_tr_b16 a[224:225], v213 offset:16384
ds_read_b64_tr_b16 a[226:227], v213 offset:18432
v_mfma_f32_16x16x32_bf16 v[200:203], a[236:239], a[168:171], v[200:203]
v_cvt_pk_bf16_f32 v35, v102, v103
v_cvt_pk_bf16_f32 v36, v116, v117
v_mfma_f32_16x16x32_bf16 v[200:203], a[240:243], a[184:187], v[200:203]
v_cvt_pk_bf16_f32 v37, v118, v119
v_cvt_pk_bf16_f32 v38, v132, v133
v_mfma_f32_16x16x32_bf16 v[204:207], a[240:243], a[188:191], v[204:207]
v_cvt_pk_bf16_f32 v39, v134, v135
v_permlane16_swap_b32 v32, v34
v_mfma_f32_16x16x32_bf16 v[204:207], a[236:239], a[172:175], v[204:207]
v_permlane16_swap_b32 v33, v35
s_waitcnt lgkmcnt(4)
v_mfma_f32_16x16x32_bf16 v[144:147], a[212:215], a[128:131], v[144:147]
v_permlane16_swap_b32 v36, v38
v_permlane16_swap_b32 v37, v39
v_mfma_f32_16x16x32_bf16 v[144:147], a[216:219], a[144:147], v[144:147]
buffer_store_dwordx4 v[32:35], v4, s[32:35], s49 offen offset:0 sc0 sc1
buffer_store_dwordx4 v[36:39], v4, s[32:35], s49 offen offset:128 sc0 sc1
v_mfma_f32_16x16x32_bf16 v[148:151], a[216:219], a[148:151], v[148:151]
ds_read_b64_tr_b16 a[228:229], v214 offset:0
ds_read_b64_tr_b16 a[230:231], v214 offset:2048
v_mfma_f32_16x16x32_bf16 v[148:151], a[212:215], a[132:135], v[148:151]
ds_read_b64_tr_b16 a[232:233], v214 offset:16384
ds_read_b64_tr_b16 a[234:235], v214 offset:18432
v_mfma_f32_16x16x32_bf16 v[152:155], a[212:215], a[136:139], v[152:155]
ds_read_b128 a[160:163], v250 offset:57344
ds_read_b128 a[176:179], v250 offset:61440
v_mfma_f32_16x16x32_bf16 v[152:155], a[216:219], a[152:155], v[152:155]
ds_read_b128 a[164:167], v250 offset:58368
ds_read_b128 a[180:183], v250 offset:62464
v_mfma_f32_16x16x32_bf16 v[156:159], a[216:219], a[156:159], v[156:159]
ds_read_b128 a[168:171], v250 offset:59392
ds_read_b128 a[184:187], v250 offset:63488
v_mfma_f32_16x16x32_bf16 v[156:159], a[212:215], a[140:143], v[156:159]
ds_read_b128 a[172:175], v250 offset:60416
s_waitcnt lgkmcnt(11)
v_mfma_f32_16x16x32_bf16 v[160:163], a[220:223], a[128:131], v[160:163]
ds_read_b128 a[188:191], v250 offset:64512
v_cvt_pk_bf16_f32 v48, v88, v89
v_mfma_f32_16x16x32_bf16 v[160:163], a[224:227], a[144:147], v[160:163]
v_cvt_pk_bf16_f32 v49, v90, v91
v_cvt_pk_bf16_f32 v50, v104, v105
v_mfma_f32_16x16x32_bf16 v[164:167], a[224:227], a[148:151], v[164:167]
ds_read_b64_tr_b16 a[236:237], v215 offset:0
ds_read_b64_tr_b16 a[238:239], v215 offset:2048
v_mfma_f32_16x16x32_bf16 v[164:167], a[220:223], a[132:135], v[164:167]
ds_read_b64_tr_b16 a[240:241], v215 offset:16384
ds_read_b64_tr_b16 a[242:243], v215 offset:18432
v_mfma_f32_16x16x32_bf16 v[168:171], a[220:223], a[136:139], v[168:171]
v_cvt_pk_bf16_f32 v51, v106, v107
v_cvt_pk_bf16_f32 v52, v120, v121
v_mfma_f32_16x16x32_bf16 v[168:171], a[224:227], a[152:155], v[168:171]
v_cvt_pk_bf16_f32 v53, v122, v123
v_cvt_pk_bf16_f32 v54, v136, v137
v_mfma_f32_16x16x32_bf16 v[172:175], a[224:227], a[156:159], v[172:175]
v_cvt_pk_bf16_f32 v55, v138, v139
v_permlane16_swap_b32 v48, v50
v_mfma_f32_16x16x32_bf16 v[172:175], a[220:223], a[140:143], v[172:175]
v_permlane16_swap_b32 v49, v51
s_waitcnt lgkmcnt(12)
v_mfma_f32_16x16x32_bf16 v[176:179], a[228:231], a[128:131], v[176:179]
v_permlane16_swap_b32 v52, v54
v_permlane16_swap_b32 v53, v55
v_mfma_f32_16x16x32_bf16 v[176:179], a[232:235], a[144:147], v[176:179]
buffer_store_dwordx4 v[48:51], v4, s[32:35], s50 offen offset:0 sc0 sc1
buffer_store_dwordx4 v[52:55], v4, s[32:35], s50 offen offset:128 sc0 sc1
v_mfma_f32_16x16x32_bf16 v[180:183], a[232:235], a[148:151], v[180:183]
s_waitcnt vmcnt(6)
ds_read_b64_tr_b16 a[212:213], v212 offset:32768
v_mfma_f32_16x16x32_bf16 v[180:183], a[228:231], a[132:135], v[180:183]
ds_read_b64_tr_b16 a[214:215], v212 offset:34816
ds_read_b64_tr_b16 a[216:217], v212 offset:49152
v_mfma_f32_16x16x32_bf16 v[184:187], a[228:231], a[136:139], v[184:187]
ds_read_b64_tr_b16 a[218:219], v212 offset:51200
v_cvt_pk_bf16_f32 v64, v92, v93
v_mfma_f32_16x16x32_bf16 v[184:187], a[232:235], a[152:155], v[184:187]
v_cvt_pk_bf16_f32 v65, v94, v95
v_cvt_pk_bf16_f32 v66, v108, v109
v_mfma_f32_16x16x32_bf16 v[188:191], a[232:235], a[156:159], v[188:191]
v_cvt_pk_bf16_f32 v67, v110, v111
v_cvt_pk_bf16_f32 v68, v124, v125
v_mfma_f32_16x16x32_bf16 v[188:191], a[228:231], a[140:143], v[188:191]
v_cvt_pk_bf16_f32 v69, v126, v127
s_waitcnt lgkmcnt(4)
v_mfma_f32_16x16x32_bf16 v[192:195], a[236:239], a[128:131], v[192:195]
v_cvt_pk_bf16_f32 v70, v140, v141
v_cvt_pk_bf16_f32 v71, v142, v143
v_mfma_f32_16x16x32_bf16 v[192:195], a[240:243], a[144:147], v[192:195]
v_permlane16_swap_b32 v64, v66
v_permlane16_swap_b32 v65, v67
v_mfma_f32_16x16x32_bf16 v[196:199], a[240:243], a[148:151], v[196:199]
ds_read_b64_tr_b16 a[220:221], v213 offset:32768
ds_read_b64_tr_b16 a[222:223], v213 offset:34816
v_mfma_f32_16x16x32_bf16 v[196:199], a[236:239], a[132:135], v[196:199]
ds_read_b64_tr_b16 a[224:225], v213 offset:49152
ds_read_b64_tr_b16 a[226:227], v213 offset:51200
v_mfma_f32_16x16x32_bf16 v[200:203], a[236:239], a[136:139], v[200:203]
v_permlane16_swap_b32 v68, v70
v_permlane16_swap_b32 v69, v71
v_mfma_f32_16x16x32_bf16 v[200:203], a[240:243], a[152:155], v[200:203]
buffer_store_dwordx4 v[64:67], v4, s[32:35], s51 offen offset:0 sc0 sc1
buffer_store_dwordx4 v[68:71], v4, s[32:35], s51 offen offset:128 sc0 sc1
v_mfma_f32_16x16x32_bf16 v[204:207], a[240:243], a[156:159], v[204:207]
v_mfma_f32_16x16x32_bf16 v[204:207], a[236:239], a[140:143], v[204:207]
s_waitcnt lgkmcnt(4)
v_mfma_f32_16x16x32_bf16 v[144:147], a[212:215], a[160:163], v[144:147]
v_mfma_f32_16x16x32_bf16 v[144:147], a[216:219], a[176:179], v[144:147]
v_mfma_f32_16x16x32_bf16 v[148:151], a[216:219], a[180:183], v[148:151]
ds_read_b64_tr_b16 a[228:229], v214 offset:32768
ds_read_b64_tr_b16 a[230:231], v214 offset:34816
v_mfma_f32_16x16x32_bf16 v[148:151], a[212:215], a[164:167], v[148:151]
ds_read_b64_tr_b16 a[232:233], v214 offset:49152
ds_read_b64_tr_b16 a[234:235], v214 offset:51200
v_mfma_f32_16x16x32_bf16 v[152:155], a[212:215], a[168:171], v[152:155]
v_mfma_f32_16x16x32_bf16 v[152:155], a[216:219], a[184:187], v[152:155]
v_mfma_f32_16x16x32_bf16 v[156:159], a[216:219], a[188:191], v[156:159]
v_mfma_f32_16x16x32_bf16 v[156:159], a[212:215], a[172:175], v[156:159]
s_waitcnt lgkmcnt(4)
v_mfma_f32_16x16x32_bf16 v[160:163], a[220:223], a[160:163], v[160:163]
v_mfma_f32_16x16x32_bf16 v[160:163], a[224:227], a[176:179], v[160:163]
v_mfma_f32_16x16x32_bf16 v[164:167], a[224:227], a[180:183], v[164:167]
ds_read_b64_tr_b16 a[236:237], v215 offset:32768
ds_read_b64_tr_b16 a[238:239], v215 offset:34816
v_mfma_f32_16x16x32_bf16 v[164:167], a[220:223], a[164:167], v[164:167]
ds_read_b64_tr_b16 a[240:241], v215 offset:49152
ds_read_b64_tr_b16 a[242:243], v215 offset:51200
v_mfma_f32_16x16x32_bf16 v[168:171], a[220:223], a[168:171], v[168:171]
v_mfma_f32_16x16x32_bf16 v[168:171], a[224:227], a[184:187], v[168:171]
v_mfma_f32_16x16x32_bf16 v[172:175], a[224:227], a[188:191], v[172:175]
v_mfma_f32_16x16x32_bf16 v[172:175], a[220:223], a[172:175], v[172:175]
s_waitcnt lgkmcnt(4)
v_mfma_f32_16x16x32_bf16 v[176:179], a[228:231], a[160:163], v[176:179]
v_mfma_f32_16x16x32_bf16 v[176:179], a[232:235], a[176:179], v[176:179]
v_mfma_f32_16x16x32_bf16 v[180:183], a[232:235], a[180:183], v[180:183]
v_mfma_f32_16x16x32_bf16 v[180:183], a[228:231], a[164:167], v[180:183]
v_mfma_f32_16x16x32_bf16 v[184:187], a[228:231], a[168:171], v[184:187]
v_mfma_f32_16x16x32_bf16 v[184:187], a[232:235], a[184:187], v[184:187]
v_mfma_f32_16x16x32_bf16 v[188:191], a[232:235], a[188:191], v[188:191]
v_mfma_f32_16x16x32_bf16 v[188:191], a[228:231], a[172:175], v[188:191]
s_waitcnt lgkmcnt(0)
v_mfma_f32_16x16x32_bf16 v[192:195], a[236:239], a[160:163], v[192:195]
v_mfma_f32_16x16x32_bf16 v[192:195], a[240:243], a[176:179], v[192:195]
v_mfma_f32_16x16x32_bf16 v[196:199], a[240:243], a[180:183], v[196:199]
v_mfma_f32_16x16x32_bf16 v[196:199], a[236:239], a[164:167], v[196:199]
v_mfma_f32_16x16x32_bf16 v[200:203], a[236:239], a[168:171], v[200:203]
v_mfma_f32_16x16x32_bf16 v[200:203], a[240:243], a[184:187], v[200:203]
v_mfma_f32_16x16x32_bf16 v[204:207], a[240:243], a[188:191], v[204:207]
v_mfma_f32_16x16x32_bf16 v[204:207], a[236:239], a[172:175], v[204:207]
s_nop 7
v_cvt_pk_bf16_f32 v24, v144, v145
v_cvt_pk_bf16_f32 v25, v146, v147
v_cvt_pk_bf16_f32 v26, v160, v161
v_cvt_pk_bf16_f32 v27, v162, v163
v_cvt_pk_bf16_f32 v28, v176, v177
v_cvt_pk_bf16_f32 v29, v178, v179
v_cvt_pk_bf16_f32 v30, v192, v193
v_cvt_pk_bf16_f32 v31, v194, v195
v_permlane16_swap_b32 v24, v26
v_permlane16_swap_b32 v25, v27
v_permlane16_swap_b32 v28, v30
v_permlane16_swap_b32 v29, v31
buffer_store_dwordx4 v[24:27], v4, s[32:35], s48 offen offset:256 sc0 sc1
buffer_store_dwordx4 v[28:31], v4, s[32:35], s48 offen offset:384 sc0 sc1
v_cvt_pk_bf16_f32 v40, v148, v149
v_cvt_pk_bf16_f32 v41, v150, v151
v_cvt_pk_bf16_f32 v42, v164, v165
v_cvt_pk_bf16_f32 v43, v166, v167
v_cvt_pk_bf16_f32 v44, v180, v181
v_cvt_pk_bf16_f32 v45, v182, v183
v_cvt_pk_bf16_f32 v46, v196, v197
v_cvt_pk_bf16_f32 v47, v198, v199
v_permlane16_swap_b32 v40, v42
v_permlane16_swap_b32 v41, v43
v_permlane16_swap_b32 v44, v46
v_permlane16_swap_b32 v45, v47
buffer_store_dwordx4 v[40:43], v4, s[32:35], s49 offen offset:256 sc0 sc1
buffer_store_dwordx4 v[44:47], v4, s[32:35], s49 offen offset:384 sc0 sc1
v_cvt_pk_bf16_f32 v56, v152, v153
v_cvt_pk_bf16_f32 v57, v154, v155
v_cvt_pk_bf16_f32 v58, v168, v169
v_cvt_pk_bf16_f32 v59, v170, v171
v_cvt_pk_bf16_f32 v60, v184, v185
v_cvt_pk_bf16_f32 v61, v186, v187
v_cvt_pk_bf16_f32 v62, v200, v201
v_cvt_pk_bf16_f32 v63, v202, v203
v_permlane16_swap_b32 v56, v58
v_permlane16_swap_b32 v57, v59
v_permlane16_swap_b32 v60, v62
v_permlane16_swap_b32 v61, v63
buffer_store_dwordx4 v[56:59], v4, s[32:35], s50 offen offset:256 sc0 sc1
buffer_store_dwordx4 v[60:63], v4, s[32:35], s50 offen offset:384 sc0 sc1
v_cvt_pk_bf16_f32 v72, v156, v157
v_cvt_pk_bf16_f32 v73, v158, v159
v_cvt_pk_bf16_f32 v74, v172, v173
v_cvt_pk_bf16_f32 v75, v174, v175
v_cvt_pk_bf16_f32 v76, v188, v189
v_cvt_pk_bf16_f32 v77, v190, v191
v_cvt_pk_bf16_f32 v78, v204, v205
v_cvt_pk_bf16_f32 v79, v206, v207
v_permlane16_swap_b32 v72, v74
v_permlane16_swap_b32 v73, v75
v_permlane16_swap_b32 v76, v78
v_permlane16_swap_b32 v77, v79
buffer_store_dwordx4 v[72:75], v4, s[32:35], s51 offen offset:256 sc0 sc1
buffer_store_dwordx4 v[76:79], v4, s[32:35], s51 offen offset:384 sc0 sc1
s_lshl_b32 s44, s37, 7
s_add_u32 s44, s44, 16384
s_and_b32 s41, s36, 4
s_add_u32 s44, s44, s41
s_waitcnt vmcnt(0)
s_cmp_lg_u32 s38, 0
s_cbranch_scc1 L_f_mb_done
s_mov_b32 s60, 400000
s_mov_b32 s62, 28672
v_mov_b32 v6, 0
L_f_mb:
v_readfirstlane_b32 s61, v255
s_sub_u32 s60, s60, 1
s_cbranch_scc1 L_f_mb_done
s_cmp_ge_u32 s61, 256
s_cbranch_scc1 L_f_mb_done
buffer_load_dword v255, v6, s[28:31], s62 offen sc1
s_waitcnt vmcnt(0)
s_branch L_f_mb
L_f_mb_done:
s_barrier
s_cmp_lg_u32 s38, 0
s_cbranch_scc1 L_f_sigp
s_mov_b64 exec, 1
v_mov_b32 v4, 0
v_mov_b32_e64 v5, 1
buffer_atomic_add v5, v4, s[28:31], s44 offen sc1
s_mov_b64 exec, -1
L_f_sigp:
s_add_u32 s12, s58, 16777216
s_addc_u32 s13, s59, 0
s_mov_b32 s14, 16777216
s_mov_b32 s15, 0x20000
v_lshlrev_b32 v16, 4, v0
v_and_b32 v17, 1, v0
v_lshrrev_b32 v18, 1, v0
v_lshlrev_b32 v19, 10, v17
v_lshl_add_u32 v19, v18, 4, v19
v_lshlrev_b32 v20, 5, v18
s_lshl_b32 s40, s84, 7
s_lshl_b32 s41, s85, 2
s_add_u32 s40, s40, s41
s_add_u32 s40, s40, s38
s_lshl_b32 s40, s40, 11
v_mul_u32_u24 v21, 0x3000, v2
v_and_b32_e64 v5, 7, v18
v_lshl_add_u32 v21, v5, 7, v21
v_lshl_add_u32 v21, v17, 4, v21
s_lshl_b32 s41, s38, 5
s_add_u32 s41, s41, 114688
v_add_u32 v21, s41, v21
s_mul_i32 s43, s38, 12288
s_add_u32 s43, s43, 114688
v_add_u32 v22, s43, v16
v_lshrrev_b32 v23, 3, v0
v_lshlrev_b32 v23, 8, v23
v_and_b32 v5, 7, v0
v_lshl_add_u32 v23, v5, 4, v23
s_lshl_b32 s42, s84, 18
s_lshr_b32 s41, s85, 1
s_lshl_b32 s41, s41, 14
s_add_u32 s42, s42, s41
s_and_b32 s41, s85, 1
s_lshl_b32 s41, s41, 7
s_add_u32 s42, s42, s41
s_lshl_b32 s41, s38, 11
s_add_u32 s42, s42, s41
s_add_u32 s42, s42, 4194304
s_lshl_b32 s45, s84, 2
s_lshr_b32 s41, s85, 3
s_add_u32 s45, s45, s41
s_lshl_b32 s45, s45, 7
s_add_u32 s45, s45, 16384
s_lshl_b32 s46, s84, 1
s_lshr_b32 s41, s85, 4
s_add_u32 s46, s46, s41
s_lshl_b32 s46, s46, 7
s_add_u32 s46, s46, 20480
s_lshr_b32 s16, s84, 1
s_lshl_b32 s16, s16, 2
s_lshr_b32 s41, s85, 3
s_add_u32 s16, s16, s41
s_lshl_b32 s47, s16, 7
s_add_u32 s48, s47, 22528
s_add_u32 s47, s47, 20480
buffer_load_dwordx4 v[40:43], v19, s[8:11], s40 offen offset:0
buffer_load_dwordx4 v[44:47], v19, s[8:11], s40 offen offset:512
s_mov_b32 s41, 4096
buffer_load_dwordx4 v[112:115], v20, s[28:31], s41 offen offset:0 sc1
buffer_load_dwordx4 v[116:119], v20, s[28:31], s41 offen offset:16 sc1
buffer_load_dwordx4 v[120:123], v20, s[28:31], s41 offen offset:1024 sc1
buffer_load_dwordx4 v[124:127], v20, s[28:31], s41 offen offset:1040 sc1
s_add_u32 s41, s41, 2048
buffer_load_dwordx4 v[128:131], v20, s[28:31], s41 offen offset:0 sc1
buffer_load_dwordx4 v[132:135], v20, s[28:31], s41 offen offset:16 sc1
buffer_load_dwordx4 v[136:139], v20, s[28:31], s41 offen offset:1024 sc1
buffer_load_dwordx4 v[140:143], v20, s[28:31], s41 offen offset:1040 sc1
s_add_u32 s41, s41, 2048
buffer_load_dwordx4 v[144:147], v20, s[28:31], s41 offen offset:0 sc1
buffer_load_dwordx4 v[148:151], v20, s[28:31], s41 offen offset:16 sc1
buffer_load_dwordx4 v[152:155], v20, s[28:31], s41 offen offset:1024 sc1
buffer_load_dwordx4 v[156:159], v20, s[28:31], s41 offen offset:1040 sc1
s_movk_i32 s18, 4682
s_movk_i32 s19, 3584
v_add_u32 v4, 0, v0
v_mul_u32_u24 v5, s18, v4
v_lshrrev_b32 v5, 16, v5
v_mul_u32_u24 v6, 14, v5
v_sub_u32 v4, v4, v6
v_and_b32 v6, 0x13, v5
v_bfe_u32 v7, v5, 2, 1
v_lshl_or_b32 v6, v7, 3, v6
v_bfe_u32 v7, v5, 3, 1
v_lshl_or_b32 v6, v7, 2, v6
v_mul_u32_u24_e64 v6, s19, v6
v_lshl_add_u32 v6, v4, 4, v6
v_subrev_u32 v24, 0, v6
v_add_u32 v4, 64, v0
v_mul_u32_u24 v5, s18, v4
v_lshrrev_b32 v5, 16, v5
v_mul_u32_u24 v6, 14, v5
v_sub_u32 v4, v4, v6
v_and_b32_e64 v6, 0x13, v5
v_bfe_u32 v7, v5, 2, 1
v_lshl_or_b32 v6, v7, 3, v6
v_bfe_u32 v7, v5, 3, 1
v_lshl_or_b32 v6, v7, 2, v6
v_mul_u32_u24_e64 v6, s19, v6
v_lshl_add_u32 v6, v4, 4, v6
v_subrev_u32 v25, 1024, v6
v_add_u32 v4, 128, v0
v_mul_u32_u24 v5, s18, v4
v_lshrrev_b32 v5, 16, v5
v_mul_u32_u24 v6, 14, v5
v_sub_u32 v4, v4, v6
v_and_b32_e64 v6, 0x13, v5
v_bfe_u32 v7, v5, 2, 1
v_lshl_or_b32 v6, v7, 3, v6
v_bfe_u32 v7, v5, 3, 1
v_lshl_or_b32 v6, v7, 2, v6
v_mul_u32_u24_e64 v6, s19, v6
v_lshl_add_u32 v6, v4, 4, v6
v_subrev_u32 v26, 2048, v6
v_add_u32 v4, 192, v0
v_mul_u32_u24 v5, s18, v4
v_lshrrev_b32 v5, 16, v5
v_mul_u32_u24 v6, 14, v5
v_sub_u32 v4, v4, v6
v_and_b32_e64 v6, 0x13, v5
v_bfe_u32 v7, v5, 2, 1
v_lshl_or_b32 v6, v7, 3, v6
v_bfe_u32 v7, v5, 3, 1
v_lshl_or_b32 v6, v7, 2, v6
v_mul_u32_u24_e64 v6, s19, v6
v_lshl_add_u32 v6, v4, 4, v6
v_subrev_u32 v27, 3072, v6
v_add_u32 v4, 256, v0
v_mul_u32_u24 v5, s18, v4
v_lshrrev_b32 v5, 16, v5
v_mul_u32_u24 v6, 14, v5
v_sub_u32 v4, v4, v6
v_and_b32_e64 v6, 0x13, v5
v_bfe_u32 v7, v5, 2, 1
v_lshl_or_b32 v6, v7, 3, v6
v_bfe_u32 v7, v5, 3, 1
v_lshl_or_b32 v6, v7, 2, v6
v_mul_u32_u24_e64 v6, s19, v6
v_lshl_add_u32 v6, v4, 4, v6
v_subrev_u32_e64 v28, 0, v6
v_add_u32 v4, 320, v0
v_mul_u32_u24 v5, s18, v4
v_lshrrev_b32 v5, 16, v5
v_mul_u32_u24 v6, 14, v5
v_sub_u32 v4, v4, v6
v_and_b32_e64 v6, 0x13, v5
v_bfe_u32 v7, v5, 2, 1
v_lshl_or_b32 v6, v7, 3, v6
v_bfe_u32 v7, v5, 3, 1
v_lshl_or_b32 v6, v7, 2, v6
v_mul_u32_u24_e64 v6, s19, v6
v_lshl_add_u32 v6, v4, 4, v6
v_subrev_u32 v29, 1024, v6
v_add_u32 v4, 384, v0
v_mul_u32_u24 v5, s18, v4
v_lshrrev_b32 v5, 16, v5
v_mul_u32_u24 v6, 14, v5
v_sub_u32 v4, v4, v6
v_and_b32_e64 v6, 0x13, v5
v_bfe_u32 v7, v5, 2, 1
v_lshl_or_b32 v6, v7, 3, v6
v_bfe_u32 v7, v5, 3, 1
v_lshl_or_b32 v6, v7, 2, v6
v_mul_u32_u24_e64 v6, s19, v6
v_lshl_add_u32 v6, v4, 4, v6
v_subrev_u32 v30, 2048, v6
s_and_b32 s17, s85, 7
s_mul_i32 s18, s17, 224
s_mul_i32 s19, s38, 114688
s_add_u32 s18, s18, s19
s_mul_i32 s19, s38, 7168
v_lshrrev_b32 v5, 3, v0
v_and_b32 v6, 7, v0
v_lshlrev_b32 v7, 1, v2
v_xor_b32 v6, v6, v7
v_lshlrev_b32_e64 v5, 10, v5
v_lshl_add_u32 v32, v6, 4, v5
v_add_u32 v33, 7168, v32
v_add_u32 v34, 14336, v32
v_add_u32 v35, 21504, v32
s_mul_i32 s20, s38, 458752
s_and_b32 s21, s85, 3
s_lshl_b32 s22, s21, 7
s_add_u32 s20, s20, s22
s_lshl_b32 s23, s38, 12
s_mov_b32 s60, 400000
v_mov_b32_e64 v6, 0
L_f_pp:
buffer_load_dwordx2 v[4:5], v6, s[28:31], s45 offen sc1
s_waitcnt vmcnt(0)
s_sub_u32 s60, s60, 1
s_cbranch_scc1 L_f_pp_done
v_readfirstlane_b32 s61, v4
v_readfirstlane_b32 s62, v5
s_nop 0
s_max_u32 s63, s61, s62
s_cmp_lt_u32 s63, 4
s_cbranch_scc1 L_f_pp
L_f_pp_done:
s_cmp_ge_u32 s61, 4
s_cselect_b32 s50, 0, 8388608
s_cselect_b32 s51, 4, 0
s_xor_b32 s52, s50, 8388608
s_add_u32 s50, s50, s40
s_add_u32 s52, s52, s40
s_add_u32 s51, s51, s45
s_min_u32 s63, s61, s62
buffer_load_dwordx4 v[48:51], v16, s[12:15], s50 offen offset:0 sc1 nt
buffer_load_dwordx4 v[52:55], v16, s[12:15], s50 offen offset:1024 sc1 nt
s_add_u32 s50, s50, 2097152
buffer_load_dwordx4 v[56:59], v16, s[12:15], s50 offen offset:0 sc1 nt
buffer_load_dwordx4 v[60:63], v16, s[12:15], s50 offen offset:1024 sc1 nt
s_add_u32 s50, s50, 2097152
buffer_load_dwordx4 v[64:67], v16, s[12:15], s50 offen offset:0 sc1 nt
buffer_load_dwordx4 v[68:71], v16, s[12:15], s50 offen offset:1024 sc1 nt
s_add_u32 s50, s50, 2097152
buffer_load_dwordx4 v[72:75], v16, s[12:15], s50 offen offset:0 sc1 nt
buffer_load_dwordx4 v[76:79], v16, s[12:15], s50 offen offset:1024 sc1 nt
s_cmp_ge_u32 s63, 4
s_cbranch_scc1 L_f_both
s_waitcnt vmcnt(6)
v_lshlrev_b32_e64 v160, 16, v48
v_and_b32 v161, 0xffff0000, v48
v_lshlrev_b32_e64 v162, 16, v49
v_and_b32 v163, 0xffff0000, v49
v_lshlrev_b32_e64 v164, 16, v50
v_and_b32 v165, 0xffff0000, v50
v_lshlrev_b32_e64 v166, 16, v51
v_and_b32 v167, 0xffff0000, v51
v_lshlrev_b32_e64 v168, 16, v52
v_and_b32 v169, 0xffff0000, v52
v_lshlrev_b32_e64 v170, 16, v53
v_and_b32 v171, 0xffff0000, v53
v_lshlrev_b32_e64 v172, 16, v54
v_and_b32 v173, 0xffff0000, v54
v_lshlrev_b32_e64 v174, 16, v55
v_and_b32 v175, 0xffff0000, v55
s_add_u32 m0, s19, 0
s_nop 0
buffer_load_dwordx4 v24, s[92:95], s18 offen offset:0 lds
buffer_load_dwordx4 v25, s[92:95], s18 offen offset:1024 lds
s_waitcnt vmcnt(6)
v_lshlrev_b32 v176, 16, v56
v_and_b32 v177, 0xffff0000, v56
v_lshlrev_b32_e64 v178, 16, v57
v_and_b32 v179, 0xffff0000, v57
v_lshlrev_b32_e64 v180, 16, v58
v_and_b32 v181, 0xffff0000, v58
v_lshlrev_b32_e64 v182, 16, v59
v_and_b32 v183, 0xffff0000, v59
v_lshlrev_b32_e64 v184, 16, v60
v_and_b32 v185, 0xffff0000, v60
v_lshlrev_b32_e64 v186, 16, v61
v_and_b32 v187, 0xffff0000, v61
v_lshlrev_b32_e64 v188, 16, v62
v_and_b32 v189, 0xffff0000, v62
v_lshlrev_b32_e64 v190, 16, v63
v_and_b32 v191, 0xffff0000, v63
v_pk_add_f32 v[160:161], v[160:161], v[176:177]
v_pk_add_f32 v[162:163], v[162:163], v[178:179]
v_pk_add_f32 v[164:165], v[164:165], v[180:181]
v_pk_add_f32 v[166:167], v[166:167], v[182:183]
v_pk_add_f32 v[168:169], v[168:169], v[184:185]
v_pk_add_f32 v[170:171], v[170:171], v[186:187]
v_pk_add_f32 v[172:173], v[172:173], v[188:189]
v_pk_add_f32 v[174:175], v[174:175], v[190:191]
buffer_load_dwordx4 v26, s[92:95], s18 offen offset:2048 lds
buffer_load_dwordx4 v27, s[92:95], s18 offen offset:3072 lds
s_add_u32 m0, s19, 4096
s_nop 0
s_waitcnt vmcnt(6)
v_lshlrev_b32_e64 v176, 16, v64
v_and_b32 v177, 0xffff0000, v64
v_lshlrev_b32_e64 v178, 16, v65
v_and_b32 v179, 0xffff0000, v65
v_lshlrev_b32_e64 v180, 16, v66
v_and_b32 v181, 0xffff0000, v66
v_lshlrev_b32_e64 v182, 16, v67
v_and_b32 v183, 0xffff0000, v67
v_lshlrev_b32_e64 v184, 16, v68
v_and_b32 v185, 0xffff0000, v68
v_lshlrev_b32_e64 v186, 16, v69
v_and_b32 v187, 0xffff0000, v69
v_lshlrev_b32_e64 v188, 16, v70
v_and_b32 v189, 0xffff0000, v70
v_lshlrev_b32_e64 v190, 16, v71
v_and_b32 v191, 0xffff0000, v71
v_pk_add_f32 v[160:161], v[160:161], v[176:177]
v_pk_add_f32 v[162:163], v[162:163], v[178:179]
v_pk_add_f32 v[164:165], v[164:165], v[180:181]
v_pk_add_f32 v[166:167], v[166:167], v[182:183]
v_pk_add_f32 v[168:169], v[168:169], v[184:185]
v_pk_add_f32 v[170:171], v[170:171], v[186:187]
v_pk_add_f32 v[172:173], v[172:173], v[188:189]
v_pk_add_f32 v[174:175], v[174:175], v[190:191]
buffer_load_dwordx4 v28, s[92:95], s18 offen offset:0 lds
buffer_load_dwordx4 v29, s[92:95], s18 offen offset:1024 lds
s_waitcnt vmcnt(6)
v_lshlrev_b32 v176, 16, v72
v_and_b32 v177, 0xffff0000, v72
v_lshlrev_b32_e64 v178, 16, v73
v_and_b32 v179, 0xffff0000, v73
v_lshlrev_b32_e64 v180, 16, v74
v_and_b32 v181, 0xffff0000, v74
v_lshlrev_b32_e64 v182, 16, v75
v_and_b32 v183, 0xffff0000, v75
v_lshlrev_b32_e64 v184, 16, v76
v_and_b32 v185, 0xffff0000, v76
v_lshlrev_b32_e64 v186, 16, v77
v_and_b32 v187, 0xffff0000, v77
v_lshlrev_b32_e64 v188, 16, v78
v_and_b32 v189, 0xffff0000, v78
v_lshlrev_b32_e64 v190, 16, v79
v_and_b32 v191, 0xffff0000, v79
v_pk_add_f32 v[160:161], v[160:161], v[176:177]
v_pk_add_f32 v[162:163], v[162:163], v[178:179]
v_pk_add_f32 v[164:165], v[164:165], v[180:181]
v_pk_add_f32 v[166:167], v[166:167], v[182:183]
v_pk_add_f32 v[168:169], v[168:169], v[184:185]
v_pk_add_f32 v[170:171], v[170:171], v[186:187]
v_pk_add_f32 v[172:173], v[172:173], v[188:189]
v_pk_add_f32 v[174:175], v[174:175], v[190:191]
buffer_load_dwordx4 v30, s[92:95], s18 offen offset:2048 lds
s_add_u32 s18, s18, 458752
s_add_u32 m0, s19, 28672
s_nop 0
buffer_load_dwordx4 v24, s[92:95], s18 offen offset:0 lds
s_mov_b32 s60, 400000
v_mov_b32 v6, 0
L_f_pq:
buffer_load_dword v4, v6, s[28:31], s51 offen sc1
s_waitcnt vmcnt(0)
s_sub_u32 s60, s60, 1
s_cbranch_scc1 L_f_pq_done
v_readfirstlane_b32 s61, v4
s_nop 0
s_cmp_lt_u32 s61, 4
s_cbranch_scc1 L_f_pq
L_f_pq_done:
buffer_load_dwordx4 v[80:83], v16, s[12:15], s52 offen offset:0 sc1 nt
buffer_load_dwordx4 v[84:87], v16, s[12:15], s52 offen offset:1024 sc1 nt
s_add_u32 s52, s52, 2097152
buffer_load_dwordx4 v[88:91], v16, s[12:15], s52 offen offset:0 sc1 nt
buffer_load_dwordx4 v[92:95], v16, s[12:15], s52 offen offset:1024 sc1 nt
s_add_u32 s52, s52, 2097152
buffer_load_dwordx4 v[96:99], v16, s[12:15], s52 offen offset:0 sc1 nt
buffer_load_dwordx4 v[100:103], v16, s[12:15], s52 offen offset:1024 sc1 nt
s_add_u32 s52, s52, 2097152
buffer_load_dwordx4 v[104:107], v16, s[12:15], s52 offen offset:0 sc1 nt
buffer_load_dwordx4 v[108:111], v16, s[12:15], s52 offen offset:1024 sc1 nt
s_waitcnt vmcnt(6)
v_lshlrev_b32_e64 v192, 16, v80
v_and_b32 v193, 0xffff0000, v80
v_lshlrev_b32_e64 v194, 16, v81
v_and_b32 v195, 0xffff0000, v81
v_lshlrev_b32_e64 v196, 16, v82
v_and_b32 v197, 0xffff0000, v82
v_lshlrev_b32_e64 v198, 16, v83
v_and_b32 v199, 0xffff0000, v83
v_lshlrev_b32_e64 v200, 16, v84
v_and_b32 v201, 0xffff0000, v84
v_lshlrev_b32_e64 v202, 16, v85
v_and_b32 v203, 0xffff0000, v85
v_lshlrev_b32_e64 v204, 16, v86
v_and_b32 v205, 0xffff0000, v86
v_lshlrev_b32_e64 v206, 16, v87
v_and_b32 v207, 0xffff0000, v87
s_waitcnt vmcnt(4)
v_lshlrev_b32 v176, 16, v88
v_and_b32 v177, 0xffff0000, v88
v_lshlrev_b32_e64 v178, 16, v89
v_and_b32 v179, 0xffff0000, v89
v_lshlrev_b32_e64 v180, 16, v90
v_and_b32 v181, 0xffff0000, v90
v_lshlrev_b32_e64 v182, 16, v91
v_and_b32 v183, 0xffff0000, v91
v_lshlrev_b32_e64 v184, 16, v92
v_and_b32 v185, 0xffff0000, v92
v_lshlrev_b32_e64 v186, 16, v93
v_and_b32 v187, 0xffff0000, v93
v_lshlrev_b32_e64 v188, 16, v94
v_and_b32 v189, 0xffff0000, v94
v_lshlrev_b32_e64 v190, 16, v95
v_and_b32 v191, 0xffff0000, v95
v_pk_add_f32 v[192:193], v[192:193], v[176:177]
v_pk_add_f32 v[194:195], v[194:195], v[178:179]
v_pk_add_f32 v[196:197], v[196:197], v[180:181]
v_pk_add_f32 v[198:199], v[198:199], v[182:183]
v_pk_add_f32 v[200:201], v[200:201], v[184:185]
v_pk_add_f32 v[202:203], v[202:203], v[186:187]
v_pk_add_f32 v[204:205], v[204:205], v[188:189]
v_pk_add_f32 v[206:207], v[206:207], v[190:191]
s_waitcnt vmcnt(2)
v_lshlrev_b32 v176, 16, v96
v_and_b32 v177, 0xffff0000, v96
v_lshlrev_b32_e64 v178, 16, v97
v_and_b32 v179, 0xffff0000, v97
v_lshlrev_b32_e64 v180, 16, v98
v_and_b32 v181, 0xffff0000, v98
v_lshlrev_b32_e64 v182, 16, v99
v_and_b32 v183, 0xffff0000, v99
v_lshlrev_b32_e64 v184, 16, v100
v_and_b32 v185, 0xffff0000, v100
v_lshlrev_b32_e64 v186, 16, v101
v_and_b32 v187, 0xffff0000, v101
v_lshlrev_b32_e64 v188, 16, v102
v_and_b32 v189, 0xffff0000, v102
v_lshlrev_b32_e64 v190, 16, v103
v_and_b32 v191, 0xffff0000, v103
v_pk_add_f32 v[192:193], v[192:193], v[176:177]
v_pk_add_f32 v[194:195], v[194:195], v[178:179]
v_pk_add_f32 v[196:197], v[196:197], v[180:181]
v_pk_add_f32 v[198:199], v[198:199], v[182:183]
v_pk_add_f32 v[200:201], v[200:201], v[184:185]
v_pk_add_f32 v[202:203], v[202:203], v[186:187]
v_pk_add_f32 v[204:205], v[204:205], v[188:189]
v_pk_add_f32 v[206:207], v[206:207], v[190:191]
s_waitcnt vmcnt(0)
v_lshlrev_b32 v176, 16, v104
v_and_b32 v177, 0xffff0000, v104
v_lshlrev_b32_e64 v178, 16, v105
v_and_b32 v179, 0xffff0000, v105
v_lshlrev_b32_e64 v180, 16, v106
v_and_b32 v181, 0xffff0000, v106
v_lshlrev_b32_e64 v182, 16, v107
v_and_b32 v183, 0xffff0000, v107
v_lshlrev_b32_e64 v184, 16, v108
v_and_b32 v185, 0xffff0000, v108
v_lshlrev_b32_e64 v186, 16, v109
v_and_b32 v187, 0xffff0000, v109
v_lshlrev_b32_e64 v188, 16, v110
v_and_b32 v189, 0xffff0000, v110
v_lshlrev_b32_e64 v190, 16, v111
v_and_b32 v191, 0xffff0000, v111
v_pk_add_f32 v[192:193], v[192:193], v[176:177]
v_pk_add_f32 v[194:195], v[194:195], v[178:179]
v_pk_add_f32 v[196:197], v[196:197], v[180:181]
v_pk_add_f32 v[198:199], v[198:199], v[182:183]
v_pk_add_f32 v[200:201], v[200:201], v[184:185]
v_pk_add_f32 v[202:203], v[202:203], v[186:187]
v_pk_add_f32 v[204:205], v[204:205], v[188:189]
v_pk_add_f32 v[206:207], v[206:207], v[190:191]
s_branch L_f_summed
L_f_both:
buffer_load_dwordx4 v[80:83], v16, s[12:15], s52 offen offset:0 sc1 nt
buffer_load_dwordx4 v[84:87], v16, s[12:15], s52 offen offset:1024 sc1 nt
s_add_u32 s52, s52, 2097152
buffer_load_dwordx4 v[88:91], v16, s[12:15], s52 offen offset:0 sc1 nt
buffer_load_dwordx4 v[92:95], v16, s[12:15], s52 offen offset:1024 sc1 nt
s_add_u32 s52, s52, 2097152
buffer_load_dwordx4 v[96:99], v16, s[12:15], s52 offen offset:0 sc1 nt
buffer_load_dwordx4 v[100:103], v16, s[12:15], s52 offen offset:1024 sc1 nt
s_add_u32 s52, s52, 2097152
buffer_load_dwordx4 v[104:107], v16, s[12:15], s52 offen offset:0 sc1 nt
buffer_load_dwordx4 v[108:111], v16, s[12:15], s52 offen offset:1024 sc1 nt
s_waitcnt vmcnt(14)
v_lshlrev_b32_e64 v160, 16, v48
v_and_b32 v161, 0xffff0000, v48
v_lshlrev_b32_e64 v162, 16, v49
v_and_b32 v163, 0xffff0000, v49
v_lshlrev_b32_e64 v164, 16, v50
v_and_b32 v165, 0xffff0000, v50
v_lshlrev_b32_e64 v166, 16, v51
v_and_b32 v167, 0xffff0000, v51
v_lshlrev_b32_e64 v168, 16, v52
v_and_b32 v169, 0xffff0000, v52
v_lshlrev_b32_e64 v170, 16, v53
v_and_b32 v171, 0xffff0000, v53
v_lshlrev_b32_e64 v172, 16, v54
v_and_b32 v173, 0xffff0000, v54
v_lshlrev_b32_e64 v174, 16, v55
v_and_b32 v175, 0xffff0000, v55
s_waitcnt vmcnt(12)
v_lshlrev_b32 v176, 16, v56
v_and_b32 v177, 0xffff0000, v56
v_lshlrev_b32_e64 v178, 16, v57
v_and_b32 v179, 0xffff0000, v57
v_lshlrev_b32_e64 v180, 16, v58
v_and_b32 v181, 0xffff0000, v58
v_lshlrev_b32_e64 v182, 16, v59
v_and_b32 v183, 0xffff0000, v59
v_lshlrev_b32_e64 v184, 16, v60
v_and_b32 v185, 0xffff0000, v60
v_lshlrev_b32_e64 v186, 16, v61
v_and_b32 v187, 0xffff0000, v61
v_lshlrev_b32_e64 v188, 16, v62
v_and_b32 v189, 0xffff0000, v62
v_lshlrev_b32_e64 v190, 16, v63
v_and_b32 v191, 0xffff0000, v63
v_pk_add_f32 v[160:161], v[160:161], v[176:177]
v_pk_add_f32 v[162:163], v[162:163], v[178:179]
v_pk_add_f32 v[164:165], v[164:165], v[180:181]
v_pk_add_f32 v[166:167], v[166:167], v[182:183]
v_pk_add_f32 v[168:169], v[168:169], v[184:185]
v_pk_add_f32 v[170:171], v[170:171], v[186:187]
v_pk_add_f32 v[172:173], v[172:173], v[188:189]
v_pk_add_f32 v[174:175], v[174:175], v[190:191]
s_waitcnt vmcnt(10)
v_lshlrev_b32 v176, 16, v64
v_and_b32 v177, 0xffff0000, v64
v_lshlrev_b32_e64 v178, 16, v65
v_and_b32 v179, 0xffff0000, v65
v_lshlrev_b32_e64 v180, 16, v66
v_and_b32 v181, 0xffff0000, v66
v_lshlrev_b32_e64 v182, 16, v67
v_and_b32 v183, 0xffff0000, v67
v_lshlrev_b32_e64 v184, 16, v68
v_and_b32 v185, 0xffff0000, v68
v_lshlrev_b32_e64 v186, 16, v69
v_and_b32 v187, 0xffff0000, v69
v_lshlrev_b32_e64 v188, 16, v70
v_and_b32 v189, 0xffff0000, v70
v_lshlrev_b32_e64 v190, 16, v71
v_and_b32 v191, 0xffff0000, v71
v_pk_add_f32 v[160:161], v[160:161], v[176:177]
v_pk_add_f32 v[162:163], v[162:163], v[178:179]
v_pk_add_f32 v[164:165], v[164:165], v[180:181]
v_pk_add_f32 v[166:167], v[166:167], v[182:183]
v_pk_add_f32 v[168:169], v[168:169], v[184:185]
v_pk_add_f32 v[170:171], v[170:171], v[186:187]
v_pk_add_f32 v[172:173], v[172:173], v[188:189]
v_pk_add_f32 v[174:175], v[174:175], v[190:191]
s_waitcnt vmcnt(8)
v_lshlrev_b32 v176, 16, v72
v_and_b32 v177, 0xffff0000, v72
v_lshlrev_b32_e64 v178, 16, v73
v_and_b32 v179, 0xffff0000, v73
v_lshlrev_b32_e64 v180, 16, v74
v_and_b32 v181, 0xffff0000, v74
v_lshlrev_b32_e64 v182, 16, v75
v_and_b32 v183, 0xffff0000, v75
v_lshlrev_b32_e64 v184, 16, v76
v_and_b32 v185, 0xffff0000, v76
v_lshlrev_b32_e64 v186, 16, v77
v_and_b32 v187, 0xffff0000, v77
v_lshlrev_b32_e64 v188, 16, v78
v_and_b32 v189, 0xffff0000, v78
v_lshlrev_b32_e64 v190, 16, v79
v_and_b32 v191, 0xffff0000, v79
v_pk_add_f32 v[160:161], v[160:161], v[176:177]
v_pk_add_f32 v[162:163], v[162:163], v[178:179]
v_pk_add_f32 v[164:165], v[164:165], v[180:181]
v_pk_add_f32 v[166:167], v[166:167], v[182:183]
v_pk_add_f32 v[168:169], v[168:169], v[184:185]
v_pk_add_f32 v[170:171], v[170:171], v[186:187]
v_pk_add_f32 v[172:173], v[172:173], v[188:189]
v_pk_add_f32 v[174:175], v[174:175], v[190:191]
s_waitcnt vmcnt(6)
v_lshlrev_b32 v192, 16, v80
v_and_b32 v193, 0xffff0000, v80
v_lshlrev_b32_e64 v194, 16, v81
v_and_b32 v195, 0xffff0000, v81
v_lshlrev_b32_e64 v196, 16, v82
v_and_b32 v197, 0xffff0000, v82
v_lshlrev_b32_e64 v198, 16, v83
v_and_b32 v199, 0xffff0000, v83
v_lshlrev_b32_e64 v200, 16, v84
v_and_b32 v201, 0xffff0000, v84
v_lshlrev_b32_e64 v202, 16, v85
v_and_b32 v203, 0xffff0000, v85
v_lshlrev_b32_e64 v204, 16, v86
v_and_b32 v205, 0xffff0000, v86
v_lshlrev_b32_e64 v206, 16, v87
v_and_b32 v207, 0xffff0000, v87
s_add_u32 m0, s19, 0
s_nop 0
buffer_load_dwordx4 v24, s[92:95], s18 offen offset:0 lds
buffer_load_dwordx4 v25, s[92:95], s18 offen offset:1024 lds
s_waitcnt vmcnt(6)
v_lshlrev_b32 v176, 16, v88
v_and_b32 v177, 0xffff0000, v88
v_lshlrev_b32_e64 v178, 16, v89
v_and_b32 v179, 0xffff0000, v89
v_lshlrev_b32_e64 v180, 16, v90
v_and_b32 v181, 0xffff0000, v90
v_lshlrev_b32_e64 v182, 16, v91
v_and_b32 v183, 0xffff0000, v91
v_lshlrev_b32_e64 v184, 16, v92
v_and_b32 v185, 0xffff0000, v92
v_lshlrev_b32_e64 v186, 16, v93
v_and_b32 v187, 0xffff0000, v93
v_lshlrev_b32_e64 v188, 16, v94
v_and_b32 v189, 0xffff0000, v94
v_lshlrev_b32_e64 v190, 16, v95
v_and_b32 v191, 0xffff0000, v95
v_pk_add_f32 v[192:193], v[192:193], v[176:177]
v_pk_add_f32 v[194:195], v[194:195], v[178:179]
v_pk_add_f32 v[196:197], v[196:197], v[180:181]
v_pk_add_f32 v[198:199], v[198:199], v[182:183]
v_pk_add_f32 v[200:201], v[200:201], v[184:185]
v_pk_add_f32 v[202:203], v[202:203], v[186:187]
v_pk_add_f32 v[204:205], v[204:205], v[188:189]
v_pk_add_f32 v[206:207], v[206:207], v[190:191]
buffer_load_dwordx4 v26, s[92:95], s18 offen offset:2048 lds
buffer_load_dwordx4 v27, s[92:95], s18 offen offset:3072 lds
s_add_u32 m0, s19, 4096
s_nop 0
s_waitcnt vmcnt(6)
v_lshlrev_b32_e64 v176, 16, v96
v_and_b32 v177, 0xffff0000, v96
v_lshlrev_b32_e64 v178, 16, v97
v_and_b32 v179, 0xffff0000, v97
v_lshlrev_b32_e64 v180, 16, v98
v_and_b32 v181, 0xffff0000, v98
v_lshlrev_b32_e64 v182, 16, v99
v_and_b32 v183, 0xffff0000, v99
v_lshlrev_b32_e64 v184, 16, v100
v_and_b32 v185, 0xffff0000, v100
v_lshlrev_b32_e64 v186, 16, v101
v_and_b32 v187, 0xffff0000, v101
v_lshlrev_b32_e64 v188, 16, v102
v_and_b32 v189, 0xffff0000, v102
v_lshlrev_b32_e64 v190, 16, v103
v_and_b32 v191, 0xffff0000, v103
v_pk_add_f32 v[192:193], v[192:193], v[176:177]
v_pk_add_f32 v[194:195], v[194:195], v[178:179]
v_pk_add_f32 v[196:197], v[196:197], v[180:181]
v_pk_add_f32 v[198:199], v[198:199], v[182:183]
v_pk_add_f32 v[200:201], v[200:201], v[184:185]
v_pk_add_f32 v[202:203], v[202:203], v[186:187]
v_pk_add_f32 v[204:205], v[204:205], v[188:189]
v_pk_add_f32 v[206:207], v[206:207], v[190:191]
buffer_load_dwordx4 v28, s[92:95], s18 offen offset:0 lds
buffer_load_dwordx4 v29, s[92:95], s18 offen offset:1024 lds
s_waitcnt vmcnt(6)
v_lshlrev_b32 v176, 16, v104
v_and_b32 v177, 0xffff0000, v104
v_lshlrev_b32_e64 v178, 16, v105
v_and_b32 v179, 0xffff0000, v105
v_lshlrev_b32_e64 v180, 16, v106
v_and_b32 v181, 0xffff0000, v106
v_lshlrev_b32_e64 v182, 16, v107
v_and_b32 v183, 0xffff0000, v107
v_lshlrev_b32_e64 v184, 16, v108
v_and_b32 v185, 0xffff0000, v108
v_lshlrev_b32_e64 v186, 16, v109
v_and_b32 v187, 0xffff0000, v109
v_lshlrev_b32_e64 v188, 16, v110
v_and_b32 v189, 0xffff0000, v110
v_lshlrev_b32_e64 v190, 16, v111
v_and_b32 v191, 0xffff0000, v111
v_pk_add_f32 v[192:193], v[192:193], v[176:177]
v_pk_add_f32 v[194:195], v[194:195], v[178:179]
v_pk_add_f32 v[196:197], v[196:197], v[180:181]
v_pk_add_f32 v[198:199], v[198:199], v[182:183]
v_pk_add_f32 v[200:201], v[200:201], v[184:185]
v_pk_add_f32 v[202:203], v[202:203], v[186:187]
v_pk_add_f32 v[204:205], v[204:205], v[188:189]
v_pk_add_f32 v[206:207], v[206:207], v[190:191]
buffer_load_dwordx4 v30, s[92:95], s18 offen offset:2048 lds
s_add_u32 s18, s18, 458752
s_add_u32 m0, s19, 28672
s_nop 0
buffer_load_dwordx4 v24, s[92:95], s18 offen offset:0 lds
L_f_summed:
v_pk_add_f32 v[160:161], v[160:161], v[192:193]
v_pk_add_f32 v[162:163], v[162:163], v[194:195]
v_pk_add_f32 v[164:165], v[164:165], v[196:197]
v_pk_add_f32 v[166:167], v[166:167], v[198:199]
v_pk_add_f32 v[168:169], v[168:169], v[200:201]
v_pk_add_f32 v[170:171], v[170:171], v[202:203]
v_pk_add_f32 v[172:173], v[172:173], v[204:205]
v_pk_add_f32 v[174:175], v[174:175], v[206:207]
v_lshlrev_b32 v176, 16, v40
v_and_b32 v177, 0xffff0000, v40
v_lshlrev_b32_e64 v178, 16, v41
v_and_b32 v179, 0xffff0000, v41
v_lshlrev_b32_e64 v180, 16, v42
v_and_b32 v181, 0xffff0000, v42
v_lshlrev_b32_e64 v182, 16, v43
v_and_b32 v183, 0xffff0000, v43
v_lshlrev_b32_e64 v184, 16, v44
v_and_b32 v185, 0xffff0000, v44
v_lshlrev_b32_e64 v186, 16, v45
v_and_b32 v187, 0xffff0000, v45
v_lshlrev_b32_e64 v188, 16, v46
v_and_b32 v189, 0xffff0000, v46
v_lshlrev_b32_e64 v190, 16, v47
v_and_b32 v191, 0xffff0000, v47
v_pk_fma_f32 v[160:161], v[160:161], v[112:113], v[176:177]
v_pk_fma_f32 v[162:163], v[162:163], v[114:115], v[178:179]
v_pk_fma_f32 v[164:165], v[164:165], v[116:117], v[180:181]
v_pk_fma_f32 v[166:167], v[166:167], v[118:119], v[182:183]
v_pk_fma_f32 v[168:169], v[168:169], v[120:121], v[184:185]
v_pk_fma_f32 v[170:171], v[170:171], v[122:123], v[186:187]
v_pk_fma_f32 v[172:173], v[172:173], v[124:125], v[188:189]
v_pk_fma_f32 v[174:175], v[174:175], v[126:127], v[190:191]
v_cvt_pk_bf16_f32 v48, v160, v161
v_cvt_pk_bf16_f32 v49, v162, v163
v_cvt_pk_bf16_f32 v50, v164, v165
v_cvt_pk_bf16_f32 v51, v166, v167
v_cvt_pk_bf16_f32 v52, v168, v169
v_cvt_pk_bf16_f32 v53, v170, v171
v_cvt_pk_bf16_f32 v54, v172, v173
v_cvt_pk_bf16_f32 v55, v174, v175
s_add_u32 s41, s40, 1048576
v_lshlrev_b32_e64 v160, 16, v48
v_and_b32 v161, 0xffff0000, v48
v_lshlrev_b32_e64 v162, 16, v49
v_and_b32 v163, 0xffff0000, v49
v_lshlrev_b32_e64 v164, 16, v50
v_and_b32 v165, 0xffff0000, v50
v_lshlrev_b32_e64 v166, 16, v51
v_and_b32 v167, 0xffff0000, v51
v_lshlrev_b32_e64 v168, 16, v52
v_and_b32 v169, 0xffff0000, v52
v_lshlrev_b32_e64 v170, 16, v53
v_and_b32 v171, 0xffff0000, v53
v_lshlrev_b32_e64 v172, 16, v54
v_and_b32 v173, 0xffff0000, v54
v_lshlrev_b32_e64 v174, 16, v55
v_and_b32 v175, 0xffff0000, v55
buffer_store_dwordx4 v[48:51], v16, s[28:31], s41 offen offset:0 sc1
buffer_store_dwordx4 v[52:55], v16, s[28:31], s41 offen offset:1024 sc1
v_pk_add_f32 v[176:177], v[160:161], v[168:169]
v_pk_add_f32 v[178:179], v[162:163], v[170:171]
v_pk_add_f32 v[180:181], v[164:165], v[172:173]
v_pk_add_f32 v[182:183], v[166:167], v[174:175]
v_pk_add_f32 v[176:177], v[176:177], v[178:179]
v_pk_add_f32 v[180:181], v[180:181], v[182:183]
v_pk_add_f32 v[176:177], v[176:177], v[180:181]
v_add_f32 v6, v176, v177
s_nop 1
v_add_f32_dpp v6, v6, v6 row_ror:2 row_mask:0xf bank_mask:0xf
s_nop 1
v_add_f32_dpp v6, v6, v6 row_ror:4 row_mask:0xf bank_mask:0xf
s_nop 1
v_add_f32_dpp v6, v6, v6 row_ror:8 row_mask:0xf bank_mask:0xf
v_mov_b32 v7, v6
s_nop 1
v_permlane32_swap_b32 v7, v6
s_nop 0
v_add_f32 v6, v6, v7
v_mov_b32 v7, v6
s_nop 1
v_permlane16_swap_b32 v7, v6
s_nop 0
v_add_f32 v6, v6, v7
v_mul_f32 v6, 0xbb000000, v6
v_pk_add_f32 v[160:161], v[160:161], v[6:7] op_sel_hi:[1,0]
v_pk_add_f32 v[162:163], v[162:163], v[6:7] op_sel_hi:[1,0]
v_pk_add_f32 v[164:165], v[164:165], v[6:7] op_sel_hi:[1,0]
v_pk_add_f32 v[166:167], v[166:167], v[6:7] op_sel_hi:[1,0]
v_pk_add_f32 v[168:169], v[168:169], v[6:7] op_sel_hi:[1,0]
v_pk_add_f32 v[170:171], v[170:171], v[6:7] op_sel_hi:[1,0]
v_pk_add_f32 v[172:173], v[172:173], v[6:7] op_sel_hi:[1,0]
v_pk_add_f32 v[174:175], v[174:175], v[6:7] op_sel_hi:[1,0]
v_pk_mul_f32 v[176:177], v[160:161], v[160:161]
v_pk_mul_f32 v[178:179], v[162:163], v[162:163]
v_pk_mul_f32 v[180:181], v[164:165], v[164:165]
v_pk_mul_f32 v[182:183], v[166:167], v[166:167]
v_pk_fma_f32 v[176:177], v[168:169], v[168:169], v[176:177]
v_pk_fma_f32 v[178:179], v[170:171], v[170:171], v[178:179]
v_pk_fma_f32 v[180:181], v[172:173], v[172:173], v[180:181]
v_pk_fma_f32 v[182:183], v[174:175], v[174:175], v[182:183]
v_pk_add_f32 v[176:177], v[176:177], v[178:179]
v_pk_add_f32 v[180:181], v[180:181], v[182:183]
v_pk_add_f32 v[176:177], v[176:177], v[180:181]
v_add_f32 v6, v176, v177
s_nop 1
v_add_f32_dpp v6, v6, v6 row_ror:2 row_mask:0xf bank_mask:0xf
s_nop 1
v_add_f32_dpp v6, v6, v6 row_ror:4 row_mask:0xf bank_mask:0xf
s_nop 1
v_add_f32_dpp v6, v6, v6 row_ror:8 row_mask:0xf bank_mask:0xf
v_mov_b32 v7, v6
s_nop 1
v_permlane32_swap_b32 v7, v6
s_nop 0
v_add_f32 v6, v6, v7
v_mov_b32 v7, v6
s_nop 1
v_permlane16_swap_b32 v7, v6
s_nop 0
v_add_f32 v6, v6, v7
v_mov_b32 v7, 0x3727c5ac
v_fmac_f32 v7, 0x3b000000, v6
v_rsq_f32_e64 v6, v7
s_add_u32 s41, s42, 8192
v_pk_mul_f32 v[160:161], v[160:161], v[6:7] op_sel_hi:[1,0]
v_pk_mul_f32 v[162:163], v[162:163], v[6:7] op_sel_hi:[1,0]
v_pk_mul_f32 v[164:165], v[164:165], v[6:7] op_sel_hi:[1,0]
v_pk_mul_f32 v[166:167], v[166:167], v[6:7] op_sel_hi:[1,0]
v_pk_mul_f32 v[168:169], v[168:169], v[6:7] op_sel_hi:[1,0]
v_pk_mul_f32 v[170:171], v[170:171], v[6:7] op_sel_hi:[1,0]
v_pk_mul_f32 v[172:173], v[172:173], v[6:7] op_sel_hi:[1,0]
v_pk_mul_f32 v[174:175], v[174:175], v[6:7] op_sel_hi:[1,0]
v_pk_fma_f32 v[160:161], v[160:161], v[128:129], v[144:145]
v_pk_fma_f32 v[162:163], v[162:163], v[130:131], v[146:147]
v_pk_fma_f32 v[164:165], v[164:165], v[132:133], v[148:149]
v_pk_fma_f32 v[166:167], v[166:167], v[134:135], v[150:151]
v_pk_fma_f32 v[168:169], v[168:169], v[136:137], v[152:153]
v_pk_fma_f32 v[170:171], v[170:171], v[138:139], v[154:155]
v_pk_fma_f32 v[172:173], v[172:173], v[140:141], v[156:157]
v_pk_fma_f32 v[174:175], v[174:175], v[142:143], v[158:159]
v_cvt_pk_bf16_f32 v56, v160, v161
v_cvt_pk_bf16_f32 v57, v162, v163
v_cvt_pk_bf16_f32 v58, v164, v165
v_cvt_pk_bf16_f32 v59, v166, v167
v_cvt_pk_bf16_f32 v60, v168, v169
v_cvt_pk_bf16_f32 v61, v170, v171
v_cvt_pk_bf16_f32 v62, v172, v173
v_cvt_pk_bf16_f32 v63, v174, v175
ds_write_b128 v21, v[56:59] offset:0
ds_write_b128 v21, v[60:63] offset:1024
s_waitcnt lgkmcnt(0)
s_barrier
ds_read_b128 v[64:67], v22 offset:0
ds_read_b128 v[68:71], v22 offset:1024
s_waitcnt lgkmcnt(1)
buffer_store_dwordx4 v[64:67], v23, s[28:31], s42 offen sc1
s_waitcnt lgkmcnt(0)
buffer_store_dwordx4 v[68:71], v23, s[28:31], s41 offen sc1
s_waitcnt vmcnt(0)
s_barrier
s_cmp_lg_u32 s38, 0
s_cbranch_scc1 L_f_sigh2
s_mov_b64 exec, 1
v_mov_b32 v4, 0
v_mov_b32_e64 v5, 1
buffer_atomic_add v5, v4, s[28:31], s46 offen sc1
s_mov_b64 exec, -1
L_f_sigh2:
buffer_load_dwordx4 v25, s[92:95], s18 offen offset:1024 lds
buffer_load_dwordx4 v26, s[92:95], s18 offen offset:2048 lds
buffer_load_dwordx4 v27, s[92:95], s18 offen offset:3072 lds
s_add_u32 m0, s19, 32768
s_nop 0
buffer_load_dwordx4 v28, s[92:95], s18 offen offset:0 lds
buffer_load_dwordx4 v29, s[92:95], s18 offen offset:1024 lds
buffer_load_dwordx4 v30, s[92:95], s18 offen offset:2048 lds
s_add_u32 s18, s18, 458752
s_add_u32 m0, s19, 57344
s_nop 0
buffer_load_dwordx4 v24, s[92:95], s18 offen offset:0 lds
buffer_load_dwordx4 v25, s[92:95], s18 offen offset:1024 lds
buffer_load_dwordx4 v26, s[92:95], s18 offen offset:2048 lds
buffer_load_dwordx4 v27, s[92:95], s18 offen offset:3072 lds
s_add_u32 m0, s19, 61440
s_nop 0
buffer_load_dwordx4 v28, s[92:95], s18 offen offset:0 lds
buffer_load_dwordx4 v29, s[92:95], s18 offen offset:1024 lds
buffer_load_dwordx4 v30, s[92:95], s18 offen offset:2048 lds
s_add_u32 s18, s18, 458752
s_add_u32 m0, s19, 86016
s_nop 0
buffer_load_dwordx4 v24, s[92:95], s18 offen offset:0 lds
buffer_load_dwordx4 v25, s[92:95], s18 offen offset:1024 lds
buffer_load_dwordx4 v26, s[92:95], s18 offen offset:2048 lds
buffer_load_dwordx4 v27, s[92:95], s18 offen offset:3072 lds
s_add_u32 m0, s19, 90112
s_nop 0
buffer_load_dwordx4 v28, s[92:95], s18 offen offset:0 lds
buffer_load_dwordx4 v29, s[92:95], s18 offen offset:1024 lds
buffer_load_dwordx4 v30, s[92:95], s18 offen offset:2048 lds
v_lshrrev_b32 v4, 1, v2
v_lshlrev_b32 v4, 4, v4
v_and_b32_e64 v5, 1, v2
v_lshl_add_u32 v4, v5, 2, v4
v_lshrrev_b32 v5, 2, v1
v_add_u32 v4, v4, v5
v_mul_u32_u24 v4, 0xe0, v4
v_and_b32_e64 v5, 3, v1
v_lshl_add_u32 v36, v5, 3, v4
v_add_u32 v37, 57344, v36
v_lshlrev_b32 v38, 3, v0
s_lshl_b32 s25, s16, 17
s_lshl_b32 s26, s38, 15
s_add_u32 s25, s25, s26
s_add_u32 s25, s25, 4194304
s_add_u32 s49, s25, 0
s_add_u32 s50, s25, 16384
s_add_u32 s51, s25, 4096
s_add_u32 s52, s25, 20480
s_add_u32 s53, s25, 8192
s_add_u32 s54, s25, 24576
s_add_u32 s55, s25, 12288
s_add_u32 s56, s25, 28672
s_and_b32 s26, s84, 1
s_lshl_b32 s27, s26, 3
s_add_u32 s27, s27, s17
s_lshl_b32 s32, s16, 2
s_add_u32 s32, s32, s38
s_lshl_b32 s32, s32, 4
s_add_u32 s32, s32, s27
s_mul_i32 s32, s32, 7168
s_add_u32 s32, s32, 8388608
s_add_u32 s33, s32, 3072
s_cmp_lg_u32 s38, 0
s_cbranch_scc1 L_f_ph2_done
s_mov_b32 s60, 400000
v_mov_b32_e64 v6, 0
L_f_ph2:
buffer_load_dword v4, v6, s[28:31], s47 offen sc1
s_waitcnt vmcnt(0)
s_sub_u32 s60, s60, 1
s_cbranch_scc1 L_f_ph2_done
v_readfirstlane_b32 s61, v4
s_nop 0
s_cmp_lt_u32 s61, 16
s_cbranch_scc1 L_f_ph2
L_f_ph2_done:
s_waitcnt vmcnt(0)
s_barrier
s_nop 0
buffer_load_dwordx4 a[0:3], v16, s[28:31], s49 offen offset:0 sc1
buffer_load_dwordx4 a[4:7], v16, s[28:31], s50 offen offset:0 sc1
buffer_load_dwordx4 a[8:11], v16, s[28:31], s49 offen offset:1024 sc1
buffer_load_dwordx4 a[12:15], v16, s[28:31], s50 offen offset:1024 sc1
buffer_load_dwordx4 a[16:19], v16, s[28:31], s49 offen offset:2048 sc1
buffer_load_dwordx4 a[20:23], v16, s[28:31], s50 offen offset:2048 sc1
buffer_load_dwordx4 a[24:27], v16, s[28:31], s49 offen offset:3072 sc1
buffer_load_dwordx4 a[28:31], v16, s[28:31], s50 offen offset:3072 sc1
ds_read_b64_tr_b16 v[112:113], v36 offset:0
ds_read_b64_tr_b16 v[114:115], v36 offset:1792
ds_read_b64_tr_b16 v[116:117], v36 offset:7168
ds_read_b64_tr_b16 v[118:119], v36 offset:8960
ds_read_b64_tr_b16 v[120:121], v36 offset:32
ds_read_b64_tr_b16 v[122:123], v36 offset:1824
ds_read_b64_tr_b16 v[124:125], v36 offset:7200
ds_read_b64_tr_b16 v[126:127], v36 offset:8992
ds_read_b64_tr_b16 v[128:129], v36 offset:64
ds_read_b64_tr_b16 v[130:131], v36 offset:1856
ds_read_b64_tr_b16 v[132:133], v36 offset:7232
ds_read_b64_tr_b16 v[134:135], v36 offset:9024
s_waitcnt vmcnt(4) lgkmcnt(8)
v_mfma_f32_16x16x32_bf16 v[48:51], v[112:115], a[0:3], 0
buffer_load_dwordx4 a[32:35], v16, s[28:31], s51 offen offset:0 sc1
v_mfma_f32_16x16x32_bf16 v[48:51], v[116:119], a[8:11], v[48:51]
v_mfma_f32_16x16x32_bf16 v[52:55], v[116:119], a[12:15], 0
ds_read_b64_tr_b16 v[136:137], v36 offset:96
ds_read_b64_tr_b16 v[138:139], v36 offset:1888
v_mfma_f32_16x16x32_bf16 v[52:55], v[112:115], a[4:7], v[52:55]
ds_read_b64_tr_b16 v[140:141], v36 offset:7264
s_waitcnt lgkmcnt(7)
v_mfma_f32_16x16x32_bf16 v[56:59], v[120:123], a[0:3], 0
buffer_load_dwordx4 a[36:39], v16, s[28:31], s52 offen offset:0 sc1
v_mfma_f32_16x16x32_bf16 v[56:59], v[124:127], a[8:11], v[56:59]
ds_read_b64_tr_b16 v[142:143], v36 offset:9056
v_mfma_f32_16x16x32_bf16 v[60:63], v[124:127], a[12:15], 0
ds_read_b64_tr_b16 v[144:145], v36 offset:128
ds_read_b64_tr_b16 v[146:147], v36 offset:1920
v_mfma_f32_16x16x32_bf16 v[60:63], v[120:123], a[4:7], v[60:63]
ds_read_b64_tr_b16 v[148:149], v36 offset:7296
s_waitcnt lgkmcnt(7)
v_mfma_f32_16x16x32_bf16 v[64:67], v[128:131], a[0:3], 0
buffer_load_dwordx4 a[40:43], v16, s[28:31], s51 offen offset:1024 sc1
v_mfma_f32_16x16x32_bf16 v[64:67], v[132:135], a[8:11], v[64:67]
ds_read_b64_tr_b16 v[150:151], v36 offset:9088
v_mfma_f32_16x16x32_bf16 v[68:71], v[132:135], a[12:15], 0
ds_read_b64_tr_b16 v[152:153], v36 offset:160
ds_read_b64_tr_b16 v[154:155], v36 offset:1952
v_mfma_f32_16x16x32_bf16 v[68:71], v[128:131], a[4:7], v[68:71]
ds_read_b64_tr_b16 v[156:157], v36 offset:7328
s_waitcnt lgkmcnt(7)
v_mfma_f32_16x16x32_bf16 v[72:75], v[136:139], a[0:3], 0
buffer_load_dwordx4 a[44:47], v16, s[28:31], s52 offen offset:1024 sc1
v_mfma_f32_16x16x32_bf16 v[72:75], v[140:143], a[8:11], v[72:75]
ds_read_b64_tr_b16 v[158:159], v36 offset:9120
v_mfma_f32_16x16x32_bf16 v[76:79], v[140:143], a[12:15], 0
ds_read_b64_tr_b16 v[112:113], v36 offset:192
ds_read_b64_tr_b16 v[114:115], v36 offset:1984
v_mfma_f32_16x16x32_bf16 v[76:79], v[136:139], a[4:7], v[76:79]
ds_read_b64_tr_b16 v[116:117], v36 offset:7360
s_waitcnt lgkmcnt(7)
v_mfma_f32_16x16x32_bf16 v[80:83], v[144:147], a[0:3], 0
buffer_load_dwordx4 a[48:51], v16, s[28:31], s51 offen offset:2048 sc1
v_mfma_f32_16x16x32_bf16 v[80:83], v[148:151], a[8:11], v[80:83]
ds_read_b64_tr_b16 v[118:119], v36 offset:9152
v_mfma_f32_16x16x32_bf16 v[84:87], v[148:151], a[12:15], 0
ds_read_b64_tr_b16 v[120:121], v36 offset:14336
ds_read_b64_tr_b16 v[122:123], v36 offset:16128
v_mfma_f32_16x16x32_bf16 v[84:87], v[144:147], a[4:7], v[84:87]
ds_read_b64_tr_b16 v[124:125], v36 offset:21504
s_waitcnt lgkmcnt(7)
v_mfma_f32_16x16x32_bf16 v[88:91], v[152:155], a[0:3], 0
buffer_load_dwordx4 a[52:55], v16, s[28:31], s52 offen offset:2048 sc1
v_mfma_f32_16x16x32_bf16 v[88:91], v[156:159], a[8:11], v[88:91]
ds_read_b64_tr_b16 v[126:127], v36 offset:23296
v_mfma_f32_16x16x32_bf16 v[92:95], v[156:159], a[12:15], 0
ds_read_b64_tr_b16 v[128:129], v36 offset:14368
ds_read_b64_tr_b16 v[130:131], v36 offset:16160
v_mfma_f32_16x16x32_bf16 v[92:95], v[152:155], a[4:7], v[92:95]
ds_read_b64_tr_b16 v[132:133], v36 offset:21536
s_waitcnt lgkmcnt(7)
v_mfma_f32_16x16x32_bf16 v[96:99], v[112:115], a[0:3], 0
buffer_load_dwordx4 a[56:59], v16, s[28:31], s51 offen offset:3072 sc1
v_mfma_f32_16x16x32_bf16 v[96:99], v[116:119], a[8:11], v[96:99]
ds_read_b64_tr_b16 v[134:135], v36 offset:23328
v_mfma_f32_16x16x32_bf16 v[100:103], v[116:119], a[12:15], 0
ds_read_b64_tr_b16 v[136:137], v36 offset:14400
ds_read_b64_tr_b16 v[138:139], v36 offset:16192
v_mfma_f32_16x16x32_bf16 v[100:103], v[112:115], a[4:7], v[100:103]
ds_read_b64_tr_b16 v[140:141], v36 offset:21568
s_waitcnt vmcnt(7) lgkmcnt(7)
v_mfma_f32_16x16x32_bf16 v[48:51], v[120:123], a[16:19], v[48:51]
buffer_load_dwordx4 a[60:63], v16, s[28:31], s52 offen offset:3072 sc1
v_mfma_f32_16x16x32_bf16 v[48:51], v[124:127], a[24:27], v[48:51]
ds_read_b64_tr_b16 v[142:143], v36 offset:23360
v_mfma_f32_16x16x32_bf16 v[52:55], v[124:127], a[28:31], v[52:55]
ds_read_b64_tr_b16 v[144:145], v36 offset:14432
ds_read_b64_tr_b16 v[146:147], v36 offset:16224
v_mfma_f32_16x16x32_bf16 v[52:55], v[120:123], a[20:23], v[52:55]
ds_read_b64_tr_b16 v[148:149], v36 offset:21600
s_waitcnt lgkmcnt(7)
v_mfma_f32_16x16x32_bf16 v[56:59], v[128:131], a[16:19], v[56:59]
buffer_load_dwordx4 a[64:67], v16, s[28:31], s53 offen offset:0 sc1
v_mfma_f32_16x16x32_bf16 v[56:59], v[132:135], a[24:27], v[56:59]
ds_read_b64_tr_b16 v[150:151], v36 offset:23392
v_mfma_f32_16x16x32_bf16 v[60:63], v[132:135], a[28:31], v[60:63]
ds_read_b64_tr_b16 v[152:153], v36 offset:14464
ds_read_b64_tr_b16 v[154:155], v36 offset:16256
v_mfma_f32_16x16x32_bf16 v[60:63], v[128:131], a[20:23], v[60:63]
ds_read_b64_tr_b16 v[156:157], v36 offset:21632
s_waitcnt lgkmcnt(7)
v_mfma_f32_16x16x32_bf16 v[64:67], v[136:139], a[16:19], v[64:67]
buffer_load_dwordx4 a[68:71], v16, s[28:31], s54 offen offset:0 sc1
v_mfma_f32_16x16x32_bf16 v[64:67], v[140:143], a[24:27], v[64:67]
ds_read_b64_tr_b16 v[158:159], v36 offset:23424
v_mfma_f32_16x16x32_bf16 v[68:71], v[140:143], a[28:31], v[68:71]
ds_read_b64_tr_b16 v[112:113], v36 offset:14496
ds_read_b64_tr_b16 v[114:115], v36 offset:16288
v_mfma_f32_16x16x32_bf16 v[68:71], v[136:139], a[20:23], v[68:71]
ds_read_b64_tr_b16 v[116:117], v36 offset:21664
s_waitcnt lgkmcnt(7)
v_mfma_f32_16x16x32_bf16 v[72:75], v[144:147], a[16:19], v[72:75]
buffer_load_dwordx4 a[72:75], v16, s[28:31], s53 offen offset:1024 sc1
v_mfma_f32_16x16x32_bf16 v[72:75], v[148:151], a[24:27], v[72:75]
ds_read_b64_tr_b16 v[118:119], v36 offset:23456
v_mfma_f32_16x16x32_bf16 v[76:79], v[148:151], a[28:31], v[76:79]
ds_read_b64_tr_b16 v[120:121], v36 offset:14528
ds_read_b64_tr_b16 v[122:123], v36 offset:16320
v_mfma_f32_16x16x32_bf16 v[76:79], v[144:147], a[20:23], v[76:79]
ds_read_b64_tr_b16 v[124:125], v36 offset:21696
s_waitcnt lgkmcnt(7)
v_mfma_f32_16x16x32_bf16 v[80:83], v[152:155], a[16:19], v[80:83]
buffer_load_dwordx4 a[76:79], v16, s[28:31], s54 offen offset:1024 sc1
v_mfma_f32_16x16x32_bf16 v[80:83], v[156:159], a[24:27], v[80:83]
ds_read_b64_tr_b16 v[126:127], v36 offset:23488
v_mfma_f32_16x16x32_bf16 v[84:87], v[156:159], a[28:31], v[84:87]
ds_read_b64_tr_b16 v[128:129], v36 offset:28672
ds_read_b64_tr_b16 v[130:131], v36 offset:30464
v_mfma_f32_16x16x32_bf16 v[84:87], v[152:155], a[20:23], v[84:87]
ds_read_b64_tr_b16 v[132:133], v36 offset:35840
s_waitcnt lgkmcnt(7)
v_mfma_f32_16x16x32_bf16 v[88:91], v[112:115], a[16:19], v[88:91]
buffer_load_dwordx4 a[80:83], v16, s[28:31], s53 offen offset:2048 sc1
v_mfma_f32_16x16x32_bf16 v[88:91], v[116:119], a[24:27], v[88:91]
ds_read_b64_tr_b16 v[134:135], v36 offset:37632
v_mfma_f32_16x16x32_bf16 v[92:95], v[116:119], a[28:31], v[92:95]
ds_read_b64_tr_b16 v[136:137], v36 offset:28704
ds_read_b64_tr_b16 v[138:139], v36 offset:30496
v_mfma_f32_16x16x32_bf16 v[92:95], v[112:115], a[20:23], v[92:95]
ds_read_b64_tr_b16 v[140:141], v36 offset:35872
s_waitcnt lgkmcnt(7)
v_mfma_f32_16x16x32_bf16 v[96:99], v[120:123], a[16:19], v[96:99]
buffer_load_dwordx4 a[84:87], v16, s[28:31], s54 offen offset:2048 sc1
v_mfma_f32_16x16x32_bf16 v[96:99], v[124:127], a[24:27], v[96:99]
ds_read_b64_tr_b16 v[142:143], v36 offset:37664
v_mfma_f32_16x16x32_bf16 v[100:103], v[124:127], a[28:31], v[100:103]
ds_read_b64_tr_b16 v[144:145], v36 offset:28736
ds_read_b64_tr_b16 v[146:147], v36 offset:30528
v_mfma_f32_16x16x32_bf16 v[100:103], v[120:123], a[20:23], v[100:103]
ds_read_b64_tr_b16 v[148:149], v36 offset:35904
s_waitcnt vmcnt(10) lgkmcnt(7)
v_mfma_f32_16x16x32_bf16 v[48:51], v[128:131], a[32:35], v[48:51]
buffer_load_dwordx4 a[88:91], v16, s[28:31], s53 offen offset:3072 sc1
v_mfma_f32_16x16x32_bf16 v[48:51], v[132:135], a[40:43], v[48:51]
ds_read_b64_tr_b16 v[150:151], v36 offset:37696
v_mfma_f32_16x16x32_bf16 v[52:55], v[132:135], a[44:47], v[52:55]
ds_read_b64_tr_b16 v[152:153], v36 offset:28768
ds_read_b64_tr_b16 v[154:155], v36 offset:30560
v_mfma_f32_16x16x32_bf16 v[52:55], v[128:131], a[36:39], v[52:55]
ds_read_b64_tr_b16 v[156:157], v36 offset:35936
s_waitcnt lgkmcnt(7)
v_mfma_f32_16x16x32_bf16 v[56:59], v[136:139], a[32:35], v[56:59]
buffer_load_dwordx4 a[92:95], v16, s[28:31], s54 offen offset:3072 sc1
v_mfma_f32_16x16x32_bf16 v[56:59], v[140:143], a[40:43], v[56:59]
ds_read_b64_tr_b16 v[158:159], v36 offset:37728
v_mfma_f32_16x16x32_bf16 v[60:63], v[140:143], a[44:47], v[60:63]
ds_read_b64_tr_b16 v[112:113], v36 offset:28800
ds_read_b64_tr_b16 v[114:115], v36 offset:30592
v_mfma_f32_16x16x32_bf16 v[60:63], v[136:139], a[36:39], v[60:63]
ds_read_b64_tr_b16 v[116:117], v36 offset:35968
s_waitcnt lgkmcnt(7)
v_mfma_f32_16x16x32_bf16 v[64:67], v[144:147], a[32:35], v[64:67]
buffer_load_dwordx4 a[96:99], v16, s[28:31], s55 offen offset:0 sc1
v_mfma_f32_16x16x32_bf16 v[64:67], v[148:151], a[40:43], v[64:67]
ds_read_b64_tr_b16 v[118:119], v36 offset:37760
v_mfma_f32_16x16x32_bf16 v[68:71], v[148:151], a[44:47], v[68:71]
ds_read_b64_tr_b16 v[120:121], v36 offset:28832
ds_read_b64_tr_b16 v[122:123], v36 offset:30624
v_mfma_f32_16x16x32_bf16 v[68:71], v[144:147], a[36:39], v[68:71]
ds_read_b64_tr_b16 v[124:125], v36 offset:36000
s_waitcnt lgkmcnt(7)
v_mfma_f32_16x16x32_bf16 v[72:75], v[152:155], a[32:35], v[72:75]
buffer_load_dwordx4 a[100:103], v16, s[28:31], s56 offen offset:0 sc1
v_mfma_f32_16x16x32_bf16 v[72:75], v[156:159], a[40:43], v[72:75]
ds_read_b64_tr_b16 v[126:127], v36 offset:37792
v_mfma_f32_16x16x32_bf16 v[76:79], v[156:159], a[44:47], v[76:79]
ds_read_b64_tr_b16 v[128:129], v36 offset:28864
ds_read_b64_tr_b16 v[130:131], v36 offset:30656
v_mfma_f32_16x16x32_bf16 v[76:79], v[152:155], a[36:39], v[76:79]
ds_read_b64_tr_b16 v[132:133], v36 offset:36032
s_waitcnt lgkmcnt(7)
v_mfma_f32_16x16x32_bf16 v[80:83], v[112:115], a[32:35], v[80:83]
buffer_load_dwordx4 a[104:107], v16, s[28:31], s55 offen offset:1024 sc1
v_mfma_f32_16x16x32_bf16 v[80:83], v[116:119], a[40:43], v[80:83]
ds_read_b64_tr_b16 v[134:135], v36 offset:37824
v_mfma_f32_16x16x32_bf16 v[84:87], v[116:119], a[44:47], v[84:87]
ds_read_b64_tr_b16 v[136:137], v36 offset:43008
ds_read_b64_tr_b16 v[138:139], v36 offset:44800
v_mfma_f32_16x16x32_bf16 v[84:87], v[112:115], a[36:39], v[84:87]
ds_read_b64_tr_b16 v[140:141], v36 offset:50176
s_waitcnt lgkmcnt(7)
v_mfma_f32_16x16x32_bf16 v[88:91], v[120:123], a[32:35], v[88:91]
buffer_load_dwordx4 a[108:111], v16, s[28:31], s56 offen offset:1024 sc1
v_mfma_f32_16x16x32_bf16 v[88:91], v[124:127], a[40:43], v[88:91]
ds_read_b64_tr_b16 v[142:143], v36 offset:51968
v_mfma_f32_16x16x32_bf16 v[92:95], v[124:127], a[44:47], v[92:95]
ds_read_b64_tr_b16 v[144:145], v36 offset:43040
ds_read_b64_tr_b16 v[146:147], v36 offset:44832
v_mfma_f32_16x16x32_bf16 v[92:95], v[120:123], a[36:39], v[92:95]
ds_read_b64_tr_b16 v[148:149], v36 offset:50208
s_waitcnt lgkmcnt(7)
v_mfma_f32_16x16x32_bf16 v[96:99], v[128:131], a[32:35], v[96:99]
buffer_load_dwordx4 a[112:115], v16, s[28:31], s55 offen offset:2048 sc1
v_mfma_f32_16x16x32_bf16 v[96:99], v[132:135], a[40:43], v[96:99]
ds_read_b64_tr_b16 v[150:151], v36 offset:52000
v_mfma_f32_16x16x32_bf16 v[100:103], v[132:135], a[44:47], v[100:103]
ds_read_b64_tr_b16 v[152:153], v36 offset:43072
ds_read_b64_tr_b16 v[154:155], v36 offset:44864
v_mfma_f32_16x16x32_bf16 v[100:103], v[128:131], a[36:39], v[100:103]
ds_read_b64_tr_b16 v[156:157], v36 offset:50240
s_waitcnt vmcnt(13) lgkmcnt(7)
v_mfma_f32_16x16x32_bf16 v[48:51], v[136:139], a[48:51], v[48:51]
buffer_load_dwordx4 a[116:119], v16, s[28:31], s56 offen offset:2048 sc1
v_mfma_f32_16x16x32_bf16 v[48:51], v[140:143], a[56:59], v[48:51]
ds_read_b64_tr_b16 v[158:159], v36 offset:52032
v_mfma_f32_16x16x32_bf16 v[52:55], v[140:143], a[60:63], v[52:55]
ds_read_b64_tr_b16 v[112:113], v36 offset:43104
ds_read_b64_tr_b16 v[114:115], v36 offset:44896
v_mfma_f32_16x16x32_bf16 v[52:55], v[136:139], a[52:55], v[52:55]
ds_read_b64_tr_b16 v[116:117], v36 offset:50272
s_waitcnt lgkmcnt(7)
v_mfma_f32_16x16x32_bf16 v[56:59], v[144:147], a[48:51], v[56:59]
buffer_load_dwordx4 a[120:123], v16, s[28:31], s55 offen offset:3072 sc1
v_mfma_f32_16x16x32_bf16 v[56:59], v[148:151], a[56:59], v[56:59]
ds_read_b64_tr_b16 v[118:119], v36 offset:52064
v_mfma_f32_16x16x32_bf16 v[60:63], v[148:151], a[60:63], v[60:63]
ds_read_b64_tr_b16 v[120:121], v36 offset:43136
ds_read_b64_tr_b16 v[122:123], v36 offset:44928
v_mfma_f32_16x16x32_bf16 v[60:63], v[144:147], a[52:55], v[60:63]
ds_read_b64_tr_b16 v[124:125], v36 offset:50304
s_waitcnt lgkmcnt(7)
v_mfma_f32_16x16x32_bf16 v[64:67], v[152:155], a[48:51], v[64:67]
buffer_load_dwordx4 a[124:127], v16, s[28:31], s56 offen offset:3072 sc1
v_mfma_f32_16x16x32_bf16 v[64:67], v[156:159], a[56:59], v[64:67]
ds_read_b64_tr_b16 v[126:127], v36 offset:52096
s_add_u32 m0, s43, 0
v_mfma_f32_16x16x32_bf16 v[68:71], v[156:159], a[60:63], v[68:71]
ds_read_b64_tr_b16 v[128:129], v36 offset:43168
ds_read_b64_tr_b16 v[130:131], v36 offset:44960
v_mfma_f32_16x16x32_bf16 v[68:71], v[152:155], a[52:55], v[68:71]
ds_read_b64_tr_b16 v[132:133], v36 offset:50336
s_waitcnt lgkmcnt(7)
v_mfma_f32_16x16x32_bf16 v[72:75], v[112:115], a[48:51], v[72:75]
ds_read_b64_tr_b16 v[134:135], v36 offset:52128
s_add_u32 s24, s20, 0
v_mfma_f32_16x16x32_bf16 v[72:75], v[116:119], a[56:59], v[72:75]
buffer_load_dwordx4 v32, s[96:99], s24 offen offset:0 lds
v_mfma_f32_16x16x32_bf16 v[76:79], v[116:119], a[60:63], v[76:79]
ds_read_b64_tr_b16 v[136:137], v36 offset:43200
ds_read_b64_tr_b16 v[138:139], v36 offset:44992
v_mfma_f32_16x16x32_bf16 v[76:79], v[112:115], a[52:55], v[76:79]
ds_read_b64_tr_b16 v[140:141], v36 offset:50368
s_waitcnt lgkmcnt(7)
v_mfma_f32_16x16x32_bf16 v[80:83], v[120:123], a[48:51], v[80:83]
ds_read_b64_tr_b16 v[142:143], v36 offset:52160
v_mfma_f32_16x16x32_bf16 v[80:83], v[124:127], a[56:59], v[80:83]
buffer_load_dwordx4 v33, s[96:99], s24 offen offset:1024 lds
v_mfma_f32_16x16x32_bf16 v[84:87], v[124:127], a[60:63], v[84:87]
ds_read_b64_tr_b16 v[144:145], v37 offset:0
ds_read_b64_tr_b16 v[146:147], v37 offset:1792
v_mfma_f32_16x16x32_bf16 v[84:87], v[120:123], a[52:55], v[84:87]
ds_read_b64_tr_b16 v[148:149], v37 offset:7168
s_waitcnt lgkmcnt(7)
v_mfma_f32_16x16x32_bf16 v[88:91], v[128:131], a[48:51], v[88:91]
ds_read_b64_tr_b16 v[150:151], v37 offset:8960
v_mfma_f32_16x16x32_bf16 v[88:91], v[132:135], a[56:59], v[88:91]
buffer_load_dwordx4 v34, s[96:99], s24 offen offset:2048 lds
v_mfma_f32_16x16x32_bf16 v[92:95], v[132:135], a[60:63], v[92:95]
ds_read_b64_tr_b16 v[152:153], v37 offset:32
ds_read_b64_tr_b16 v[154:155], v37 offset:1824
v_mfma_f32_16x16x32_bf16 v[92:95], v[128:131], a[52:55], v[92:95]
ds_read_b64_tr_b16 v[156:157], v37 offset:7200
s_waitcnt lgkmcnt(7)
v_mfma_f32_16x16x32_bf16 v[96:99], v[136:139], a[48:51], v[96:99]
ds_read_b64_tr_b16 v[158:159], v37 offset:8992
v_mfma_f32_16x16x32_bf16 v[96:99], v[140:143], a[56:59], v[96:99]
buffer_load_dwordx4 v35, s[96:99], s24 offen offset:3072 lds
v_mfma_f32_16x16x32_bf16 v[100:103], v[140:143], a[60:63], v[100:103]
ds_read_b64_tr_b16 v[112:113], v37 offset:64
ds_read_b64_tr_b16 v[114:115], v37 offset:1856
v_mfma_f32_16x16x32_bf16 v[100:103], v[136:139], a[52:55], v[100:103]
s_waitcnt vmcnt(16) lgkmcnt(6)
s_barrier
v_mfma_f32_16x16x32_bf16 v[48:51], v[144:147], a[64:67], v[48:51]
ds_read_b64_tr_b16 v[116:117], v37 offset:7232
ds_read_b64_tr_b16 v[118:119], v37 offset:9024
v_mfma_f32_16x16x32_bf16 v[48:51], v[148:151], a[72:75], v[48:51]
s_add_u32 m0, s43, 4096
v_mfma_f32_16x16x32_bf16 v[52:55], v[148:151], a[76:79], v[52:55]
ds_read_b64_tr_b16 v[120:121], v37 offset:96
ds_read_b64_tr_b16 v[122:123], v37 offset:1888
v_mfma_f32_16x16x32_bf16 v[52:55], v[144:147], a[68:71], v[52:55]
ds_read_b64_tr_b16 v[124:125], v37 offset:7264
s_waitcnt lgkmcnt(7)
v_mfma_f32_16x16x32_bf16 v[56:59], v[152:155], a[64:67], v[56:59]
ds_read_b64_tr_b16 v[126:127], v37 offset:9056
s_add_u32 s24, s20, 32768
v_mfma_f32_16x16x32_bf16 v[56:59], v[156:159], a[72:75], v[56:59]
buffer_load_dwordx4 v32, s[96:99], s24 offen offset:0 lds
v_mfma_f32_16x16x32_bf16 v[60:63], v[156:159], a[76:79], v[60:63]
ds_read_b64_tr_b16 v[128:129], v37 offset:128
ds_read_b64_tr_b16 v[130:131], v37 offset:1920
v_mfma_f32_16x16x32_bf16 v[60:63], v[152:155], a[68:71], v[60:63]
ds_read_b64_tr_b16 v[132:133], v37 offset:7296
s_waitcnt lgkmcnt(7)
v_mfma_f32_16x16x32_bf16 v[64:67], v[112:115], a[64:67], v[64:67]
ds_read_b64_tr_b16 v[134:135], v37 offset:9088
v_mfma_f32_16x16x32_bf16 v[64:67], v[116:119], a[72:75], v[64:67]
buffer_load_dwordx4 v33, s[96:99], s24 offen offset:1024 lds
v_mfma_f32_16x16x32_bf16 v[68:71], v[116:119], a[76:79], v[68:71]
ds_read_b64_tr_b16 v[136:137], v37 offset:160
ds_read_b64_tr_b16 v[138:139], v37 offset:1952
v_mfma_f32_16x16x32_bf16 v[68:71], v[112:115], a[68:71], v[68:71]
ds_read_b64_tr_b16 v[140:141], v37 offset:7328
s_waitcnt lgkmcnt(7)
v_mfma_f32_16x16x32_bf16 v[72:75], v[120:123], a[64:67], v[72:75]
ds_read_b64_tr_b16 v[142:143], v37 offset:9120
v_mfma_f32_16x16x32_bf16 v[72:75], v[124:127], a[72:75], v[72:75]
buffer_load_dwordx4 v34, s[96:99], s24 offen offset:2048 lds
v_mfma_f32_16x16x32_bf16 v[76:79], v[124:127], a[76:79], v[76:79]
ds_read_b64_tr_b16 v[144:145], v37 offset:192
ds_read_b64_tr_b16 v[146:147], v37 offset:1984
v_mfma_f32_16x16x32_bf16 v[76:79], v[120:123], a[68:71], v[76:79]
ds_read_b64_tr_b16 v[148:149], v37 offset:7360
s_waitcnt lgkmcnt(7)
v_mfma_f32_16x16x32_bf16 v[80:83], v[128:131], a[64:67], v[80:83]
ds_read_b64_tr_b16 v[150:151], v37 offset:9152
v_mfma_f32_16x16x32_bf16 v[80:83], v[132:135], a[72:75], v[80:83]
buffer_load_dwordx4 v35, s[96:99], s24 offen offset:3072 lds
v_mfma_f32_16x16x32_bf16 v[84:87], v[132:135], a[76:79], v[84:87]
ds_read_b64_tr_b16 v[152:153], v37 offset:14336
ds_read_b64_tr_b16 v[154:155], v37 offset:16128
v_mfma_f32_16x16x32_bf16 v[84:87], v[128:131], a[68:71], v[84:87]
ds_read_b64_tr_b16 v[156:157], v37 offset:21504
s_waitcnt lgkmcnt(7)
v_mfma_f32_16x16x32_bf16 v[88:91], v[136:139], a[64:67], v[88:91]
ds_read_b64_tr_b16 v[158:159], v37 offset:23296
s_add_u32 m0, s43, 8192
v_mfma_f32_16x16x32_bf16 v[88:91], v[140:143], a[72:75], v[88:91]
s_add_u32 s24, s20, 65536
v_mfma_f32_16x16x32_bf16 v[92:95], v[140:143], a[76:79], v[92:95]
buffer_load_dwordx4 v32, s[96:99], s24 offen offset:0 lds
v_mfma_f32_16x16x32_bf16 v[92:95], v[136:139], a[68:71], v[92:95]
ds_read_b64_tr_b16 v[112:113], v37 offset:14368
s_waitcnt lgkmcnt(5)
v_mfma_f32_16x16x32_bf16 v[96:99], v[144:147], a[64:67], v[96:99]
ds_read_b64_tr_b16 v[114:115], v37 offset:16160
ds_read_b64_tr_b16 v[116:117], v37 offset:21536
v_mfma_f32_16x16x32_bf16 v[96:99], v[148:151], a[72:75], v[96:99]
ds_read_b64_tr_b16 v[118:119], v37 offset:23328
v_mfma_f32_16x16x32_bf16 v[100:103], v[148:151], a[76:79], v[100:103]
buffer_load_dwordx4 v33, s[96:99], s24 offen offset:1024 lds
v_mfma_f32_16x16x32_bf16 v[100:103], v[144:147], a[68:71], v[100:103]
ds_read_b64_tr_b16 v[120:121], v37 offset:14400
s_waitcnt vmcnt(18) lgkmcnt(5)
v_mfma_f32_16x16x32_bf16 v[48:51], v[152:155], a[80:83], v[48:51]
ds_read_b64_tr_b16 v[122:123], v37 offset:16192
ds_read_b64_tr_b16 v[124:125], v37 offset:21568
v_mfma_f32_16x16x32_bf16 v[48:51], v[156:159], a[88:91], v[48:51]
ds_read_b64_tr_b16 v[126:127], v37 offset:23360
v_mfma_f32_16x16x32_bf16 v[52:55], v[156:159], a[92:95], v[52:55]
buffer_load_dwordx4 v34, s[96:99], s24 offen offset:2048 lds
v_mfma_f32_16x16x32_bf16 v[52:55], v[152:155], a[84:87], v[52:55]
ds_read_b64_tr_b16 v[128:129], v37 offset:14432
s_waitcnt lgkmcnt(5)
v_mfma_f32_16x16x32_bf16 v[56:59], v[112:115], a[80:83], v[56:59]
ds_read_b64_tr_b16 v[130:131], v37 offset:16224
ds_read_b64_tr_b16 v[132:133], v37 offset:21600
v_mfma_f32_16x16x32_bf16 v[56:59], v[116:119], a[88:91], v[56:59]
ds_read_b64_tr_b16 v[134:135], v37 offset:23392
v_mfma_f32_16x16x32_bf16 v[60:63], v[116:119], a[92:95], v[60:63]
buffer_load_dwordx4 v35, s[96:99], s24 offen offset:3072 lds
v_mfma_f32_16x16x32_bf16 v[60:63], v[112:115], a[84:87], v[60:63]
ds_read_b64_tr_b16 v[136:137], v37 offset:14464
s_waitcnt lgkmcnt(5)
v_mfma_f32_16x16x32_bf16 v[64:67], v[120:123], a[80:83], v[64:67]
ds_read_b64_tr_b16 v[138:139], v37 offset:16256
ds_read_b64_tr_b16 v[140:141], v37 offset:21632
v_mfma_f32_16x16x32_bf16 v[64:67], v[124:127], a[88:91], v[64:67]
ds_read_b64_tr_b16 v[142:143], v37 offset:23424
s_add_u32 m0, s23, 0
v_mfma_f32_16x16x32_bf16 v[68:71], v[124:127], a[92:95], v[68:71]
ds_read_b64_tr_b16 v[144:145], v37 offset:14496
ds_read_b64_tr_b16 v[146:147], v37 offset:16288
v_mfma_f32_16x16x32_bf16 v[68:71], v[120:123], a[84:87], v[68:71]
ds_read_b64_tr_b16 v[148:149], v37 offset:21664
s_waitcnt lgkmcnt(7)
v_mfma_f32_16x16x32_bf16 v[72:75], v[128:131], a[80:83], v[72:75]
ds_read_b64_tr_b16 v[150:151], v37 offset:23456
s_add_u32 s24, s20, 114688
v_mfma_f32_16x16x32_bf16 v[72:75], v[132:135], a[88:91], v[72:75]
buffer_load_dwordx4 v32, s[96:99], s24 offen offset:0 lds
v_mfma_f32_16x16x32_bf16 v[76:79], v[132:135], a[92:95], v[76:79]
ds_read_b64_tr_b16 v[152:153], v37 offset:14528
ds_read_b64_tr_b16 v[154:155], v37 offset:16320
v_mfma_f32_16x16x32_bf16 v[76:79], v[128:131], a[84:87], v[76:79]
ds_read_b64_tr_b16 v[156:157], v37 offset:21696
s_waitcnt lgkmcnt(7)
v_mfma_f32_16x16x32_bf16 v[80:83], v[136:139], a[80:83], v[80:83]
ds_read_b64_tr_b16 v[158:159], v37 offset:23488
v_mfma_f32_16x16x32_bf16 v[80:83], v[140:143], a[88:91], v[80:83]
buffer_load_dwordx4 v33, s[96:99], s24 offen offset:1024 lds
v_mfma_f32_16x16x32_bf16 v[84:87], v[140:143], a[92:95], v[84:87]
ds_read_b64_tr_b16 v[112:113], v37 offset:28672
ds_read_b64_tr_b16 v[114:115], v37 offset:30464
v_mfma_f32_16x16x32_bf16 v[84:87], v[136:139], a[84:87], v[84:87]
ds_read_b64_tr_b16 v[116:117], v37 offset:35840
s_waitcnt lgkmcnt(7)
v_mfma_f32_16x16x32_bf16 v[88:91], v[144:147], a[80:83], v[88:91]
ds_read_b64_tr_b16 v[118:119], v37 offset:37632
v_mfma_f32_16x16x32_bf16 v[88:91], v[148:151], a[88:91], v[88:91]
buffer_load_dwordx4 v34, s[96:99], s24 offen offset:2048 lds
v_mfma_f32_16x16x32_bf16 v[92:95], v[148:151], a[92:95], v[92:95]
ds_read_b64_tr_b16 v[120:121], v37 offset:28704
ds_read_b64_tr_b16 v[122:123], v37 offset:30496
v_mfma_f32_16x16x32_bf16 v[92:95], v[144:147], a[84:87], v[92:95]
ds_read_b64_tr_b16 v[124:125], v37 offset:35872
s_waitcnt lgkmcnt(7)
v_mfma_f32_16x16x32_bf16 v[96:99], v[152:155], a[80:83], v[96:99]
ds_read_b64_tr_b16 v[126:127], v37 offset:37664
v_mfma_f32_16x16x32_bf16 v[96:99], v[156:159], a[88:91], v[96:99]
buffer_load_dwordx4 v35, s[96:99], s24 offen offset:3072 lds
v_mfma_f32_16x16x32_bf16 v[100:103], v[156:159], a[92:95], v[100:103]
ds_read_b64_tr_b16 v[128:129], v37 offset:28736
ds_read_b64_tr_b16 v[130:131], v37 offset:30528
v_mfma_f32_16x16x32_bf16 v[100:103], v[152:155], a[84:87], v[100:103]
s_waitcnt vmcnt(20) lgkmcnt(6)
s_barrier
v_mfma_f32_16x16x32_bf16 v[48:51], v[112:115], a[96:99], v[48:51]
ds_read_b64_tr_b16 v[132:133], v37 offset:35904
ds_read_b64_tr_b16 v[134:135], v37 offset:37696
v_mfma_f32_16x16x32_bf16 v[48:51], v[116:119], a[104:107], v[48:51]
s_add_u32 m0, s23, 16384
v_mfma_f32_16x16x32_bf16 v[52:55], v[116:119], a[108:111], v[52:55]
ds_read_b64_tr_b16 v[136:137], v37 offset:28768
ds_read_b64_tr_b16 v[138:139], v37 offset:30560
v_mfma_f32_16x16x32_bf16 v[52:55], v[112:115], a[100:103], v[52:55]
ds_read_b64_tr_b16 v[140:141], v37 offset:35936
s_waitcnt lgkmcnt(7)
v_mfma_f32_16x16x32_bf16 v[56:59], v[120:123], a[96:99], v[56:59]
ds_read_b64_tr_b16 v[142:143], v37 offset:37728
s_add_u32 s24, s20, 147456
v_mfma_f32_16x16x32_bf16 v[56:59], v[124:127], a[104:107], v[56:59]
buffer_load_dwordx4 v32, s[96:99], s24 offen offset:0 lds
v_mfma_f32_16x16x32_bf16 v[60:63], v[124:127], a[108:111], v[60:63]
ds_read_b64_tr_b16 v[144:145], v37 offset:28800
ds_read_b64_tr_b16 v[146:147], v37 offset:30592
v_mfma_f32_16x16x32_bf16 v[60:63], v[120:123], a[100:103], v[60:63]
ds_read_b64_tr_b16 v[148:149], v37 offset:35968
s_waitcnt lgkmcnt(7)
v_mfma_f32_16x16x32_bf16 v[64:67], v[128:131], a[96:99], v[64:67]
ds_read_b64_tr_b16 v[150:151], v37 offset:37760
v_mfma_f32_16x16x32_bf16 v[64:67], v[132:135], a[104:107], v[64:67]
buffer_load_dwordx4 v33, s[96:99], s24 offen offset:1024 lds
v_mfma_f32_16x16x32_bf16 v[68:71], v[132:135], a[108:111], v[68:71]
ds_read_b64_tr_b16 v[152:153], v37 offset:28832
ds_read_b64_tr_b16 v[154:155], v37 offset:30624
v_mfma_f32_16x16x32_bf16 v[68:71], v[128:131], a[100:103], v[68:71]
ds_read_b64_tr_b16 v[156:157], v37 offset:36000
s_waitcnt lgkmcnt(7)
v_mfma_f32_16x16x32_bf16 v[72:75], v[136:139], a[96:99], v[72:75]
ds_read_b64_tr_b16 v[158:159], v37 offset:37792
v_mfma_f32_16x16x32_bf16 v[72:75], v[140:143], a[104:107], v[72:75]
buffer_load_dwordx4 v34, s[96:99], s24 offen offset:2048 lds
v_mfma_f32_16x16x32_bf16 v[76:79], v[140:143], a[108:111], v[76:79]
ds_read_b64_tr_b16 v[112:113], v37 offset:28864
ds_read_b64_tr_b16 v[114:115], v37 offset:30656
v_mfma_f32_16x16x32_bf16 v[76:79], v[136:139], a[100:103], v[76:79]
ds_read_b64_tr_b16 v[116:117], v37 offset:36032
s_waitcnt lgkmcnt(7)
v_mfma_f32_16x16x32_bf16 v[80:83], v[144:147], a[96:99], v[80:83]
ds_read_b64_tr_b16 v[118:119], v37 offset:37824
v_mfma_f32_16x16x32_bf16 v[80:83], v[148:151], a[104:107], v[80:83]
buffer_load_dwordx4 v35, s[96:99], s24 offen offset:3072 lds
v_mfma_f32_16x16x32_bf16 v[84:87], v[148:151], a[108:111], v[84:87]
ds_read_b64_tr_b16 v[120:121], v37 offset:43008
ds_read_b64_tr_b16 v[122:123], v37 offset:44800
v_mfma_f32_16x16x32_bf16 v[84:87], v[144:147], a[100:103], v[84:87]
ds_read_b64_tr_b16 v[124:125], v37 offset:50176
s_waitcnt lgkmcnt(7)
v_mfma_f32_16x16x32_bf16 v[88:91], v[152:155], a[96:99], v[88:91]
ds_read_b64_tr_b16 v[126:127], v37 offset:51968
s_add_u32 m0, s23, 32768
v_mfma_f32_16x16x32_bf16 v[88:91], v[156:159], a[104:107], v[88:91]
s_add_u32 s24, s20, 180224
v_mfma_f32_16x16x32_bf16 v[92:95], v[156:159], a[108:111], v[92:95]
buffer_load_dwordx4 v32, s[96:99], s24 offen offset:0 lds
v_mfma_f32_16x16x32_bf16 v[92:95], v[152:155], a[100:103], v[92:95]
ds_read_b64_tr_b16 v[128:129], v37 offset:43040
s_waitcnt lgkmcnt(5)
v_mfma_f32_16x16x32_bf16 v[96:99], v[112:115], a[96:99], v[96:99]
ds_read_b64_tr_b16 v[130:131], v37 offset:44832
ds_read_b64_tr_b16 v[132:133], v37 offset:50208
v_mfma_f32_16x16x32_bf16 v[96:99], v[116:119], a[104:107], v[96:99]
ds_read_b64_tr_b16 v[134:135], v37 offset:52000
v_mfma_f32_16x16x32_bf16 v[100:103], v[116:119], a[108:111], v[100:103]
buffer_load_dwordx4 v33, s[96:99], s24 offen offset:1024 lds
v_mfma_f32_16x16x32_bf16 v[100:103], v[112:115], a[100:103], v[100:103]
ds_read_b64_tr_b16 v[136:137], v37 offset:43072
s_waitcnt vmcnt(22) lgkmcnt(5)
v_mfma_f32_16x16x32_bf16 v[48:51], v[120:123], a[112:115], v[48:51]
ds_read_b64_tr_b16 v[138:139], v37 offset:44864
ds_read_b64_tr_b16 v[140:141], v37 offset:50240
v_mfma_f32_16x16x32_bf16 v[48:51], v[124:127], a[120:123], v[48:51]
ds_read_b64_tr_b16 v[142:143], v37 offset:52032
v_mfma_f32_16x16x32_bf16 v[52:55], v[124:127], a[124:127], v[52:55]
buffer_load_dwordx4 v34, s[96:99], s24 offen offset:2048 lds
v_mfma_f32_16x16x32_bf16 v[52:55], v[120:123], a[116:119], v[52:55]
ds_read_b64_tr_b16 v[144:145], v37 offset:43104
s_waitcnt lgkmcnt(5)
v_mfma_f32_16x16x32_bf16 v[56:59], v[128:131], a[112:115], v[56:59]
ds_read_b64_tr_b16 v[146:147], v37 offset:44896
ds_read_b64_tr_b16 v[148:149], v37 offset:50272
v_mfma_f32_16x16x32_bf16 v[56:59], v[132:135], a[120:123], v[56:59]
ds_read_b64_tr_b16 v[150:151], v37 offset:52064
v_mfma_f32_16x16x32_bf16 v[60:63], v[132:135], a[124:127], v[60:63]
buffer_load_dwordx4 v35, s[96:99], s24 offen offset:3072 lds
v_mfma_f32_16x16x32_bf16 v[60:63], v[128:131], a[116:119], v[60:63]
ds_read_b64_tr_b16 v[152:153], v37 offset:43136
s_waitcnt lgkmcnt(5)
v_mfma_f32_16x16x32_bf16 v[64:67], v[136:139], a[112:115], v[64:67]
ds_read_b64_tr_b16 v[154:155], v37 offset:44928
ds_read_b64_tr_b16 v[156:157], v37 offset:50304
v_mfma_f32_16x16x32_bf16 v[64:67], v[140:143], a[120:123], v[64:67]
ds_read_b64_tr_b16 v[158:159], v37 offset:52096
s_add_u32 m0, s23, 49152
v_mfma_f32_16x16x32_bf16 v[68:71], v[140:143], a[124:127], v[68:71]
ds_read_b64_tr_b16 v[112:113], v37 offset:43168
ds_read_b64_tr_b16 v[114:115], v37 offset:44960
v_mfma_f32_16x16x32_bf16 v[68:71], v[136:139], a[116:119], v[68:71]
ds_read_b64_tr_b16 v[116:117], v37 offset:50336
s_waitcnt lgkmcnt(7)
v_mfma_f32_16x16x32_bf16 v[72:75], v[144:147], a[112:115], v[72:75]
ds_read_b64_tr_b16 v[118:119], v37 offset:52128
s_add_u32 s24, s20, 98304
v_mfma_f32_16x16x32_bf16 v[72:75], v[148:151], a[120:123], v[72:75]
buffer_load_dwordx4 v32, s[96:99], s24 offen offset:0 lds
v_mfma_f32_16x16x32_bf16 v[76:79], v[148:151], a[124:127], v[76:79]
ds_read_b64_tr_b16 v[120:121], v37 offset:43200
ds_read_b64_tr_b16 v[122:123], v37 offset:44992
v_mfma_f32_16x16x32_bf16 v[76:79], v[144:147], a[116:119], v[76:79]
ds_read_b64_tr_b16 v[124:125], v37 offset:50368
s_waitcnt lgkmcnt(7)
v_mfma_f32_16x16x32_bf16 v[80:83], v[152:155], a[112:115], v[80:83]
ds_read_b64_tr_b16 v[126:127], v37 offset:52160
v_mfma_f32_16x16x32_bf16 v[80:83], v[156:159], a[120:123], v[80:83]
buffer_load_dwordx4 v33, s[96:99], s24 offen offset:1024 lds
v_mfma_f32_16x16x32_bf16 v[84:87], v[156:159], a[124:127], v[84:87]
s_add_u32 s24, s20, 196608
v_mfma_f32_16x16x32_bf16 v[84:87], v[152:155], a[116:119], v[84:87]
s_waitcnt lgkmcnt(4)
v_mfma_f32_16x16x32_bf16 v[88:91], v[112:115], a[112:115], v[88:91]
v_mfma_f32_16x16x32_bf16 v[88:91], v[116:119], a[120:123], v[88:91]
buffer_load_dwordx4 v34, s[96:99], s24 offen offset:2048 lds
v_mfma_f32_16x16x32_bf16 v[92:95], v[116:119], a[124:127], v[92:95]
v_mfma_f32_16x16x32_bf16 v[92:95], v[112:115], a[116:119], v[92:95]
s_waitcnt lgkmcnt(0)
v_mfma_f32_16x16x32_bf16 v[96:99], v[120:123], a[112:115], v[96:99]
v_mfma_f32_16x16x32_bf16 v[96:99], v[124:127], a[120:123], v[96:99]
buffer_load_dwordx4 v35, s[96:99], s24 offen offset:3072 lds
v_mfma_f32_16x16x32_bf16 v[100:103], v[124:127], a[124:127], v[100:103]
s_add_u32 m0, s23, 65536
v_mfma_f32_16x16x32_bf16 v[100:103], v[120:123], a[116:119], v[100:103]
s_add_u32 s24, s20, 229376
buffer_load_dwordx4 v32, s[96:99], s24 offen offset:0 lds
buffer_load_dwordx4 v33, s[96:99], s24 offen offset:1024 lds
buffer_load_dwordx4 v34, s[96:99], s24 offen offset:2048 lds
buffer_load_dwordx4 v35, s[96:99], s24 offen offset:3072 lds
v_lshrrev_b32 v5, 2, v1
v_lshl_add_u32 v5, v2, 2, v5
v_bfe_u32 v6, v5, 1, 2
v_and_b32 v7, 3, v1
v_lshlrev_b32 v7, 3, v7
v_lshl_add_u32 v7, v5, 7, v7
v_max_f32 v48, 0, v48
v_max_f32 v49, 0, v49
v_max_f32 v50, 0, v50
v_max_f32 v51, 0, v51
v_cvt_pk_bf16_f32 v112, v48, v49
v_cvt_pk_bf16_f32 v113, v50, v51
v_max_f32 v56, 0, v56
v_max_f32 v57, 0, v57
v_max_f32 v58, 0, v58
v_max_f32 v59, 0, v59
v_cvt_pk_bf16_f32 v114, v56, v57
v_cvt_pk_bf16_f32 v115, v58, v59
buffer_store_dwordx4 v[112:115], v16, s[28:31], s32 offen offset:0 sc1
v_max_f32 v64, 0, v64
v_max_f32 v65, 0, v65
v_max_f32 v66, 0, v66
v_max_f32 v67, 0, v67
v_cvt_pk_bf16_f32 v116, v64, v65
v_cvt_pk_bf16_f32 v117, v66, v67
v_max_f32 v72, 0, v72
v_max_f32 v73, 0, v73
v_max_f32 v74, 0, v74
v_max_f32 v75, 0, v75
v_cvt_pk_bf16_f32 v118, v72, v73
v_cvt_pk_bf16_f32 v119, v74, v75
buffer_store_dwordx4 v[116:119], v16, s[28:31], s32 offen offset:1024 sc1
v_max_f32 v80, 0, v80
v_max_f32 v81, 0, v81
v_max_f32 v82, 0, v82
v_max_f32 v83, 0, v83
v_cvt_pk_bf16_f32 v120, v80, v81
v_cvt_pk_bf16_f32 v121, v82, v83
v_max_f32 v88, 0, v88
v_max_f32 v89, 0, v89
v_max_f32 v90, 0, v90
v_max_f32 v91, 0, v91
v_cvt_pk_bf16_f32 v122, v88, v89
v_cvt_pk_bf16_f32 v123, v90, v91
buffer_store_dwordx4 v[120:123], v16, s[28:31], s32 offen offset:2048 sc1
v_max_f32 v52, 0, v52
v_max_f32 v53, 0, v53
v_max_f32 v54, 0, v54
v_max_f32 v55, 0, v55
v_cvt_pk_bf16_f32 v124, v52, v53
v_cvt_pk_bf16_f32 v125, v54, v55
v_max_f32 v60, 0, v60
v_max_f32 v61, 0, v61
v_max_f32 v62, 0, v62
v_max_f32 v63, 0, v63
v_cvt_pk_bf16_f32 v126, v60, v61
v_cvt_pk_bf16_f32 v127, v62, v63
buffer_store_dwordx4 v[124:127], v16, s[28:31], s33 offen offset:0 sc1
v_max_f32 v68, 0, v68
v_max_f32 v69, 0, v69
v_max_f32 v70, 0, v70
v_max_f32 v71, 0, v71
v_cvt_pk_bf16_f32 v128, v68, v69
v_cvt_pk_bf16_f32 v129, v70, v71
v_max_f32 v76, 0, v76
v_max_f32 v77, 0, v77
v_max_f32 v78, 0, v78
v_max_f32 v79, 0, v79
v_cvt_pk_bf16_f32 v130, v76, v77
v_cvt_pk_bf16_f32 v131, v78, v79
buffer_store_dwordx4 v[128:131], v16, s[28:31], s33 offen offset:1024 sc1
v_max_f32 v84, 0, v84
v_max_f32 v85, 0, v85
v_max_f32 v86, 0, v86
v_max_f32 v87, 0, v87
v_cvt_pk_bf16_f32 v132, v84, v85
v_cvt_pk_bf16_f32 v133, v86, v87
v_max_f32 v92, 0, v92
v_max_f32 v93, 0, v93
v_max_f32 v94, 0, v94
v_max_f32 v95, 0, v95
v_cvt_pk_bf16_f32 v134, v92, v93
v_cvt_pk_bf16_f32 v135, v94, v95
buffer_store_dwordx4 v[132:135], v16, s[28:31], s33 offen offset:2048 sc1
v_max_f32 v96, 0, v96
v_max_f32 v97, 0, v97
v_max_f32 v98, 0, v98
v_max_f32 v99, 0, v99
v_cvt_pk_bf16_f32 v136, v96, v97
v_cvt_pk_bf16_f32 v137, v98, v99
v_max_f32 v100, 0, v100
v_max_f32 v101, 0, v101
v_max_f32 v102, 0, v102
v_max_f32 v103, 0, v103
v_cvt_pk_bf16_f32 v138, v100, v101
v_cvt_pk_bf16_f32 v139, v102, v103
buffer_store_dwordx4 v[136:139], v16, s[28:31], s33 offen offset:3072 sc1
v_xor_b32_e64 v5, 0, v6
v_lshl_add_u32 v5, v5, 5, v7
v_add_u32 v40, s43, v5
v_add_u32 v44, s23, v5
v_add_u32 v156, 0x10000, v44
v_xor_b32_e64 v5, 1, v6
v_lshl_add_u32 v5, v5, 5, v7
v_add_u32 v41, s43, v5
v_add_u32 v45, s23, v5
v_add_u32 v157, 0x10000, v45
v_xor_b32_e64 v5, 2, v6
v_lshl_add_u32 v5, v5, 5, v7
v_add_u32 v42, s43, v5
v_add_u32 v46, s23, v5
v_add_u32 v158, 0x10000, v46
v_xor_b32_e64 v5, 3, v6
v_lshl_add_u32 v5, v5, 5, v7
v_add_u32 v43, s43, v5
v_add_u32 v47, s23, v5
v_add_u32 v159, 0x10000, v47
s_waitcnt vmcnt(23)
s_nop 0
ds_read_b64_tr_b16 v[188:189], v40 offset:0
ds_read_b64_tr_b16 v[190:191], v40 offset:2048
ds_read_b64_tr_b16 v[192:193], v41 offset:0
ds_read_b64_tr_b16 v[194:195], v41 offset:2048
ds_read_b64_tr_b16 v[196:197], v42 offset:0
ds_read_b64_tr_b16 v[198:199], v42 offset:2048
ds_read_b64_tr_b16 v[200:201], v43 offset:0
ds_read_b64_tr_b16 v[202:203], v43 offset:2048
ds_read_b64_tr_b16 v[204:205], v40 offset:4096
ds_read_b64_tr_b16 v[206:207], v40 offset:6144
ds_read_b64_tr_b16 v[208:209], v41 offset:4096
ds_read_b64_tr_b16 v[210:211], v41 offset:6144
ds_read_b64_tr_b16 v[212:213], v42 offset:4096
ds_read_b64_tr_b16 v[214:215], v42 offset:6144
ds_read_b64_tr_b16 v[216:217], v43 offset:4096
ds_read_b64_tr_b16 v[218:219], v43 offset:6144
ds_read_b64_tr_b16 v[220:221], v40 offset:8192
ds_read_b64_tr_b16 v[222:223], v40 offset:10240
ds_read_b64_tr_b16 v[224:225], v41 offset:8192
ds_read_b64_tr_b16 v[226:227], v41 offset:10240
ds_read_b64_tr_b16 v[228:229], v42 offset:8192
ds_read_b64_tr_b16 v[230:231], v42 offset:10240
ds_read_b64_tr_b16 v[232:233], v43 offset:8192
ds_read_b64_tr_b16 v[234:235], v43 offset:10240
ds_read_b64_tr_b16 v[236:237], v44 offset:0
ds_read_b64_tr_b16 v[238:239], v44 offset:2048
ds_read_b64_tr_b16 v[240:241], v45 offset:0
ds_read_b64_tr_b16 v[242:243], v45 offset:2048
ds_read_b64_tr_b16 v[244:245], v46 offset:0
ds_read_b64_tr_b16 v[246:247], v46 offset:2048
ds_read_b64_tr_b16 v[248:249], v47 offset:0
ds_read_b64_tr_b16 v[250:251], v47 offset:2048
s_waitcnt vmcnt(0) lgkmcnt(0)
s_barrier
s_cmp_lg_u32 s38, 0
s_cbranch_scc1 L_f_sigh1
s_mov_b64 exec, 1
v_mov_b32 v4, 0
v_mov_b32_e64 v5, 1
buffer_atomic_add v5, v4, s[28:31], s48 offen sc1
s_mov_b64 exec, -1
L_f_sigh1:
s_nop 0
s_add_u32 m0, s23, 81920
s_add_u32 s24, s20, 262144
buffer_load_dwordx4 v32, s[96:99], s24 offen offset:0 lds
buffer_load_dwordx4 v33, s[96:99], s24 offen offset:1024 lds
buffer_load_dwordx4 v34, s[96:99], s24 offen offset:2048 lds
buffer_load_dwordx4 v35, s[96:99], s24 offen offset:3072 lds
s_add_u32 m0, s23, 98304
s_add_u32 s24, s20, 294912
buffer_load_dwordx4 v32, s[96:99], s24 offen offset:0 lds
buffer_load_dwordx4 v33, s[96:99], s24 offen offset:1024 lds
buffer_load_dwordx4 v34, s[96:99], s24 offen offset:2048 lds
buffer_load_dwordx4 v35, s[96:99], s24 offen offset:3072 lds
s_add_u32 m0, s43, 0
s_nop 0
s_add_u32 s24, s20, 344064
buffer_load_dwordx4 v32, s[96:99], s24 offen offset:0 lds
buffer_load_dwordx4 v33, s[96:99], s24 offen offset:1024 lds
buffer_load_dwordx4 v34, s[96:99], s24 offen offset:2048 lds
buffer_load_dwordx4 v35, s[96:99], s24 offen offset:3072 lds
s_add_u32 m0, s43, 4096
s_add_u32 s24, s20, 376832
buffer_load_dwordx4 v32, s[96:99], s24 offen offset:0 lds
buffer_load_dwordx4 v33, s[96:99], s24 offen offset:1024 lds
buffer_load_dwordx4 v34, s[96:99], s24 offen offset:2048 lds
buffer_load_dwordx4 v35, s[96:99], s24 offen offset:3072 lds
s_add_u32 m0, s43, 8192
s_add_u32 s24, s20, 409600
buffer_load_dwordx4 v32, s[96:99], s24 offen offset:0 lds
buffer_load_dwordx4 v33, s[96:99], s24 offen offset:1024 lds
buffer_load_dwordx4 v34, s[96:99], s24 offen offset:2048 lds
buffer_load_dwordx4 v35, s[96:99], s24 offen offset:3072 lds
s_add_u32 m0, s23, 0
s_add_u32 s24, s20, 327680
buffer_load_dwordx4 v32, s[96:99], s24 offen offset:0 lds
buffer_load_dwordx4 v33, s[96:99], s24 offen offset:1024 lds
s_add_u32 s24, s20, 425984
buffer_load_dwordx4 v34, s[96:99], s24 offen offset:2048 lds
buffer_load_dwordx4 v35, s[96:99], s24 offen offset:3072 lds
s_lshr_b32 s25, s84, 1
s_lshl_b32 s25, s25, 3
s_lshr_b32 s27, s85, 2
s_add_u32 s25, s25, s27
s_lshl_b32 s26, s26, 2
s_add_u32 s26, s26, s21
s_lshl_b32 s27, s25, 5
s_lshl_b32 s32, s38, 2
s_add_u32 s27, s27, s32
s_mul_i32 s27, s27, 7168
s_add_u32 s27, s27, 8388608
s_add_u32 s49, s27, 0
s_add_u32 s50, s27, 7168
s_add_u32 s51, s27, 14336
s_add_u32 s52, s27, 21504
v_add_u32 v144, 0, v16
v_add_u32 v145, 3072, v16
v_add_u32 v146, 114688, v16
v_add_u32 v147, 117760, v16
v_lshrrev_b32 v5, 3, v0
v_and_b32 v6, 7, v0
v_lshlrev_b32_e64 v24, 10, v5
v_lshl_add_u32 v24, v6, 4, v24
v_lshrrev_b32 v7, 1, v5
v_lshlrev_b32 v25, 11, v7
v_lshl_add_u32 v25, v6, 5, v25
v_and_b32_e64 v7, 1, v5
v_lshl_add_u32 v25, v7, 4, v25
v_lshlrev_b32 v26, 5, v6
v_lshlrev_b32 v7, 1, v6
v_xor_b32 v7, v7, v5
v_lshlrev_b32 v27, 4, v7
v_lshl_add_u32 v27, v6, 9, v27
s_lshl_b32 s32, s38, 14
s_add_u32 s32, s32, 16384
v_add_u32 v27, s32, v27
v_xor_b32 v28, 0x80, v27
v_lshrrev_b32 v5, 1, v2
v_lshlrev_b32 v5, 1, v5
v_xor_b32_e64 v5, v5, v1
s_add_u32 s24, s23, 16384
v_lshl_add_u32 v6, v2, 8, s24
v_xor_b32_e64 v7, 0, v5
v_lshl_add_u32 v152, v7, 4, v6
v_xor_b32_e64 v7, 4, v5
v_lshl_add_u32 v153, v7, 4, v6
v_xor_b32_e64 v7, 8, v5
v_lshl_add_u32 v154, v7, 4, v6
v_xor_b32_e64 v7, 12, v5
v_lshl_add_u32 v155, v7, 4, v6
s_lshl_b32 s32, s25, 16
s_lshl_b32 s33, s38, 14
s_add_u32 s32, s32, s33
s_lshl_b32 s34, s26, 8
s_add_u32 s33, s32, s34
s_add_u32 s33, s33, 1048576
s_lshl_b32 s35, s26, 7
s_add_u32 s32, s32, s35
s_add_u32 s34, s34, 10240
s_add_u32 s35, s32, 8192
s_add_u32 s40, s33, 8192
s_mov_b32 s12, s68
s_mov_b32 s13, s69
s_mov_b32 s14, 2097152
s_mov_b32 s15, 0x20000
buffer_load_dwordx4 v[160:163], v25, s[28:31], s33 offen sc1
buffer_load_dwordx4 v[164:167], v25, s[28:31], s40 offen sc1
buffer_load_dwordx4 v[168:171], v26, s[28:31], s34 offen offset:0 sc1
buffer_load_dwordx4 v[172:175], v26, s[28:31], s34 offen offset:16 sc1
s_cmp_lg_u32 s38, 0
s_cbranch_scc1 L_f_ph1_done
s_mov_b32 s60, 400000
v_mov_b32 v6, 0
L_f_ph1:
buffer_load_dword v4, v6, s[28:31], s48 offen sc1
s_waitcnt vmcnt(0)
s_sub_u32 s60, s60, 1
s_cbranch_scc1 L_f_ph1_done
v_readfirstlane_b32 s61, v4
s_nop 0
s_cmp_lt_u32 s61, 16
s_cbranch_scc1 L_f_ph1
L_f_ph1_done:
s_barrier
buffer_load_dwordx4 a[0:3], v144, s[28:31], s49 offen offset:0 sc1
buffer_load_dwordx4 a[4:7], v145, s[28:31], s49 offen offset:0 sc1
buffer_load_dwordx4 a[8:11], v146, s[28:31], s49 offen offset:0 sc1
buffer_load_dwordx4 a[12:15], v147, s[28:31], s49 offen offset:0 sc1
buffer_load_dwordx4 a[16:19], v144, s[28:31], s49 offen offset:1024 sc1
buffer_load_dwordx4 a[20:23], v145, s[28:31], s49 offen offset:1024 sc1
buffer_load_dwordx4 a[24:27], v146, s[28:31], s49 offen offset:1024 sc1
buffer_load_dwordx4 a[28:31], v147, s[28:31], s49 offen offset:1024 sc1
buffer_load_dwordx4 a[32:35], v144, s[28:31], s49 offen offset:2048 sc1
buffer_load_dwordx4 a[36:39], v145, s[28:31], s49 offen offset:2048 sc1
buffer_load_dwordx4 a[40:43], v146, s[28:31], s49 offen offset:2048 sc1
buffer_load_dwordx4 a[44:47], v147, s[28:31], s49 offen offset:2048 sc1
buffer_load_dwordx4 a[48:51], v144, s[28:31], s50 offen offset:0 sc1
buffer_load_dwordx4 a[52:55], v145, s[28:31], s50 offen offset:0 sc1
buffer_load_dwordx4 a[56:59], v146, s[28:31], s50 offen offset:0 sc1
buffer_load_dwordx4 a[60:63], v147, s[28:31], s50 offen offset:0 sc1
s_waitcnt vmcnt(8)
v_mfma_f32_16x16x32_bf16 v[48:51], v[188:191], a[0:3], 0
buffer_load_dwordx4 a[64:67], v144, s[28:31], s50 offen offset:1024 sc1
v_mfma_f32_16x16x32_bf16 v[48:51], v[204:207], a[16:19], v[48:51]
buffer_load_dwordx4 a[68:71], v145, s[28:31], s50 offen offset:1024 sc1
v_mfma_f32_16x16x32_bf16 v[52:55], v[204:207], a[20:23], 0
buffer_load_dwordx4 a[72:75], v146, s[28:31], s50 offen offset:1024 sc1
v_mfma_f32_16x16x32_bf16 v[52:55], v[188:191], a[4:7], v[52:55]
buffer_load_dwordx4 a[76:79], v147, s[28:31], s50 offen offset:1024 sc1
v_mfma_f32_16x16x32_bf16 v[56:59], v[188:191], a[8:11], 0
buffer_load_dwordx4 a[80:83], v144, s[28:31], s50 offen offset:2048 sc1
v_mfma_f32_16x16x32_bf16 v[56:59], v[204:207], a[24:27], v[56:59]
buffer_load_dwordx4 a[84:87], v145, s[28:31], s50 offen offset:2048 sc1
v_mfma_f32_16x16x32_bf16 v[60:63], v[204:207], a[28:31], 0
buffer_load_dwordx4 a[88:91], v146, s[28:31], s50 offen offset:2048 sc1
v_mfma_f32_16x16x32_bf16 v[60:63], v[188:191], a[12:15], v[60:63]
buffer_load_dwordx4 a[92:95], v147, s[28:31], s50 offen offset:2048 sc1
v_mfma_f32_16x16x32_bf16 v[64:67], v[192:195], a[0:3], 0
v_mfma_f32_16x16x32_bf16 v[64:67], v[208:211], a[16:19], v[64:67]
v_mfma_f32_16x16x32_bf16 v[68:71], v[208:211], a[20:23], 0
v_mfma_f32_16x16x32_bf16 v[68:71], v[192:195], a[4:7], v[68:71]
v_mfma_f32_16x16x32_bf16 v[72:75], v[192:195], a[8:11], 0
v_mfma_f32_16x16x32_bf16 v[72:75], v[208:211], a[24:27], v[72:75]
v_mfma_f32_16x16x32_bf16 v[76:79], v[208:211], a[28:31], 0
v_mfma_f32_16x16x32_bf16 v[76:79], v[192:195], a[12:15], v[76:79]
v_mfma_f32_16x16x32_bf16 v[80:83], v[196:199], a[0:3], 0
v_mfma_f32_16x16x32_bf16 v[80:83], v[212:215], a[16:19], v[80:83]
v_mfma_f32_16x16x32_bf16 v[84:87], v[212:215], a[20:23], 0
v_mfma_f32_16x16x32_bf16 v[84:87], v[196:199], a[4:7], v[84:87]
v_mfma_f32_16x16x32_bf16 v[88:91], v[196:199], a[8:11], 0
v_mfma_f32_16x16x32_bf16 v[88:91], v[212:215], a[24:27], v[88:91]
v_mfma_f32_16x16x32_bf16 v[92:95], v[212:215], a[28:31], 0
v_mfma_f32_16x16x32_bf16 v[92:95], v[196:199], a[12:15], v[92:95]
v_mfma_f32_16x16x32_bf16 v[96:99], v[200:203], a[0:3], 0
v_mfma_f32_16x16x32_bf16 v[96:99], v[216:219], a[16:19], v[96:99]
v_mfma_f32_16x16x32_bf16 v[100:103], v[216:219], a[20:23], 0
v_mfma_f32_16x16x32_bf16 v[100:103], v[200:203], a[4:7], v[100:103]
v_mfma_f32_16x16x32_bf16 v[104:107], v[200:203], a[8:11], 0
v_mfma_f32_16x16x32_bf16 v[104:107], v[216:219], a[24:27], v[104:107]
v_mfma_f32_16x16x32_bf16 v[108:111], v[216:219], a[28:31], 0
v_mfma_f32_16x16x32_bf16 v[108:111], v[200:203], a[12:15], v[108:111]
s_waitcnt vmcnt(8)
v_mfma_f32_16x16x32_bf16 v[48:51], v[220:223], a[32:35], v[48:51]
buffer_load_dwordx4 v[188:191], v145, s[28:31], s49 offen offset:3072 sc1
v_mfma_f32_16x16x32_bf16 v[48:51], v[236:239], a[48:51], v[48:51]
buffer_load_dwordx4 v[192:195], v145, s[28:31], s50 offen offset:3072 sc1
v_mfma_f32_16x16x32_bf16 v[52:55], v[236:239], a[52:55], v[52:55]
buffer_load_dwordx4 v[196:199], v147, s[28:31], s49 offen offset:3072 sc1
v_mfma_f32_16x16x32_bf16 v[52:55], v[220:223], a[36:39], v[52:55]
buffer_load_dwordx4 v[200:203], v147, s[28:31], s50 offen offset:3072 sc1
v_mfma_f32_16x16x32_bf16 v[56:59], v[220:223], a[40:43], v[56:59]
buffer_load_dwordx4 a[112:115], v144, s[28:31], s51 offen offset:0 sc1
v_mfma_f32_16x16x32_bf16 v[56:59], v[236:239], a[56:59], v[56:59]
buffer_load_dwordx4 a[116:119], v145, s[28:31], s51 offen offset:0 sc1
v_mfma_f32_16x16x32_bf16 v[60:63], v[236:239], a[60:63], v[60:63]
buffer_load_dwordx4 a[120:123], v146, s[28:31], s51 offen offset:0 sc1
v_mfma_f32_16x16x32_bf16 v[60:63], v[220:223], a[44:47], v[60:63]
buffer_load_dwordx4 a[124:127], v147, s[28:31], s51 offen offset:0 sc1
v_mfma_f32_16x16x32_bf16 v[64:67], v[224:227], a[32:35], v[64:67]
v_mfma_f32_16x16x32_bf16 v[64:67], v[240:243], a[48:51], v[64:67]
v_mfma_f32_16x16x32_bf16 v[68:71], v[240:243], a[52:55], v[68:71]
v_mfma_f32_16x16x32_bf16 v[68:71], v[224:227], a[36:39], v[68:71]
v_mfma_f32_16x16x32_bf16 v[72:75], v[224:227], a[40:43], v[72:75]
v_mfma_f32_16x16x32_bf16 v[72:75], v[240:243], a[56:59], v[72:75]
v_mfma_f32_16x16x32_bf16 v[76:79], v[240:243], a[60:63], v[76:79]
v_mfma_f32_16x16x32_bf16 v[76:79], v[224:227], a[44:47], v[76:79]
v_mfma_f32_16x16x32_bf16 v[80:83], v[228:231], a[32:35], v[80:83]
v_mfma_f32_16x16x32_bf16 v[80:83], v[244:247], a[48:51], v[80:83]
v_mfma_f32_16x16x32_bf16 v[84:87], v[244:247], a[52:55], v[84:87]
v_mfma_f32_16x16x32_bf16 v[84:87], v[228:231], a[36:39], v[84:87]
v_mfma_f32_16x16x32_bf16 v[88:91], v[228:231], a[40:43], v[88:91]
ds_read_b64_tr_b16 v[112:113], v44 offset:16384
ds_read_b64_tr_b16 v[114:115], v44 offset:18432
v_mfma_f32_16x16x32_bf16 v[88:91], v[244:247], a[56:59], v[88:91]
ds_read_b64_tr_b16 v[116:117], v44 offset:32768
ds_read_b64_tr_b16 v[118:119], v44 offset:34816
v_mfma_f32_16x16x32_bf16 v[92:95], v[244:247], a[60:63], v[92:95]
v_mfma_f32_16x16x32_bf16 v[92:95], v[228:231], a[44:47], v[92:95]
v_mfma_f32_16x16x32_bf16 v[96:99], v[232:235], a[32:35], v[96:99]
v_mfma_f32_16x16x32_bf16 v[96:99], v[248:251], a[48:51], v[96:99]
v_mfma_f32_16x16x32_bf16 v[100:103], v[248:251], a[52:55], v[100:103]
v_mfma_f32_16x16x32_bf16 v[100:103], v[232:235], a[36:39], v[100:103]
v_mfma_f32_16x16x32_bf16 v[104:107], v[232:235], a[40:43], v[104:107]
ds_read_b64_tr_b16 v[120:121], v45 offset:16384
ds_read_b64_tr_b16 v[122:123], v45 offset:18432
v_mfma_f32_16x16x32_bf16 v[104:107], v[248:251], a[56:59], v[104:107]
ds_read_b64_tr_b16 v[124:125], v45 offset:32768
ds_read_b64_tr_b16 v[126:127], v45 offset:34816
v_mfma_f32_16x16x32_bf16 v[108:111], v[248:251], a[60:63], v[108:111]
v_mfma_f32_16x16x32_bf16 v[108:111], v[232:235], a[44:47], v[108:111]
s_waitcnt vmcnt(8) lgkmcnt(4)
v_mfma_f32_16x16x32_bf16 v[48:51], v[112:115], a[64:67], v[48:51]
buffer_load_dwordx4 a[128:131], v144, s[28:31], s51 offen offset:1024 sc1
v_mfma_f32_16x16x32_bf16 v[48:51], v[116:119], a[80:83], v[48:51]
buffer_load_dwordx4 a[132:135], v145, s[28:31], s51 offen offset:1024 sc1
v_mfma_f32_16x16x32_bf16 v[52:55], v[116:119], a[84:87], v[52:55]
buffer_load_dwordx4 a[136:139], v146, s[28:31], s51 offen offset:1024 sc1
v_mfma_f32_16x16x32_bf16 v[52:55], v[112:115], a[68:71], v[52:55]
buffer_load_dwordx4 a[140:143], v147, s[28:31], s51 offen offset:1024 sc1
v_mfma_f32_16x16x32_bf16 v[56:59], v[112:115], a[72:75], v[56:59]
ds_read_b64_tr_b16 v[128:129], v46 offset:16384
ds_read_b64_tr_b16 v[130:131], v46 offset:18432
v_mfma_f32_16x16x32_bf16 v[56:59], v[116:119], a[88:91], v[56:59]
ds_read_b64_tr_b16 v[132:133], v46 offset:32768
ds_read_b64_tr_b16 v[134:135], v46 offset:34816
v_mfma_f32_16x16x32_bf16 v[60:63], v[116:119], a[92:95], v[60:63]
buffer_load_dwordx4 a[144:147], v144, s[28:31], s51 offen offset:2048 sc1
v_mfma_f32_16x16x32_bf16 v[60:63], v[112:115], a[76:79], v[60:63]
buffer_load_dwordx4 a[148:151], v145, s[28:31], s51 offen offset:2048 sc1
s_waitcnt lgkmcnt(4)
v_mfma_f32_16x16x32_bf16 v[64:67], v[120:123], a[64:67], v[64:67]
buffer_load_dwordx4 a[152:155], v146, s[28:31], s51 offen offset:2048 sc1
v_mfma_f32_16x16x32_bf16 v[64:67], v[124:127], a[80:83], v[64:67]
buffer_load_dwordx4 a[156:159], v147, s[28:31], s51 offen offset:2048 sc1
v_mfma_f32_16x16x32_bf16 v[68:71], v[124:127], a[84:87], v[68:71]
v_mfma_f32_16x16x32_bf16 v[68:71], v[120:123], a[68:71], v[68:71]
v_mfma_f32_16x16x32_bf16 v[72:75], v[120:123], a[72:75], v[72:75]
ds_read_b64_tr_b16 v[136:137], v47 offset:16384
ds_read_b64_tr_b16 v[138:139], v47 offset:18432
v_mfma_f32_16x16x32_bf16 v[72:75], v[124:127], a[88:91], v[72:75]
ds_read_b64_tr_b16 v[140:141], v47 offset:32768
ds_read_b64_tr_b16 v[142:143], v47 offset:34816
v_mfma_f32_16x16x32_bf16 v[76:79], v[124:127], a[92:95], v[76:79]
v_mfma_f32_16x16x32_bf16 v[76:79], v[120:123], a[76:79], v[76:79]
s_waitcnt lgkmcnt(4)
v_mfma_f32_16x16x32_bf16 v[80:83], v[128:131], a[64:67], v[80:83]
v_mfma_f32_16x16x32_bf16 v[80:83], v[132:135], a[80:83], v[80:83]
v_mfma_f32_16x16x32_bf16 v[84:87], v[132:135], a[84:87], v[84:87]
v_mfma_f32_16x16x32_bf16 v[84:87], v[128:131], a[68:71], v[84:87]
v_mfma_f32_16x16x32_bf16 v[88:91], v[128:131], a[72:75], v[88:91]
ds_read_b64_tr_b16 v[112:113], v44 offset:49152
ds_read_b64_tr_b16 v[114:115], v44 offset:51200
v_mfma_f32_16x16x32_bf16 v[88:91], v[132:135], a[88:91], v[88:91]
ds_read_b64_tr_b16 v[116:117], v156 offset:0
ds_read_b64_tr_b16 v[118:119], v156 offset:2048
v_mfma_f32_16x16x32_bf16 v[92:95], v[132:135], a[92:95], v[92:95]
v_mfma_f32_16x16x32_bf16 v[92:95], v[128:131], a[76:79], v[92:95]
s_waitcnt lgkmcnt(4)
v_mfma_f32_16x16x32_bf16 v[96:99], v[136:139], a[64:67], v[96:99]
v_mfma_f32_16x16x32_bf16 v[96:99], v[140:143], a[80:83], v[96:99]
v_mfma_f32_16x16x32_bf16 v[100:103], v[140:143], a[84:87], v[100:103]
v_mfma_f32_16x16x32_bf16 v[100:103], v[136:139], a[68:71], v[100:103]
v_mfma_f32_16x16x32_bf16 v[104:107], v[136:139], a[72:75], v[104:107]
ds_read_b64_tr_b16 v[120:121], v45 offset:49152
ds_read_b64_tr_b16 v[122:123], v45 offset:51200
v_mfma_f32_16x16x32_bf16 v[104:107], v[140:143], a[88:91], v[104:107]
ds_read_b64_tr_b16 v[124:125], v157 offset:0
ds_read_b64_tr_b16 v[126:127], v157 offset:2048
v_mfma_f32_16x16x32_bf16 v[108:111], v[140:143], a[92:95], v[108:111]
v_mfma_f32_16x16x32_bf16 v[108:111], v[136:139], a[76:79], v[108:111]
s_waitcnt vmcnt(8) lgkmcnt(4)
v_swap_b32 v190, v192
v_swap_b32 v191, v193
v_swap_b32 v198, v200
v_swap_b32 v199, v201
s_nop 1
v_mfma_f32_16x16x32_bf16 v[48:51], v[112:115], v[188:191], v[48:51]
buffer_load_dwordx4 a[160:163], v144, s[28:31], s52 offen offset:0 sc1
v_mfma_f32_16x16x32_bf16 v[48:51], v[116:119], a[112:115], v[48:51]
buffer_load_dwordx4 a[164:167], v145, s[28:31], s52 offen offset:0 sc1
v_mfma_f32_16x16x32_bf16 v[52:55], v[116:119], a[116:119], v[52:55]
buffer_load_dwordx4 a[168:171], v146, s[28:31], s52 offen offset:0 sc1
v_mfma_f32_16x16x32_bf16 v[52:55], v[112:115], v[192:195], v[52:55]
buffer_load_dwordx4 a[172:175], v147, s[28:31], s52 offen offset:0 sc1
v_mfma_f32_16x16x32_bf16 v[56:59], v[112:115], v[196:199], v[56:59]
ds_read_b64_tr_b16 v[128:129], v46 offset:49152
ds_read_b64_tr_b16 v[130:131], v46 offset:51200
v_mfma_f32_16x16x32_bf16 v[56:59], v[116:119], a[120:123], v[56:59]
ds_read_b64_tr_b16 v[132:133], v158 offset:0
ds_read_b64_tr_b16 v[134:135], v158 offset:2048
v_mfma_f32_16x16x32_bf16 v[60:63], v[116:119], a[124:127], v[60:63]
buffer_load_dwordx4 a[176:179], v144, s[28:31], s52 offen offset:1024 sc1
v_mfma_f32_16x16x32_bf16 v[60:63], v[112:115], v[200:203], v[60:63]
buffer_load_dwordx4 a[180:183], v145, s[28:31], s52 offen offset:1024 sc1
s_waitcnt lgkmcnt(4)
v_mfma_f32_16x16x32_bf16 v[64:67], v[120:123], v[188:191], v[64:67]
buffer_load_dwordx4 a[184:187], v146, s[28:31], s52 offen offset:1024 sc1
v_mfma_f32_16x16x32_bf16 v[64:67], v[124:127], a[112:115], v[64:67]
buffer_load_dwordx4 a[188:191], v147, s[28:31], s52 offen offset:1024 sc1
v_mfma_f32_16x16x32_bf16 v[68:71], v[124:127], a[116:119], v[68:71]
v_mfma_f32_16x16x32_bf16 v[68:71], v[120:123], v[192:195], v[68:71]
v_mfma_f32_16x16x32_bf16 v[72:75], v[120:123], v[196:199], v[72:75]
ds_read_b64_tr_b16 v[136:137], v47 offset:49152
ds_read_b64_tr_b16 v[138:139], v47 offset:51200
v_mfma_f32_16x16x32_bf16 v[72:75], v[124:127], a[120:123], v[72:75]
ds_read_b64_tr_b16 v[140:141], v159 offset:0
ds_read_b64_tr_b16 v[142:143], v159 offset:2048
v_mfma_f32_16x16x32_bf16 v[76:79], v[124:127], a[124:127], v[76:79]
v_mfma_f32_16x16x32_bf16 v[76:79], v[120:123], v[200:203], v[76:79]
s_waitcnt lgkmcnt(4)
v_mfma_f32_16x16x32_bf16 v[80:83], v[128:131], v[188:191], v[80:83]
v_mfma_f32_16x16x32_bf16 v[80:83], v[132:135], a[112:115], v[80:83]
v_mfma_f32_16x16x32_bf16 v[84:87], v[132:135], a[116:119], v[84:87]
v_mfma_f32_16x16x32_bf16 v[84:87], v[128:131], v[192:195], v[84:87]
v_mfma_f32_16x16x32_bf16 v[88:91], v[128:131], v[196:199], v[88:91]
s_waitcnt vmcnt(63)
ds_read_b64_tr_b16 v[112:113], v156 offset:16384
v_mfma_f32_16x16x32_bf16 v[88:91], v[132:135], a[120:123], v[88:91]
ds_read_b64_tr_b16 v[114:115], v156 offset:18432
s_waitcnt vmcnt(63)
v_mfma_f32_16x16x32_bf16 v[92:95], v[132:135], a[124:127], v[92:95]
ds_read_b64_tr_b16 v[116:117], v156 offset:32768
ds_read_b64_tr_b16 v[118:119], v156 offset:34816
v_mfma_f32_16x16x32_bf16 v[92:95], v[128:131], v[200:203], v[92:95]
s_waitcnt lgkmcnt(4)
v_mfma_f32_16x16x32_bf16 v[96:99], v[136:139], v[188:191], v[96:99]
v_mfma_f32_16x16x32_bf16 v[96:99], v[140:143], a[112:115], v[96:99]
v_mfma_f32_16x16x32_bf16 v[100:103], v[140:143], a[116:119], v[100:103]
v_mfma_f32_16x16x32_bf16 v[100:103], v[136:139], v[192:195], v[100:103]
v_mfma_f32_16x16x32_bf16 v[104:107], v[136:139], v[196:199], v[104:107]
ds_read_b64_tr_b16 v[120:121], v157 offset:16384
ds_read_b64_tr_b16 v[122:123], v157 offset:18432
v_mfma_f32_16x16x32_bf16 v[104:107], v[140:143], a[120:123], v[104:107]
ds_read_b64_tr_b16 v[124:125], v157 offset:32768
ds_read_b64_tr_b16 v[126:127], v157 offset:34816
v_mfma_f32_16x16x32_bf16 v[108:111], v[140:143], a[124:127], v[108:111]
v_mfma_f32_16x16x32_bf16 v[108:111], v[136:139], v[200:203], v[108:111]
s_waitcnt vmcnt(8) lgkmcnt(4)
v_mfma_f32_16x16x32_bf16 v[48:51], v[112:115], a[128:131], v[48:51]
buffer_load_dwordx4 a[192:195], v144, s[28:31], s52 offen offset:2048 sc1
v_mfma_f32_16x16x32_bf16 v[48:51], v[116:119], a[144:147], v[48:51]
buffer_load_dwordx4 a[196:199], v145, s[28:31], s52 offen offset:2048 sc1
v_mfma_f32_16x16x32_bf16 v[52:55], v[116:119], a[148:151], v[52:55]
buffer_load_dwordx4 a[200:203], v146, s[28:31], s52 offen offset:2048 sc1
v_mfma_f32_16x16x32_bf16 v[52:55], v[112:115], a[132:135], v[52:55]
buffer_load_dwordx4 a[204:207], v147, s[28:31], s52 offen offset:2048 sc1
v_mfma_f32_16x16x32_bf16 v[56:59], v[112:115], a[136:139], v[56:59]
ds_read_b64_tr_b16 v[128:129], v158 offset:16384
ds_read_b64_tr_b16 v[130:131], v158 offset:18432
v_mfma_f32_16x16x32_bf16 v[56:59], v[116:119], a[152:155], v[56:59]
ds_read_b64_tr_b16 v[132:133], v158 offset:32768
ds_read_b64_tr_b16 v[134:135], v158 offset:34816
v_mfma_f32_16x16x32_bf16 v[60:63], v[116:119], a[156:159], v[60:63]
buffer_load_dwordx4 v[220:223], v145, s[28:31], s51 offen offset:3072 sc1
v_mfma_f32_16x16x32_bf16 v[60:63], v[112:115], a[140:143], v[60:63]
buffer_load_dwordx4 v[224:227], v145, s[28:31], s52 offen offset:3072 sc1
s_waitcnt lgkmcnt(4)
v_mfma_f32_16x16x32_bf16 v[64:67], v[120:123], a[128:131], v[64:67]
buffer_load_dwordx4 v[228:231], v147, s[28:31], s51 offen offset:3072 sc1
v_mfma_f32_16x16x32_bf16 v[64:67], v[124:127], a[144:147], v[64:67]
buffer_load_dwordx4 v[232:235], v147, s[28:31], s52 offen offset:3072 sc1
v_mfma_f32_16x16x32_bf16 v[68:71], v[124:127], a[148:151], v[68:71]
v_mfma_f32_16x16x32_bf16 v[68:71], v[120:123], a[132:135], v[68:71]
v_mfma_f32_16x16x32_bf16 v[72:75], v[120:123], a[136:139], v[72:75]
ds_read_b64_tr_b16 v[136:137], v159 offset:16384
ds_read_b64_tr_b16 v[138:139], v159 offset:18432
v_mfma_f32_16x16x32_bf16 v[72:75], v[124:127], a[152:155], v[72:75]
ds_read_b64_tr_b16 v[140:141], v159 offset:32768
ds_read_b64_tr_b16 v[142:143], v159 offset:34816
v_mfma_f32_16x16x32_bf16 v[76:79], v[124:127], a[156:159], v[76:79]
v_mfma_f32_16x16x32_bf16 v[76:79], v[120:123], a[140:143], v[76:79]
s_waitcnt lgkmcnt(4)
v_mfma_f32_16x16x32_bf16 v[80:83], v[128:131], a[128:131], v[80:83]
v_mfma_f32_16x16x32_bf16 v[80:83], v[132:135], a[144:147], v[80:83]
v_mfma_f32_16x16x32_bf16 v[84:87], v[132:135], a[148:151], v[84:87]
v_mfma_f32_16x16x32_bf16 v[84:87], v[128:131], a[132:135], v[84:87]
v_mfma_f32_16x16x32_bf16 v[88:91], v[128:131], a[136:139], v[88:91]
s_waitcnt vmcnt(63)
ds_read_b64_tr_b16 v[112:113], v40 offset:0
v_mfma_f32_16x16x32_bf16 v[88:91], v[132:135], a[152:155], v[88:91]
ds_read_b64_tr_b16 v[114:115], v40 offset:2048
s_waitcnt vmcnt(63)
v_mfma_f32_16x16x32_bf16 v[92:95], v[132:135], a[156:159], v[92:95]
ds_read_b64_tr_b16 v[116:117], v40 offset:4096
ds_read_b64_tr_b16 v[118:119], v40 offset:6144
v_mfma_f32_16x16x32_bf16 v[92:95], v[128:131], a[140:143], v[92:95]
s_waitcnt lgkmcnt(4)
v_mfma_f32_16x16x32_bf16 v[96:99], v[136:139], a[128:131], v[96:99]
v_mfma_f32_16x16x32_bf16 v[96:99], v[140:143], a[144:147], v[96:99]
v_mfma_f32_16x16x32_bf16 v[100:103], v[140:143], a[148:151], v[100:103]
v_mfma_f32_16x16x32_bf16 v[100:103], v[136:139], a[132:135], v[100:103]
v_mfma_f32_16x16x32_bf16 v[104:107], v[136:139], a[136:139], v[104:107]
ds_read_b64_tr_b16 v[120:121], v41 offset:0
ds_read_b64_tr_b16 v[122:123], v41 offset:2048
v_mfma_f32_16x16x32_bf16 v[104:107], v[140:143], a[152:155], v[104:107]
ds_read_b64_tr_b16 v[124:125], v41 offset:4096
ds_read_b64_tr_b16 v[126:127], v41 offset:6144
v_mfma_f32_16x16x32_bf16 v[108:111], v[140:143], a[156:159], v[108:111]
v_mfma_f32_16x16x32_bf16 v[108:111], v[136:139], a[140:143], v[108:111]
s_waitcnt vmcnt(8) lgkmcnt(4)
v_mfma_f32_16x16x32_bf16 v[48:51], v[112:115], a[160:163], v[48:51]
v_mfma_f32_16x16x32_bf16 v[48:51], v[116:119], a[176:179], v[48:51]
v_mfma_f32_16x16x32_bf16 v[52:55], v[116:119], a[180:183], v[52:55]
v_mfma_f32_16x16x32_bf16 v[52:55], v[112:115], a[164:167], v[52:55]
v_mfma_f32_16x16x32_bf16 v[56:59], v[112:115], a[168:171], v[56:59]
ds_read_b64_tr_b16 v[128:129], v42 offset:0
ds_read_b64_tr_b16 v[130:131], v42 offset:2048
v_mfma_f32_16x16x32_bf16 v[56:59], v[116:119], a[184:187], v[56:59]
ds_read_b64_tr_b16 v[132:133], v42 offset:4096
ds_read_b64_tr_b16 v[134:135], v42 offset:6144
v_mfma_f32_16x16x32_bf16 v[60:63], v[116:119], a[188:191], v[60:63]
v_mfma_f32_16x16x32_bf16 v[60:63], v[112:115], a[172:175], v[60:63]
s_waitcnt lgkmcnt(4)
v_mfma_f32_16x16x32_bf16 v[64:67], v[120:123], a[160:163], v[64:67]
v_mfma_f32_16x16x32_bf16 v[64:67], v[124:127], a[176:179], v[64:67]
v_mfma_f32_16x16x32_bf16 v[68:71], v[124:127], a[180:183], v[68:71]
v_mfma_f32_16x16x32_bf16 v[68:71], v[120:123], a[164:167], v[68:71]
v_mfma_f32_16x16x32_bf16 v[72:75], v[120:123], a[168:171], v[72:75]
ds_read_b64_tr_b16 v[136:137], v43 offset:0
ds_read_b64_tr_b16 v[138:139], v43 offset:2048
v_mfma_f32_16x16x32_bf16 v[72:75], v[124:127], a[184:187], v[72:75]
ds_read_b64_tr_b16 v[140:141], v43 offset:4096
ds_read_b64_tr_b16 v[142:143], v43 offset:6144
v_mfma_f32_16x16x32_bf16 v[76:79], v[124:127], a[188:191], v[76:79]
v_mfma_f32_16x16x32_bf16 v[76:79], v[120:123], a[172:175], v[76:79]
s_waitcnt lgkmcnt(4)
v_mfma_f32_16x16x32_bf16 v[80:83], v[128:131], a[160:163], v[80:83]
v_mfma_f32_16x16x32_bf16 v[80:83], v[132:135], a[176:179], v[80:83]
v_mfma_f32_16x16x32_bf16 v[84:87], v[132:135], a[180:183], v[84:87]
v_mfma_f32_16x16x32_bf16 v[84:87], v[128:131], a[164:167], v[84:87]
v_mfma_f32_16x16x32_bf16 v[88:91], v[128:131], a[168:171], v[88:91]
s_waitcnt vmcnt(63)
ds_read_b64_tr_b16 v[112:113], v40 offset:8192
v_mfma_f32_16x16x32_bf16 v[88:91], v[132:135], a[184:187], v[88:91]
ds_read_b64_tr_b16 v[114:115], v40 offset:10240
s_waitcnt vmcnt(60)
v_mfma_f32_16x16x32_bf16 v[92:95], v[132:135], a[188:191], v[92:95]
ds_read_b64_tr_b16 v[116:117], v44 offset:0
ds_read_b64_tr_b16 v[118:119], v44 offset:2048
v_mfma_f32_16x16x32_bf16 v[92:95], v[128:131], a[172:175], v[92:95]
s_waitcnt lgkmcnt(4)
v_mfma_f32_16x16x32_bf16 v[96:99], v[136:139], a[160:163], v[96:99]
v_mfma_f32_16x16x32_bf16 v[96:99], v[140:143], a[176:179], v[96:99]
v_mfma_f32_16x16x32_bf16 v[100:103], v[140:143], a[180:183], v[100:103]
v_mfma_f32_16x16x32_bf16 v[100:103], v[136:139], a[164:167], v[100:103]
v_mfma_f32_16x16x32_bf16 v[104:107], v[136:139], a[168:171], v[104:107]
ds_read_b64_tr_b16 v[120:121], v41 offset:8192
ds_read_b64_tr_b16 v[122:123], v41 offset:10240
v_mfma_f32_16x16x32_bf16 v[104:107], v[140:143], a[184:187], v[104:107]
ds_read_b64_tr_b16 v[124:125], v45 offset:0
ds_read_b64_tr_b16 v[126:127], v45 offset:2048
v_mfma_f32_16x16x32_bf16 v[108:111], v[140:143], a[188:191], v[108:111]
v_mfma_f32_16x16x32_bf16 v[108:111], v[136:139], a[172:175], v[108:111]
s_waitcnt vmcnt(0) lgkmcnt(4)
v_swap_b32 v222, v224
v_swap_b32 v223, v225
v_swap_b32 v230, v232
v_swap_b32 v231, v233
s_nop 1
v_mfma_f32_16x16x32_bf16 v[48:51], v[112:115], a[192:195], v[48:51]
v_mfma_f32_16x16x32_bf16 v[48:51], v[116:119], v[220:223], v[48:51]
v_mfma_f32_16x16x32_bf16 v[52:55], v[116:119], v[224:227], v[52:55]
v_mfma_f32_16x16x32_bf16 v[52:55], v[112:115], a[196:199], v[52:55]
v_mfma_f32_16x16x32_bf16 v[56:59], v[112:115], a[200:203], v[56:59]
ds_read_b64_tr_b16 v[128:129], v42 offset:8192
ds_read_b64_tr_b16 v[130:131], v42 offset:10240
v_mfma_f32_16x16x32_bf16 v[56:59], v[116:119], v[228:231], v[56:59]
ds_read_b64_tr_b16 v[132:133], v46 offset:0
ds_read_b64_tr_b16 v[134:135], v46 offset:2048
v_mfma_f32_16x16x32_bf16 v[60:63], v[116:119], v[232:235], v[60:63]
v_mfma_f32_16x16x32_bf16 v[60:63], v[112:115], a[204:207], v[60:63]
s_waitcnt lgkmcnt(4)
v_mfma_f32_16x16x32_bf16 v[64:67], v[120:123], a[192:195], v[64:67]
v_mfma_f32_16x16x32_bf16 v[64:67], v[124:127], v[220:223], v[64:67]
v_mfma_f32_16x16x32_bf16 v[68:71], v[124:127], v[224:227], v[68:71]
v_mfma_f32_16x16x32_bf16 v[68:71], v[120:123], a[196:199], v[68:71]
v_mfma_f32_16x16x32_bf16 v[72:75], v[120:123], a[200:203], v[72:75]
ds_read_b64_tr_b16 v[136:137], v43 offset:8192
ds_read_b64_tr_b16 v[138:139], v43 offset:10240
v_mfma_f32_16x16x32_bf16 v[72:75], v[124:127], v[228:231], v[72:75]
ds_read_b64_tr_b16 v[140:141], v47 offset:0
ds_read_b64_tr_b16 v[142:143], v47 offset:2048
v_mfma_f32_16x16x32_bf16 v[76:79], v[124:127], v[232:235], v[76:79]
v_mfma_f32_16x16x32_bf16 v[76:79], v[120:123], a[204:207], v[76:79]
s_waitcnt lgkmcnt(4)
v_mfma_f32_16x16x32_bf16 v[80:83], v[128:131], a[192:195], v[80:83]
v_mfma_f32_16x16x32_bf16 v[80:83], v[132:135], v[220:223], v[80:83]
v_mfma_f32_16x16x32_bf16 v[84:87], v[132:135], v[224:227], v[84:87]
v_mfma_f32_16x16x32_bf16 v[84:87], v[128:131], a[196:199], v[84:87]
v_mfma_f32_16x16x32_bf16 v[88:91], v[128:131], a[200:203], v[88:91]
v_mfma_f32_16x16x32_bf16 v[88:91], v[132:135], v[228:231], v[88:91]
v_mfma_f32_16x16x32_bf16 v[92:95], v[132:135], v[232:235], v[92:95]
v_mfma_f32_16x16x32_bf16 v[92:95], v[128:131], a[204:207], v[92:95]
s_waitcnt lgkmcnt(0)
v_mfma_f32_16x16x32_bf16 v[96:99], v[136:139], a[192:195], v[96:99]
v_mfma_f32_16x16x32_bf16 v[96:99], v[140:143], v[220:223], v[96:99]
v_mfma_f32_16x16x32_bf16 v[100:103], v[140:143], v[224:227], v[100:103]
v_mfma_f32_16x16x32_bf16 v[100:103], v[136:139], a[196:199], v[100:103]
v_mfma_f32_16x16x32_bf16 v[104:107], v[136:139], a[200:203], v[104:107]
v_mfma_f32_16x16x32_bf16 v[104:107], v[140:143], v[228:231], v[104:107]
v_mfma_f32_16x16x32_bf16 v[108:111], v[140:143], v[232:235], v[108:111]
v_mfma_f32_16x16x32_bf16 v[108:111], v[136:139], a[204:207], v[108:111]
s_nop 1
ds_write_b128 v152, v[48:51] offset:0
ds_write_b128 v152, v[52:55] offset:16384
ds_write_b128 v152, v[56:59] offset:32768
ds_write_b128 v152, v[60:63] offset:49152
ds_write_b128 v153, v[64:67] offset:1024
ds_write_b128 v153, v[68:71] offset:17408
ds_write_b128 v153, v[72:75] offset:33792
ds_write_b128 v153, v[76:79] offset:50176
ds_write_b128 v154, v[80:83] offset:2048
ds_write_b128 v154, v[84:87] offset:18432
ds_write_b128 v154, v[88:91] offset:34816
ds_write_b128 v154, v[92:95] offset:51200
s_nop 1
ds_write_b128 v155, v[96:99] offset:3072
ds_write_b128 v155, v[100:103] offset:19456
ds_write_b128 v155, v[104:107] offset:35840
ds_write_b128 v155, v[108:111] offset:52224
v_lshlrev_b32_e64 v176, 16, v160
v_and_b32 v177, 0xffff0000, v160
v_lshlrev_b32_e64 v178, 16, v161
v_and_b32 v179, 0xffff0000, v161
v_lshlrev_b32_e64 v180, 16, v162
v_and_b32 v181, 0xffff0000, v162
v_lshlrev_b32_e64 v182, 16, v163
v_and_b32 v183, 0xffff0000, v163
v_lshlrev_b32_e64 v184, 16, v164
v_and_b32 v185, 0xffff0000, v164
v_lshlrev_b32_e64 v186, 16, v165
v_and_b32 v187, 0xffff0000, v165
v_lshlrev_b32_e64 v188, 16, v166
v_and_b32 v189, 0xffff0000, v166
v_lshlrev_b32_e64 v190, 16, v167
v_and_b32 v191, 0xffff0000, v167
s_waitcnt lgkmcnt(0)
s_barrier
ds_read_b128 v[48:51], v27 offset:0
ds_read_b128 v[52:55], v27 offset:256
ds_read_b128 v[56:59], v28 offset:0
ds_read_b128 v[60:63], v28 offset:256
ds_read_b128 v[64:67], v27 offset:4096
ds_read_b128 v[68:71], v27 offset:4352
ds_read_b128 v[72:75], v28 offset:4096
ds_read_b128 v[76:79], v28 offset:4352
ds_read_b128 v[80:83], v27 offset:8192
ds_read_b128 v[84:87], v27 offset:8448
ds_read_b128 v[88:91], v28 offset:8192
ds_read_b128 v[92:95], v28 offset:8448
ds_read_b128 v[96:99], v27 offset:12288
ds_read_b128 v[100:103], v27 offset:12544
ds_read_b128 v[104:107], v28 offset:12288
ds_read_b128 v[108:111], v28 offset:12544
s_waitcnt lgkmcnt(8)
v_pk_add_f32 v[48:49], v[48:49], v[64:65]
v_pk_add_f32 v[50:51], v[50:51], v[66:67]
v_pk_add_f32 v[52:53], v[52:53], v[68:69]
v_pk_add_f32 v[54:55], v[54:55], v[70:71]
v_pk_add_f32 v[56:57], v[56:57], v[72:73]
v_pk_add_f32 v[58:59], v[58:59], v[74:75]
v_pk_add_f32 v[60:61], v[60:61], v[76:77]
v_pk_add_f32 v[62:63], v[62:63], v[78:79]
s_waitcnt lgkmcnt(0)
v_pk_add_f32 v[80:81], v[80:81], v[96:97]
v_pk_add_f32 v[82:83], v[82:83], v[98:99]
v_pk_add_f32 v[84:85], v[84:85], v[100:101]
v_pk_add_f32 v[86:87], v[86:87], v[102:103]
v_pk_add_f32 v[88:89], v[88:89], v[104:105]
v_pk_add_f32 v[90:91], v[90:91], v[106:107]
v_pk_add_f32 v[92:93], v[92:93], v[108:109]
v_pk_add_f32 v[94:95], v[94:95], v[110:111]
v_pk_add_f32 v[48:49], v[48:49], v[80:81]
v_pk_add_f32 v[50:51], v[50:51], v[82:83]
v_pk_add_f32 v[52:53], v[52:53], v[84:85]
v_pk_add_f32 v[54:55], v[54:55], v[86:87]
v_pk_add_f32 v[56:57], v[56:57], v[88:89]
v_pk_add_f32 v[58:59], v[58:59], v[90:91]
v_pk_add_f32 v[60:61], v[60:61], v[92:93]
v_pk_add_f32 v[62:63], v[62:63], v[94:95]
v_pk_fma_f32 v[48:49], v[48:49], v[168:169], v[176:177]
v_pk_fma_f32 v[50:51], v[50:51], v[170:171], v[178:179]
v_pk_fma_f32 v[52:53], v[52:53], v[172:173], v[180:181]
v_pk_fma_f32 v[54:55], v[54:55], v[174:175], v[182:183]
v_pk_fma_f32 v[56:57], v[56:57], v[168:169], v[184:185]
v_pk_fma_f32 v[58:59], v[58:59], v[170:171], v[186:187]
v_pk_fma_f32 v[60:61], v[60:61], v[172:173], v[188:189]
v_pk_fma_f32 v[62:63], v[62:63], v[174:175], v[190:191]
v_cvt_pk_bf16_f32 v160, v48, v49
v_cvt_pk_bf16_f32 v161, v50, v51
v_cvt_pk_bf16_f32 v162, v52, v53
v_cvt_pk_bf16_f32 v163, v54, v55
v_cvt_pk_bf16_f32 v164, v56, v57
v_cvt_pk_bf16_f32 v165, v58, v59
v_cvt_pk_bf16_f32 v166, v60, v61
v_cvt_pk_bf16_f32 v167, v62, v63
buffer_store_dwordx4 v[160:163], v24, s[12:15], s32 offen
buffer_store_dwordx4 v[164:167], v24, s[12:15], s35 offen
s_endpgm
L_k1_slow:
s_mov_b32 s46, 1
s_setreg_imm32_b32 hwreg(HW_REG_MODE, 4, 2), 0
s_waitcnt vmcnt(0) lgkmcnt(0)
s_barrier
s_mov_b32 s40, 0
s_mov_b32 s44, 32
v_mov_b32 v4, 0xff800000
v_mov_b32 v5, 0xff800000
v_mov_b32 v6, 0xff800000
v_mov_b32 v7, 0xff800000
L_k1_slow_loop:
s_add_u32 m0, s39, 0
s_nop 0
buffer_load_dwordx4 v236, s[16:19], s40 offen offset:0 lds
buffer_load_dwordx4 v237, s[16:19], s40 offen offset:1024 lds
buffer_load_dwordx4 v238, s[16:19], s40 offen offset:2048 lds
buffer_load_dwordx4 v239, s[16:19], s40 offen offset:3072 lds
s_add_u32 s40, s40, 16384
s_waitcnt vmcnt(0)
s_barrier
ds_read_b128 a[128:131], v224 offset:0
ds_read_b128 a[132:135], v225 offset:0
ds_read_b128 a[136:139], v226 offset:0
ds_read_b128 a[140:143], v227 offset:0
ds_read_b128 a[144:147], v224 offset:4096
ds_read_b128 a[148:151], v225 offset:4096
ds_read_b128 a[152:155], v226 offset:4096
ds_read_b128 a[156:159], v227 offset:4096
s_waitcnt lgkmcnt(4)
v_mfma_f32_16x16x32_bf16 v[80:83], a[128:131], v[16:19], 0
v_mfma_f32_16x16x32_bf16 v[80:83], a[132:135], v[20:23], v[80:83]
v_mfma_f32_16x16x32_bf16 v[80:83], a[136:139], v[24:27], v[80:83]
v_mfma_f32_16x16x32_bf16 v[80:83], a[140:143], v[28:31], v[80:83]
v_mfma_f32_16x16x32_bf16 v[84:87], a[140:143], v[44:47], 0
v_mfma_f32_16x16x32_bf16 v[84:87], a[136:139], v[40:43], v[84:87]
v_mfma_f32_16x16x32_bf16 v[84:87], a[132:135], v[36:39], v[84:87]
v_mfma_f32_16x16x32_bf16 v[84:87], a[128:131], v[32:35], v[84:87]
v_mfma_f32_16x16x32_bf16 v[88:91], a[128:131], v[48:51], 0
v_mfma_f32_16x16x32_bf16 v[88:91], a[132:135], v[52:55], v[88:91]
v_mfma_f32_16x16x32_bf16 v[88:91], a[136:139], v[56:59], v[88:91]
v_mfma_f32_16x16x32_bf16 v[88:91], a[140:143], v[60:63], v[88:91]
v_mfma_f32_16x16x32_bf16 v[92:95], a[140:143], v[76:79], 0
ds_read_b128 a[160:163], v224 offset:8192
v_mfma_f32_16x16x32_bf16 v[92:95], a[136:139], v[72:75], v[92:95]
ds_read_b128 a[164:167], v225 offset:8192
v_mfma_f32_16x16x32_bf16 v[92:95], a[132:135], v[68:71], v[92:95]
ds_read_b128 a[168:171], v226 offset:8192
v_mfma_f32_16x16x32_bf16 v[92:95], a[128:131], v[64:67], v[92:95]
ds_read_b128 a[172:175], v227 offset:8192
s_waitcnt lgkmcnt(4)
v_mfma_f32_16x16x32_bf16 v[96:99], a[144:147], v[16:19], 0
v_mfma_f32_16x16x32_bf16 v[96:99], a[148:151], v[20:23], v[96:99]
v_mfma_f32_16x16x32_bf16 v[96:99], a[152:155], v[24:27], v[96:99]
v_mfma_f32_16x16x32_bf16 v[96:99], a[156:159], v[28:31], v[96:99]
v_mfma_f32_16x16x32_bf16 v[100:103], a[156:159], v[44:47], 0
v_mfma_f32_16x16x32_bf16 v[100:103], a[152:155], v[40:43], v[100:103]
v_mfma_f32_16x16x32_bf16 v[100:103], a[148:151], v[36:39], v[100:103]
v_mfma_f32_16x16x32_bf16 v[100:103], a[144:147], v[32:35], v[100:103]
v_mfma_f32_16x16x32_bf16 v[104:107], a[144:147], v[48:51], 0
v_mfma_f32_16x16x32_bf16 v[104:107], a[148:151], v[52:55], v[104:107]
v_mfma_f32_16x16x32_bf16 v[104:107], a[152:155], v[56:59], v[104:107]
v_mfma_f32_16x16x32_bf16 v[104:107], a[156:159], v[60:63], v[104:107]
v_mfma_f32_16x16x32_bf16 v[108:111], a[156:159], v[76:79], 0
ds_read_b128 a[176:179], v224 offset:12288
v_mfma_f32_16x16x32_bf16 v[108:111], a[152:155], v[72:75], v[108:111]
ds_read_b128 a[180:183], v225 offset:12288
v_mfma_f32_16x16x32_bf16 v[108:111], a[148:151], v[68:71], v[108:111]
ds_read_b128 a[184:187], v226 offset:12288
v_mfma_f32_16x16x32_bf16 v[108:111], a[144:147], v[64:67], v[108:111]
ds_read_b128 a[188:191], v227 offset:12288
s_waitcnt lgkmcnt(4)
v_mfma_f32_16x16x32_bf16 v[112:115], a[160:163], v[16:19], 0
v_max3_f32 v4, v80, v81, v4
v_max3_f32 v5, v84, v85, v5
v_mfma_f32_16x16x32_bf16 v[112:115], a[164:167], v[20:23], v[112:115]
v_max3_f32 v6, v88, v89, v6
v_max3_f32 v7, v92, v93, v7
v_mfma_f32_16x16x32_bf16 v[112:115], a[168:171], v[24:27], v[112:115]
v_max3_f32 v4, v82, v83, v4
v_max3_f32 v5, v86, v87, v5
v_mfma_f32_16x16x32_bf16 v[112:115], a[172:175], v[28:31], v[112:115]
v_max3_f32 v6, v90, v91, v6
v_max3_f32 v7, v94, v95, v7
v_mfma_f32_16x16x32_bf16 v[116:119], a[172:175], v[44:47], 0
v_mfma_f32_16x16x32_bf16 v[116:119], a[168:171], v[40:43], v[116:119]
v_mfma_f32_16x16x32_bf16 v[116:119], a[164:167], v[36:39], v[116:119]
v_mfma_f32_16x16x32_bf16 v[116:119], a[160:163], v[32:35], v[116:119]
v_mfma_f32_16x16x32_bf16 v[120:123], a[160:163], v[48:51], 0
v_mfma_f32_16x16x32_bf16 v[120:123], a[164:167], v[52:55], v[120:123]
v_mfma_f32_16x16x32_bf16 v[120:123], a[168:171], v[56:59], v[120:123]
v_mfma_f32_16x16x32_bf16 v[120:123], a[172:175], v[60:63], v[120:123]
v_mfma_f32_16x16x32_bf16 v[124:127], a[172:175], v[76:79], 0
v_mfma_f32_16x16x32_bf16 v[124:127], a[168:171], v[72:75], v[124:127]
v_mfma_f32_16x16x32_bf16 v[124:127], a[164:167], v[68:71], v[124:127]
v_mfma_f32_16x16x32_bf16 v[124:127], a[160:163], v[64:67], v[124:127]
s_waitcnt lgkmcnt(0)
v_mfma_f32_16x16x32_bf16 v[128:131], a[176:179], v[16:19], 0
v_max3_f32 v4, v96, v97, v4
v_max3_f32 v5, v100, v101, v5
v_mfma_f32_16x16x32_bf16 v[128:131], a[180:183], v[20:23], v[128:131]
v_max3_f32 v6, v104, v105, v6
v_max3_f32 v7, v108, v109, v7
v_mfma_f32_16x16x32_bf16 v[128:131], a[184:187], v[24:27], v[128:131]
v_max3_f32 v4, v98, v99, v4
v_max3_f32 v5, v102, v103, v5
v_mfma_f32_16x16x32_bf16 v[128:131], a[188:191], v[28:31], v[128:131]
v_max3_f32 v6, v106, v107, v6
v_max3_f32 v7, v110, v111, v7
v_mfma_f32_16x16x32_bf16 v[132:135], a[188:191], v[44:47], 0
v_max3_f32 v4, v112, v113, v4
v_max3_f32 v5, v116, v117, v5
v_mfma_f32_16x16x32_bf16 v[132:135], a[184:187], v[40:43], v[132:135]
v_max3_f32 v6, v120, v121, v6
v_max3_f32 v7, v124, v125, v7
v_mfma_f32_16x16x32_bf16 v[132:135], a[180:183], v[36:39], v[132:135]
v_max3_f32 v4, v114, v115, v4
v_max3_f32 v5, v118, v119, v5
v_mfma_f32_16x16x32_bf16 v[132:135], a[176:179], v[32:35], v[132:135]
v_max3_f32 v6, v122, v123, v6
v_max3_f32 v7, v126, v127, v7
v_mfma_f32_16x16x32_bf16 v[136:139], a[176:179], v[48:51], 0
v_mfma_f32_16x16x32_bf16 v[136:139], a[180:183], v[52:55], v[136:139]
v_mfma_f32_16x16x32_bf16 v[136:139], a[184:187], v[56:59], v[136:139]
v_mfma_f32_16x16x32_bf16 v[136:139], a[188:191], v[60:63], v[136:139]
v_mfma_f32_16x16x32_bf16 v[140:143], a[188:191], v[76:79], 0
v_mfma_f32_16x16x32_bf16 v[140:143], a[184:187], v[72:75], v[140:143]
v_mfma_f32_16x16x32_bf16 v[140:143], a[180:183], v[68:71], v[140:143]
v_mfma_f32_16x16x32_bf16 v[140:143], a[176:179], v[64:67], v[140:143]
s_nop 7
v_max3_f32 v4, v128, v129, v4
v_max3_f32 v5, v132, v133, v5
v_max3_f32 v6, v136, v137, v6
v_max3_f32 v7, v140, v141, v7
v_max3_f32 v4, v130, v131, v4
v_max3_f32 v5, v134, v135, v5
v_max3_f32 v6, v138, v139, v6
v_max3_f32 v7, v142, v143, v7
s_barrier
s_sub_u32 s44, s44, 1
s_cmp_lg_u32 s44, 0
s_cbranch_scc1 L_k1_slow_loop
v_mov_b32 v8, v4
v_mov_b32 v9, v5
v_mov_b32 v10, v6
v_mov_b32 v11, v7
v_permlane32_swap_b32 v8, v4
v_permlane32_swap_b32 v9, v5
v_permlane32_swap_b32 v10, v6
v_permlane32_swap_b32 v11, v7
v_max_f32 v4, v4, v8
v_max_f32 v5, v5, v9
v_max_f32 v6, v6, v10
v_max_f32 v7, v7, v11
v_mov_b32 v8, v4
v_mov_b32 v9, v5
v_mov_b32 v10, v6
v_mov_b32 v11, v7
v_permlane16_swap_b32 v8, v4
v_permlane16_swap_b32 v9, v5
v_permlane16_swap_b32 v10, v6
v_permlane16_swap_b32 v11, v7
v_max_f32 v4, v4, v8
v_max_f32 v5, v5, v9
v_max_f32 v6, v6, v10
v_max_f32_e64 v7, v7, v11
v_sub_f32 v208, 0xc2cc0000, v4
v_sub_f32 v209, 0xc2cc0000, v4
v_sub_f32 v210, 0xc2cc0000, v4
v_sub_f32 v211, 0xc2cc0000, v4
v_sub_f32 v212, 0xc2cc0000, v5
v_sub_f32 v213, 0xc2cc0000, v5
v_sub_f32 v214, 0xc2cc0000, v5
v_sub_f32 v215, 0xc2cc0000, v5
v_sub_f32 v216, 0xc2cc0000, v6
v_sub_f32 v217, 0xc2cc0000, v6
v_sub_f32 v218, 0xc2cc0000, v6
v_sub_f32 v219, 0xc2cc0000, v6
v_sub_f32 v220, 0xc2cc0000, v7
v_sub_f32 v221, 0xc2cc0000, v7
v_sub_f32 v222, 0xc2cc0000, v7
v_sub_f32 v223, 0xc2cc0000, v7
v_accvgpr_write_b32 a0, 0
v_accvgpr_write_b32 a1, 0
v_accvgpr_write_b32 a2, 0
v_accvgpr_write_b32 a3, 0
v_accvgpr_write_b32 a4, 0
v_accvgpr_write_b32 a5, 0
v_accvgpr_write_b32 a6, 0
v_accvgpr_write_b32 a7, 0
v_accvgpr_write_b32 a8, 0
v_accvgpr_write_b32 a9, 0
v_accvgpr_write_b32 a10, 0
v_accvgpr_write_b32 a11, 0
v_accvgpr_write_b32 a12, 0
v_accvgpr_write_b32 a13, 0
v_accvgpr_write_b32 a14, 0
v_accvgpr_write_b32 a15, 0
v_accvgpr_write_b32 a16, 0
v_accvgpr_write_b32 a17, 0
v_accvgpr_write_b32 a18, 0
v_accvgpr_write_b32 a19, 0
v_accvgpr_write_b32 a20, 0
v_accvgpr_write_b32 a21, 0
v_accvgpr_write_b32 a22, 0
v_accvgpr_write_b32 a23, 0
v_accvgpr_write_b32 a24, 0
v_accvgpr_write_b32 a25, 0
v_accvgpr_write_b32 a26, 0
v_accvgpr_write_b32 a27, 0
v_accvgpr_write_b32 a28, 0
v_accvgpr_write_b32 a29, 0
v_accvgpr_write_b32 a30, 0
v_accvgpr_write_b32 a31, 0
v_accvgpr_write_b32 a32, 0
v_accvgpr_write_b32 a33, 0
v_accvgpr_write_b32 a34, 0
v_accvgpr_write_b32 a35, 0
v_accvgpr_write_b32 a36, 0
v_accvgpr_write_b32 a37, 0
v_accvgpr_write_b32 a38, 0
v_accvgpr_write_b32 a39, 0
v_accvgpr_write_b32 a40, 0
v_accvgpr_write_b32 a41, 0
v_accvgpr_write_b32 a42, 0
v_accvgpr_write_b32 a43, 0
v_accvgpr_write_b32 a44, 0
v_accvgpr_write_b32 a45, 0
v_accvgpr_write_b32 a46, 0
v_accvgpr_write_b32 a47, 0
v_accvgpr_write_b32 a48, 0
v_accvgpr_write_b32 a49, 0
v_accvgpr_write_b32 a50, 0
v_accvgpr_write_b32 a51, 0
v_accvgpr_write_b32 a52, 0
v_accvgpr_write_b32 a53, 0
v_accvgpr_write_b32 a54, 0
v_accvgpr_write_b32 a55, 0
v_accvgpr_write_b32 a56, 0
v_accvgpr_write_b32 a57, 0
v_accvgpr_write_b32 a58, 0
v_accvgpr_write_b32 a59, 0
v_accvgpr_write_b32 a60, 0
v_accvgpr_write_b32 a61, 0
v_accvgpr_write_b32 a62, 0
v_accvgpr_write_b32 a63, 0
v_accvgpr_write_b32 a64, 0
v_accvgpr_write_b32 a65, 0
v_accvgpr_write_b32 a66, 0
v_accvgpr_write_b32 a67, 0
v_accvgpr_write_b32 a68, 0
v_accvgpr_write_b32 a69, 0
v_accvgpr_write_b32 a70, 0
v_accvgpr_write_b32 a71, 0
v_accvgpr_write_b32 a72, 0
v_accvgpr_write_b32 a73, 0
v_accvgpr_write_b32 a74, 0
v_accvgpr_write_b32 a75, 0
v_accvgpr_write_b32 a76, 0
v_accvgpr_write_b32 a77, 0
v_accvgpr_write_b32 a78, 0
v_accvgpr_write_b32 a79, 0
v_accvgpr_write_b32 a80, 0
v_accvgpr_write_b32 a81, 0
v_accvgpr_write_b32 a82, 0
v_accvgpr_write_b32 a83, 0
v_accvgpr_write_b32 a84, 0
v_accvgpr_write_b32 a85, 0
v_accvgpr_write_b32 a86, 0
v_accvgpr_write_b32 a87, 0
v_accvgpr_write_b32 a88, 0
v_accvgpr_write_b32 a89, 0
v_accvgpr_write_b32 a90, 0
v_accvgpr_write_b32 a91, 0
v_accvgpr_write_b32 a92, 0
v_accvgpr_write_b32 a93, 0
v_accvgpr_write_b32 a94, 0
v_accvgpr_write_b32 a95, 0
v_accvgpr_write_b32 a96, 0
v_accvgpr_write_b32 a97, 0
v_accvgpr_write_b32 a98, 0
v_accvgpr_write_b32 a99, 0
v_accvgpr_write_b32 a100, 0
v_accvgpr_write_b32 a101, 0
v_accvgpr_write_b32 a102, 0
v_accvgpr_write_b32 a103, 0
v_accvgpr_write_b32 a104, 0
v_accvgpr_write_b32 a105, 0
v_accvgpr_write_b32 a106, 0
v_accvgpr_write_b32 a107, 0
v_accvgpr_write_b32 a108, 0
v_accvgpr_write_b32 a109, 0
v_accvgpr_write_b32 a110, 0
v_accvgpr_write_b32 a111, 0
v_accvgpr_write_b32 a112, 0
v_accvgpr_write_b32 a113, 0
v_accvgpr_write_b32 a114, 0
v_accvgpr_write_b32 a115, 0
v_accvgpr_write_b32 a116, 0
v_accvgpr_write_b32 a117, 0
v_accvgpr_write_b32 a118, 0
v_accvgpr_write_b32 a119, 0
v_accvgpr_write_b32 a120, 0
v_accvgpr_write_b32 a121, 0
v_accvgpr_write_b32 a122, 0
v_accvgpr_write_b32 a123, 0
v_accvgpr_write_b32 a124, 0
v_accvgpr_write_b32 a125, 0
v_accvgpr_write_b32 a126, 0
v_accvgpr_write_b32 a127, 0
v_accvgpr_write_b32 a192, 0
v_accvgpr_write_b32 a193, 0
v_accvgpr_write_b32 a194, 0
v_accvgpr_write_b32 a195, 0
v_accvgpr_write_b32 a196, 0
v_accvgpr_write_b32 a197, 0
v_accvgpr_write_b32 a198, 0
v_accvgpr_write_b32 a199, 0
v_accvgpr_write_b32 a200, 0
v_accvgpr_write_b32 a201, 0
v_accvgpr_write_b32 a202, 0
v_accvgpr_write_b32 a203, 0
v_accvgpr_write_b32 a204, 0
v_accvgpr_write_b32 a205, 0
v_accvgpr_write_b32 a206, 0
v_accvgpr_write_b32 a207, 0
v_mov_b32 v5, 0x3f803f80
v_accvgpr_write_b32 a208, v5
v_accvgpr_write_b32 a209, v5
v_accvgpr_write_b32 a210, v5
v_accvgpr_write_b32 a211, v5
s_mov_b32 s40, 0
s_mov_b32 s41, 0
s_add_u32 m0, s39, 0
s_nop 0
buffer_load_dwordx4 v236, s[16:19], s40 offen offset:0 lds
buffer_load_dwordx4 v237, s[16:19], s40 offen offset:1024 lds
buffer_load_dwordx4 v238, s[16:19], s40 offen offset:2048 lds
buffer_load_dwordx4 v239, s[16:19], s40 offen offset:3072 lds
s_add_u32 s40, s40, 16384
s_add_u32 m0, s39, 16384
s_nop 0
buffer_load_dwordx4 v236, s[16:19], s40 offen offset:0 lds
buffer_load_dwordx4 v237, s[16:19], s40 offen offset:1024 lds
buffer_load_dwordx4 v238, s[16:19], s40 offen offset:2048 lds
buffer_load_dwordx4 v239, s[16:19], s40 offen offset:3072 lds
s_add_u32 s40, s40, 16384
s_add_u32 m0, s43, 0
s_nop 0
buffer_load_dwordx4 v240, s[20:23], s41 offen offset:0 lds
buffer_load_dwordx4 v241, s[20:23], s41 offen offset:1024 lds
buffer_load_dwordx4 v240, s[20:23], s41 offen offset:2048 lds
buffer_load_dwordx4 v241, s[20:23], s41 offen offset:3072 lds
s_add_u32 s41, s41, 16384
s_add_u32 m0, s43, 16384
s_nop 0
buffer_load_dwordx4 v240, s[20:23], s41 offen offset:0 lds
buffer_load_dwordx4 v241, s[20:23], s41 offen offset:1024 lds
buffer_load_dwordx4 v240, s[20:23], s41 offen offset:2048 lds
buffer_load_dwordx4 v241, s[20:23], s41 offen offset:3072 lds
s_add_u32 s41, s41, 16384
s_waitcnt vmcnt(0)
s_barrier
s_branch L_k1_attn_start
L_k1_end:
s_endpgm
.section .rodata,"a"
.p2align 6
.amdhsa_kernel adaLN_cond__gqa_block_cached__dense_activation_relu__prompt_kernel
  .amdhsa_next_free_vgpr 512
  .amdhsa_next_free_sgpr 102
  .amdhsa_accum_offset 256
  .amdhsa_group_segment_fixed_size 0
  .amdhsa_kernarg_size 104
  .amdhsa_user_sgpr_count 2
  .amdhsa_user_sgpr_kernarg_segment_ptr 1
  .amdhsa_system_sgpr_workgroup_id_x 1
.end_amdhsa_kernel
```
